```python
import torch

def _softmax(x, axis=-1):
    return torch.softmax(x, dim=axis)

def _gelu(x):
    return torch.nn.functional.gelu(x, approximate='tanh')

def _silu(x):
    return torch.nn.functional.silu(x)

def _sigmoid(x):
    return torch.sigmoid(x)

def _layernorm(x, axis=-1, eps=1e-05):
    m = x.mean(dim=axis, keepdim=True)
    v = x.var(dim=axis, keepdim=True, unbiased=False)
    return (x - m) / torch.sqrt(v + eps)

def _scatter_add(tgt, idx, src, axis=0):
    return tgt.clone().index_add_(axis, idx, src)

def _segment_sum(src, seg, n):
    out = torch.zeros((n,) + src.shape[1:], dtype=src.dtype)
    return out.index_add_(0, seg, src)

def _pad(x, pw):
    flat = tuple((v for pair in reversed(pw) for v in pair))
    return torch.nn.functional.pad(x, flat)
kernel_name = 'concat_heads__memory_aug_recurrent_mem_tr__linear_attn_block__prompt'

def setup_inputs():

    _w = lambda a: (lambda t: t.to(torch.bfloat16) if t.is_floating_point() else t)(torch.as_tensor(a))

    def _A_setup():
        B, S, Dm = (1, 2048, 1024)
        H, Dh = (32, 128)
        M, seg = (8, 32)
        seg = min(seg, S)
        S = S // seg * seg
        return {'x': _w((lambda *s: torch.randn(*s, dtype=torch.bfloat16) * 0.05)(B, S, Dm)), 'mem0': _w((lambda *s: torch.randn(*s, dtype=torch.bfloat16) * 0.8)(B, M, Dm)), 'Wq': _w((lambda *s: torch.randn(*s, dtype=torch.bfloat16) * 3.2)(Dm, H, Dh) * Dm ** (-0.5)), 'Wk': _w((lambda *s: torch.randn(*s, dtype=torch.bfloat16) * 3.2)(Dm, H, Dh) * Dm ** (-0.5)), 'Wv': _w((lambda *s: torch.randn(*s, dtype=torch.bfloat16) * 0.8)(Dm, H, Dh) * Dm ** (-0.5)), 'Wo': _w((lambda *s: torch.randn(*s, dtype=torch.bfloat16) * 0.8)(H, Dh, Dm) * (H * Dh) ** (-0.5)), 'seg_len': seg}
    _A_in = _A_setup()

    def _B_setup():
        B, S, D = (1, 2048, 1024)
        return {'x': _w((lambda *s: torch.randn(*s, dtype=torch.bfloat16) * 0.05)(B, S, D)), 'wqkv': _w((lambda *s: torch.randn(*s, dtype=torch.bfloat16) * 0.8)(D, 3 * D)), 'wo': _w((lambda *s: torch.randn(*s, dtype=torch.bfloat16) * 0.1)(D, D))}
    _B_in = _B_setup()
    return {'A_x': _A_in['x'], 'A_mem0': _A_in['mem0'], 'A_Wq': _A_in['Wq'], 'A_Wk': _A_in['Wk'], 'A_Wv': _A_in['Wv'], 'A_Wo': _A_in['Wo'], 'A_seg_len': _A_in['seg_len'], 'B_x': _B_in['x'], 'B_wqkv': _B_in['wqkv'], 'B_wo': _B_in['wo']}

def reference(A_x, A_mem0, A_Wq, A_Wk, A_Wv, A_Wo, A_seg_len, B_x, B_wqkv, B_wo):

    def _A_ref(x, mem0, Wq, Wk, Wv, Wo, seg_len):
        B, S, Dm = x.shape
        H, Dh = (Wq.shape[1], Wq.shape[2])
        M = mem0.shape[1]
        scale = Dh ** (-0.5)
        n_seg = S // seg_len
        L = M + seg_len
        idx = torch.arange(L)
        mask = (idx[:, None] < M) | (idx[:, None] >= idx[None, :])
        mem = mem0
        outs = []
        for s in range(n_seg):
            xs = x[:, s * seg_len:(s + 1) * seg_len, :].clone()
            h = torch.concatenate([mem, xs], axis=1)
            q = torch.einsum('btd,dhe->bhte', h, Wq)
            k = torch.einsum('btd,dhe->bhte', h, Wk)
            v = torch.einsum('btd,dhe->bhte', h, Wv)
            scores = torch.einsum('bhqe,bhke->bhqk', q, k) * scale
            scores = torch.where(mask[None, None], scores, -1000000000.0)
            p = _softmax(scores, axis=-1)
            o = torch.einsum('bhqk,bhke->bhqe', p, v)
            o = torch.einsum('bhte,hed->btd', o, Wo)
            mem = o[:, :M, :].clone()
            outs.append(o[:, M:, :])
        return torch.concatenate(outs, axis=1)

    def _B_ref(x, wqkv, wo):
        B, S, D = x.shape
        H = 32
        Dh = D // H
        qkv = (lambda x, *d: x.permute(*d))((x @ wqkv).reshape(B, S, 3, H, Dh), 2, 0, 3, 1, 4)
        q, k, v = (qkv[0], qkv[1], qkv[2])
        phi = lambda t: torch.where(t > 0, t + 1, torch.exp(t)) + 1e-06
        pq, pk = (phi(q), phi(k))
        kv = torch.einsum('bhsd,bhse->bhde', pk, v)
        z = torch.einsum('bhsd->bhd', pk)
        num = torch.einsum('bhqd,bhde->bhqe', pq, kv)
        den = torch.einsum('bhqd,bhd->bhq', pq, z)[..., None] + 1e-06
        o = num / den
        return (lambda x, *d: x.permute(*d))(o, 0, 2, 1, 3).reshape(B, S, D) @ wo
    a = _A_ref(A_x, A_mem0, A_Wq, A_Wk, A_Wv, A_Wo, A_seg_len)
    b = _B_ref(B_x, B_wqkv, B_wo)
    return torch.concatenate([a, b], axis=-1)
```

```asm
; @launch grid=(256,1,1) block=(256,1,1) lds=163840
.amdgcn_target "amdgcn-amd-amdhsa--gfx950"
.macro mm x:vararg
v_mfma_f32_16x16x32_bf16 \x
.endm
.macro mh x:vararg
v_mfma_f32_16x16x16_bf16 \x
.endm
.macro ms x:vararg
v_smfmac_f32_16x16x64_bf16 \x
.endm
.macro dt x:vararg
ds_read_b64_tr_b16 \x
.endm
.macro dr x:vararg
ds_read_b128 \x
.endm
.macro l4 x:vararg
buffer_load_dwordx4 \x
.endm
.macro w4 x:vararg
buffer_store_dwordx4 \x
.endm
.macro ar x:vararg
v_accvgpr_read_b32 \x
.endm
.macro aw x:vararg
v_accvgpr_write_b32 \x
.endm
.macro cv x:vararg
v_cvt_pk_bf16_f32 \x
.endm
.macro pa x:vararg
v_pk_add_f32 \x
.endm
.macro pm x:vararg
v_pk_mul_f32 \x
.endm
.macro wt x:vararg
s_waitcnt \x
.endm
.text
.globl concat_heads__memory_aug_recurrent_mem_tr__linear_attn_block__prompt_kernel
.p2align 8
.type concat_heads__memory_aug_recurrent_mem_tr__linear_attn_block__prompt_kernel,@function
concat_heads__memory_aug_recurrent_mem_tr__linear_attn_block__prompt_kernel:
s_cmp_ge_u32 s2,256
s_cbranch_scc1 L_exit
s_getpc_b64 s[6:7]
L_pc0:
s_load_dwordx2 s[8:9],s[0:1],96
s_load_dwordx2 s[16:17],s[0:1],88
s_load_dword s20,s[0:1],0
s_getreg_b32 s12,hwreg(HW_REG_XCC_ID,0,3)
s_lshr_b32 s13,s2,3
v_lshrrev_b32 v1,6,v0
s_nop 0
v_readfirstlane_b32 s14,v1
v_and_b32 v1,63,v0
s_mov_b32 s15,400000
s_lshr_b32 s3,s2,31
s_lshr_b32 s4,s2,31
s_lshr_b32 s5,s2,31
s_lshr_b32 s99,s2,31
s_lshl_b32 s40,s13,9
s_lshl_b32 s41,s14,7
s_add_u32 s40,s40,s41
v_bfe_u32 v40,v1,0,4
v_lshlrev_b32 v40,14,v40
v_add_u32 v40,s40,v40
s_mov_b32 s40,L_codeend-L_pc0-4
v_min_u32 v40,s40,v40
s_mov_b64 exec,0xffff
global_load_dword v56,v40,s[6:7]
s_mov_b64 exec,-1
v_mov_b32 v44,-1
v_mov_b32 v48,0
v_mov_b32 v45,-1
v_mov_b32 v49,0
v_mov_b32 v46,-1
v_mov_b32 v50,0
v_mov_b32 v47,-1
v_mov_b32 v51,0
v_mov_b32 v42,163776
ds_write_b64 v42,v[48:49]
wt lgkmcnt(0)
s_add_u32 s8,s8,0x1fffff
s_addc_u32 s9,s9,0
s_and_b32 s8,s8,0xffe00000
s_mov_b32 s10,266338304
s_mov_b32 s11,0x20000
s_barrier
s_lshl_b32 s40,s14,19
s_lshl_b32 s41,s2,10
s_add_u32 s40,s40,s41
v_bfe_u32 v40,v1,0,6
v_lshlrev_b32 v40,4,v40
w4 v[44:47],v40,s[8:11],s40 offen sc1
s_xor_b32 s41,s40,0x42000
s_cmp_eq_u32 s14,0
s_cselect_b32 s41,s41,0x40000000
w4 v[44:47],v40,s[8:11],s41 offen sc1
s_add_u32 s40,s40,2162688
w4 v[44:47],v40,s[8:11],s40 offen sc1
s_lshl_b32 s40,s14,19
s_lshl_b32 s41,s2,8
s_add_u32 s40,s40,s41
s_add_u32 s40,s40,2097152
v_bfe_u32 v41,v1,0,4
v_lshlrev_b32 v41,4,v41
v_add_u32 v41,s40,v41
s_lshl_b32 s40,s2,7
s_add_u32 s40,s40,2424832
v_bfe_u32 v53,v1,0,3
v_lshlrev_b32 v53,4,v53
v_add_u32 v53,s40,v53
v_cmp_gt_u32 vcc,16,v1
s_nop 1
v_cndmask_b32 v41,v53,v41,vcc
s_lshl2_add_u32 s60,s2,s14
s_lshl_b32 s60,s60,7
s_and_b32 s61,s60,0x1e000
s_add_u32 s60,s60,s61
s_and_b32 s64,s14,1
s_lshl_b32 s61,s64,13
s_add_u32 s60,s60,s61
s_add_u32 s60,s60,5242880
s_xor_b32 s61,s60,0x2000
v_writelane_b32 v41,s60,24
v_writelane_b32 v41,s61,25
s_bfm_b64 exec,26,0
w4 v[44:47],v41,s[8:11],0 offen sc1
s_mov_b64 exec,15
s_lshl_b32 s40,s2,8
s_lshl_b32 s41,s14,6
s_add_u32 s40,s40,s41
s_add_u32 s40,s40,4194304
w4 v[48:51],v40,s[8:11],s40 offen sc1
s_mov_b64 exec,-1
L_role:
s_cmp_ge_u32 s12,4
s_cbranch_scc1 L_G
s_load_dwordx2 s[36:37],s[0:1],16
s_load_dwordx2 s[38:39],s[0:1],24
s_load_dwordx2 s[40:41],s[0:1],32
s_load_dwordx2 s[42:43],s[0:1],40
s_mul_i32 s29,s14,32768
s_lshr_b32 s32,s13,4
s_lshl1_add_u32 s20,s12,s32
s_and_b32 s21,s13,15
s_and_b32 s22,s21,3
s_xor_b32 s92,s22,2
s_lshr_b32 s32,s21,2
s_lshl2_add_u32 s23,s20,s32
s_lshl_b32 s32,s14,21
s_lshl_b32 s33,s23,8
s_add_u32 s32,s32,s33
s_lshl_b32 s33,s22,6
s_add_u32 s32,s32,s33
v_bfe_u32 v212,v1,2,4
v_lshlrev_b32 v212,13,v212
v_bfe_u32 v195,v1,0,2
v_lshl_add_u32 v212,v195,4,v212
v_add_u32 v212,s32,v212
v_add_u32 v213,130048,v212
v_add_u32 v214,260096,v212
v_add_u32 v215,390144,v212
v_xor_b32 v220,128,v212
v_xor_b32 v221,128,v213
v_xor_b32 v222,128,v214
v_xor_b32 v223,128,v215
s_lshl_b32 s32,s20,20
s_lshl_b32 s33,s14,18
s_add_u32 s32,s32,s33
s_lshl_b32 s33,s21,7
s_add_u32 s32,s32,s33
v_bfe_u32 v216,v1,3,3
v_lshlrev_b32 v216,11,v216
v_bfe_u32 v195,v1,0,3
v_lshl_add_u32 v216,v195,4,v216
v_add_u32 v216,s32,v216
v_add_u32 v217,15360,v216
v_add_u32 v218,30720,v216
v_add_u32 v219,46080,v216
s_mov_b32 s34,0x800000
s_mov_b32 s35,0x20000
wt lgkmcnt(0)
s_lshl_b32 s28,s13,18
s_lshl_b32 s30,s14,16
s_add_u32 s28,s28,s30
s_lshl_b32 s30,s12,11
s_add_u32 s28,s28,s30
s_add_u32 s28,s28,384
v_bfe_u32 v224,v1,0,3
v_lshlrev_b32 v224,13,v224
v_bfe_u32 v195,v1,3,1
v_lshl_add_u32 v224,v195,10,v224
v_bfe_u32 v195,v1,4,1
v_lshl_add_u32 v224,v195,10,v224
v_bfe_u32 v195,v1,4,1
v_lshl_add_u32 v224,v195,9,v224
v_add_u32 v224,s28,v224
s_lshl_b32 s28,s12,21
s_lshl_b32 s30,s13,16
s_add_u32 s28,s28,s30
s_lshl_b32 s30,s14,14
s_add_u32 s28,s28,s30
s_add_u32 s28,s28,384
v_bfe_u32 v225,v1,0,4
v_lshlrev_b32 v225,10,v225
v_add_u32 v225,s28,v225
s_buffer_load_dword s62,s[8:11],s60 offset:0x80000
s_bfm_b64 exec,24,0
s_mov_b32 s32,s38
s_mov_b32 s33,s39
buffer_load_dword v226,v224,s[32:35],0 offen offset:0
s_mov_b64 exec,-1
s_mov_b32 s32,s38
s_mov_b32 s33,s39
s_add_u32 m0,s29,0
s_mov_b32 s28,0
l4 v212,s[32:35],s28 offen lds
l4 v213,s[32:35],s28 offen offset:1024 lds
l4 v214,s[32:35],s28 offen offset:2048 lds
l4 v215,s[32:35],s28 offen offset:3072 lds
s_mov_b32 s32,s38
s_mov_b32 s33,s39
s_add_u32 m0,s29,4096
s_mov_b32 s28,524288
l4 v212,s[32:35],s28 offen lds
l4 v213,s[32:35],s28 offen offset:1024 lds
l4 v214,s[32:35],s28 offen offset:2048 lds
l4 v215,s[32:35],s28 offen offset:3072 lds
s_bfm_b64 exec,24,0
s_mov_b32 s32,s40
s_mov_b32 s33,s41
buffer_load_dword v226,v224,s[32:35],0 offen offset:0
s_mov_b64 exec,-1
s_mov_b32 s32,s38
s_mov_b32 s33,s39
s_add_u32 m0,s29,8192
s_mov_b32 s28,1048576
l4 v212,s[32:35],s28 offen lds
l4 v213,s[32:35],s28 offen offset:1024 lds
l4 v214,s[32:35],s28 offen offset:2048 lds
l4 v215,s[32:35],s28 offen offset:3072 lds
s_mov_b32 s32,s38
s_mov_b32 s33,s39
s_add_u32 m0,s29,12288
s_mov_b32 s28,1572864
l4 v212,s[32:35],s28 offen lds
l4 v213,s[32:35],s28 offen offset:1024 lds
l4 v214,s[32:35],s28 offen offset:2048 lds
l4 v215,s[32:35],s28 offen offset:3072 lds
s_cmp_lg_u32 s4,0
wt vmcnt(18) lgkmcnt(0)
s_cbranch_scc1 R_race_skip
s_mov_b64 s[62:63],0
s_mov_b32 s65,2000
s_buffer_load_dword s62,s[8:11],s60 glc
s_buffer_load_dword s63,s[8:11],s61 glc
R_race0:
s_mov_b64 s[66:67],s[62:63]
s_sub_u32 s65,s65,1
s_cselect_b64 s[66:67],-1,s[66:67]
s_cmp_eq_u64 s[66:67],0
s_cbranch_scc1 R_race0
R_race_skip:
s_cmp_lg_u32 s4,0
s_cbranch_scc1 R_race_end
wt vmcnt(18)
s_sub_u32 s66,s66,s67
s_sub_u32 s67,0,s66
s_cmp_eq_u32 s64,0
s_cselect_b32 s66,s66,s67
s_add_u32 s66,s66,0x101
v_mov_b32 v208,163776
v_mov_b32 v209,s66
s_mov_b64 exec,1
ds_add_rtn_u32 v209,v208,v209
wt lgkmcnt(0)
v_readfirstlane_b32 s67,v209
s_mov_b64 exec,-1
s_add_u32 s66,s66,s67
s_cmp_lt_u32 s66,0x400
s_cbranch_scc1 R_race_end
s_and_b32 s66,s66,0xff
s_lshl_b32 s61,s66,18
s_add_u32 s61,s61,0x100
s_mov_b32 s99,1
s_lshl_b32 s60,1,s13
s_lshl_b32 s62,s12,5
v_mov_b32 v210,s60
v_mov_b32 v211,s61
v_mov_b32 v208,s62
s_mov_b64 exec,1
global_atomic_add_x2 v[254:255],v208,v[210:211],s[16:17] sc0 sc1
s_mov_b64 exec,-1
R_race_end:
s_mov_b32 s32,s40
s_mov_b32 s33,s41
s_add_u32 m0,s29,16384
s_mov_b32 s28,0
l4 v220,s[32:35],s28 offen lds
l4 v221,s[32:35],s28 offen offset:1024 lds
l4 v222,s[32:35],s28 offen offset:2048 lds
l4 v223,s[32:35],s28 offen offset:3072 lds
s_mov_b32 s32,s40
s_mov_b32 s33,s41
s_add_u32 m0,s29,20480
s_mov_b32 s28,524288
l4 v220,s[32:35],s28 offen lds
l4 v221,s[32:35],s28 offen offset:1024 lds
l4 v222,s[32:35],s28 offen offset:2048 lds
l4 v223,s[32:35],s28 offen offset:3072 lds
s_bfm_b64 exec,24,0
s_mov_b32 s32,s36
s_mov_b32 s33,s37
buffer_load_dword v226,v224,s[32:35],0 offen offset:0
s_mov_b64 exec,-1
s_mov_b32 s32,s40
s_mov_b32 s33,s41
s_add_u32 m0,s29,24576
s_mov_b32 s28,1048576
l4 v220,s[32:35],s28 offen lds
l4 v221,s[32:35],s28 offen offset:1024 lds
l4 v222,s[32:35],s28 offen offset:2048 lds
l4 v223,s[32:35],s28 offen offset:3072 lds
s_mov_b32 s32,s40
s_mov_b32 s33,s41
s_add_u32 m0,s29,28672
s_mov_b32 s28,1572864
l4 v220,s[32:35],s28 offen lds
l4 v221,s[32:35],s28 offen offset:1024 lds
l4 v222,s[32:35],s28 offen offset:2048 lds
l4 v223,s[32:35],s28 offen offset:3072 lds
s_lshl2_add_u32 s76,s20,s14
s_mov_b32 s52,-1
s_mov_b32 s53,0
s_mov_b32 s54,0x3e0293ee
s_mov_b32 s55,0x05040100
s_mov_b32 s56,0x07060302
s_lshl_b32 s73,s12,14
s_lshl_b32 s75,s14,12
s_add_u32 s73,s73,s75
s_add_u32 s73,s73,2097152
v_bfe_u32 v2,v1,0,6
v_lshlrev_b32 v2,4,v2
v_add_u32 v2,s73,v2
s_lshl_b32 s73,s12,14
s_lshl_b32 s75,s13,9
s_add_u32 s73,s73,s75
s_lshl_b32 s75,s14,7
s_add_u32 s73,s73,s75
s_add_u32 s73,s73,2097152
v_bfe_u32 v3,v1,0,3
v_lshlrev_b32 v3,4,v3
v_bfe_u32 v195,v1,4,1
v_lshl_add_u32 v3,v195,3,v3
v_add_u32 v3,s73,v3
s_lshr_b32 s72,s13,1
s_and_b32 s74,s13,1
s_lshl_b32 s73,s72,14
s_lshl_b32 s75,s74,12
s_add_u32 s73,s73,s75
s_lshl_b32 s75,s14,10
s_add_u32 s73,s73,s75
v_bfe_u32 v10,v1,0,6
v_lshlrev_b32 v10,4,v10
v_add_u32 v10,s73,v10
s_lshl_b32 s73,s21,14
s_lshl_b32 s75,s14,12
s_add_u32 s73,s73,s75
s_lshl_b32 s75,s20,7
s_add_u32 s73,s73,s75
v_bfe_u32 v9,v1,0,4
v_lshlrev_b32 v9,3,v9
v_bfe_u32 v195,v1,4,2
v_lshl_add_u32 v9,v195,10,v9
v_add_u32 v9,s73,v9
s_lshl_b32 s73,s76,13
s_add_u32 s73,s73,2162688
v_bfe_u32 v4,v1,0,6
v_lshlrev_b32 v4,4,v4
v_add_u32 v4,s73,v4
v_add_u32 v6,3072,v4
s_lshl_b32 s73,s76,13
s_add_u32 s73,s73,2164736
v_bfe_u32 v5,v1,0,6
v_lshlrev_b32 v5,3,v5
v_add_u32 v5,s73,v5
s_lshl_b32 s73,s76,14
s_add_u32 s73,s73,18882560
v_bfe_u32 v12,v1,4,2
v_lshlrev_b32 v12,9,v12
v_bfe_u32 v195,v1,3,1
v_lshl_add_u32 v12,v195,8,v12
v_bfe_u32 v195,v1,1,1
v_lshl_add_u32 v12,v195,6,v12
v_bfe_u32 v195,v1,2,1
v_lshl_add_u32 v12,v195,5,v12
v_bfe_u32 v195,v1,0,1
v_lshl_add_u32 v12,v195,4,v12
v_add_u32 v12,s73,v12
v_add_u32 v13,4096,v12
s_lshl_b32 s88,s76,14
s_lshl_b32 s75,s21,9
s_add_u32 s88,s88,s75
s_add_u32 s88,s88,18882560
s_lshl_b32 s89,s23,14
s_lshl_b32 s75,s22,11
s_add_u32 s89,s89,s75
s_lshl_b32 s75,s14,9
s_add_u32 s89,s89,s75
s_add_u32 s89,s89,16777216
s_lshr_b32 s72,s13,2
s_lshl_b32 s73,s12,12
s_lshl_b32 s75,s72,7
s_add_u32 s73,s73,s75
s_lshl_b32 s75,s22,4
s_add_u32 s73,s73,s75
s_lshl_b32 s75,s14,2
s_add_u32 s73,s73,s75
s_add_u32 s73,s73,2424832
v_bfe_u32 v252,v1,0,2
v_lshlrev_b32 v252,10,v252
v_add_u32 v252,s73,v252
v_mov_b32 v194,2147483632
v_cmp_gt_u32 vcc,4,v1
s_nop 1
v_cndmask_b32 v252,v194,v252,vcc
s_and_b32 s72,s20,1
s_lshl_b32 s73,s12,12
s_lshl_b32 s75,s72,9
s_add_u32 s73,s73,s75
s_lshl_b32 s75,s14,7
s_add_u32 s73,s73,s75
s_add_u32 s73,s73,2424832
v_bfe_u32 v250,v1,0,4
v_lshlrev_b32 v250,2,v250
v_add_u32 v250,s73,v250
s_lshl_b32 s73,s12,12
s_lshl_b32 s75,s14,8
s_add_u32 s73,s73,s75
s_add_u32 s73,s73,2441216
v_bfe_u32 v251,v1,4,1
v_lshlrev_b32 v251,7,v251
v_bfe_u32 v195,v1,0,4
v_lshl_add_u32 v251,v195,2,v251
v_add_u32 v251,s73,v251
v_mov_b32 v248,-1
v_mov_b32 v249,-1
s_lshl_b32 s73,s20,8
s_add_u32 s73,s73,4194304
v_mov_b32 v0,s73
s_lshl_b32 s73,s21,6
v_mov_b32 v194,2147483632
v_cmp_eq_u32 vcc,s73,v1
s_nop 1
v_cndmask_b32 v0,v194,v0,vcc
v_bfe_u32 v193,v1,3,1
v_bfe_u32 v195,v1,5,1
v_lshl_add_u32 v193,v195,1,v193
v_mov_b32 v194,2147483632
v_cmp_eq_u32 vcc,0,v193
s_nop 1
v_cndmask_b32 v3,v194,v3,vcc
s_and_b32 s72,s20,3
s_lshr_b32 s74,s20,2
s_lshl_b32 s73,s72,15
s_lshl_b32 s75,s21,8
s_add_u32 s73,s73,s75
s_lshl_b32 s75,s74,2
s_add_u32 s73,s73,s75
s_add_u32 s73,s73,262144
v_bfe_u32 v14,v1,2,1
v_lshlrev_b32 v14,14,v14
v_bfe_u32 v195,v1,1,1
v_lshl_add_u32 v14,v195,12,v14
v_bfe_u32 v195,v1,0,1
v_lshl_add_u32 v14,v195,7,v14
v_add_u32 v14,s73,v14
v_mov_b32 v194,0x20000000
v_cmp_gt_u32 vcc,8,v1
s_nop 1
v_cndmask_b32 v14,v194,v14,vcc
s_lshr_b32 s72,s12,1
s_and_b32 s74,s12,1
s_lshl_b32 s98,s72,14
s_lshl_b32 s75,s74,12
s_add_u32 s98,s98,s75
s_lshl_b32 s75,s13,7
s_add_u32 s98,s98,s75
s_add_u32 s98,s98,262144
s_and_b32 s72,s14,1
s_lshl_b32 s72,s72,15
s_add_u32 s98,s98,s72
v_bfe_u32 v245,v1,0,6
v_lshlrev_b32 v245,2,v245
v_add_u32 v245,20480,v245
s_lshl_b32 s73,s23,14
s_lshl_b32 s75,s22,11
s_add_u32 s73,s73,s75
s_add_u32 s73,s73,16777216
v_bfe_u32 v11,v1,4,2
v_lshlrev_b32 v11,9,v11
v_bfe_u32 v195,v1,0,4
v_lshl_add_u32 v11,v195,4,v11
v_add_u32 v11,s73,v11
v_and_b32 v193,2,v1
v_cmp_eq_u32 vcc,0,v193
v_mov_b32 v193,0x4444
v_mov_b32 v194,0xeeee
v_cndmask_b32 v23,v194,v193,vcc
v_mov_b32 v193,0xe484
v_mov_b32 v194,0xee9e
v_cndmask_b32 v24,v194,v193,vcc
v_mov_b32 v193,0x84e4
v_mov_b32 v194,0x9eee
v_cndmask_b32 v193,v194,v193,vcc
v_cmp_gt_u32 vcc,32,v1
s_nop 1
v_cndmask_b32 v24,v193,v24,vcc
v_mov_b32 v28,-1
v_mov_b32 v29,-1
v_mov_b32 v30,-1
v_mov_b32 v31,-1
v_mov_b32 v32,0x3f803f80
v_mov_b32 v33,0x3f803f80
v_mov_b32 v34,0x3f803f80
v_mov_b32 v35,0
v_mov_b32 v36,0x3f803f80
v_mov_b32 v37,0x3f803f80
v_mov_b32 v38,0x3f803f80
v_mov_b32 v39,0
v_mov_b32 v43,0
v_mov_b32 v47,0
v_mov_b32 v51,0
v_mov_b32 v55,0
v_mov_b32 v59,0
v_mov_b32 v63,0
v_mov_b32 v67,0
v_mov_b32 v71,0
v_bfe_u32 v193,v1,0,1
v_lshlrev_b32 v193,4,v193
v_mov_b32 v194,0x3f80
v_lshlrev_b32 v193,v193,v194
v_bfe_u32 v194,v1,1,3
v_cmp_eq_u32 vcc,0,v194
s_nop 1
v_cndmask_b32 v180,0,v193,vcc
v_cmp_eq_u32 vcc,1,v194
s_nop 1
v_cndmask_b32 v181,0,v193,vcc
v_cmp_eq_u32 vcc,2,v194
s_nop 1
v_cndmask_b32 v182,0,v193,vcc
v_cmp_eq_u32 vcc,3,v194
s_nop 1
v_cndmask_b32 v183,0,v193,vcc
v_cmp_eq_u32 vcc,4,v194
s_nop 1
v_cndmask_b32 v184,0,v193,vcc
v_cmp_eq_u32 vcc,5,v194
s_nop 1
v_cndmask_b32 v185,0,v193,vcc
v_cmp_eq_u32 vcc,6,v194
s_nop 1
v_cndmask_b32 v186,0,v193,vcc
v_cmp_eq_u32 vcc,7,v194
s_nop 1
v_cndmask_b32 v187,0,v193,vcc
v_bfe_u32 v193,v1,3,1
v_lshlrev_b32 v193,4,v193
v_mov_b32 v194,0x3f80
v_lshlrev_b32 v193,v193,v194
v_bfe_u32 v194,v1,2,1
v_cmp_eq_u32 vcc,0,v194
s_nop 1
v_cndmask_b32 v26,0,v193,vcc
v_cmp_eq_u32 vcc,1,v194
s_nop 1
v_cndmask_b32 v27,0,v193,vcc
s_lshl_b32 s73,s14,10
v_bfe_u32 v193,v1,4,2
v_lshlrev_b32 v193,8,v193
v_bfe_u32 v195,v1,1,3
v_lshl_add_u32 v193,v195,4,v193
v_bfe_u32 v195,v1,0,1
v_lshl_add_u32 v193,v195,3,v193
v_add_u32 v193,s73,v193
v_bfe_u32 v194,v1,4,2
v_lshlrev_b32 v194,5,v194
v_xor_b32 v15,v193,v194
v_xor_b32 v16,16,v15
v_add_u32 v16,4096,v16
v_bfe_u32 v194,v1,4,1
v_lshlrev_b32 v194,6,v194
v_bfe_u32 v195,v1,5,1
v_lshl_add_u32 v194,v195,5,v194
v_xor_b32 v17,v193,v194
v_add_u32 v17,8192,v17
s_lshl_b32 s73,s14,11
s_add_u32 s73,s73,12288
v_bfe_u32 v193,v1,4,2
v_lshlrev_b32 v193,9,v193
v_bfe_u32 v195,v1,0,4
v_lshl_add_u32 v193,v195,4,v193
v_add_u32 v193,s73,v193
v_bfe_u32 v194,v1,4,2
v_lshlrev_b32 v194,6,v194
v_xor_b32 v20,v193,v194
v_xor_b32 v21,32,v20
s_and_b32 s72,s14,1
s_lshl_b32 s73,s72,7
s_add_u32 s73,s73,12288
v_bfe_u32 v193,v1,3,2
v_lshlrev_b32 v193,9,v193
v_bfe_u32 v195,v1,1,1
v_lshl_add_u32 v193,v195,8,v193
v_bfe_u32 v195,v1,5,1
v_lshl_add_u32 v193,v195,6,v193
v_bfe_u32 v195,v1,2,1
v_lshl_add_u32 v193,v195,5,v193
v_bfe_u32 v195,v1,0,1
v_lshl_add_u32 v193,v195,4,v193
v_add_u32 v193,s73,v193
v_bfe_u32 v194,v1,3,2
v_lshlrev_b32 v194,6,v194
v_bfe_u32 v195,v1,1,1
v_lshl_add_u32 v194,v195,5,v194
v_xor_b32 v22,v193,v194
s_lshl_b32 s77,s23,13
s_add_u32 s77,s77,2162688
s_cmp_eq_u32 s14,1
s_cbranch_scc1 R_su1
s_cmp_eq_u32 s14,2
s_cbranch_scc1 R_su2
s_cmp_eq_u32 s14,3
s_cbranch_scc1 R_su3
v_bfe_u32 v193,v1,3,1
v_lshlrev_b32 v193,12,v193
v_bfe_u32 v195,v1,0,3
v_lshl_add_u32 v193,v195,7,v193
v_bfe_u32 v195,v1,4,2
v_lshl_add_u32 v193,v195,5,v193
v_bfe_u32 v194,v1,1,2
v_lshlrev_b32 v194,5,v194
v_bfe_u32 v195,v1,3,1
v_lshl_add_u32 v194,v195,4,v194
v_xor_b32 v18,v193,v194
v_xor_b32 v19,16,v18
s_lshl_b32 s73,s77,0
s_lshl_b32 s75,s22,8
s_add_u32 s73,s73,s75
v_bfe_u32 v7,v1,5,1
v_lshlrev_b32 v7,10,v7
v_bfe_u32 v195,v1,1,2
v_lshl_add_u32 v7,v195,6,v7
v_bfe_u32 v195,v1,4,1
v_lshl_add_u32 v7,v195,5,v7
v_bfe_u32 v195,v1,0,1
v_lshl_add_u32 v7,v195,4,v7
v_add_u32 v7,s73,v7
s_lshl_b32 s73,s77,0
s_lshl_b32 s75,s22,7
s_add_u32 s73,s73,s75
s_add_u32 s73,s73,2048
v_bfe_u32 v8,v1,1,2
v_lshlrev_b32 v8,5,v8
v_bfe_u32 v195,v1,4,1
v_lshl_add_u32 v8,v195,4,v8
v_bfe_u32 v195,v1,0,1
v_lshl_add_u32 v8,v195,3,v8
v_add_u32 v8,s73,v8
s_lshl_b32 s73,s23,11
s_lshl_b32 s75,s22,9
s_add_u32 s73,s73,s75
s_add_u32 s73,s73,8388608
v_bfe_u32 v25,v1,4,2
v_lshlrev_b32 v25,7,v25
v_bfe_u32 v195,v1,0,3
v_lshl_add_u32 v25,v195,4,v25
v_add_u32 v25,s73,v25
v_bfe_u32 v193,v1,3,1
v_mov_b32 v194,2147483632
v_cmp_eq_u32 vcc,0,v193
s_nop 1
v_cndmask_b32 v7,v194,v7,vcc
v_mov_b32 v194,2147483632
v_cmp_eq_u32 vcc,1,v193
s_nop 1
v_cndmask_b32 v25,v194,v25,vcc
v_bfe_u32 v193,v1,3,1
v_bfe_u32 v195,v1,5,1
v_lshl_add_u32 v193,v195,1,v193
v_mov_b32 v194,2147483632
v_cmp_eq_u32 vcc,2,v193
s_nop 1
v_cndmask_b32 v8,v194,v8,vcc
s_branch R_sud
R_su1:
v_cmp_gt_u32 vcc,32,v1
s_lshl_b32 s73,s77,0
s_lshl_b32 s75,s22,8
s_add_u32 s73,s73,s75
v_bfe_u32 v193,v1,4,1
v_lshlrev_b32 v193,10,v193
v_bfe_u32 v195,v1,0,4
v_lshl_add_u32 v193,v195,4,v193
v_add_u32 v193,s73,v193
s_lshl_b32 s73,s77,0
s_lshl_b32 s75,s92,9
s_add_u32 s73,s73,s75
s_add_u32 s73,s73,3072
v_bfe_u32 v194,v1,0,5
v_lshlrev_b32 v194,4,v194
v_add_u32 v194,s73,v194
v_cndmask_b32 v7,v194,v193,vcc
s_lshl_b32 s73,s12,14
s_lshl_b32 s75,s13,9
s_add_u32 s73,s73,s75
s_add_u32 s73,s73,2097152
v_bfe_u32 v193,v1,0,5
v_lshlrev_b32 v193,4,v193
v_add_u32 v193,s73,v193
s_lshl_b32 s73,s77,0
s_lshl_b32 s75,s22,7
s_add_u32 s73,s73,s75
s_add_u32 s73,s73,2048
v_bfe_u32 v194,v1,0,3
v_lshlrev_b32 v194,4,v194
v_add_u32 v194,s73,v194
v_cndmask_b32 v8,v194,v193,vcc
s_lshl_b32 s73,s21,14
s_lshl_b32 s75,s20,7
s_add_u32 s73,s73,s75
v_bfe_u32 v11,v1,0,3
v_lshlrev_b32 v11,4,v11
v_bfe_u32 v195,v1,3,2
v_lshl_add_u32 v11,v195,10,v11
v_bfe_u32 v195,v1,5,1
v_lshl_add_u32 v11,v195,18,v11
v_add_u32 v11,s73,v11
v_mov_b32 v194,2147483632
v_cmp_gt_u32 vcc,32,v1
s_nop 1
v_cndmask_b32 v11,v194,v11,vcc
v_mov_b32 v25,0
v_mov_b32 v18,0
v_mov_b32 v19,0
s_branch R_sud
R_su2:
v_bfe_u32 v193,v1,5,1
v_lshlrev_b32 v193,6,v193
v_bfe_u32 v195,v1,2,1
v_lshl_add_u32 v193,v195,5,v193
v_bfe_u32 v195,v1,3,2
v_lshl_add_u32 v193,v195,3,v193
v_bfe_u32 v195,v1,1,1
v_lshl_add_u32 v193,v195,2,v193
v_bfe_u32 v195,v1,0,1
v_lshl_add_u32 v193,v195,9,v193
v_add_u32 v193,8192,v193
v_bfe_u32 v194,v1,0,1
v_lshlrev_b32 v194,5,v194
v_xor_b32 v18,v193,v194
v_xor_b32 v19,64,v18
s_lshl_b32 s73,s23,11
s_lshl_b32 s75,s92,9
s_add_u32 s73,s73,s75
s_add_u32 s73,s73,12582912
v_bfe_u32 v25,v1,0,6
v_lshlrev_b32 v25,3,v25
v_add_u32 v25,s73,v25
v_mov_b32 v7,0
v_mov_b32 v8,0
s_branch R_sud
R_su3:
v_bfe_u32 v193,v1,1,1
v_lshlrev_b32 v193,9,v193
v_bfe_u32 v195,v1,3,2
v_lshl_add_u32 v193,v195,7,v193
v_bfe_u32 v195,v1,5,1
v_lshl_add_u32 v193,v195,6,v193
v_bfe_u32 v195,v1,2,1
v_lshl_add_u32 v193,v195,5,v193
v_bfe_u32 v195,v1,0,1
v_lshl_add_u32 v193,v195,4,v193
v_add_u32 v193,8192,v193
v_bfe_u32 v194,v1,4,1
v_lshlrev_b32 v194,6,v194
v_bfe_u32 v195,v1,1,1
v_lshl_add_u32 v194,v195,5,v194
v_xor_b32 v18,v193,v194
s_lshl_b32 s73,s77,0
s_lshl_b32 s75,s92,9
s_add_u32 s73,s73,s75
s_add_u32 s73,s73,3072
v_bfe_u32 v7,v1,0,6
v_lshlrev_b32 v7,3,v7
v_add_u32 v7,s73,v7
s_lshl_b32 s73,s21,14
s_lshl_b32 s75,s20,7
s_add_u32 s73,s73,s75
s_add_u32 s73,s73,4096
v_bfe_u32 v11,v1,0,3
v_lshlrev_b32 v11,4,v11
v_bfe_u32 v195,v1,3,2
v_lshl_add_u32 v11,v195,10,v11
v_bfe_u32 v195,v1,5,1
v_lshl_add_u32 v11,v195,18,v11
v_add_u32 v11,s73,v11
v_mov_b32 v194,2147483632
v_cmp_gt_u32 vcc,32,v1
s_nop 1
v_cndmask_b32 v11,v194,v11,vcc
v_mov_b32 v19,0
v_mov_b32 v8,0
v_mov_b32 v25,0
R_sud:
v_bfe_u32 v196,v1,5,1
v_lshlrev_b32 v196,10,v196
v_bfe_u32 v195,v1,4,1
v_lshl_add_u32 v196,v195,8,v196
v_bfe_u32 v195,v1,1,1
v_lshl_add_u32 v196,v195,5,v196
v_bfe_u32 v195,v1,2,2
v_lshl_add_u32 v196,v195,3,v196
v_bfe_u32 v195,v1,0,1
v_lshl_add_u32 v196,v195,2,v196
v_add_u32 v196,s29,v196
v_bfe_u32 v197,v1,5,1
v_lshlrev_b32 v197,10,v197
v_bfe_u32 v195,v1,4,1
v_lshl_add_u32 v197,v195,8,v197
v_bfe_u32 v195,v1,0,1
v_lshl_add_u32 v197,v195,5,v197
v_bfe_u32 v195,v1,3,1
v_lshl_add_u32 v197,v195,4,v197
v_bfe_u32 v195,v1,1,1
v_lshl_add_u32 v197,v195,3,v197
v_bfe_u32 v195,v1,2,1
v_lshl_add_u32 v197,v195,2,v197
v_add_u32 v197,s29,v197
v_bfe_u32 v198,v1,4,2
v_lshlrev_b32 v198,9,v198
v_bfe_u32 v195,v1,0,4
v_lshl_add_u32 v198,v195,3,v198
v_add_u32 v198,s29,v198
wt vmcnt(24)
v_add_u32 v199,0,v196
ds_read2_b32 v[72:73],v199 offset0:0 offset1:16
ds_read2_b32 v[74:75],v199 offset0:128 offset1:144
ds_read2_b32 v[76:77],v199 offset0:32 offset1:48
ds_read2_b32 v[78:79],v199 offset0:160 offset1:176
v_add_u32 v199,2048,v196
ds_read2_b32 v[80:81],v199 offset0:0 offset1:16
ds_read2_b32 v[82:83],v199 offset0:128 offset1:144
ds_read2_b32 v[84:85],v199 offset0:32 offset1:48
ds_read2_b32 v[86:87],v199 offset0:160 offset1:176
wt lgkmcnt(0)
v_perm_b32 v200,v73,v72,s55
v_perm_b32 v201,v73,v72,s56
aw a64,v200
aw a96,v201
v_perm_b32 v200,v75,v74,s55
v_perm_b32 v201,v75,v74,s56
aw a65,v200
aw a97,v201
v_perm_b32 v200,v77,v76,s55
v_perm_b32 v201,v77,v76,s56
aw a66,v200
aw a98,v201
v_perm_b32 v200,v79,v78,s55
v_perm_b32 v201,v79,v78,s56
aw a67,v200
aw a99,v201
v_perm_b32 v200,v81,v80,s55
v_perm_b32 v201,v81,v80,s56
aw a68,v200
aw a100,v201
v_perm_b32 v200,v83,v82,s55
v_perm_b32 v201,v83,v82,s56
aw a69,v200
aw a101,v201
v_perm_b32 v200,v85,v84,s55
v_perm_b32 v201,v85,v84,s56
aw a70,v200
aw a102,v201
v_perm_b32 v200,v87,v86,s55
v_perm_b32 v201,v87,v86,s56
aw a71,v200
aw a103,v201
v_add_u32 v199,4096,v196
ds_read2_b32 v[72:73],v199 offset0:0 offset1:16
ds_read2_b32 v[74:75],v199 offset0:128 offset1:144
ds_read2_b32 v[76:77],v199 offset0:32 offset1:48
ds_read2_b32 v[78:79],v199 offset0:160 offset1:176
v_add_u32 v199,6144,v196
ds_read2_b32 v[80:81],v199 offset0:0 offset1:16
ds_read2_b32 v[82:83],v199 offset0:128 offset1:144
ds_read2_b32 v[84:85],v199 offset0:32 offset1:48
ds_read2_b32 v[86:87],v199 offset0:160 offset1:176
wt lgkmcnt(0)
s_mov_b32 s32,s36
s_mov_b32 s33,s37
s_add_u32 m0,s29,0
s_mov_b32 s28,0
l4 v212,s[32:35],s28 offen lds
l4 v213,s[32:35],s28 offen offset:1024 lds
l4 v214,s[32:35],s28 offen offset:2048 lds
l4 v215,s[32:35],s28 offen offset:3072 lds
s_mov_b32 s32,s36
s_mov_b32 s33,s37
s_add_u32 m0,s29,4096
s_mov_b32 s28,524288
l4 v212,s[32:35],s28 offen lds
l4 v213,s[32:35],s28 offen offset:1024 lds
l4 v214,s[32:35],s28 offen offset:2048 lds
l4 v215,s[32:35],s28 offen offset:3072 lds
v_perm_b32 v200,v73,v72,s55
v_perm_b32 v201,v73,v72,s56
aw a72,v200
aw a104,v201
v_perm_b32 v200,v75,v74,s55
v_perm_b32 v201,v75,v74,s56
aw a73,v200
aw a105,v201
v_perm_b32 v200,v77,v76,s55
v_perm_b32 v201,v77,v76,s56
aw a74,v200
aw a106,v201
v_perm_b32 v200,v79,v78,s55
v_perm_b32 v201,v79,v78,s56
aw a75,v200
aw a107,v201
v_perm_b32 v200,v81,v80,s55
v_perm_b32 v201,v81,v80,s56
aw a76,v200
aw a108,v201
v_perm_b32 v200,v83,v82,s55
v_perm_b32 v201,v83,v82,s56
aw a77,v200
aw a109,v201
v_perm_b32 v200,v85,v84,s55
v_perm_b32 v201,v85,v84,s56
aw a78,v200
aw a110,v201
v_perm_b32 v200,v87,v86,s55
v_perm_b32 v201,v87,v86,s56
aw a79,v200
aw a111,v201
wt vmcnt(24)
v_add_u32 v199,8192,v196
ds_read2_b32 v[72:73],v199 offset0:0 offset1:16
ds_read2_b32 v[74:75],v199 offset0:128 offset1:144
ds_read2_b32 v[76:77],v199 offset0:32 offset1:48
ds_read2_b32 v[78:79],v199 offset0:160 offset1:176
v_add_u32 v199,10240,v196
ds_read2_b32 v[80:81],v199 offset0:0 offset1:16
ds_read2_b32 v[82:83],v199 offset0:128 offset1:144
ds_read2_b32 v[84:85],v199 offset0:32 offset1:48
ds_read2_b32 v[86:87],v199 offset0:160 offset1:176
wt lgkmcnt(0)
v_perm_b32 v200,v73,v72,s55
v_perm_b32 v201,v73,v72,s56
aw a80,v200
aw a112,v201
v_perm_b32 v200,v75,v74,s55
v_perm_b32 v201,v75,v74,s56
aw a81,v200
aw a113,v201
v_perm_b32 v200,v77,v76,s55
v_perm_b32 v201,v77,v76,s56
aw a82,v200
aw a114,v201
v_perm_b32 v200,v79,v78,s55
v_perm_b32 v201,v79,v78,s56
aw a83,v200
aw a115,v201
v_perm_b32 v200,v81,v80,s55
v_perm_b32 v201,v81,v80,s56
aw a84,v200
aw a116,v201
v_perm_b32 v200,v83,v82,s55
v_perm_b32 v201,v83,v82,s56
aw a85,v200
aw a117,v201
v_perm_b32 v200,v85,v84,s55
v_perm_b32 v201,v85,v84,s56
aw a86,v200
aw a118,v201
v_perm_b32 v200,v87,v86,s55
v_perm_b32 v201,v87,v86,s56
aw a87,v200
aw a119,v201
v_add_u32 v199,12288,v196
ds_read2_b32 v[72:73],v199 offset0:0 offset1:16
ds_read2_b32 v[74:75],v199 offset0:128 offset1:144
ds_read2_b32 v[76:77],v199 offset0:32 offset1:48
ds_read2_b32 v[78:79],v199 offset0:160 offset1:176
v_add_u32 v199,14336,v196
ds_read2_b32 v[80:81],v199 offset0:0 offset1:16
ds_read2_b32 v[82:83],v199 offset0:128 offset1:144
ds_read2_b32 v[84:85],v199 offset0:32 offset1:48
ds_read2_b32 v[86:87],v199 offset0:160 offset1:176
wt lgkmcnt(0)
s_bfm_b64 exec,24,0
s_mov_b32 s32,s42
s_mov_b32 s33,s43
buffer_load_dword v226,v225,s[32:35],0 offen offset:0
s_mov_b64 exec,-1
s_mov_b32 s32,s36
s_mov_b32 s33,s37
s_add_u32 m0,s29,8192
s_mov_b32 s28,1048576
l4 v212,s[32:35],s28 offen lds
l4 v213,s[32:35],s28 offen offset:1024 lds
l4 v214,s[32:35],s28 offen offset:2048 lds
l4 v215,s[32:35],s28 offen offset:3072 lds
s_mov_b32 s32,s36
s_mov_b32 s33,s37
s_add_u32 m0,s29,12288
s_mov_b32 s28,1572864
l4 v212,s[32:35],s28 offen lds
l4 v213,s[32:35],s28 offen offset:1024 lds
l4 v214,s[32:35],s28 offen offset:2048 lds
l4 v215,s[32:35],s28 offen offset:3072 lds
v_perm_b32 v200,v73,v72,s55
v_perm_b32 v201,v73,v72,s56
aw a88,v200
aw a120,v201
v_perm_b32 v200,v75,v74,s55
v_perm_b32 v201,v75,v74,s56
aw a89,v200
aw a121,v201
v_perm_b32 v200,v77,v76,s55
v_perm_b32 v201,v77,v76,s56
aw a90,v200
aw a122,v201
v_perm_b32 v200,v79,v78,s55
v_perm_b32 v201,v79,v78,s56
aw a91,v200
aw a123,v201
v_perm_b32 v200,v81,v80,s55
v_perm_b32 v201,v81,v80,s56
aw a92,v200
aw a124,v201
v_perm_b32 v200,v83,v82,s55
v_perm_b32 v201,v83,v82,s56
aw a93,v200
aw a125,v201
v_perm_b32 v200,v85,v84,s55
v_perm_b32 v201,v85,v84,s56
aw a94,v200
aw a126,v201
v_perm_b32 v200,v87,v86,s55
v_perm_b32 v201,v87,v86,s56
aw a95,v200
aw a127,v201
wt vmcnt(24)
v_add_u32 v199,16384,v197
ds_read2_b32 v[72:73],v199 offset0:0 offset1:16
ds_read2_b32 v[74:75],v199 offset0:128 offset1:144
ds_read2_b32 v[76:77],v199 offset0:32 offset1:48
ds_read2_b32 v[78:79],v199 offset0:160 offset1:176
v_add_u32 v199,18432,v197
ds_read2_b32 v[80:81],v199 offset0:0 offset1:16
ds_read2_b32 v[82:83],v199 offset0:128 offset1:144
ds_read2_b32 v[84:85],v199 offset0:32 offset1:48
ds_read2_b32 v[86:87],v199 offset0:160 offset1:176
wt lgkmcnt(0)
v_perm_b32 v200,v73,v72,s55
v_perm_b32 v201,v73,v72,s56
aw a128,v200
aw a160,v201
v_perm_b32 v200,v75,v74,s55
v_perm_b32 v201,v75,v74,s56
aw a129,v200
aw a161,v201
v_perm_b32 v200,v77,v76,s55
v_perm_b32 v201,v77,v76,s56
aw a130,v200
aw a162,v201
v_perm_b32 v200,v79,v78,s55
v_perm_b32 v201,v79,v78,s56
aw a131,v200
aw a163,v201
v_perm_b32 v200,v81,v80,s55
v_perm_b32 v201,v81,v80,s56
aw a132,v200
aw a164,v201
v_perm_b32 v200,v83,v82,s55
v_perm_b32 v201,v83,v82,s56
aw a133,v200
aw a165,v201
v_perm_b32 v200,v85,v84,s55
v_perm_b32 v201,v85,v84,s56
aw a134,v200
aw a166,v201
v_perm_b32 v200,v87,v86,s55
v_perm_b32 v201,v87,v86,s56
aw a135,v200
aw a167,v201
v_add_u32 v199,20480,v197
ds_read2_b32 v[72:73],v199 offset0:0 offset1:16
ds_read2_b32 v[74:75],v199 offset0:128 offset1:144
ds_read2_b32 v[76:77],v199 offset0:32 offset1:48
ds_read2_b32 v[78:79],v199 offset0:160 offset1:176
v_add_u32 v199,22528,v197
ds_read2_b32 v[80:81],v199 offset0:0 offset1:16
ds_read2_b32 v[82:83],v199 offset0:128 offset1:144
ds_read2_b32 v[84:85],v199 offset0:32 offset1:48
ds_read2_b32 v[86:87],v199 offset0:160 offset1:176
wt lgkmcnt(0)
s_mov_b32 s32,s42
s_mov_b32 s33,s43
s_add_u32 m0,s29,16384
s_mov_b32 s28,0
l4 v216,s[32:35],s28 offen lds
l4 v217,s[32:35],s28 offen offset:1024 lds
l4 v218,s[32:35],s28 offen offset:2048 lds
l4 v219,s[32:35],s28 offen offset:3072 lds
s_mov_b32 s32,s42
s_mov_b32 s33,s43
s_add_u32 m0,s29,20480
s_mov_b32 s28,65536
l4 v216,s[32:35],s28 offen lds
l4 v217,s[32:35],s28 offen offset:1024 lds
l4 v218,s[32:35],s28 offen offset:2048 lds
l4 v219,s[32:35],s28 offen offset:3072 lds
v_perm_b32 v200,v73,v72,s55
v_perm_b32 v201,v73,v72,s56
aw a136,v200
aw a168,v201
v_perm_b32 v200,v75,v74,s55
v_perm_b32 v201,v75,v74,s56
aw a137,v200
aw a169,v201
v_perm_b32 v200,v77,v76,s55
v_perm_b32 v201,v77,v76,s56
aw a138,v200
aw a170,v201
v_perm_b32 v200,v79,v78,s55
v_perm_b32 v201,v79,v78,s56
aw a139,v200
aw a171,v201
v_perm_b32 v200,v81,v80,s55
v_perm_b32 v201,v81,v80,s56
aw a140,v200
aw a172,v201
v_perm_b32 v200,v83,v82,s55
v_perm_b32 v201,v83,v82,s56
aw a141,v200
aw a173,v201
v_perm_b32 v200,v85,v84,s55
v_perm_b32 v201,v85,v84,s56
aw a142,v200
aw a174,v201
v_perm_b32 v200,v87,v86,s55
v_perm_b32 v201,v87,v86,s56
aw a143,v200
aw a175,v201
wt vmcnt(24)
v_add_u32 v199,24576,v197
ds_read2_b32 v[72:73],v199 offset0:0 offset1:16
ds_read2_b32 v[74:75],v199 offset0:128 offset1:144
ds_read2_b32 v[76:77],v199 offset0:32 offset1:48
ds_read2_b32 v[78:79],v199 offset0:160 offset1:176
v_add_u32 v199,26624,v197
ds_read2_b32 v[80:81],v199 offset0:0 offset1:16
ds_read2_b32 v[82:83],v199 offset0:128 offset1:144
ds_read2_b32 v[84:85],v199 offset0:32 offset1:48
ds_read2_b32 v[86:87],v199 offset0:160 offset1:176
wt lgkmcnt(0)
v_perm_b32 v200,v73,v72,s55
v_perm_b32 v201,v73,v72,s56
aw a144,v200
aw a176,v201
v_perm_b32 v200,v75,v74,s55
v_perm_b32 v201,v75,v74,s56
aw a145,v200
aw a177,v201
v_perm_b32 v200,v77,v76,s55
v_perm_b32 v201,v77,v76,s56
aw a146,v200
aw a178,v201
v_perm_b32 v200,v79,v78,s55
v_perm_b32 v201,v79,v78,s56
aw a147,v200
aw a179,v201
v_perm_b32 v200,v81,v80,s55
v_perm_b32 v201,v81,v80,s56
aw a148,v200
aw a180,v201
v_perm_b32 v200,v83,v82,s55
v_perm_b32 v201,v83,v82,s56
aw a149,v200
aw a181,v201
v_perm_b32 v200,v85,v84,s55
v_perm_b32 v201,v85,v84,s56
aw a150,v200
aw a182,v201
v_perm_b32 v200,v87,v86,s55
v_perm_b32 v201,v87,v86,s56
aw a151,v200
aw a183,v201
v_add_u32 v199,28672,v197
ds_read2_b32 v[72:73],v199 offset0:0 offset1:16
ds_read2_b32 v[74:75],v199 offset0:128 offset1:144
ds_read2_b32 v[76:77],v199 offset0:32 offset1:48
ds_read2_b32 v[78:79],v199 offset0:160 offset1:176
v_add_u32 v199,30720,v197
ds_read2_b32 v[80:81],v199 offset0:0 offset1:16
ds_read2_b32 v[82:83],v199 offset0:128 offset1:144
ds_read2_b32 v[84:85],v199 offset0:32 offset1:48
ds_read2_b32 v[86:87],v199 offset0:160 offset1:176
wt lgkmcnt(0)
s_mov_b32 s32,s42
s_mov_b32 s33,s43
s_add_u32 m0,s29,24576
s_mov_b32 s28,131072
l4 v216,s[32:35],s28 offen lds
l4 v217,s[32:35],s28 offen offset:1024 lds
l4 v218,s[32:35],s28 offen offset:2048 lds
l4 v219,s[32:35],s28 offen offset:3072 lds
s_mov_b32 s32,s42
s_mov_b32 s33,s43
s_add_u32 m0,s29,28672
s_mov_b32 s28,196608
l4 v216,s[32:35],s28 offen lds
l4 v217,s[32:35],s28 offen offset:1024 lds
l4 v218,s[32:35],s28 offen offset:2048 lds
l4 v219,s[32:35],s28 offen offset:3072 lds
v_perm_b32 v200,v73,v72,s55
v_perm_b32 v201,v73,v72,s56
aw a152,v200
aw a184,v201
v_perm_b32 v200,v75,v74,s55
v_perm_b32 v201,v75,v74,s56
aw a153,v200
aw a185,v201
v_perm_b32 v200,v77,v76,s55
v_perm_b32 v201,v77,v76,s56
aw a154,v200
aw a186,v201
v_perm_b32 v200,v79,v78,s55
v_perm_b32 v201,v79,v78,s56
aw a155,v200
aw a187,v201
v_perm_b32 v200,v81,v80,s55
v_perm_b32 v201,v81,v80,s56
aw a156,v200
aw a188,v201
v_perm_b32 v200,v83,v82,s55
v_perm_b32 v201,v83,v82,s56
aw a157,v200
aw a189,v201
v_perm_b32 v200,v85,v84,s55
v_perm_b32 v201,v85,v84,s56
aw a158,v200
aw a190,v201
v_perm_b32 v200,v87,v86,s55
v_perm_b32 v201,v87,v86,s56
aw a159,v200
aw a191,v201
wt vmcnt(24)
v_add_u32 v199,0,v196
ds_read2_b32 v[72:73],v199 offset0:0 offset1:16
ds_read2_b32 v[74:75],v199 offset0:128 offset1:144
ds_read2_b32 v[76:77],v199 offset0:32 offset1:48
ds_read2_b32 v[78:79],v199 offset0:160 offset1:176
v_add_u32 v199,2048,v196
ds_read2_b32 v[80:81],v199 offset0:0 offset1:16
ds_read2_b32 v[82:83],v199 offset0:128 offset1:144
ds_read2_b32 v[84:85],v199 offset0:32 offset1:48
ds_read2_b32 v[86:87],v199 offset0:160 offset1:176
wt lgkmcnt(0)
s_load_dwordx2 s[36:37],s[0:1],8
s_lshl_b32 s28,s14,9
v_bfe_u32 v212,v1,2,2
v_lshlrev_b32 v212,12,v212
v_bfe_u32 v195,v1,0,1
v_lshl_add_u32 v212,v195,11,v212
v_bfe_u32 v195,v1,4,2
v_lshl_add_u32 v212,v195,5,v212
v_bfe_u32 v195,v1,1,1
v_lshl_add_u32 v212,v195,4,v212
wt lgkmcnt(0)
s_mov_b32 s32,s36
s_mov_b32 s33,s37
s_mov_b32 s34,16384
l4 v[228:231],v212,s[32:35],s28 offen offset:0
l4 v[232:235],v212,s[32:35],s28 offen offset:128
l4 v[236:239],v212,s[32:35],s28 offen offset:256
l4 v[240:243],v212,s[32:35],s28 offen offset:384
v_and_b32 v208,7,v1
v_lshlrev_b32 v208,5,v208
global_load_dwordx2 v[210:211],v208,s[16:17] sc1
v_perm_b32 v200,v73,v72,s55
v_perm_b32 v201,v73,v72,s56
aw a0,v200
aw a32,v201
v_perm_b32 v200,v75,v74,s55
v_perm_b32 v201,v75,v74,s56
aw a1,v200
aw a33,v201
v_perm_b32 v200,v77,v76,s55
v_perm_b32 v201,v77,v76,s56
aw a2,v200
aw a34,v201
v_perm_b32 v200,v79,v78,s55
v_perm_b32 v201,v79,v78,s56
aw a3,v200
aw a35,v201
v_perm_b32 v200,v81,v80,s55
v_perm_b32 v201,v81,v80,s56
aw a4,v200
aw a36,v201
v_perm_b32 v200,v83,v82,s55
v_perm_b32 v201,v83,v82,s56
aw a5,v200
aw a37,v201
v_perm_b32 v200,v85,v84,s55
v_perm_b32 v201,v85,v84,s56
aw a6,v200
aw a38,v201
v_perm_b32 v200,v87,v86,s55
v_perm_b32 v201,v87,v86,s56
aw a7,v200
aw a39,v201
v_add_u32 v199,4096,v196
ds_read2_b32 v[72:73],v199 offset0:0 offset1:16
ds_read2_b32 v[74:75],v199 offset0:128 offset1:144
ds_read2_b32 v[76:77],v199 offset0:32 offset1:48
ds_read2_b32 v[78:79],v199 offset0:160 offset1:176
v_add_u32 v199,6144,v196
ds_read2_b32 v[80:81],v199 offset0:0 offset1:16
ds_read2_b32 v[82:83],v199 offset0:128 offset1:144
ds_read2_b32 v[84:85],v199 offset0:32 offset1:48
ds_read2_b32 v[86:87],v199 offset0:160 offset1:176
wt lgkmcnt(0)
v_perm_b32 v200,v73,v72,s55
v_perm_b32 v201,v73,v72,s56
aw a8,v200
aw a40,v201
v_perm_b32 v200,v75,v74,s55
v_perm_b32 v201,v75,v74,s56
aw a9,v200
aw a41,v201
v_perm_b32 v200,v77,v76,s55
v_perm_b32 v201,v77,v76,s56
aw a10,v200
aw a42,v201
v_perm_b32 v200,v79,v78,s55
v_perm_b32 v201,v79,v78,s56
aw a11,v200
aw a43,v201
v_perm_b32 v200,v81,v80,s55
v_perm_b32 v201,v81,v80,s56
aw a12,v200
aw a44,v201
v_perm_b32 v200,v83,v82,s55
v_perm_b32 v201,v83,v82,s56
aw a13,v200
aw a45,v201
v_perm_b32 v200,v85,v84,s55
v_perm_b32 v201,v85,v84,s56
aw a14,v200
aw a46,v201
v_perm_b32 v200,v87,v86,s55
v_perm_b32 v201,v87,v86,s56
aw a15,v200
aw a47,v201
wt vmcnt(21)
v_add_u32 v199,8192,v196
ds_read2_b32 v[72:73],v199 offset0:0 offset1:16
ds_read2_b32 v[74:75],v199 offset0:128 offset1:144
ds_read2_b32 v[76:77],v199 offset0:32 offset1:48
ds_read2_b32 v[78:79],v199 offset0:160 offset1:176
v_add_u32 v199,10240,v196
ds_read2_b32 v[80:81],v199 offset0:0 offset1:16
ds_read2_b32 v[82:83],v199 offset0:128 offset1:144
ds_read2_b32 v[84:85],v199 offset0:32 offset1:48
ds_read2_b32 v[86:87],v199 offset0:160 offset1:176
wt lgkmcnt(0)
v_perm_b32 v200,v73,v72,s55
v_perm_b32 v201,v73,v72,s56
aw a16,v200
aw a48,v201
v_perm_b32 v200,v75,v74,s55
v_perm_b32 v201,v75,v74,s56
aw a17,v200
aw a49,v201
v_perm_b32 v200,v77,v76,s55
v_perm_b32 v201,v77,v76,s56
aw a18,v200
aw a50,v201
v_perm_b32 v200,v79,v78,s55
v_perm_b32 v201,v79,v78,s56
aw a19,v200
aw a51,v201
v_perm_b32 v200,v81,v80,s55
v_perm_b32 v201,v81,v80,s56
aw a20,v200
aw a52,v201
v_perm_b32 v200,v83,v82,s55
v_perm_b32 v201,v83,v82,s56
aw a21,v200
aw a53,v201
v_perm_b32 v200,v85,v84,s55
v_perm_b32 v201,v85,v84,s56
aw a22,v200
aw a54,v201
v_perm_b32 v200,v87,v86,s55
v_perm_b32 v201,v87,v86,s56
aw a23,v200
aw a55,v201
v_add_u32 v199,12288,v196
ds_read2_b32 v[72:73],v199 offset0:0 offset1:16
ds_read2_b32 v[74:75],v199 offset0:128 offset1:144
ds_read2_b32 v[76:77],v199 offset0:32 offset1:48
ds_read2_b32 v[78:79],v199 offset0:160 offset1:176
v_add_u32 v199,14336,v196
ds_read2_b32 v[80:81],v199 offset0:0 offset1:16
ds_read2_b32 v[82:83],v199 offset0:128 offset1:144
ds_read2_b32 v[84:85],v199 offset0:32 offset1:48
ds_read2_b32 v[86:87],v199 offset0:160 offset1:176
wt lgkmcnt(0)
v_perm_b32 v200,v73,v72,s55
v_perm_b32 v201,v73,v72,s56
aw a24,v200
aw a56,v201
v_perm_b32 v200,v75,v74,s55
v_perm_b32 v201,v75,v74,s56
aw a25,v200
aw a57,v201
v_perm_b32 v200,v77,v76,s55
v_perm_b32 v201,v77,v76,s56
aw a26,v200
aw a58,v201
v_perm_b32 v200,v79,v78,s55
v_perm_b32 v201,v79,v78,s56
aw a27,v200
aw a59,v201
v_perm_b32 v200,v81,v80,s55
v_perm_b32 v201,v81,v80,s56
aw a28,v200
aw a60,v201
v_perm_b32 v200,v83,v82,s55
v_perm_b32 v201,v83,v82,s56
aw a29,v200
aw a61,v201
v_perm_b32 v200,v85,v84,s55
v_perm_b32 v201,v85,v84,s56
aw a30,v200
aw a62,v201
v_perm_b32 v200,v87,v86,s55
v_perm_b32 v201,v87,v86,s56
aw a31,v200
aw a63,v201
wt vmcnt(13)
v_add_u32 v199,16384,v198
ds_read2_b64 v[72:75],v199 offset0:0 offset1:16
ds_read2_b64 v[76:79],v199 offset0:32 offset1:48
v_add_u32 v199,18432,v198
ds_read2_b64 v[80:83],v199 offset0:0 offset1:16
ds_read2_b64 v[84:87],v199 offset0:32 offset1:48
wt lgkmcnt(0)
v_perm_b32 v200,v74,v72,s55
v_perm_b32 v201,v74,v72,s56
v_perm_b32 v202,v75,v73,s55
v_perm_b32 v203,v75,v73,s56
aw a192,v200
aw a208,v201
aw a224,v202
aw a240,v203
v_perm_b32 v200,v78,v76,s55
v_perm_b32 v201,v78,v76,s56
v_perm_b32 v202,v79,v77,s55
v_perm_b32 v203,v79,v77,s56
aw a193,v200
aw a209,v201
aw a225,v202
aw a241,v203
v_perm_b32 v200,v82,v80,s55
v_perm_b32 v201,v82,v80,s56
v_perm_b32 v202,v83,v81,s55
v_perm_b32 v203,v83,v81,s56
aw a194,v200
aw a210,v201
aw a226,v202
aw a242,v203
v_perm_b32 v200,v86,v84,s55
v_perm_b32 v201,v86,v84,s56
v_perm_b32 v202,v87,v85,s55
v_perm_b32 v203,v87,v85,s56
aw a195,v200
aw a211,v201
aw a227,v202
aw a243,v203
v_add_u32 v199,20480,v198
ds_read2_b64 v[72:75],v199 offset0:0 offset1:16
ds_read2_b64 v[76:79],v199 offset0:32 offset1:48
v_add_u32 v199,22528,v198
ds_read2_b64 v[80:83],v199 offset0:0 offset1:16
ds_read2_b64 v[84:87],v199 offset0:32 offset1:48
wt lgkmcnt(0)
v_perm_b32 v200,v74,v72,s55
v_perm_b32 v201,v74,v72,s56
v_perm_b32 v202,v75,v73,s55
v_perm_b32 v203,v75,v73,s56
aw a196,v200
aw a212,v201
aw a228,v202
aw a244,v203
v_perm_b32 v200,v78,v76,s55
v_perm_b32 v201,v78,v76,s56
v_perm_b32 v202,v79,v77,s55
v_perm_b32 v203,v79,v77,s56
aw a197,v200
aw a213,v201
aw a229,v202
aw a245,v203
v_perm_b32 v200,v82,v80,s55
v_perm_b32 v201,v82,v80,s56
v_perm_b32 v202,v83,v81,s55
v_perm_b32 v203,v83,v81,s56
aw a198,v200
aw a214,v201
aw a230,v202
aw a246,v203
v_perm_b32 v200,v86,v84,s55
v_perm_b32 v201,v86,v84,s56
v_perm_b32 v202,v87,v85,s55
v_perm_b32 v203,v87,v85,s56
aw a199,v200
aw a215,v201
aw a231,v202
aw a247,v203
wt vmcnt(5)
s_cmp_lg_u32 s4,0
s_cbranch_scc1 RV_ok
s_branch RV_1
RV:
v_and_b32 v208,7,v1
v_lshlrev_b32 v208,5,v208
global_load_dwordx2 v[210:211],v208,s[16:17] sc1
RV_1:
s_sub_u32 s15,s15,1
s_max_i32 s15,s15,0
s_mov_b32 s36,0
wt vmcnt(0)
v_readlane_b32 s37,v211,0
s_nop 0
s_lshr_b32 s37,s37,8
s_add_u32 s36,s36,s37
v_readlane_b32 s37,v211,1
s_nop 0
s_lshr_b32 s37,s37,8
s_add_u32 s36,s36,s37
v_readlane_b32 s37,v211,2
s_nop 0
s_lshr_b32 s37,s37,8
s_add_u32 s36,s36,s37
v_readlane_b32 s37,v211,3
s_nop 0
s_lshr_b32 s37,s37,8
s_add_u32 s36,s36,s37
v_readlane_b32 s37,v211,4
s_nop 0
s_lshr_b32 s37,s37,8
s_add_u32 s36,s36,s37
v_readlane_b32 s37,v211,5
s_nop 0
s_lshr_b32 s37,s37,8
s_add_u32 s36,s36,s37
v_readlane_b32 s37,v211,6
s_nop 0
s_lshr_b32 s37,s37,8
s_add_u32 s36,s36,s37
v_readlane_b32 s37,v211,7
s_nop 0
s_lshr_b32 s37,s37,8
s_add_u32 s36,s36,s37
s_and_b32 s37,s36,0x3ff
s_cmp_ge_u32 s37,256
s_cbranch_scc1 RV_all
s_cmp_eq_u32 s15,0
s_cbranch_scc1 RV_all
s_sleep 2
s_branch RV
RV_all:
s_mov_b32 s4,1
s_lshr_b32 s36,s36,10
s_cmp_gt_u32 s36,512
s_cselect_b32 s5,1,0
s_xor_b32 s7,s5,1
s_lshl_b32 s7,s7,13
v_bfe_u32 v209,v211,8,10
v_cmp_ne_u32 s[38:39],32,v209
v_and_b32 v209,0xff,v211
v_cmp_ne_u32 s[40:41],0,v209
v_cmp_ne_u32 vcc,-1,v210
s_or_b64 s[40:41],s[40:41],s[38:39]
s_or_b64 vcc,vcc,s[40:41]
s_cbranch_vccz RV_ok
v_mov_b32 v208,163784
wt vmcnt(0) lgkmcnt(0)
s_cmp_eq_u32 s99,1
s_cbranch_scc0 RV_t
s_mov_b64 exec,1
ds_write_b32 v208,v255
s_mov_b64 exec,-1
wt lgkmcnt(0)
RV_t:
s_barrier
ds_read_b32 v209,v208
wt lgkmcnt(0)
v_readfirstlane_b32 s13,v209
s_nop 0
s_bfe_u32 s13,s13,0x50008
s_cmp_eq_u64 s[38:39],0
s_cbranch_scc1 L_role
s_mov_b32 s3,1
s_and_b32 s12,s2,7
s_lshr_b32 s13,s2,3
s_branch L_role
RV_ok:
s_lshl_b32 s36,s12,16
s_lshl_b32 s37,s13,11
s_add_u32 s36,s36,s37
s_add_u32 s36,s36,2162688
v_bfe_u32 v226,v1,0,4
v_lshlrev_b32 v226,7,v226
v_add_u32 v226,s36,v226
s_lshl_b32 s36,s12,14
s_lshl_b32 s37,s13,9
s_add_u32 s36,s36,s37
s_add_u32 s36,s36,2097152
v_bfe_u32 v227,v1,0,2
v_lshlrev_b32 v227,7,v227
v_add_u32 v227,s36,v227
v_cmp_gt_u32 vcc,16,v1
s_nop 1
v_cndmask_b32 v226,v227,v226,vcc
s_lshl_b32 s36,s14,19
v_add_u32 v226,s36,v226
s_lshl_b32 s36,s12,12
s_lshl_b32 s37,s13,7
s_add_u32 s36,s36,s37
s_add_u32 s36,s36,2424832
v_writelane_b32 v226,s36,20
s_bfm_b64 exec,21,0
buffer_load_dword v227,v226,s[8:11],0 offen sc1
s_mov_b64 exec,-1
s_lshl_b32 s19,s20,8
s_add_u32 s19,s19,4227072
v_mov_b32 v224,0
buffer_load_dword v225,v224,s[8:11],s19 offen sc1
v_add_u32 v199,24576,v198
ds_read2_b64 v[72:75],v199 offset0:0 offset1:16
ds_read2_b64 v[76:79],v199 offset0:32 offset1:48
v_add_u32 v199,26624,v198
ds_read2_b64 v[80:83],v199 offset0:0 offset1:16
ds_read2_b64 v[84:87],v199 offset0:32 offset1:48
wt lgkmcnt(0)
v_perm_b32 v200,v74,v72,s55
v_perm_b32 v201,v74,v72,s56
v_perm_b32 v202,v75,v73,s55
v_perm_b32 v203,v75,v73,s56
aw a200,v200
aw a216,v201
aw a232,v202
aw a248,v203
v_perm_b32 v200,v78,v76,s55
v_perm_b32 v201,v78,v76,s56
v_perm_b32 v202,v79,v77,s55
v_perm_b32 v203,v79,v77,s56
aw a201,v200
aw a217,v201
aw a233,v202
aw a249,v203
v_perm_b32 v200,v82,v80,s55
v_perm_b32 v201,v82,v80,s56
v_perm_b32 v202,v83,v81,s55
v_perm_b32 v203,v83,v81,s56
aw a202,v200
aw a218,v201
aw a234,v202
aw a250,v203
v_perm_b32 v200,v86,v84,s55
v_perm_b32 v201,v86,v84,s56
v_perm_b32 v202,v87,v85,s55
v_perm_b32 v203,v87,v85,s56
aw a203,v200
aw a219,v201
aw a235,v202
aw a251,v203
v_add_u32 v199,28672,v198
ds_read2_b64 v[72:75],v199 offset0:0 offset1:16
ds_read2_b64 v[76:79],v199 offset0:32 offset1:48
v_add_u32 v199,30720,v198
ds_read2_b64 v[80:83],v199 offset0:0 offset1:16
ds_read2_b64 v[84:87],v199 offset0:32 offset1:48
wt lgkmcnt(0)
v_perm_b32 v200,v74,v72,s55
v_perm_b32 v201,v74,v72,s56
v_perm_b32 v202,v75,v73,s55
v_perm_b32 v203,v75,v73,s56
aw a204,v200
aw a220,v201
aw a236,v202
aw a252,v203
v_perm_b32 v200,v78,v76,s55
v_perm_b32 v201,v78,v76,s56
v_perm_b32 v202,v79,v77,s55
v_perm_b32 v203,v79,v77,s56
aw a205,v200
aw a221,v201
aw a237,v202
aw a253,v203
v_perm_b32 v200,v82,v80,s55
v_perm_b32 v201,v82,v80,s56
v_perm_b32 v202,v83,v81,s55
v_perm_b32 v203,v83,v81,s56
aw a206,v200
aw a222,v201
aw a238,v202
aw a254,v203
v_perm_b32 v200,v86,v84,s55
v_perm_b32 v201,v86,v84,s56
v_perm_b32 v202,v87,v85,s55
v_perm_b32 v203,v87,v85,s56
aw a207,v200
aw a223,v201
aw a239,v202
aw a255,v203
s_barrier
s_mov_b32 s57,s5
s_cmp_lg_u32 s3,0
s_cbranch_scc1 L_Rslow
wt vmcnt(0)
R_kv0:
v_readfirstlane_b32 s18,v225
s_nop 0
s_and_b32 s36,s18,0xff
s_cmp_ge_u32 s36,8
s_cbranch_scc1 R_kv0k
s_cmp_eq_u32 s15,0
s_cbranch_scc1 R_kv0k
buffer_load_dword v225,v224,s[8:11],s19 offen sc1
s_sub_u32 s15,s15,1
s_max_i32 s15,s15,0
wt vmcnt(0)
s_branch R_kv0
R_kv0k:
s_xor_b32 s36,s7,0
v_xor_b32 v12,s36,v12
v_xor_b32 v13,s36,v13
s_xor_b32 s88,s88,s36
s_xor_b32 s89,s89,s36
s_bitcmp1_b32 s14,0
s_cselect_b32 s36,0,s36
v_xor_b32 v11,s36,v11
s_mov_b32 s29,0
l4 v[72:75],v12,s[8:11],s29 offen sc1
l4 v[76:79],v12,s[8:11],s29 offen offset:2048 sc1
l4 v[80:83],v13,s[8:11],s29 offen sc1
l4 v[84:87],v13,s[8:11],s29 offen offset:2048 sc1
l4 v[88:91],v12,s[8:11],s29 offen offset:128 sc1
l4 v[92:95],v12,s[8:11],s29 offen offset:2176 sc1
l4 v[96:99],v13,s[8:11],s29 offen offset:128 sc1
l4 v[100:103],v13,s[8:11],s29 offen offset:2176 sc1
l4 v[104:107],v11,s[8:11],s29 offen sc1
l4 v[108:111],v11,s[8:11],s29 offen offset:256 sc1
v_mov_b64 v[112:113],0
v_mov_b64 v[114:115],0
v_mov_b64 v[116:117],0
v_mov_b64 v[118:119],0
v_mov_b64 v[120:121],0
v_mov_b64 v[122:123],0
v_mov_b64 v[124:125],0
v_mov_b64 v[126:127],0
v_mov_b64 v[128:129],0
v_mov_b64 v[130:131],0
v_mov_b64 v[132:133],0
v_mov_b64 v[134:135],0
v_mov_b64 v[136:137],0
v_mov_b64 v[138:139],0
v_mov_b64 v[140:141],0
v_mov_b64 v[142:143],0
v_mov_b64 v[144:145],0
v_mov_b64 v[146:147],0
v_mov_b64 v[148:149],0
v_mov_b64 v[150:151],0
v_mov_b64 v[152:153],0
v_mov_b64 v[154:155],0
v_mov_b64 v[156:157],0
v_mov_b64 v[158:159],0
v_mov_b64 v[160:161],0
v_mov_b64 v[162:163],0
v_mov_b64 v[164:165],0
v_mov_b64 v[166:167],0
v_mov_b64 v[168:169],0
v_mov_b64 v[170:171],0
s_mov_b32 s29,524288
wt vmcnt(9)
mm v[188:191],v[72:75],a[192:195],0
mm v[192:195],v[72:75],a[208:211],0
mm v[196:199],v[72:75],a[224:227],0
mm v[200:203],v[72:75],a[240:243],0
l4 v[72:75],v12,s[8:11],s29 offen sc1
wt vmcnt(9)
mm v[188:191],v[76:79],a[196:199],v[188:191]
mm v[192:195],v[76:79],a[212:215],v[192:195]
mm v[196:199],v[76:79],a[228:231],v[196:199]
mm v[200:203],v[76:79],a[244:247],v[200:203]
l4 v[76:79],v12,s[8:11],s29 offen offset:2048 sc1
wt vmcnt(9)
mm v[188:191],v[80:83],a[200:203],v[188:191]
mm v[192:195],v[80:83],a[216:219],v[192:195]
mm v[196:199],v[80:83],a[232:235],v[196:199]
mm v[200:203],v[80:83],a[248:251],v[200:203]
l4 v[80:83],v13,s[8:11],s29 offen sc1
wt vmcnt(9)
mm v[188:191],v[84:87],a[204:207],v[188:191]
mm v[192:195],v[84:87],a[220:223],v[192:195]
mm v[196:199],v[84:87],a[236:239],v[196:199]
mm v[200:203],v[84:87],a[252:255],v[200:203]
l4 v[84:87],v13,s[8:11],s29 offen offset:2048 sc1
wt vmcnt(9)
mm v[204:207],v[88:91],a[192:195],0
mm v[208:211],v[88:91],a[208:211],0
mm v[212:215],v[88:91],a[224:227],0
mm v[216:219],v[88:91],a[240:243],0
l4 v[88:91],v12,s[8:11],s29 offen offset:128 sc1
wt vmcnt(9)
mm v[204:207],v[92:95],a[196:199],v[204:207]
mm v[208:211],v[92:95],a[212:215],v[208:211]
mm v[212:215],v[92:95],a[228:231],v[212:215]
mm v[216:219],v[92:95],a[244:247],v[216:219]
l4 v[92:95],v12,s[8:11],s29 offen offset:2176 sc1
wt vmcnt(9)
mm v[204:207],v[96:99],a[200:203],v[204:207]
mm v[208:211],v[96:99],a[216:219],v[208:211]
mm v[212:215],v[96:99],a[232:235],v[212:215]
mm v[216:219],v[96:99],a[248:251],v[216:219]
l4 v[96:99],v13,s[8:11],s29 offen offset:128 sc1
wt vmcnt(9)
mm v[204:207],v[100:103],a[204:207],v[204:207]
mm v[208:211],v[100:103],a[220:223],v[208:211]
mm v[212:215],v[100:103],a[236:239],v[212:215]
mm v[216:219],v[100:103],a[252:255],v[216:219]
l4 v[100:103],v13,s[8:11],s29 offen offset:2176 sc1
cv v40,v188,v189
cv v41,v190,v191
cv v48,v192,v193
cv v49,v194,v195
cv v56,v196,v197
cv v57,v198,v199
cv v64,v200,v201
cv v65,v202,v203
cv v44,v204,v205
cv v45,v206,v207
cv v52,v208,v209
cv v53,v210,v211
cv v60,v212,v213
cv v61,v214,v215
cv v68,v216,v217
cv v69,v218,v219
v_mov_b64 v[188:189],v[228:229]
v_mov_b64 v[190:191],v[230:231]
v_mov_b64 v[192:193],v[232:233]
v_mov_b64 v[194:195],v[234:235]
v_mov_b64 v[196:197],v[236:237]
v_mov_b64 v[198:199],v[238:239]
v_mov_b64 v[200:201],v[240:241]
v_mov_b64 v[202:203],v[242:243]
s_mov_b32 s24,0
s_mov_b32 s25,0
s_mov_b32 s26,0x80000
s_mov_b32 s27,0x100000
s_mov_b32 s28,524288
s_mov_b32 s29,1048576
s_mov_b32 s30,1572864
s_mov_b32 s31,0
s_lshl_b32 s36,s57,13
v_add_u32 v9,s36,v9
v_add_u32 v10,s36,v10
v_mov_b32 v253,1
v_add_u32 v14,s36,v14
s_add_u32 s98,s98,s36
s_mov_b32 s97,1
v_mov_b32 v244,1
ds_write_b32 v245,v244
s_mov_b64 s[44:45],0
s_mov_b64 s[46:47],0
s_mov_b64 s[48:49],0
s_mov_b64 s[50:51],0
s_bitcmp1_b32 s14,0
s_cselect_b32 s37,s36,0
v_add_u32 v11,s37,v11
s_mov_b32 s86,1
wt lgkmcnt(0)
s_mov_b32 s58,0
s_cmp_eq_u32 s14,1
s_cbranch_scc1 R_cw01
s_cmp_eq_u32 s14,2
s_cbranch_scc1 R_cw02
s_cmp_eq_u32 s14,3
s_cbranch_scc1 R_cw03
s_branch R_cw00
R_cr00:
s_cmp_eq_u32 s58,0
s_cbranch_scc1 R_cg00
l4 v[188:191],v2,s[8:11],s25 offen sc1
l4 v[192:195],v2,s[8:11],s25 offen offset:1024 sc1
l4 v[196:199],v2,s[8:11],s25 offen offset:2048 sc1
l4 v[200:203],v2,s[8:11],s25 offen offset:3072 sc1
s_sub_u32 s15,s15,1
s_max_i32 s15,s15,0
s_mov_b32 s58,s15
v_mov_b64 v[112:113],0
v_mov_b64 v[114:115],0
v_mov_b64 v[116:117],0
v_mov_b64 v[118:119],0
v_mov_b64 v[120:121],0
v_mov_b64 v[122:123],0
v_mov_b64 v[124:125],0
v_mov_b64 v[126:127],0
v_mov_b64 v[128:129],0
v_mov_b64 v[130:131],0
v_mov_b64 v[132:133],0
v_mov_b64 v[134:135],0
s_branch R_cw00
R_cr10:
s_cmp_eq_u32 s58,0
s_cbranch_scc1 R_cg10
l4 v[192:195],v2,s[8:11],s25 offen offset:1024 sc1
l4 v[196:199],v2,s[8:11],s25 offen offset:2048 sc1
l4 v[200:203],v2,s[8:11],s25 offen offset:3072 sc1
s_sub_u32 s15,s15,1
s_max_i32 s15,s15,0
s_mov_b32 s58,s15
wt vmcnt(2)
v_max3_u32 v246,v192,v193,v194
v_max_u32 v246,v246,v195
v_cmp_eq_u32 vcc,-1,v246
s_cbranch_vccz R_cg10
s_branch R_cr10
R_cr20:
s_cmp_eq_u32 s58,0
s_cbranch_scc1 R_cg20
l4 v[196:199],v2,s[8:11],s25 offen offset:2048 sc1
l4 v[200:203],v2,s[8:11],s25 offen offset:3072 sc1
s_sub_u32 s15,s15,1
s_max_i32 s15,s15,0
s_mov_b32 s58,s15
wt vmcnt(1)
v_max3_u32 v246,v196,v197,v198
v_max_u32 v246,v246,v199
v_cmp_eq_u32 vcc,-1,v246
s_cbranch_vccz R_cg20
s_branch R_cr20
R_cr30:
s_cmp_eq_u32 s58,0
s_cbranch_scc1 R_cg30
l4 v[200:203],v2,s[8:11],s25 offen offset:3072 sc1
s_sub_u32 s15,s15,1
s_max_i32 s15,s15,0
s_mov_b32 s58,s15
wt vmcnt(0)
v_max3_u32 v246,v200,v201,v202
v_max_u32 v246,v246,v203
v_cmp_eq_u32 vcc,-1,v246
s_cbranch_vccz R_cg30
s_branch R_cr30
R_step0:
s_add_u32 s24,s24,1
s_add_u32 s86,s86,1
v_mov_b32 v253,s86
s_lshl_b32 s97,1,s24
v_mov_b32 v244,s97
s_mov_b32 s28,s29
s_mov_b32 s29,s30
s_add_u32 s30,s24,3
s_min_u32 s30,s30,63
s_lshl_b32 s30,s30,19
s_and_b32 s95,s30,0xffe00000
s_add_u32 s30,s30,s95
s_add_u32 s31,s31,0x10000
s_add_u32 s26,s26,0x80000
s_and_b32 s26,s26,0x180000
s_xor_b32 s27,s25,0x100000
s_mov_b32 s58,s15
v_mov_b64 v[136:137],0
v_mov_b64 v[138:139],0
v_mov_b64 v[140:141],0
v_mov_b64 v[142:143],0
v_mov_b64 v[144:145],0
v_mov_b64 v[146:147],0
v_mov_b64 v[148:149],0
v_mov_b64 v[150:151],0
v_mov_b64 v[152:153],0
v_mov_b64 v[154:155],0
v_mov_b64 v[156:157],0
v_mov_b64 v[158:159],0
v_mov_b64 v[160:161],0
v_mov_b64 v[162:163],0
v_mov_b64 v[164:165],0
v_mov_b64 v[166:167],0
v_mov_b64 v[168:169],0
v_mov_b64 v[170:171],0
cv v44,v204,v205
cv v45,v206,v207
cv v52,v208,v209
cv v53,v210,v211
cv v60,v212,v213
cv v61,v214,v215
cv v68,v216,v217
cv v69,v218,v219
s_nop 14
l4 v[188:191],v2,s[8:11],s25 offen sc1
s_nop 5
l4 v[192:195],v2,s[8:11],s25 offen offset:1024 sc1
s_nop 5
l4 v[196:199],v2,s[8:11],s25 offen offset:2048 sc1
s_nop 5
l4 v[200:203],v2,s[8:11],s25 offen offset:3072 sc1
R_cw00:
wt vmcnt(3)
ms v[128:131],v[188:191],a[128:135],v23
v_max3_u32 v246,v188,v189,v190
v_max_u32 v246,v246,v191
ms v[132:135],v[188:191],a[160:167],v23
v_cmp_eq_u32 vcc,-1,v246
ms v[112:115],v[188:191],a[0:7],v23
wt vmcnt(2)
v_max3_u32 v247,v192,v193,v194
ms v[116:119],v[188:191],a[32:39],v23
v_max_u32 v247,v247,v195
s_cbranch_vccnz R_cr00
R_cg00:
v_cmp_eq_u32 vcc,-1,v247
ms v[120:123],v[188:191],a[64:71],v23
ms v[124:127],v[188:191],a[96:103],v23
s_cbranch_vccnz R_cr10
R_cg10:
ms v[128:131],v[192:195],a[136:143],v23
wt vmcnt(1)
ms v[132:135],v[192:195],a[168:175],v23
v_max3_u32 v246,v196,v197,v198
ms v[112:115],v[192:195],a[8:15],v23
v_max_u32 v246,v246,v199
ms v[116:119],v[192:195],a[40:47],v23
v_cmp_eq_u32 vcc,-1,v246
ms v[120:123],v[192:195],a[72:79],v23
ms v[124:127],v[192:195],a[104:111],v23
s_cbranch_vccnz R_cr20
R_cg20:
ms v[128:131],v[196:199],a[144:151],v23
wt vmcnt(0)
ms v[132:135],v[196:199],a[176:183],v23
v_max3_u32 v246,v200,v201,v202
ms v[112:115],v[196:199],a[16:23],v23
v_max_u32 v246,v246,v203
ms v[116:119],v[196:199],a[48:55],v23
v_cmp_eq_u32 vcc,-1,v246
ms v[120:123],v[196:199],a[80:87],v23
ms v[124:127],v[196:199],a[112:119],v23
s_cbranch_vccnz R_cr30
R_cg30:
ms v[128:131],v[200:203],a[152:159],v23
ms v[132:135],v[200:203],a[184:191],v23
ms v[112:115],v[200:203],a[24:31],v23
pa v[228:229],v[128:129],v[130:131]
ms v[116:119],v[200:203],a[56:63],v23
pa v[230:231],v[132:133],v[134:135]
ms v[120:123],v[200:203],a[88:95],v23
ds_write2_b32 v17,v228,v230 offset0:0 offset1:1
ms v[124:127],v[200:203],a[120:127],v23
ds_write2_b32 v17,v229,v231 offset0:32 offset1:33
pa v[220:221],v[112:113],v[114:115]
pa v[222:223],v[116:117],v[118:119]
ds_write2_b32 v15,v220,v222 offset0:0 offset1:1
ds_write2_b32 v15,v221,v223 offset0:32 offset1:33
buffer_store_dword v253,v252,s[8:11],0 offen offset:0
pa v[224:225],v[120:121],v[122:123]
s_nop 0
pa v[226:227],v[124:125],v[126:127]
ds_write2_b32 v16,v224,v226 offset0:0 offset1:1
ds_write2_b32 v16,v225,v227 offset0:32 offset1:33
s_cmp_eq_u32 s24,63
wt lgkmcnt(4)
s_barrier
buffer_load_dword v248,v250,s[8:11],0 offen offset:1024 sc1
wt lgkmcnt(0)
s_barrier
dr v[188:191],v18 offset:0
dr v[192:195],v19 offset:0
dr v[196:199],v18 offset:1024
dr v[200:203],v19 offset:1024
dr v[204:207],v18 offset:2048
dr v[208:211],v19 offset:2048
dr v[212:215],v18 offset:3072
dr v[216:219],v19 offset:3072
buffer_load_dword v248,v250,s[8:11],0 offen offset:2048 sc1
wt lgkmcnt(4)
pa v[188:189],v[188:189],v[196:197]
pa v[190:191],v[190:191],v[198:199]
pa v[192:193],v[192:193],v[200:201]
pa v[194:195],v[194:195],v[202:203]
buffer_load_dword v248,v250,s[8:11],0 offen offset:3072 sc1
wt lgkmcnt(2)
pa v[188:189],v[188:189],v[204:205]
pa v[190:191],v[190:191],v[206:207]
pa v[192:193],v[192:193],v[208:209]
pa v[194:195],v[194:195],v[210:211]
wt lgkmcnt(1)
pa v[188:189],v[188:189],v[212:213]
pa v[190:191],v[190:191],v[214:215]
cv v172,v188,v189
cv v173,v190,v191
v_cmp_gt_i32 vcc,s86,v248
wt lgkmcnt(0)
pa v[192:193],v[192:193],v[216:217]
pa v[194:195],v[194:195],v[218:219]
cv v174,v192,v193
cv v175,v194,v195
s_cbranch_scc1 R_last0
buffer_load_dword v248,v250,s[8:11],0 offen sc1
mm v[224:227],v[104:107],v[172:175],0
l4 v[232:235],v6,s[8:11],s25 offen sc1
mm v[228:231],v[108:111],v[172:175],0
l4 v[236:239],v6,s[8:11],s25 offen offset:1024 sc1
mm v[220:223],v[172:175],v[172:175],0
buffer_load_dword v248,v250,s[8:11],0 offen offset:1024 sc1
cv v240,v224,v225
cv v241,v226,v227
s_nop 0
cv v242,v228,v229
cv v243,v230,v231
w4 v[240:243],v7,s[8:11],s25 offen offset:0
s_nop 0
cv v246,v220,v221
cv v247,v222,v223
buffer_store_dwordx2 v[246:247],v8,s[8:11],s25 offen offset:0
s_cbranch_vccnz R_nv0
v_mov_b64 v[112:113],0
v_mov_b64 v[114:115],0
v_mov_b64 v[116:117],0
v_mov_b64 v[118:119],0
v_mov_b64 v[120:121],0
v_mov_b64 v[122:123],0
v_mov_b64 v[124:125],0
v_mov_b64 v[126:127],0
v_mov_b64 v[128:129],0
v_mov_b64 v[130:131],0
v_mov_b64 v[132:133],0
v_mov_b64 v[134:135],0
s_nop 15
s_nop 1
R_nvj0:
l4 v[188:191],v4,s[8:11],s25 offen sc1
l4 v[192:195],v4,s[8:11],s25 offen offset:1024 sc1
buffer_load_dwordx2 v[196:197],v5,s[8:11],s25 offen sc1
wt vmcnt(3)
R_aw00:
ms v[136:139],v[232:235],a[192:199],v23
v_max3_u32 v246,v232,v233,v234
ms v[136:139],v[236:239],a[200:207],v23
v_max3_u32 v247,v235,v236,v237
ms v[140:143],v[232:235],a[208:215],v23
v_max3_u32 v246,v246,v238,v239
ms v[140:143],v[236:239],a[216:223],v23
v_max_u32 v246,v246,v247
ms v[144:147],v[232:235],a[224:231],v23
v_cmp_eq_u32 vcc,-1,v246
ms v[144:147],v[236:239],a[232:239],v23
pa v[136:137],v[136:137],v[138:139]
ms v[148:151],v[232:235],a[240:247],v23
cv v42,v136,v137
ms v[148:151],v[236:239],a[248:255],v23
s_cbranch_vccnz R_ar00
R_ag00:
cv v46,v136,v137
pa v[140:141],v[140:141],v[142:143]
wt vmcnt(2)
mm v[200:203],v[180:183],v[188:191],0
wt vmcnt(1)
mm v[200:203],v[184:187],v[192:195],v[200:203]
wt vmcnt(0)
mh v[240:243],v[26:27],v[196:197],0
cv v50,v140,v141
cv v54,v140,v141
pa v[144:145],v[144:145],v[146:147]
cv v58,v144,v145
cv v62,v144,v145
v_max3_f32 v198,v200,v201,v202
pa v[148:149],v[148:149],v[150:151]
cv v66,v148,v149
v_cmp_u_f32 vcc,v200,v240
v_max3_f32 v198,v198,v203,v240
R_ag10:
v_mul_f32 v224,s54,v203
cv v70,v148,v149
v_max_f32_dpp v198,v198,v198 quad_perm:[2,3,0,1] row_mask:0xf bank_mask:0xf
v_mul_f32 v199,s54,v198
v_mul_f32 v198,s54,v198
v_mul_f32 v220,s54,v200
v_mul_f32 v221,s54,v201
s_cbranch_vccnz R_ar10
R_ah10:
v_permlane16_swap_b32 v198,v199
v_max_f32 v246,v198,v199
v_max_f32 v247,v198,v199
ds_sub_rtn_u32 v226,v245,v28
v_mul_f32 v223,s54,v202
v_permlane32_swap_b32 v246,v247
v_max_f32 v198,v246,v247
v_sub_f32 v220,v220,v198
v_sub_f32 v221,v221,v198
v_exp_f32 v220,v220
v_mul_f32 v222,s54,v240
v_sub_f32 v222,v222,v198
v_exp_f32 v221,v221
v_sub_f32 v223,v223,v198
v_exp_f32 v222,v222
v_sub_f32 v224,v224,v198
v_exp_f32 v223,v223
cv v176,v220,v221
v_exp_f32 v224,v224
cv v177,v222,0
cv v179,v222,0
cv v178,v223,v224
wt lgkmcnt(0)
v_lshl_add_u32 v226,v226,30,v14
buffer_store_dword v244,v226,s[8:11],0 offen sc1
ms v[152:155],v[176:179],v[32:39],v24
l4 v[104:107],v11,s[8:11],s28 offen sc1
ms v[156:159],v[176:179],v[40:47],v24
l4 v[108:111],v11,s[8:11],s28 offen offset:256 sc1
ms v[160:163],v[176:179],v[48:55],v24
pa v[236:237],v[152:153],v[154:155]
ms v[164:167],v[176:179],v[56:63],v24
v_rcp_f32 v236,v236
ms v[168:171],v[176:179],v[64:71],v24
v_rcp_f32 v237,v237
pa v[156:157],v[156:157],v[158:159]
v_mul_f32 v228,v156,v236
v_mul_f32 v232,v157,v237
pa v[160:161],v[160:161],v[162:163]
v_mul_f32 v229,v160,v236
v_mul_f32 v233,v161,v237
pa v[164:165],v[164:165],v[166:167]
v_mul_f32 v230,v164,v236
v_mul_f32 v234,v165,v237
pa v[168:169],v[168:169],v[170:171]
v_mul_f32 v231,v168,v236
ds_write_b128 v20,v[228:231]
v_mul_f32 v235,v169,v237
ds_write_b128 v21,v[232:235] offset:256
l4 v[96:99],v13,s[8:11],s28 offen offset:128 sc1
l4 v[100:103],v13,s[8:11],s28 offen offset:2176 sc1
w4 v[172:175],v25,s[8:11],s31 offen sc1
wt lgkmcnt(0)
s_barrier
dr v[220:223],v22 offset:0
dr v[224:227],v22 offset:2048
dr v[228:231],v22 offset:4096
dr v[232:235],v22 offset:6144
wt lgkmcnt(2)
pa v[220:221],v[220:221],v[224:225]
pa v[222:223],v[222:223],v[226:227]
wt lgkmcnt(1)
pa v[220:221],v[220:221],v[228:229]
pa v[222:223],v[222:223],v[230:231]
wt lgkmcnt(0)
pa v[220:221],v[220:221],v[232:233]
pa v[222:223],v[222:223],v[234:235]
cv v224,v220,v221
cv v225,v222,v223
buffer_store_dwordx2 v[224:225],v9,s[8:11],s25 offen sc1
mm v[188:191],v[72:75],a[192:195],0
mm v[192:195],v[72:75],a[208:211],0
mm v[196:199],v[72:75],a[224:227],0
mm v[200:203],v[72:75],a[240:243],0
l4 v[72:75],v12,s[8:11],s29 offen sc1
mm v[188:191],v[76:79],a[196:199],v[188:191]
mm v[192:195],v[76:79],a[212:215],v[192:195]
mm v[196:199],v[76:79],a[228:231],v[196:199]
mm v[200:203],v[76:79],a[244:247],v[200:203]
l4 v[76:79],v12,s[8:11],s29 offen offset:2048 sc1
mm v[188:191],v[80:83],a[200:203],v[188:191]
mm v[192:195],v[80:83],a[216:219],v[192:195]
mm v[196:199],v[80:83],a[232:235],v[196:199]
mm v[200:203],v[80:83],a[248:251],v[200:203]
l4 v[80:83],v13,s[8:11],s29 offen sc1
s_barrier
s_nop 3
l4 v[236:239],v10,s[8:11],s25 offen sc1
mm v[188:191],v[84:87],a[204:207],v[188:191]
mm v[192:195],v[84:87],a[220:223],v[192:195]
mm v[196:199],v[84:87],a[236:239],v[196:199]
mm v[200:203],v[84:87],a[252:255],v[200:203]
l4 v[84:87],v13,s[8:11],s29 offen offset:2048 sc1
mm v[204:207],v[88:91],a[192:195],0
mm v[208:211],v[88:91],a[208:211],0
cv v40,v188,v189
mm v[212:215],v[88:91],a[224:227],0
cv v41,v190,v191
mm v[216:219],v[88:91],a[240:243],0
cv v48,v192,v193
l4 v[88:91],v12,s[8:11],s29 offen offset:128 sc1
mm v[204:207],v[92:95],a[196:199],v[204:207]
cv v49,v194,v195
mm v[208:211],v[92:95],a[212:215],v[208:211]
cv v56,v196,v197
mm v[212:215],v[92:95],a[228:231],v[212:215]
cv v57,v198,v199
mm v[216:219],v[92:95],a[244:247],v[216:219]
cv v64,v200,v201
l4 v[92:95],v12,s[8:11],s29 offen offset:2176 sc1
wt vmcnt(9)
mm v[204:207],v[96:99],a[200:203],v[204:207]
cv v65,v202,v203
mm v[208:211],v[96:99],a[216:219],v[208:211]
mm v[212:215],v[96:99],a[232:235],v[212:215]
mm v[216:219],v[96:99],a[248:251],v[216:219]
mm v[204:207],v[100:103],a[204:207],v[204:207]
mm v[208:211],v[100:103],a[220:223],v[208:211]
mm v[212:215],v[100:103],a[236:239],v[212:215]
mm v[216:219],v[100:103],a[252:255],v[216:219]
s_mov_b32 s59,s25
s_mov_b32 s25,s26
wt vmcnt(3)
mm v[228:231],v[180:183],v[236:239],0
s_add_u32 s36,s88,s30
s_buffer_load_dwordx2 s[100:101],s[8:11],s36 offset:60
s_buffer_load_dwordx2 s[100:101],s[8:11],s36 offset:188
s_buffer_load_dwordx2 s[100:101],s[8:11],s36 offset:316
s_buffer_load_dwordx2 s[100:101],s[8:11],s36 offset:444
s_nop 2
v_cmp_u_f32 vcc,v228,v228
v_add_f32_dpp v228,v228,v228 row_ror:8 row_mask:0xf bank_mask:0xf
v_add_f32_dpp v229,v229,v229 row_ror:8 row_mask:0xf bank_mask:0xf
v_add_f32_dpp v230,v230,v230 row_ror:8 row_mask:0xf bank_mask:0xf
v_add_f32_dpp v231,v231,v231 row_ror:8 row_mask:0xf bank_mask:0xf
cv v232,v228,v229
cv v233,v230,v231
s_cbranch_vccnz R_br0
R_bg0:
buffer_store_dwordx2 v[232:233],v3,s[8:11],s25 offen offset:0
s_branch R_step0
R_last0:
w4 v[172:175],v25,s[8:11],s31 offen sc1
s_branch R_fin
R_nv0:
v_cmp_gt_i32 vcc,s86,v248
buffer_load_dword v248,v250,s[8:11],0 offen offset:2048 sc1
s_cbranch_vccnz R_nw0
l4 v[232:235],v6,s[8:11],s25 offen sc1
l4 v[236:239],v6,s[8:11],s25 offen offset:1024 sc1
v_mov_b64 v[112:113],0
v_mov_b64 v[114:115],0
v_mov_b64 v[116:117],0
v_mov_b64 v[118:119],0
v_mov_b64 v[120:121],0
v_mov_b64 v[122:123],0
v_mov_b64 v[124:125],0
v_mov_b64 v[126:127],0
v_mov_b64 v[128:129],0
v_mov_b64 v[130:131],0
v_mov_b64 v[132:133],0
v_mov_b64 v[134:135],0
s_nop 15
s_nop 1
s_branch R_nvj0
R_nw0:
s_mov_b64 exec,0xffff
s_min_u32 s94,s15,1000
R_fa0:
v_cmp_gt_i32 vcc,s86,v248
buffer_load_dword v248,v250,s[8:11],0 offen offset:3072 sc1
s_cbranch_vccz R_fa0_ok
v_cmp_gt_i32 vcc,s86,v248
s_cbranch_vccz R_fa0_ok
v_cmp_gt_i32 vcc,s86,v248
s_cbranch_vccz R_fa0_ok
v_cmp_gt_i32 vcc,s86,v248
buffer_load_dword v248,v250,s[8:11],0 offen sc1
s_cbranch_vccz R_fa0_ok
v_cmp_gt_i32 vcc,s86,v248
s_cbranch_vccz R_fa0_ok
v_cmp_gt_i32 vcc,s86,v248
s_cbranch_vccz R_fa0_ok
v_cmp_gt_i32 vcc,s86,v248
buffer_load_dword v248,v250,s[8:11],0 offen offset:1024 sc1
s_cbranch_vccz R_fa0_ok
v_cmp_gt_i32 vcc,s86,v248
s_cbranch_vccz R_fa0_ok
v_cmp_gt_i32 vcc,s86,v248
s_cbranch_vccz R_fa0_ok
v_cmp_gt_i32 vcc,s86,v248
buffer_load_dword v248,v250,s[8:11],0 offen offset:2048 sc1
s_cbranch_vccz R_fa0_ok
v_cmp_gt_i32 vcc,s86,v248
s_cbranch_vccz R_fa0_ok
v_cmp_gt_i32 vcc,s86,v248
s_cbranch_vccz R_fa0_ok
s_sub_u32 s94,s94,1
s_cbranch_scc0 R_fa0
R_fa0_ok:
s_mov_b64 exec,-1
l4 v[232:235],v6,s[8:11],s25 offen sc1
l4 v[236:239],v6,s[8:11],s25 offen offset:1024 sc1
v_mov_b64 v[112:113],0
v_mov_b64 v[114:115],0
v_mov_b64 v[116:117],0
v_mov_b64 v[118:119],0
v_mov_b64 v[120:121],0
v_mov_b64 v[122:123],0
v_mov_b64 v[124:125],0
v_mov_b64 v[126:127],0
v_mov_b64 v[128:129],0
v_mov_b64 v[130:131],0
v_mov_b64 v[132:133],0
v_mov_b64 v[134:135],0
s_nop 15
s_nop 15
s_branch R_nvj0
R_ar00:
s_cmp_eq_u32 s15,0
s_cbranch_scc1 R_ag00
l4 v[232:235],v6,s[8:11],s25 offen sc1
l4 v[236:239],v6,s[8:11],s25 offen offset:1024 sc1
l4 v[188:191],v4,s[8:11],s25 offen sc1
l4 v[192:195],v4,s[8:11],s25 offen offset:1024 sc1
buffer_load_dwordx2 v[196:197],v5,s[8:11],s25 offen sc1
s_sub_u32 s15,s15,1
s_max_i32 s15,s15,0
v_mov_b64 v[136:137],0
v_mov_b64 v[138:139],0
v_mov_b64 v[140:141],0
v_mov_b64 v[142:143],0
v_mov_b64 v[144:145],0
v_mov_b64 v[146:147],0
v_mov_b64 v[148:149],0
v_mov_b64 v[150:151],0
wt vmcnt(0)
s_branch R_aw00
R_ar10:
s_cmp_eq_u32 s15,0
s_cbranch_scc1 R_ah10
l4 v[188:191],v4,s[8:11],s25 offen sc1
l4 v[192:195],v4,s[8:11],s25 offen offset:1024 sc1
buffer_load_dwordx2 v[196:197],v5,s[8:11],s25 offen sc1
s_sub_u32 s15,s15,1
s_max_i32 s15,s15,0
wt vmcnt(2)
mm v[200:203],v[180:183],v[188:191],0
wt vmcnt(1)
mm v[200:203],v[184:187],v[192:195],v[200:203]
wt vmcnt(0)
mh v[240:243],v[26:27],v[196:197],0
s_nop 3
v_max3_f32 v198,v200,v201,v202
s_nop 2
v_cmp_u_f32 vcc,v200,v240
v_max3_f32 v198,v198,v203,v240
s_branch R_ag10
R_br0:
R_br20:
s_cmp_eq_u32 s15,0
s_cbranch_scc1 R_bg0
l4 v[236:239],v10,s[8:11],s59 offen sc1
R_br30:
s_sub_u32 s15,s15,1
s_max_i32 s15,s15,0
wt vmcnt(0)
mm v[228:231],v[180:183],v[236:239],0
s_nop 7
v_cmp_u_f32 vcc,v228,v228
v_add_f32_dpp v228,v228,v228 row_ror:8 row_mask:0xf bank_mask:0xf
v_add_f32_dpp v229,v229,v229 row_ror:8 row_mask:0xf bank_mask:0xf
v_add_f32_dpp v230,v230,v230 row_ror:8 row_mask:0xf bank_mask:0xf
v_add_f32_dpp v231,v231,v231 row_ror:8 row_mask:0xf bank_mask:0xf
cv v232,v228,v229
cv v233,v230,v231
s_cbranch_vccz R_bg0
s_branch R_br20
R_cr01:
s_cmp_eq_u32 s58,0
s_cbranch_scc1 R_cg01
l4 v[188:191],v2,s[8:11],s25 offen sc1
l4 v[192:195],v2,s[8:11],s25 offen offset:1024 sc1
l4 v[196:199],v2,s[8:11],s25 offen offset:2048 sc1
l4 v[200:203],v2,s[8:11],s25 offen offset:3072 sc1
s_sub_u32 s15,s15,1
s_max_i32 s15,s15,0
s_mov_b32 s58,s15
v_mov_b64 v[112:113],0
v_mov_b64 v[114:115],0
v_mov_b64 v[116:117],0
v_mov_b64 v[118:119],0
v_mov_b64 v[120:121],0
v_mov_b64 v[122:123],0
v_mov_b64 v[124:125],0
v_mov_b64 v[126:127],0
v_mov_b64 v[128:129],0
v_mov_b64 v[130:131],0
v_mov_b64 v[132:133],0
v_mov_b64 v[134:135],0
s_branch R_cw01
R_cr11:
s_cmp_eq_u32 s58,0
s_cbranch_scc1 R_cg11
l4 v[192:195],v2,s[8:11],s25 offen offset:1024 sc1
l4 v[196:199],v2,s[8:11],s25 offen offset:2048 sc1
l4 v[200:203],v2,s[8:11],s25 offen offset:3072 sc1
s_sub_u32 s15,s15,1
s_max_i32 s15,s15,0
s_mov_b32 s58,s15
wt vmcnt(2)
v_max3_u32 v246,v192,v193,v194
v_max_u32 v246,v246,v195
v_cmp_eq_u32 vcc,-1,v246
s_cbranch_vccz R_cg11
s_branch R_cr11
R_cr21:
s_cmp_eq_u32 s58,0
s_cbranch_scc1 R_cg21
l4 v[196:199],v2,s[8:11],s25 offen offset:2048 sc1
l4 v[200:203],v2,s[8:11],s25 offen offset:3072 sc1
s_sub_u32 s15,s15,1
s_max_i32 s15,s15,0
s_mov_b32 s58,s15
wt vmcnt(1)
v_max3_u32 v246,v196,v197,v198
v_max_u32 v246,v246,v199
v_cmp_eq_u32 vcc,-1,v246
s_cbranch_vccz R_cg21
s_branch R_cr21
R_cr31:
s_cmp_eq_u32 s58,0
s_cbranch_scc1 R_cg31
l4 v[200:203],v2,s[8:11],s25 offen offset:3072 sc1
s_sub_u32 s15,s15,1
s_max_i32 s15,s15,0
s_mov_b32 s58,s15
wt vmcnt(0)
v_max3_u32 v246,v200,v201,v202
v_max_u32 v246,v246,v203
v_cmp_eq_u32 vcc,-1,v246
s_cbranch_vccz R_cg31
s_branch R_cr31
R_step1:
s_add_u32 s24,s24,1
s_add_u32 s86,s86,1
v_mov_b32 v253,s86
s_lshl_b32 s97,1,s24
v_mov_b32 v244,s97
s_mov_b32 s28,s29
s_mov_b32 s29,s30
s_add_u32 s30,s24,3
s_min_u32 s30,s30,63
s_lshl_b32 s30,s30,19
s_and_b32 s95,s30,0xffe00000
s_add_u32 s30,s30,s95
s_add_u32 s31,s31,0x10000
s_add_u32 s26,s26,0x80000
s_and_b32 s26,s26,0x180000
s_xor_b32 s27,s25,0x100000
s_mov_b32 s58,s15
v_mov_b64 v[136:137],0
v_mov_b64 v[138:139],0
v_mov_b64 v[140:141],0
v_mov_b64 v[142:143],0
v_mov_b64 v[144:145],0
v_mov_b64 v[146:147],0
v_mov_b64 v[148:149],0
v_mov_b64 v[150:151],0
v_mov_b64 v[152:153],0
v_mov_b64 v[154:155],0
v_mov_b64 v[156:157],0
v_mov_b64 v[158:159],0
v_mov_b64 v[160:161],0
v_mov_b64 v[162:163],0
v_mov_b64 v[164:165],0
v_mov_b64 v[166:167],0
v_mov_b64 v[168:169],0
v_mov_b64 v[170:171],0
cv v44,v204,v205
cv v45,v206,v207
cv v52,v208,v209
cv v53,v210,v211
cv v60,v212,v213
cv v61,v214,v215
cv v68,v216,v217
cv v69,v218,v219
s_nop 14
l4 v[188:191],v2,s[8:11],s25 offen sc1
s_nop 5
l4 v[192:195],v2,s[8:11],s25 offen offset:1024 sc1
s_nop 5
l4 v[196:199],v2,s[8:11],s25 offen offset:2048 sc1
s_nop 5
l4 v[200:203],v2,s[8:11],s25 offen offset:3072 sc1
R_cw01:
wt vmcnt(3)
ms v[128:131],v[188:191],a[128:135],v23
v_max3_u32 v246,v188,v189,v190
v_max_u32 v246,v246,v191
ms v[132:135],v[188:191],a[160:167],v23
v_cmp_eq_u32 vcc,-1,v246
ms v[112:115],v[188:191],a[0:7],v23
wt vmcnt(2)
v_max3_u32 v247,v192,v193,v194
ms v[116:119],v[188:191],a[32:39],v23
v_max_u32 v247,v247,v195
s_cbranch_vccnz R_cr01
R_cg01:
v_cmp_eq_u32 vcc,-1,v247
ms v[120:123],v[188:191],a[64:71],v23
ms v[124:127],v[188:191],a[96:103],v23
s_cbranch_vccnz R_cr11
R_cg11:
ms v[128:131],v[192:195],a[136:143],v23
wt vmcnt(1)
ms v[132:135],v[192:195],a[168:175],v23
v_max3_u32 v246,v196,v197,v198
ms v[112:115],v[192:195],a[8:15],v23
v_max_u32 v246,v246,v199
ms v[116:119],v[192:195],a[40:47],v23
v_cmp_eq_u32 vcc,-1,v246
ms v[120:123],v[192:195],a[72:79],v23
ms v[124:127],v[192:195],a[104:111],v23
s_cbranch_vccnz R_cr21
R_cg21:
ms v[128:131],v[196:199],a[144:151],v23
wt vmcnt(0)
ms v[132:135],v[196:199],a[176:183],v23
v_max3_u32 v246,v200,v201,v202
ms v[112:115],v[196:199],a[16:23],v23
v_max_u32 v246,v246,v203
ms v[116:119],v[196:199],a[48:55],v23
v_cmp_eq_u32 vcc,-1,v246
ms v[120:123],v[196:199],a[80:87],v23
ms v[124:127],v[196:199],a[112:119],v23
s_cbranch_vccnz R_cr31
R_cg31:
ms v[128:131],v[200:203],a[152:159],v23
ms v[132:135],v[200:203],a[184:191],v23
ms v[112:115],v[200:203],a[24:31],v23
pa v[228:229],v[128:129],v[130:131]
ms v[116:119],v[200:203],a[56:63],v23
pa v[230:231],v[132:133],v[134:135]
ms v[120:123],v[200:203],a[88:95],v23
ds_write2_b32 v17,v228,v230 offset0:0 offset1:1
ms v[124:127],v[200:203],a[120:127],v23
ds_write2_b32 v17,v229,v231 offset0:32 offset1:33
pa v[220:221],v[112:113],v[114:115]
pa v[222:223],v[116:117],v[118:119]
ds_write2_b32 v15,v220,v222 offset0:0 offset1:1
ds_write2_b32 v15,v221,v223 offset0:32 offset1:33
buffer_store_dword v253,v252,s[8:11],0 offen offset:0
pa v[224:225],v[120:121],v[122:123]
s_nop 0
pa v[226:227],v[124:125],v[126:127]
ds_write2_b32 v16,v224,v226 offset0:0 offset1:1
ds_write2_b32 v16,v225,v227 offset0:32 offset1:33
s_cmp_eq_u32 s24,63
wt lgkmcnt(4)
s_barrier
buffer_load_dword v248,v250,s[8:11],0 offen offset:1024 sc1
wt lgkmcnt(0)
s_barrier
s_cbranch_scc1 R_fin
s_mov_b64 exec,0xffff
s_min_u32 s94,s15,1000
R_fa1:
v_cmp_gt_i32 vcc,s86,v248
buffer_load_dword v248,v250,s[8:11],0 offen offset:2048 sc1
s_cbranch_vccz R_fa1_ok
v_cmp_gt_i32 vcc,s86,v248
s_cbranch_vccz R_fa1_ok
v_cmp_gt_i32 vcc,s86,v248
s_cbranch_vccz R_fa1_ok
v_cmp_gt_i32 vcc,s86,v248
buffer_load_dword v248,v250,s[8:11],0 offen offset:3072 sc1
s_cbranch_vccz R_fa1_ok
v_cmp_gt_i32 vcc,s86,v248
s_cbranch_vccz R_fa1_ok
v_cmp_gt_i32 vcc,s86,v248
s_cbranch_vccz R_fa1_ok
v_cmp_gt_i32 vcc,s86,v248
buffer_load_dword v248,v250,s[8:11],0 offen sc1
s_cbranch_vccz R_fa1_ok
v_cmp_gt_i32 vcc,s86,v248
s_cbranch_vccz R_fa1_ok
v_cmp_gt_i32 vcc,s86,v248
s_cbranch_vccz R_fa1_ok
v_cmp_gt_i32 vcc,s86,v248
buffer_load_dword v248,v250,s[8:11],0 offen offset:1024 sc1
s_cbranch_vccz R_fa1_ok
v_cmp_gt_i32 vcc,s86,v248
s_cbranch_vccz R_fa1_ok
v_cmp_gt_i32 vcc,s86,v248
s_cbranch_vccz R_fa1_ok
s_sub_u32 s94,s94,1
s_cbranch_scc0 R_fa1
R_fa1_ok:
s_mov_b64 exec,-1
v_mov_b64 v[112:113],0
v_mov_b64 v[114:115],0
v_mov_b64 v[116:117],0
v_mov_b64 v[118:119],0
v_mov_b64 v[120:121],0
v_mov_b64 v[122:123],0
l4 v[232:235],v6,s[8:11],s25 offen sc1
l4 v[236:239],v6,s[8:11],s25 offen offset:1024 sc1
v_mov_b64 v[124:125],0
v_mov_b64 v[126:127],0
v_mov_b64 v[128:129],0
v_mov_b64 v[130:131],0
v_mov_b64 v[132:133],0
v_mov_b64 v[134:135],0
s_nop 15
s_nop 15
s_nop 15
s_nop 1
l4 v[188:191],v4,s[8:11],s25 offen sc1
l4 v[192:195],v4,s[8:11],s25 offen offset:1024 sc1
buffer_load_dwordx2 v[196:197],v5,s[8:11],s25 offen sc1
w4 v[28:31],v7,s[8:11],s27 offen offset:0
w4 v[28:31],v8,s[8:11],s27 offen offset:0
wt vmcnt(5)
R_aw01:
ms v[136:139],v[232:235],a[192:199],v23
v_max3_u32 v246,v232,v233,v234
ms v[136:139],v[236:239],a[200:207],v23
v_max3_u32 v247,v235,v236,v237
ms v[140:143],v[232:235],a[208:215],v23
v_max3_u32 v246,v246,v238,v239
ms v[140:143],v[236:239],a[216:223],v23
v_max_u32 v246,v246,v247
ms v[144:147],v[232:235],a[224:231],v23
v_cmp_eq_u32 vcc,-1,v246
ms v[144:147],v[236:239],a[232:239],v23
pa v[136:137],v[136:137],v[138:139]
ms v[148:151],v[232:235],a[240:247],v23
cv v42,v136,v137
ms v[148:151],v[236:239],a[248:255],v23
s_cbranch_vccnz R_ar01
R_ag01:
cv v46,v136,v137
pa v[140:141],v[140:141],v[142:143]
wt vmcnt(4)
mm v[200:203],v[180:183],v[188:191],0
wt vmcnt(3)
mm v[200:203],v[184:187],v[192:195],v[200:203]
wt vmcnt(2)
mh v[240:243],v[26:27],v[196:197],0
cv v50,v140,v141
cv v54,v140,v141
pa v[144:145],v[144:145],v[146:147]
cv v58,v144,v145
cv v62,v144,v145
v_max3_f32 v198,v200,v201,v202
pa v[148:149],v[148:149],v[150:151]
cv v66,v148,v149
v_cmp_u_f32 vcc,v200,v240
v_max3_f32 v198,v198,v203,v240
R_ag11:
v_mul_f32 v224,s54,v203
cv v70,v148,v149
v_max_f32_dpp v198,v198,v198 quad_perm:[2,3,0,1] row_mask:0xf bank_mask:0xf
v_mul_f32 v199,s54,v198
v_mul_f32 v198,s54,v198
v_mul_f32 v220,s54,v200
v_mul_f32 v221,s54,v201
s_cbranch_vccnz R_ar11
R_ah11:
v_permlane16_swap_b32 v198,v199
v_max_f32 v246,v198,v199
v_max_f32 v247,v198,v199
ds_sub_rtn_u32 v226,v245,v28
v_mul_f32 v223,s54,v202
v_permlane32_swap_b32 v246,v247
v_max_f32 v198,v246,v247
v_sub_f32 v220,v220,v198
v_sub_f32 v221,v221,v198
v_exp_f32 v220,v220
v_mul_f32 v222,s54,v240
v_sub_f32 v222,v222,v198
v_exp_f32 v221,v221
v_sub_f32 v223,v223,v198
v_exp_f32 v222,v222
v_sub_f32 v224,v224,v198
v_exp_f32 v223,v223
cv v176,v220,v221
v_exp_f32 v224,v224
cv v177,v222,0
cv v179,v222,0
cv v178,v223,v224
wt lgkmcnt(0)
v_lshl_add_u32 v226,v226,30,v14
buffer_store_dword v244,v226,s[8:11],0 offen sc1
ms v[152:155],v[176:179],v[32:39],v24
l4 v[96:99],v13,s[8:11],s28 offen offset:128 sc1
ms v[156:159],v[176:179],v[40:47],v24
l4 v[100:103],v13,s[8:11],s28 offen offset:2176 sc1
ms v[160:163],v[176:179],v[48:55],v24
pa v[236:237],v[152:153],v[154:155]
ms v[164:167],v[176:179],v[56:63],v24
v_rcp_f32 v236,v236
ms v[168:171],v[176:179],v[64:71],v24
v_rcp_f32 v237,v237
pa v[156:157],v[156:157],v[158:159]
v_mul_f32 v228,v156,v236
v_mul_f32 v232,v157,v237
pa v[160:161],v[160:161],v[162:163]
v_mul_f32 v229,v160,v236
v_mul_f32 v233,v161,v237
pa v[164:165],v[164:165],v[166:167]
v_mul_f32 v230,v164,v236
v_mul_f32 v234,v165,v237
pa v[168:169],v[168:169],v[170:171]
v_mul_f32 v231,v168,v236
ds_write_b128 v20,v[228:231]
v_mul_f32 v235,v169,v237
ds_write_b128 v21,v[232:235] offset:256
w4 v[28:31],v11,s[8:11],s27 offen sc1
buffer_store_dword v253,v0,s[8:11],0 offen sc1
wt lgkmcnt(0)
s_barrier
dr v[220:223],v22 offset:0
dr v[224:227],v22 offset:2048
dr v[228:231],v22 offset:4096
dr v[232:235],v22 offset:6144
wt lgkmcnt(2)
pa v[220:221],v[220:221],v[224:225]
pa v[222:223],v[222:223],v[226:227]
wt lgkmcnt(1)
pa v[220:221],v[220:221],v[228:229]
pa v[222:223],v[222:223],v[230:231]
wt lgkmcnt(0)
pa v[220:221],v[220:221],v[232:233]
pa v[222:223],v[222:223],v[234:235]
cv v224,v220,v221
cv v225,v222,v223
buffer_store_dwordx2 v[224:225],v9,s[8:11],s25 offen sc1
mm v[188:191],v[72:75],a[192:195],0
mm v[192:195],v[72:75],a[208:211],0
mm v[196:199],v[72:75],a[224:227],0
mm v[200:203],v[72:75],a[240:243],0
l4 v[72:75],v12,s[8:11],s29 offen sc1
mm v[188:191],v[76:79],a[196:199],v[188:191]
mm v[192:195],v[76:79],a[212:215],v[192:195]
mm v[196:199],v[76:79],a[228:231],v[196:199]
mm v[200:203],v[76:79],a[244:247],v[200:203]
l4 v[76:79],v12,s[8:11],s29 offen offset:2048 sc1
mm v[188:191],v[80:83],a[200:203],v[188:191]
mm v[192:195],v[80:83],a[216:219],v[192:195]
mm v[196:199],v[80:83],a[232:235],v[196:199]
mm v[200:203],v[80:83],a[248:251],v[200:203]
l4 v[80:83],v13,s[8:11],s29 offen sc1
s_barrier
s_nop 3
l4 v[236:239],v10,s[8:11],s25 offen sc1
mm v[188:191],v[84:87],a[204:207],v[188:191]
mm v[192:195],v[84:87],a[220:223],v[192:195]
mm v[196:199],v[84:87],a[236:239],v[196:199]
mm v[200:203],v[84:87],a[252:255],v[200:203]
l4 v[84:87],v13,s[8:11],s29 offen offset:2048 sc1
mm v[204:207],v[88:91],a[192:195],0
mm v[208:211],v[88:91],a[208:211],0
cv v40,v188,v189
mm v[212:215],v[88:91],a[224:227],0
cv v41,v190,v191
mm v[216:219],v[88:91],a[240:243],0
cv v48,v192,v193
l4 v[88:91],v12,s[8:11],s29 offen offset:128 sc1
mm v[204:207],v[92:95],a[196:199],v[204:207]
cv v49,v194,v195
mm v[208:211],v[92:95],a[212:215],v[208:211]
cv v56,v196,v197
mm v[212:215],v[92:95],a[228:231],v[212:215]
cv v57,v198,v199
mm v[216:219],v[92:95],a[244:247],v[216:219]
cv v64,v200,v201
l4 v[92:95],v12,s[8:11],s29 offen offset:2176 sc1
wt vmcnt(10)
mm v[204:207],v[96:99],a[200:203],v[204:207]
cv v65,v202,v203
mm v[208:211],v[96:99],a[216:219],v[208:211]
mm v[212:215],v[96:99],a[232:235],v[212:215]
mm v[216:219],v[96:99],a[248:251],v[216:219]
mm v[204:207],v[100:103],a[204:207],v[204:207]
mm v[208:211],v[100:103],a[220:223],v[208:211]
mm v[212:215],v[100:103],a[236:239],v[212:215]
mm v[216:219],v[100:103],a[252:255],v[216:219]
s_mov_b32 s59,s25
s_mov_b32 s25,s26
wt vmcnt(3)
mm v[228:231],v[180:183],v[236:239],0
s_add_u32 s36,s88,s30
s_buffer_load_dwordx2 s[100:101],s[8:11],s36 offset:60
s_buffer_load_dwordx2 s[100:101],s[8:11],s36 offset:188
s_buffer_load_dwordx2 s[100:101],s[8:11],s36 offset:316
s_buffer_load_dwordx2 s[100:101],s[8:11],s36 offset:444
s_nop 2
v_cmp_u_f32 vcc,v228,v228
v_add_f32_dpp v228,v228,v228 row_ror:8 row_mask:0xf bank_mask:0xf
v_add_f32_dpp v229,v229,v229 row_ror:8 row_mask:0xf bank_mask:0xf
v_add_f32_dpp v230,v230,v230 row_ror:8 row_mask:0xf bank_mask:0xf
v_add_f32_dpp v231,v231,v231 row_ror:8 row_mask:0xf bank_mask:0xf
cv v232,v228,v229
cv v233,v230,v231
s_cbranch_vccnz R_br1
R_bg1:
buffer_store_dwordx2 v[232:233],v3,s[8:11],s25 offen offset:0
s_branch R_step1
R_ar01:
s_cmp_eq_u32 s15,0
s_cbranch_scc1 R_ag01
l4 v[232:235],v6,s[8:11],s25 offen sc1
l4 v[236:239],v6,s[8:11],s25 offen offset:1024 sc1
l4 v[188:191],v4,s[8:11],s25 offen sc1
l4 v[192:195],v4,s[8:11],s25 offen offset:1024 sc1
buffer_load_dwordx2 v[196:197],v5,s[8:11],s25 offen sc1
s_sub_u32 s15,s15,1
s_max_i32 s15,s15,0
v_mov_b64 v[136:137],0
v_mov_b64 v[138:139],0
v_mov_b64 v[140:141],0
v_mov_b64 v[142:143],0
v_mov_b64 v[144:145],0
v_mov_b64 v[146:147],0
v_mov_b64 v[148:149],0
v_mov_b64 v[150:151],0
wt vmcnt(0)
s_branch R_aw01
R_ar11:
s_cmp_eq_u32 s15,0
s_cbranch_scc1 R_ah11
l4 v[188:191],v4,s[8:11],s25 offen sc1
l4 v[192:195],v4,s[8:11],s25 offen offset:1024 sc1
buffer_load_dwordx2 v[196:197],v5,s[8:11],s25 offen sc1
s_sub_u32 s15,s15,1
s_max_i32 s15,s15,0
wt vmcnt(2)
mm v[200:203],v[180:183],v[188:191],0
wt vmcnt(1)
mm v[200:203],v[184:187],v[192:195],v[200:203]
wt vmcnt(0)
mh v[240:243],v[26:27],v[196:197],0
s_nop 3
v_max3_f32 v198,v200,v201,v202
s_nop 2
v_cmp_u_f32 vcc,v200,v240
v_max3_f32 v198,v198,v203,v240
s_branch R_ag11
R_br1:
R_br21:
s_cmp_eq_u32 s15,0
s_cbranch_scc1 R_bg1
l4 v[236:239],v10,s[8:11],s59 offen sc1
R_br31:
s_sub_u32 s15,s15,1
s_max_i32 s15,s15,0
wt vmcnt(0)
mm v[228:231],v[180:183],v[236:239],0
s_nop 7
v_cmp_u_f32 vcc,v228,v228
v_add_f32_dpp v228,v228,v228 row_ror:8 row_mask:0xf bank_mask:0xf
v_add_f32_dpp v229,v229,v229 row_ror:8 row_mask:0xf bank_mask:0xf
v_add_f32_dpp v230,v230,v230 row_ror:8 row_mask:0xf bank_mask:0xf
v_add_f32_dpp v231,v231,v231 row_ror:8 row_mask:0xf bank_mask:0xf
cv v232,v228,v229
cv v233,v230,v231
s_cbranch_vccz R_bg1
s_branch R_br21
R_cr02:
s_cmp_eq_u32 s58,0
s_cbranch_scc1 R_cg02
l4 v[188:191],v2,s[8:11],s25 offen sc1
l4 v[192:195],v2,s[8:11],s25 offen offset:1024 sc1
l4 v[196:199],v2,s[8:11],s25 offen offset:2048 sc1
l4 v[200:203],v2,s[8:11],s25 offen offset:3072 sc1
s_sub_u32 s15,s15,1
s_max_i32 s15,s15,0
s_mov_b32 s58,s15
v_mov_b64 v[112:113],0
v_mov_b64 v[114:115],0
v_mov_b64 v[116:117],0
v_mov_b64 v[118:119],0
v_mov_b64 v[120:121],0
v_mov_b64 v[122:123],0
v_mov_b64 v[124:125],0
v_mov_b64 v[126:127],0
v_mov_b64 v[128:129],0
v_mov_b64 v[130:131],0
v_mov_b64 v[132:133],0
v_mov_b64 v[134:135],0
s_branch R_cw02
R_cr12:
s_cmp_eq_u32 s58,0
s_cbranch_scc1 R_cg12
l4 v[192:195],v2,s[8:11],s25 offen offset:1024 sc1
l4 v[196:199],v2,s[8:11],s25 offen offset:2048 sc1
l4 v[200:203],v2,s[8:11],s25 offen offset:3072 sc1
s_sub_u32 s15,s15,1
s_max_i32 s15,s15,0
s_mov_b32 s58,s15
wt vmcnt(2)
v_max3_u32 v246,v192,v193,v194
v_max_u32 v246,v246,v195
v_cmp_eq_u32 vcc,-1,v246
s_cbranch_vccz R_cg12
s_branch R_cr12
R_cr22:
s_cmp_eq_u32 s58,0
s_cbranch_scc1 R_cg22
l4 v[196:199],v2,s[8:11],s25 offen offset:2048 sc1
l4 v[200:203],v2,s[8:11],s25 offen offset:3072 sc1
s_sub_u32 s15,s15,1
s_max_i32 s15,s15,0
s_mov_b32 s58,s15
wt vmcnt(1)
v_max3_u32 v246,v196,v197,v198
v_max_u32 v246,v246,v199
v_cmp_eq_u32 vcc,-1,v246
s_cbranch_vccz R_cg22
s_branch R_cr22
R_cr32:
s_cmp_eq_u32 s58,0
s_cbranch_scc1 R_cg32
l4 v[200:203],v2,s[8:11],s25 offen offset:3072 sc1
s_sub_u32 s15,s15,1
s_max_i32 s15,s15,0
s_mov_b32 s58,s15
wt vmcnt(0)
v_max3_u32 v246,v200,v201,v202
v_max_u32 v246,v246,v203
v_cmp_eq_u32 vcc,-1,v246
s_cbranch_vccz R_cg32
s_branch R_cr32
R_step2:
s_add_u32 s24,s24,1
s_add_u32 s86,s86,1
v_mov_b32 v253,s86
s_lshl_b32 s97,1,s24
v_mov_b32 v244,s97
s_mov_b32 s28,s29
s_mov_b32 s29,s30
s_add_u32 s30,s24,3
s_min_u32 s30,s30,63
s_lshl_b32 s30,s30,19
s_and_b32 s95,s30,0xffe00000
s_add_u32 s30,s30,s95
s_add_u32 s31,s31,0x10000
s_add_u32 s26,s26,0x80000
s_and_b32 s26,s26,0x180000
s_xor_b32 s27,s25,0x100000
s_mov_b32 s58,s15
v_mov_b64 v[136:137],0
v_mov_b64 v[138:139],0
v_mov_b64 v[140:141],0
v_mov_b64 v[142:143],0
v_mov_b64 v[144:145],0
v_mov_b64 v[146:147],0
v_mov_b64 v[148:149],0
v_mov_b64 v[150:151],0
v_mov_b64 v[152:153],0
v_mov_b64 v[154:155],0
v_mov_b64 v[156:157],0
v_mov_b64 v[158:159],0
v_mov_b64 v[160:161],0
v_mov_b64 v[162:163],0
v_mov_b64 v[164:165],0
v_mov_b64 v[166:167],0
v_mov_b64 v[168:169],0
v_mov_b64 v[170:171],0
cv v44,v204,v205
cv v45,v206,v207
cv v52,v208,v209
cv v53,v210,v211
cv v60,v212,v213
cv v61,v214,v215
cv v68,v216,v217
cv v69,v218,v219
s_nop 14
l4 v[188:191],v2,s[8:11],s25 offen sc1
s_nop 5
l4 v[192:195],v2,s[8:11],s25 offen offset:1024 sc1
s_nop 5
l4 v[196:199],v2,s[8:11],s25 offen offset:2048 sc1
s_nop 5
l4 v[200:203],v2,s[8:11],s25 offen offset:3072 sc1
R_cw02:
wt vmcnt(3)
ms v[128:131],v[188:191],a[128:135],v23
v_max3_u32 v246,v188,v189,v190
v_max_u32 v246,v246,v191
ms v[132:135],v[188:191],a[160:167],v23
v_cmp_eq_u32 vcc,-1,v246
ms v[112:115],v[188:191],a[0:7],v23
wt vmcnt(2)
v_max3_u32 v247,v192,v193,v194
ms v[116:119],v[188:191],a[32:39],v23
v_max_u32 v247,v247,v195
s_cbranch_vccnz R_cr02
R_cg02:
v_cmp_eq_u32 vcc,-1,v247
ms v[120:123],v[188:191],a[64:71],v23
ms v[124:127],v[188:191],a[96:103],v23
s_cbranch_vccnz R_cr12
R_cg12:
ms v[128:131],v[192:195],a[136:143],v23
wt vmcnt(1)
ms v[132:135],v[192:195],a[168:175],v23
v_max3_u32 v246,v196,v197,v198
ms v[112:115],v[192:195],a[8:15],v23
v_max_u32 v246,v246,v199
ms v[116:119],v[192:195],a[40:47],v23
v_cmp_eq_u32 vcc,-1,v246
ms v[120:123],v[192:195],a[72:79],v23
ms v[124:127],v[192:195],a[104:111],v23
s_cbranch_vccnz R_cr22
R_cg22:
ms v[128:131],v[196:199],a[144:151],v23
wt vmcnt(0)
ms v[132:135],v[196:199],a[176:183],v23
v_max3_u32 v246,v200,v201,v202
ms v[112:115],v[196:199],a[16:23],v23
v_max_u32 v246,v246,v203
ms v[116:119],v[196:199],a[48:55],v23
v_cmp_eq_u32 vcc,-1,v246
ms v[120:123],v[196:199],a[80:87],v23
ms v[124:127],v[196:199],a[112:119],v23
s_cbranch_vccnz R_cr32
R_cg32:
ms v[128:131],v[200:203],a[152:159],v23
ms v[132:135],v[200:203],a[184:191],v23
ms v[112:115],v[200:203],a[24:31],v23
pa v[228:229],v[128:129],v[130:131]
ms v[116:119],v[200:203],a[56:63],v23
pa v[230:231],v[132:133],v[134:135]
ms v[120:123],v[200:203],a[88:95],v23
ds_write2_b32 v17,v228,v230 offset0:0 offset1:1
ms v[124:127],v[200:203],a[120:127],v23
ds_write2_b32 v17,v229,v231 offset0:32 offset1:33
pa v[220:221],v[112:113],v[114:115]
pa v[222:223],v[116:117],v[118:119]
ds_write2_b32 v15,v220,v222 offset0:0 offset1:1
ds_write2_b32 v15,v221,v223 offset0:32 offset1:33
buffer_store_dword v253,v252,s[8:11],0 offen offset:0
pa v[224:225],v[120:121],v[122:123]
s_nop 0
pa v[226:227],v[124:125],v[126:127]
ds_write2_b32 v16,v224,v226 offset0:0 offset1:1
ds_write2_b32 v16,v225,v227 offset0:32 offset1:33
s_cmp_eq_u32 s24,63
wt lgkmcnt(4)
s_barrier
buffer_load_dword v248,v250,s[8:11],0 offen offset:1024 sc1
wt lgkmcnt(0)
s_barrier
s_cbranch_scc1 R_last2
s_mov_b64 exec,0xffff
s_min_u32 s94,s15,1000
R_fa2:
v_cmp_gt_i32 vcc,s86,v248
buffer_load_dword v248,v250,s[8:11],0 offen offset:2048 sc1
s_cbranch_vccz R_fa2_ok
v_cmp_gt_i32 vcc,s86,v248
s_cbranch_vccz R_fa2_ok
v_cmp_gt_i32 vcc,s86,v248
s_cbranch_vccz R_fa2_ok
v_cmp_gt_i32 vcc,s86,v248
buffer_load_dword v248,v250,s[8:11],0 offen offset:3072 sc1
s_cbranch_vccz R_fa2_ok
v_cmp_gt_i32 vcc,s86,v248
s_cbranch_vccz R_fa2_ok
v_cmp_gt_i32 vcc,s86,v248
s_cbranch_vccz R_fa2_ok
v_cmp_gt_i32 vcc,s86,v248
buffer_load_dword v248,v250,s[8:11],0 offen sc1
s_cbranch_vccz R_fa2_ok
v_cmp_gt_i32 vcc,s86,v248
s_cbranch_vccz R_fa2_ok
v_cmp_gt_i32 vcc,s86,v248
s_cbranch_vccz R_fa2_ok
v_cmp_gt_i32 vcc,s86,v248
buffer_load_dword v248,v250,s[8:11],0 offen offset:1024 sc1
s_cbranch_vccz R_fa2_ok
v_cmp_gt_i32 vcc,s86,v248
s_cbranch_vccz R_fa2_ok
v_cmp_gt_i32 vcc,s86,v248
s_cbranch_vccz R_fa2_ok
s_sub_u32 s94,s94,1
s_cbranch_scc0 R_fa2
R_fa2_ok:
s_mov_b64 exec,-1
ds_read_b32 v204,v18 offset:0
ds_read_b32 v208,v18 offset:1024
ds_read_b32 v212,v18 offset:2048
ds_read_b32 v216,v18 offset:3072
ds_read_b32 v205,v18 offset:128
ds_read_b32 v209,v18 offset:1152
l4 v[232:235],v6,s[8:11],s25 offen sc1
l4 v[236:239],v6,s[8:11],s25 offen offset:1024 sc1
ds_read_b32 v213,v18 offset:2176
ds_read_b32 v217,v18 offset:3200
ds_read_b32 v206,v19 offset:256
ds_read_b32 v210,v19 offset:1280
ds_read_b32 v214,v19 offset:2304
ds_read_b32 v218,v19 offset:3328
ds_read_b32 v207,v19 offset:384
ds_read_b32 v211,v19 offset:1408
ds_read_b32 v215,v19 offset:2432
ds_read_b32 v219,v19 offset:3456
v_mov_b64 v[112:113],0
v_mov_b64 v[114:115],0
v_mov_b64 v[116:117],0
v_mov_b64 v[118:119],0
v_mov_b64 v[120:121],0
v_mov_b64 v[122:123],0
v_mov_b64 v[124:125],0
v_mov_b64 v[126:127],0
v_mov_b64 v[128:129],0
v_mov_b64 v[130:131],0
v_mov_b64 v[132:133],0
v_mov_b64 v[134:135],0
s_nop 15
s_nop 15
s_nop 1
l4 v[188:191],v4,s[8:11],s25 offen sc1
l4 v[192:195],v4,s[8:11],s25 offen offset:1024 sc1
buffer_load_dwordx2 v[196:197],v5,s[8:11],s25 offen sc1
wt lgkmcnt(0)
pa v[204:205],v[204:205],v[208:209]
pa v[206:207],v[206:207],v[210:211]
pa v[204:205],v[204:205],v[212:213]
pa v[206:207],v[206:207],v[214:215]
pa v[204:205],v[204:205],v[216:217]
pa v[206:207],v[206:207],v[218:219]
cv v172,v204,v205
cv v173,v206,v207
wt vmcnt(3)
R_aw02:
ms v[136:139],v[232:235],a[192:199],v23
v_max3_u32 v246,v232,v233,v234
ms v[136:139],v[236:239],a[200:207],v23
v_max3_u32 v247,v235,v236,v237
ms v[140:143],v[232:235],a[208:215],v23
v_max3_u32 v246,v246,v238,v239
ms v[140:143],v[236:239],a[216:223],v23
v_max_u32 v246,v246,v247
ms v[144:147],v[232:235],a[224:231],v23
v_cmp_eq_u32 vcc,-1,v246
ms v[144:147],v[236:239],a[232:239],v23
pa v[136:137],v[136:137],v[138:139]
ms v[148:151],v[232:235],a[240:247],v23
cv v42,v136,v137
ms v[148:151],v[236:239],a[248:255],v23
s_cbranch_vccnz R_ar02
R_ag02:
cv v46,v136,v137
pa v[140:141],v[140:141],v[142:143]
wt vmcnt(2)
mm v[200:203],v[180:183],v[188:191],0
wt vmcnt(1)
mm v[200:203],v[184:187],v[192:195],v[200:203]
wt vmcnt(0)
mh v[240:243],v[26:27],v[196:197],0
cv v50,v140,v141
cv v54,v140,v141
pa v[144:145],v[144:145],v[146:147]
cv v58,v144,v145
cv v62,v144,v145
v_max3_f32 v198,v200,v201,v202
pa v[148:149],v[148:149],v[150:151]
cv v66,v148,v149
v_cmp_u_f32 vcc,v200,v240
v_max3_f32 v198,v198,v203,v240
R_ag12:
v_mul_f32 v224,s54,v203
cv v70,v148,v149
v_max_f32_dpp v198,v198,v198 quad_perm:[2,3,0,1] row_mask:0xf bank_mask:0xf
v_mul_f32 v199,s54,v198
v_mul_f32 v198,s54,v198
v_mul_f32 v220,s54,v200
v_mul_f32 v221,s54,v201
s_cbranch_vccnz R_ar12
R_ah12:
v_permlane16_swap_b32 v198,v199
v_max_f32 v246,v198,v199
v_max_f32 v247,v198,v199
ds_sub_rtn_u32 v226,v245,v28
v_mul_f32 v223,s54,v202
v_permlane32_swap_b32 v246,v247
v_max_f32 v198,v246,v247
v_sub_f32 v220,v220,v198
v_sub_f32 v221,v221,v198
v_exp_f32 v220,v220
v_mul_f32 v222,s54,v240
v_sub_f32 v222,v222,v198
v_exp_f32 v221,v221
v_sub_f32 v223,v223,v198
v_exp_f32 v222,v222
v_sub_f32 v224,v224,v198
v_exp_f32 v223,v223
cv v176,v220,v221
v_exp_f32 v224,v224
cv v177,v222,0
cv v179,v222,0
cv v178,v223,v224
wt lgkmcnt(0)
v_lshl_add_u32 v226,v226,30,v14
buffer_store_dword v244,v226,s[8:11],0 offen sc1
ms v[152:155],v[176:179],v[32:39],v24
l4 v[96:99],v13,s[8:11],s28 offen offset:128 sc1
ms v[156:159],v[176:179],v[40:47],v24
l4 v[100:103],v13,s[8:11],s28 offen offset:2176 sc1
ms v[160:163],v[176:179],v[48:55],v24
pa v[236:237],v[152:153],v[154:155]
ms v[164:167],v[176:179],v[56:63],v24
v_rcp_f32 v236,v236
ms v[168:171],v[176:179],v[64:71],v24
v_rcp_f32 v237,v237
pa v[156:157],v[156:157],v[158:159]
v_mul_f32 v228,v156,v236
v_mul_f32 v232,v157,v237
pa v[160:161],v[160:161],v[162:163]
v_mul_f32 v229,v160,v236
v_mul_f32 v233,v161,v237
pa v[164:165],v[164:165],v[166:167]
v_mul_f32 v230,v164,v236
v_mul_f32 v234,v165,v237
pa v[168:169],v[168:169],v[170:171]
v_mul_f32 v231,v168,v236
ds_write_b128 v20,v[228:231]
v_mul_f32 v235,v169,v237
ds_write_b128 v21,v[232:235] offset:256
buffer_store_dwordx2 v[172:173],v25,s[8:11],s31 offen sc1
wt lgkmcnt(0)
s_barrier
s_buffer_load_dwordx2 s[44:45],s[8:11],s98 glc
s_buffer_load_dwordx2 s[46:47],s[8:11],s98 offset:65536 glc
mm v[188:191],v[72:75],a[192:195],0
mm v[192:195],v[72:75],a[208:211],0
mm v[196:199],v[72:75],a[224:227],0
mm v[200:203],v[72:75],a[240:243],0
mm v[188:191],v[76:79],a[196:199],v[188:191]
mm v[192:195],v[76:79],a[212:215],v[192:195]
mm v[196:199],v[76:79],a[228:231],v[196:199]
mm v[200:203],v[76:79],a[244:247],v[200:203]
mm v[188:191],v[80:83],a[200:203],v[188:191]
s_buffer_load_dwordx2 s[44:45],s[8:11],s98 glc
s_buffer_load_dwordx2 s[46:47],s[8:11],s98 offset:65536 glc
mm v[192:195],v[80:83],a[216:219],v[192:195]
mm v[196:199],v[80:83],a[232:235],v[196:199]
mm v[200:203],v[80:83],a[248:251],v[200:203]
mm v[188:191],v[84:87],a[204:207],v[188:191]
mm v[192:195],v[84:87],a[220:223],v[192:195]
mm v[196:199],v[84:87],a[236:239],v[196:199]
mm v[200:203],v[84:87],a[252:255],v[200:203]
l4 v[72:75],v12,s[8:11],s29 offen sc1
l4 v[76:79],v12,s[8:11],s29 offen offset:2048 sc1
mm v[204:207],v[88:91],a[192:195],0
mm v[208:211],v[88:91],a[208:211],0
cv v40,v188,v189
s_buffer_load_dwordx2 s[44:45],s[8:11],s98 glc
s_buffer_load_dwordx2 s[46:47],s[8:11],s98 offset:65536 glc
mm v[212:215],v[88:91],a[224:227],0
cv v41,v190,v191
mm v[216:219],v[88:91],a[240:243],0
cv v48,v192,v193
l4 v[80:83],v13,s[8:11],s29 offen sc1
l4 v[84:87],v13,s[8:11],s29 offen offset:2048 sc1
mm v[204:207],v[92:95],a[196:199],v[204:207]
cv v49,v194,v195
s_min_u32 s94,s15,2000
R_fb2:
s_and_b64 s[36:37],s[44:45],s[46:47]
s_and_b32 s36,s36,s37
s_and_b32 s36,s36,s97
s_cbranch_scc1 R_fb2_ok
s_nop 1
s_and_b64 s[36:37],s[44:45],s[46:47]
s_and_b32 s36,s36,s37
s_and_b32 s36,s36,s97
s_cbranch_scc1 R_fb2_ok
s_nop 1
s_and_b64 s[36:37],s[44:45],s[46:47]
s_and_b32 s36,s36,s37
s_and_b32 s36,s36,s97
s_cbranch_scc1 R_fb2_ok
s_nop 1
s_and_b64 s[36:37],s[44:45],s[46:47]
s_and_b32 s36,s36,s37
s_and_b32 s36,s36,s97
s_cbranch_scc1 R_fb2_ok
s_nop 1
s_buffer_load_dwordx2 s[44:45],s[8:11],s98 glc
s_buffer_load_dwordx2 s[46:47],s[8:11],s98 offset:65536 glc
s_sub_u32 s94,s94,1
s_cbranch_scc0 R_fb2
R_fb2_ok:
s_barrier
s_nop 3
l4 v[236:239],v10,s[8:11],s25 offen sc1
mm v[208:211],v[92:95],a[212:215],v[208:211]
cv v56,v196,v197
mm v[212:215],v[92:95],a[228:231],v[212:215]
cv v57,v198,v199
mm v[216:219],v[92:95],a[244:247],v[216:219]
cv v64,v200,v201
l4 v[88:91],v12,s[8:11],s29 offen offset:128 sc1
l4 v[92:95],v12,s[8:11],s29 offen offset:2176 sc1
wt vmcnt(8)
mm v[204:207],v[96:99],a[200:203],v[204:207]
cv v65,v202,v203
mm v[208:211],v[96:99],a[216:219],v[208:211]
mm v[212:215],v[96:99],a[232:235],v[212:215]
mm v[216:219],v[96:99],a[248:251],v[216:219]
mm v[204:207],v[100:103],a[204:207],v[204:207]
mm v[208:211],v[100:103],a[220:223],v[208:211]
mm v[212:215],v[100:103],a[236:239],v[212:215]
mm v[216:219],v[100:103],a[252:255],v[216:219]
s_mov_b32 s59,s25
s_mov_b32 s25,s26
wt vmcnt(2)
mm v[228:231],v[180:183],v[236:239],0
s_add_u32 s36,s88,s30
s_buffer_load_dwordx2 s[100:101],s[8:11],s36 offset:60
s_buffer_load_dwordx2 s[100:101],s[8:11],s36 offset:188
s_buffer_load_dwordx2 s[100:101],s[8:11],s36 offset:316
s_buffer_load_dwordx2 s[100:101],s[8:11],s36 offset:444
s_nop 2
v_cmp_u_f32 vcc,v228,v228
v_add_f32_dpp v228,v228,v228 row_ror:8 row_mask:0xf bank_mask:0xf
v_add_f32_dpp v229,v229,v229 row_ror:8 row_mask:0xf bank_mask:0xf
v_add_f32_dpp v230,v230,v230 row_ror:8 row_mask:0xf bank_mask:0xf
v_add_f32_dpp v231,v231,v231 row_ror:8 row_mask:0xf bank_mask:0xf
cv v232,v228,v229
cv v233,v230,v231
s_cbranch_vccnz R_br2
R_bg2:
buffer_store_dwordx2 v[232:233],v3,s[8:11],s25 offen offset:0
s_branch R_step2
R_last2:
ds_read_b32 v204,v18 offset:0
ds_read_b32 v208,v18 offset:1024
ds_read_b32 v212,v18 offset:2048
ds_read_b32 v216,v18 offset:3072
ds_read_b32 v205,v18 offset:128
ds_read_b32 v209,v18 offset:1152
ds_read_b32 v213,v18 offset:2176
ds_read_b32 v217,v18 offset:3200
ds_read_b32 v206,v19 offset:256
ds_read_b32 v210,v19 offset:1280
ds_read_b32 v214,v19 offset:2304
ds_read_b32 v218,v19 offset:3328
ds_read_b32 v207,v19 offset:384
ds_read_b32 v211,v19 offset:1408
ds_read_b32 v215,v19 offset:2432
ds_read_b32 v219,v19 offset:3456
wt lgkmcnt(0)
pa v[204:205],v[204:205],v[208:209]
pa v[206:207],v[206:207],v[210:211]
pa v[204:205],v[204:205],v[212:213]
pa v[206:207],v[206:207],v[214:215]
pa v[204:205],v[204:205],v[216:217]
pa v[206:207],v[206:207],v[218:219]
cv v172,v204,v205
cv v173,v206,v207
buffer_store_dwordx2 v[172:173],v25,s[8:11],s31 offen sc1
s_branch R_fin
R_ar02:
s_cmp_eq_u32 s15,0
s_cbranch_scc1 R_ag02
l4 v[232:235],v6,s[8:11],s25 offen sc1
l4 v[236:239],v6,s[8:11],s25 offen offset:1024 sc1
l4 v[188:191],v4,s[8:11],s25 offen sc1
l4 v[192:195],v4,s[8:11],s25 offen offset:1024 sc1
buffer_load_dwordx2 v[196:197],v5,s[8:11],s25 offen sc1
s_sub_u32 s15,s15,1
s_max_i32 s15,s15,0
v_mov_b64 v[136:137],0
v_mov_b64 v[138:139],0
v_mov_b64 v[140:141],0
v_mov_b64 v[142:143],0
v_mov_b64 v[144:145],0
v_mov_b64 v[146:147],0
v_mov_b64 v[148:149],0
v_mov_b64 v[150:151],0
wt vmcnt(0)
s_branch R_aw02
R_ar12:
s_cmp_eq_u32 s15,0
s_cbranch_scc1 R_ah12
l4 v[188:191],v4,s[8:11],s25 offen sc1
l4 v[192:195],v4,s[8:11],s25 offen offset:1024 sc1
buffer_load_dwordx2 v[196:197],v5,s[8:11],s25 offen sc1
s_sub_u32 s15,s15,1
s_max_i32 s15,s15,0
wt vmcnt(2)
mm v[200:203],v[180:183],v[188:191],0
wt vmcnt(1)
mm v[200:203],v[184:187],v[192:195],v[200:203]
wt vmcnt(0)
mh v[240:243],v[26:27],v[196:197],0
s_nop 3
v_max3_f32 v198,v200,v201,v202
s_nop 2
v_cmp_u_f32 vcc,v200,v240
v_max3_f32 v198,v198,v203,v240
s_branch R_ag12
R_br2:
R_br22:
s_cmp_eq_u32 s15,0
s_cbranch_scc1 R_bg2
l4 v[236:239],v10,s[8:11],s59 offen sc1
R_br32:
s_sub_u32 s15,s15,1
s_max_i32 s15,s15,0
wt vmcnt(0)
mm v[228:231],v[180:183],v[236:239],0
s_nop 7
v_cmp_u_f32 vcc,v228,v228
v_add_f32_dpp v228,v228,v228 row_ror:8 row_mask:0xf bank_mask:0xf
v_add_f32_dpp v229,v229,v229 row_ror:8 row_mask:0xf bank_mask:0xf
v_add_f32_dpp v230,v230,v230 row_ror:8 row_mask:0xf bank_mask:0xf
v_add_f32_dpp v231,v231,v231 row_ror:8 row_mask:0xf bank_mask:0xf
cv v232,v228,v229
cv v233,v230,v231
s_cbranch_vccz R_bg2
s_branch R_br22
R_cr03:
s_cmp_eq_u32 s58,0
s_cbranch_scc1 R_cg03
l4 v[188:191],v2,s[8:11],s25 offen sc1
l4 v[192:195],v2,s[8:11],s25 offen offset:1024 sc1
l4 v[196:199],v2,s[8:11],s25 offen offset:2048 sc1
l4 v[200:203],v2,s[8:11],s25 offen offset:3072 sc1
s_sub_u32 s15,s15,1
s_max_i32 s15,s15,0
s_mov_b32 s58,s15
v_mov_b64 v[112:113],0
v_mov_b64 v[114:115],0
v_mov_b64 v[116:117],0
v_mov_b64 v[118:119],0
v_mov_b64 v[120:121],0
v_mov_b64 v[122:123],0
v_mov_b64 v[124:125],0
v_mov_b64 v[126:127],0
v_mov_b64 v[128:129],0
v_mov_b64 v[130:131],0
v_mov_b64 v[132:133],0
v_mov_b64 v[134:135],0
s_branch R_cw03
R_cr13:
s_cmp_eq_u32 s58,0
s_cbranch_scc1 R_cg13
l4 v[192:195],v2,s[8:11],s25 offen offset:1024 sc1
l4 v[196:199],v2,s[8:11],s25 offen offset:2048 sc1
l4 v[200:203],v2,s[8:11],s25 offen offset:3072 sc1
s_sub_u32 s15,s15,1
s_max_i32 s15,s15,0
s_mov_b32 s58,s15
wt vmcnt(2)
v_max3_u32 v246,v192,v193,v194
v_max_u32 v246,v246,v195
v_cmp_eq_u32 vcc,-1,v246
s_cbranch_vccz R_cg13
s_branch R_cr13
R_cr23:
s_cmp_eq_u32 s58,0
s_cbranch_scc1 R_cg23
l4 v[196:199],v2,s[8:11],s25 offen offset:2048 sc1
l4 v[200:203],v2,s[8:11],s25 offen offset:3072 sc1
s_sub_u32 s15,s15,1
s_max_i32 s15,s15,0
s_mov_b32 s58,s15
wt vmcnt(1)
v_max3_u32 v246,v196,v197,v198
v_max_u32 v246,v246,v199
v_cmp_eq_u32 vcc,-1,v246
s_cbranch_vccz R_cg23
s_branch R_cr23
R_cr33:
s_cmp_eq_u32 s58,0
s_cbranch_scc1 R_cg33
l4 v[200:203],v2,s[8:11],s25 offen offset:3072 sc1
s_sub_u32 s15,s15,1
s_max_i32 s15,s15,0
s_mov_b32 s58,s15
wt vmcnt(0)
v_max3_u32 v246,v200,v201,v202
v_max_u32 v246,v246,v203
v_cmp_eq_u32 vcc,-1,v246
s_cbranch_vccz R_cg33
s_branch R_cr33
R_step3:
s_add_u32 s24,s24,1
s_add_u32 s86,s86,1
v_mov_b32 v253,s86
s_lshl_b32 s97,1,s24
v_mov_b32 v244,s97
s_mov_b32 s28,s29
s_mov_b32 s29,s30
s_add_u32 s30,s24,3
s_min_u32 s30,s30,63
s_lshl_b32 s30,s30,19
s_and_b32 s95,s30,0xffe00000
s_add_u32 s30,s30,s95
s_add_u32 s31,s31,0x10000
s_add_u32 s26,s26,0x80000
s_and_b32 s26,s26,0x180000
s_xor_b32 s27,s25,0x100000
s_mov_b32 s58,s15
v_mov_b64 v[136:137],0
v_mov_b64 v[138:139],0
v_mov_b64 v[140:141],0
v_mov_b64 v[142:143],0
v_mov_b64 v[144:145],0
v_mov_b64 v[146:147],0
v_mov_b64 v[148:149],0
v_mov_b64 v[150:151],0
v_mov_b64 v[152:153],0
v_mov_b64 v[154:155],0
v_mov_b64 v[156:157],0
v_mov_b64 v[158:159],0
v_mov_b64 v[160:161],0
v_mov_b64 v[162:163],0
v_mov_b64 v[164:165],0
v_mov_b64 v[166:167],0
v_mov_b64 v[168:169],0
v_mov_b64 v[170:171],0
cv v44,v204,v205
cv v45,v206,v207
cv v52,v208,v209
cv v53,v210,v211
cv v60,v212,v213
cv v61,v214,v215
cv v68,v216,v217
cv v69,v218,v219
s_nop 14
l4 v[188:191],v2,s[8:11],s25 offen sc1
s_nop 5
l4 v[192:195],v2,s[8:11],s25 offen offset:1024 sc1
s_nop 5
l4 v[196:199],v2,s[8:11],s25 offen offset:2048 sc1
s_nop 5
l4 v[200:203],v2,s[8:11],s25 offen offset:3072 sc1
R_cw03:
wt vmcnt(3)
ms v[128:131],v[188:191],a[128:135],v23
v_max3_u32 v246,v188,v189,v190
v_max_u32 v246,v246,v191
ms v[132:135],v[188:191],a[160:167],v23
v_cmp_eq_u32 vcc,-1,v246
ms v[112:115],v[188:191],a[0:7],v23
wt vmcnt(2)
v_max3_u32 v247,v192,v193,v194
ms v[116:119],v[188:191],a[32:39],v23
v_max_u32 v247,v247,v195
s_cbranch_vccnz R_cr03
R_cg03:
v_cmp_eq_u32 vcc,-1,v247
ms v[120:123],v[188:191],a[64:71],v23
ms v[124:127],v[188:191],a[96:103],v23
s_cbranch_vccnz R_cr13
R_cg13:
ms v[128:131],v[192:195],a[136:143],v23
wt vmcnt(1)
ms v[132:135],v[192:195],a[168:175],v23
v_max3_u32 v246,v196,v197,v198
ms v[112:115],v[192:195],a[8:15],v23
v_max_u32 v246,v246,v199
ms v[116:119],v[192:195],a[40:47],v23
v_cmp_eq_u32 vcc,-1,v246
ms v[120:123],v[192:195],a[72:79],v23
ms v[124:127],v[192:195],a[104:111],v23
s_cbranch_vccnz R_cr23
R_cg23:
ms v[128:131],v[196:199],a[144:151],v23
wt vmcnt(0)
ms v[132:135],v[196:199],a[176:183],v23
v_max3_u32 v246,v200,v201,v202
ms v[112:115],v[196:199],a[16:23],v23
v_max_u32 v246,v246,v203
ms v[116:119],v[196:199],a[48:55],v23
v_cmp_eq_u32 vcc,-1,v246
ms v[120:123],v[196:199],a[80:87],v23
ms v[124:127],v[196:199],a[112:119],v23
s_cbranch_vccnz R_cr33
R_cg33:
ms v[128:131],v[200:203],a[152:159],v23
ms v[132:135],v[200:203],a[184:191],v23
ms v[112:115],v[200:203],a[24:31],v23
pa v[228:229],v[128:129],v[130:131]
ms v[116:119],v[200:203],a[56:63],v23
pa v[230:231],v[132:133],v[134:135]
ms v[120:123],v[200:203],a[88:95],v23
ds_write2_b32 v17,v228,v230 offset0:0 offset1:1
ms v[124:127],v[200:203],a[120:127],v23
ds_write2_b32 v17,v229,v231 offset0:32 offset1:33
pa v[220:221],v[112:113],v[114:115]
pa v[222:223],v[116:117],v[118:119]
ds_write2_b32 v15,v220,v222 offset0:0 offset1:1
ds_write2_b32 v15,v221,v223 offset0:32 offset1:33
buffer_store_dword v253,v252,s[8:11],0 offen offset:0
pa v[224:225],v[120:121],v[122:123]
s_nop 0
pa v[226:227],v[124:125],v[126:127]
ds_write2_b32 v16,v224,v226 offset0:0 offset1:1
ds_write2_b32 v16,v225,v227 offset0:32 offset1:33
s_cmp_eq_u32 s24,63
wt lgkmcnt(4)
s_barrier
dr v[204:207],v18 offset:0
dr v[208:211],v18 offset:1024
dr v[212:215],v18 offset:2048
dr v[216:219],v18 offset:3072
buffer_load_dword v248,v250,s[8:11],0 offen offset:1024 sc1
wt lgkmcnt(4)
s_barrier
buffer_load_dword v248,v250,s[8:11],0 offen offset:2048 sc1
wt lgkmcnt(2)
pa v[204:205],v[204:205],v[208:209]
pa v[206:207],v[206:207],v[210:211]
wt lgkmcnt(1)
pa v[204:205],v[204:205],v[212:213]
pa v[206:207],v[206:207],v[214:215]
wt lgkmcnt(0)
pa v[204:205],v[204:205],v[216:217]
pa v[206:207],v[206:207],v[218:219]
cv v208,v204,v205
cv v209,v206,v207
buffer_store_dwordx2 v[208:209],v7,s[8:11],s25 offen offset:0
s_cbranch_scc1 R_fin
s_mov_b64 exec,0xffff
s_min_u32 s94,s15,1000
R_fa3:
v_cmp_gt_i32 vcc,s86,v248
buffer_load_dword v248,v250,s[8:11],0 offen offset:3072 sc1
s_cbranch_vccz R_fa3_ok
v_cmp_gt_i32 vcc,s86,v248
s_cbranch_vccz R_fa3_ok
v_cmp_gt_i32 vcc,s86,v248
s_cbranch_vccz R_fa3_ok
v_cmp_gt_i32 vcc,s86,v248
buffer_load_dword v248,v250,s[8:11],0 offen sc1
s_cbranch_vccz R_fa3_ok
v_cmp_gt_i32 vcc,s86,v248
s_cbranch_vccz R_fa3_ok
v_cmp_gt_i32 vcc,s86,v248
s_cbranch_vccz R_fa3_ok
v_cmp_gt_i32 vcc,s86,v248
buffer_load_dword v248,v250,s[8:11],0 offen offset:1024 sc1
s_cbranch_vccz R_fa3_ok
v_cmp_gt_i32 vcc,s86,v248
s_cbranch_vccz R_fa3_ok
v_cmp_gt_i32 vcc,s86,v248
s_cbranch_vccz R_fa3_ok
v_cmp_gt_i32 vcc,s86,v248
buffer_load_dword v248,v250,s[8:11],0 offen offset:2048 sc1
s_cbranch_vccz R_fa3_ok
v_cmp_gt_i32 vcc,s86,v248
s_cbranch_vccz R_fa3_ok
v_cmp_gt_i32 vcc,s86,v248
s_cbranch_vccz R_fa3_ok
s_sub_u32 s94,s94,1
s_cbranch_scc0 R_fa3
R_fa3_ok:
s_mov_b64 exec,-1
v_mov_b64 v[112:113],0
v_mov_b64 v[114:115],0
v_mov_b64 v[116:117],0
v_mov_b64 v[118:119],0
v_mov_b64 v[120:121],0
v_mov_b64 v[122:123],0
l4 v[232:235],v6,s[8:11],s25 offen sc1
l4 v[236:239],v6,s[8:11],s25 offen offset:1024 sc1
v_mov_b64 v[124:125],0
v_mov_b64 v[126:127],0
v_mov_b64 v[128:129],0
v_mov_b64 v[130:131],0
v_mov_b64 v[132:133],0
v_mov_b64 v[134:135],0
s_nop 15
s_nop 15
s_nop 15
s_nop 1
l4 v[188:191],v4,s[8:11],s25 offen sc1
l4 v[192:195],v4,s[8:11],s25 offen offset:1024 sc1
buffer_load_dwordx2 v[196:197],v5,s[8:11],s25 offen sc1
s_and_b32 s36,s18,0xff
s_cmp_ge_u32 s36,8
s_cbranch_scc0 R_kvc3
R_kvk3:
wt vmcnt(3)
R_aw03:
ms v[136:139],v[232:235],a[192:199],v23
v_max3_u32 v246,v232,v233,v234
ms v[136:139],v[236:239],a[200:207],v23
v_max3_u32 v247,v235,v236,v237
ms v[140:143],v[232:235],a[208:215],v23
v_max3_u32 v246,v246,v238,v239
ms v[140:143],v[236:239],a[216:223],v23
v_max_u32 v246,v246,v247
ms v[144:147],v[232:235],a[224:231],v23
v_cmp_eq_u32 vcc,-1,v246
ms v[144:147],v[236:239],a[232:239],v23
pa v[136:137],v[136:137],v[138:139]
ms v[148:151],v[232:235],a[240:247],v23
cv v42,v136,v137
ms v[148:151],v[236:239],a[248:255],v23
s_cbranch_vccnz R_ar03
R_ag03:
cv v46,v136,v137
pa v[140:141],v[140:141],v[142:143]
wt vmcnt(2)
mm v[200:203],v[180:183],v[188:191],0
wt vmcnt(1)
mm v[200:203],v[184:187],v[192:195],v[200:203]
wt vmcnt(0)
mh v[240:243],v[26:27],v[196:197],0
cv v50,v140,v141
cv v54,v140,v141
pa v[144:145],v[144:145],v[146:147]
cv v58,v144,v145
cv v62,v144,v145
v_max3_f32 v198,v200,v201,v202
pa v[148:149],v[148:149],v[150:151]
cv v66,v148,v149
v_cmp_u_f32 vcc,v200,v240
v_max3_f32 v198,v198,v203,v240
R_ag13:
v_mul_f32 v224,s54,v203
cv v70,v148,v149
v_max_f32_dpp v198,v198,v198 quad_perm:[2,3,0,1] row_mask:0xf bank_mask:0xf
v_mul_f32 v199,s54,v198
v_mul_f32 v198,s54,v198
v_mul_f32 v220,s54,v200
v_mul_f32 v221,s54,v201
s_cbranch_vccnz R_ar13
R_ah13:
v_permlane16_swap_b32 v198,v199
v_max_f32 v246,v198,v199
v_max_f32 v247,v198,v199
ds_sub_rtn_u32 v226,v245,v28
v_mul_f32 v223,s54,v202
v_permlane32_swap_b32 v246,v247
v_max_f32 v198,v246,v247
v_sub_f32 v220,v220,v198
v_sub_f32 v221,v221,v198
v_exp_f32 v220,v220
v_mul_f32 v222,s54,v240
v_sub_f32 v222,v222,v198
v_exp_f32 v221,v221
v_sub_f32 v223,v223,v198
v_exp_f32 v222,v222
v_sub_f32 v224,v224,v198
v_exp_f32 v223,v223
cv v176,v220,v221
v_exp_f32 v224,v224
cv v177,v222,0
cv v179,v222,0
cv v178,v223,v224
wt lgkmcnt(0)
v_lshl_add_u32 v226,v226,30,v14
buffer_store_dword v244,v226,s[8:11],0 offen sc1
ms v[152:155],v[176:179],v[32:39],v24
l4 v[96:99],v13,s[8:11],s28 offen offset:128 sc1
ms v[156:159],v[176:179],v[40:47],v24
l4 v[100:103],v13,s[8:11],s28 offen offset:2176 sc1
ms v[160:163],v[176:179],v[48:55],v24
pa v[236:237],v[152:153],v[154:155]
ms v[164:167],v[176:179],v[56:63],v24
v_rcp_f32 v236,v236
ms v[168:171],v[176:179],v[64:71],v24
v_rcp_f32 v237,v237
pa v[156:157],v[156:157],v[158:159]
v_mul_f32 v228,v156,v236
v_mul_f32 v232,v157,v237
pa v[160:161],v[160:161],v[162:163]
v_mul_f32 v229,v160,v236
v_mul_f32 v233,v161,v237
pa v[164:165],v[164:165],v[166:167]
v_mul_f32 v230,v164,v236
v_mul_f32 v234,v165,v237
pa v[168:169],v[168:169],v[170:171]
v_mul_f32 v231,v168,v236
ds_write_b128 v20,v[228:231]
v_mul_f32 v235,v169,v237
ds_write_b128 v21,v[232:235] offset:256
w4 v[28:31],v11,s[8:11],s27 offen sc1
wt lgkmcnt(0)
s_barrier
s_buffer_load_dwordx2 s[44:45],s[8:11],s98 glc
s_buffer_load_dwordx2 s[46:47],s[8:11],s98 offset:65536 glc
mm v[188:191],v[72:75],a[192:195],0
mm v[192:195],v[72:75],a[208:211],0
mm v[196:199],v[72:75],a[224:227],0
mm v[200:203],v[72:75],a[240:243],0
mm v[188:191],v[76:79],a[196:199],v[188:191]
mm v[192:195],v[76:79],a[212:215],v[192:195]
mm v[196:199],v[76:79],a[228:231],v[196:199]
mm v[200:203],v[76:79],a[244:247],v[200:203]
mm v[188:191],v[80:83],a[200:203],v[188:191]
s_buffer_load_dwordx2 s[44:45],s[8:11],s98 glc
s_buffer_load_dwordx2 s[46:47],s[8:11],s98 offset:65536 glc
mm v[192:195],v[80:83],a[216:219],v[192:195]
mm v[196:199],v[80:83],a[232:235],v[196:199]
mm v[200:203],v[80:83],a[248:251],v[200:203]
mm v[188:191],v[84:87],a[204:207],v[188:191]
mm v[192:195],v[84:87],a[220:223],v[192:195]
mm v[196:199],v[84:87],a[236:239],v[196:199]
mm v[200:203],v[84:87],a[252:255],v[200:203]
l4 v[72:75],v12,s[8:11],s29 offen sc1
l4 v[76:79],v12,s[8:11],s29 offen offset:2048 sc1
mm v[204:207],v[88:91],a[192:195],0
mm v[208:211],v[88:91],a[208:211],0
cv v40,v188,v189
s_buffer_load_dwordx2 s[44:45],s[8:11],s98 glc
s_buffer_load_dwordx2 s[46:47],s[8:11],s98 offset:65536 glc
mm v[212:215],v[88:91],a[224:227],0
cv v41,v190,v191
mm v[216:219],v[88:91],a[240:243],0
cv v48,v192,v193
l4 v[80:83],v13,s[8:11],s29 offen sc1
l4 v[84:87],v13,s[8:11],s29 offen offset:2048 sc1
mm v[204:207],v[92:95],a[196:199],v[204:207]
cv v49,v194,v195
s_min_u32 s94,s15,2000
R_fb3:
s_and_b64 s[36:37],s[44:45],s[46:47]
s_and_b32 s36,s36,s37
s_and_b32 s36,s36,s97
s_cbranch_scc1 R_fb3_ok
s_nop 1
s_and_b64 s[36:37],s[44:45],s[46:47]
s_and_b32 s36,s36,s37
s_and_b32 s36,s36,s97
s_cbranch_scc1 R_fb3_ok
s_nop 1
s_and_b64 s[36:37],s[44:45],s[46:47]
s_and_b32 s36,s36,s37
s_and_b32 s36,s36,s97
s_cbranch_scc1 R_fb3_ok
s_nop 1
s_and_b64 s[36:37],s[44:45],s[46:47]
s_and_b32 s36,s36,s37
s_and_b32 s36,s36,s97
s_cbranch_scc1 R_fb3_ok
s_nop 1
s_buffer_load_dwordx2 s[44:45],s[8:11],s98 glc
s_buffer_load_dwordx2 s[46:47],s[8:11],s98 offset:65536 glc
s_sub_u32 s94,s94,1
s_cbranch_scc0 R_fb3
R_fb3_ok:
s_barrier
s_nop 3
l4 v[236:239],v10,s[8:11],s25 offen sc1
mm v[208:211],v[92:95],a[212:215],v[208:211]
cv v56,v196,v197
s_add_u32 s19,s24,4
mm v[212:215],v[92:95],a[228:231],v[212:215]
cv v57,v198,v199
s_min_u32 s19,s19,63
mm v[216:219],v[92:95],a[244:247],v[216:219]
cv v64,v200,v201
s_lshr_b32 s19,s19,2
l4 v[88:91],v12,s[8:11],s29 offen offset:128 sc1
l4 v[92:95],v12,s[8:11],s29 offen offset:2176 sc1
wt vmcnt(8)
mm v[204:207],v[96:99],a[200:203],v[204:207]
cv v65,v202,v203
s_lshl3_add_u32 s19,s19,s20
mm v[208:211],v[96:99],a[216:219],v[208:211]
s_lshl_b32 s19,s19,8
mm v[212:215],v[96:99],a[232:235],v[212:215]
s_add_u32 s19,s19,4227072
mm v[216:219],v[96:99],a[248:251],v[216:219]
mm v[204:207],v[100:103],a[204:207],v[204:207]
mm v[208:211],v[100:103],a[220:223],v[208:211]
mm v[212:215],v[100:103],a[236:239],v[212:215]
mm v[216:219],v[100:103],a[252:255],v[216:219]
s_mov_b32 s59,s25
s_mov_b32 s25,s26
s_and_b32 s36,s24,3
s_cbranch_scc1 R_kvn3
s_buffer_load_dword s18,s[8:11],s19 glc
R_kvn3:
wt vmcnt(2)
mm v[228:231],v[180:183],v[236:239],0
s_add_u32 s36,s88,s30
s_buffer_load_dwordx2 s[100:101],s[8:11],s36 offset:60
s_buffer_load_dwordx2 s[100:101],s[8:11],s36 offset:188
s_buffer_load_dwordx2 s[100:101],s[8:11],s36 offset:316
s_buffer_load_dwordx2 s[100:101],s[8:11],s36 offset:444
s_nop 2
v_cmp_u_f32 vcc,v228,v228
v_add_f32_dpp v228,v228,v228 row_ror:8 row_mask:0xf bank_mask:0xf
v_add_f32_dpp v229,v229,v229 row_ror:8 row_mask:0xf bank_mask:0xf
v_add_f32_dpp v230,v230,v230 row_ror:8 row_mask:0xf bank_mask:0xf
v_add_f32_dpp v231,v231,v231 row_ror:8 row_mask:0xf bank_mask:0xf
cv v232,v228,v229
cv v233,v230,v231
s_cbranch_vccnz R_br3
R_bg3:
buffer_store_dwordx2 v[232:233],v3,s[8:11],s25 offen offset:0
s_branch R_step3
R_kvc3:
s_cmp_eq_u32 s15,0
s_cbranch_scc1 R_kvk3
s_sleep 4
s_buffer_load_dword s18,s[8:11],s19 glc
s_sub_u32 s15,s15,1
s_max_i32 s15,s15,0
wt lgkmcnt(0)
s_and_b32 s36,s18,0xff
s_cmp_ge_u32 s36,8
s_cbranch_scc0 R_kvc3
s_branch R_kvk3
R_ar03:
s_cmp_eq_u32 s15,0
s_cbranch_scc1 R_ag03
l4 v[232:235],v6,s[8:11],s25 offen sc1
l4 v[236:239],v6,s[8:11],s25 offen offset:1024 sc1
l4 v[188:191],v4,s[8:11],s25 offen sc1
l4 v[192:195],v4,s[8:11],s25 offen offset:1024 sc1
buffer_load_dwordx2 v[196:197],v5,s[8:11],s25 offen sc1
s_sub_u32 s15,s15,1
s_max_i32 s15,s15,0
v_mov_b64 v[136:137],0
v_mov_b64 v[138:139],0
v_mov_b64 v[140:141],0
v_mov_b64 v[142:143],0
v_mov_b64 v[144:145],0
v_mov_b64 v[146:147],0
v_mov_b64 v[148:149],0
v_mov_b64 v[150:151],0
wt vmcnt(0)
s_branch R_aw03
R_ar13:
s_cmp_eq_u32 s15,0
s_cbranch_scc1 R_ah13
l4 v[188:191],v4,s[8:11],s25 offen sc1
l4 v[192:195],v4,s[8:11],s25 offen offset:1024 sc1
buffer_load_dwordx2 v[196:197],v5,s[8:11],s25 offen sc1
s_sub_u32 s15,s15,1
s_max_i32 s15,s15,0
wt vmcnt(2)
mm v[200:203],v[180:183],v[188:191],0
wt vmcnt(1)
mm v[200:203],v[184:187],v[192:195],v[200:203]
wt vmcnt(0)
mh v[240:243],v[26:27],v[196:197],0
s_nop 3
v_max3_f32 v198,v200,v201,v202
s_nop 2
v_cmp_u_f32 vcc,v200,v240
v_max3_f32 v198,v198,v203,v240
s_branch R_ag13
R_br3:
R_br23:
s_cmp_eq_u32 s15,0
s_cbranch_scc1 R_bg3
l4 v[236:239],v10,s[8:11],s59 offen sc1
R_br33:
s_sub_u32 s15,s15,1
s_max_i32 s15,s15,0
wt vmcnt(0)
mm v[228:231],v[180:183],v[236:239],0
s_nop 7
v_cmp_u_f32 vcc,v228,v228
v_add_f32_dpp v228,v228,v228 row_ror:8 row_mask:0xf bank_mask:0xf
v_add_f32_dpp v229,v229,v229 row_ror:8 row_mask:0xf bank_mask:0xf
v_add_f32_dpp v230,v230,v230 row_ror:8 row_mask:0xf bank_mask:0xf
v_add_f32_dpp v231,v231,v231 row_ror:8 row_mask:0xf bank_mask:0xf
cv v232,v228,v229
cv v233,v230,v231
s_cbranch_vccz R_bg3
s_branch R_br23
R_fin:
wt vmcnt(0) lgkmcnt(0)
s_barrier
s_cmp_eq_u32 s14,0
s_cbranch_scc0 R_l3
s_lshl_b32 s36,s20,8
s_add_u32 s36,s36,4196352
v_mov_b32 v188,0
v_mov_b32 v189,1
s_mov_b64 exec,1
buffer_atomic_add v189,v188,s[8:11],s36 offen sc1
s_mov_b64 exec,-1
R_l3:
L_Rtail:
s_lshl_b32 s28,s20,8
s_add_u32 s28,s28,4210880
v_bfe_u32 v8,v1,2,4
v_lshlrev_b32 v8,2,v8
buffer_load_dword v9,v8,s[8:11],s28 offen sc1
s_load_dwordx2 s[32:33],s[0:1],80
s_lshl_b32 s36,s14,14
v_bfe_u32 v5,v1,0,6
v_lshlrev_b32 v5,4,v5
v_add_u32 v2,s36,v5
ds_write_b128 v2,a[192:195] offset:0
ds_write_b128 v2,a[196:199] offset:1024
ds_write_b128 v2,a[200:203] offset:2048
ds_write_b128 v2,a[204:207] offset:3072
ds_write_b128 v2,a[208:211] offset:4096
ds_write_b128 v2,a[212:215] offset:5120
ds_write_b128 v2,a[216:219] offset:6144
ds_write_b128 v2,a[220:223] offset:7168
ds_write_b128 v2,a[224:227] offset:8192
ds_write_b128 v2,a[228:231] offset:9216
ds_write_b128 v2,a[232:235] offset:10240
ds_write_b128 v2,a[236:239] offset:11264
ds_write_b128 v2,a[240:243] offset:12288
ds_write_b128 v2,a[244:247] offset:13312
ds_write_b128 v2,a[248:251] offset:14336
ds_write_b128 v2,a[252:255] offset:15360
v_bfe_u32 v6,v1,4,2
v_lshlrev_b32 v6,9,v6
v_bfe_u32 v4,v1,0,4
v_lshl_add_u32 v6,v4,4,v6
s_lshr_b32 s38,s14,1
s_and_b32 s39,s14,1
s_lshl_b32 s30,s38,19
s_lshl_b32 s36,s20,16
s_add_u32 s30,s30,s36
s_lshl_b32 s36,s38,12
s_add_u32 s30,s30,s36
s_lshl_b32 s36,s39,8
s_add_u32 s30,s30,s36
s_add_u32 s30,s30,85991424
s_xor_b32 s30,s30,s7
s_xor_b32 s26,s30,4096
s_lshr_b32 s40,s20,2
s_and_b32 s41,s20,3
s_lshl_b32 s29,s14,19
s_lshl_b32 s36,s21,15
s_add_u32 s29,s29,s36
s_lshl_b32 s36,s40,14
s_add_u32 s29,s29,s36
s_lshl_b32 s36,s57,13
s_add_u32 s29,s29,s36
s_lshl_b32 s36,s41,11
s_add_u32 s29,s29,s36
s_add_u32 s29,s29,167772160
s_add_u32 s31,s38,8
s_lshl_b32 s31,s31,2
wt lgkmcnt(0)
s_barrier
dr a[0:3],v5 offset:0
dr a[4:7],v5 offset:1024
dr a[8:11],v5 offset:2048
dr a[12:15],v5 offset:3072
dr a[16:19],v5 offset:4096
dr a[20:23],v5 offset:5120
dr a[24:27],v5 offset:6144
dr a[28:31],v5 offset:7168
dr a[32:35],v5 offset:8192
dr a[36:39],v5 offset:9216
dr a[40:43],v5 offset:10240
dr a[44:47],v5 offset:11264
dr a[48:51],v5 offset:12288
dr a[52:55],v5 offset:13312
dr a[56:59],v5 offset:14336
dr a[60:63],v5 offset:15360
wt vmcnt(0)
s_add_u32 s37,s31,0
RT_n0:
v_readlane_b32 s36,v9,s37
s_nop 0
s_cmp_ge_u32 s36,4
s_cbranch_scc1 RT_k0
s_cmp_eq_u32 s15,0
s_cbranch_scc1 RT_k0
buffer_load_dword v9,v8,s[8:11],s28 offen sc1
s_sub_u32 s15,s15,1
s_max_i32 s15,s15,0
wt vmcnt(0)
s_branch RT_n0
RT_k0:
s_add_u32 s37,s30,58720256
l4 v[40:43],v6,s[8:11],s37 offen sc1
dr a[64:67],v5 offset:16384
dr a[68:71],v5 offset:17408
dr a[72:75],v5 offset:18432
l4 v[44:47],v6,s[8:11],s37 offen offset:2048 sc1
dr a[76:79],v5 offset:19456
dr a[80:83],v5 offset:20480
dr a[84:87],v5 offset:21504
s_add_u32 s37,s26,58720256
l4 v[48:51],v6,s[8:11],s37 offen sc1
dr a[88:91],v5 offset:22528
dr a[92:95],v5 offset:23552
dr a[96:99],v5 offset:24576
l4 v[52:55],v6,s[8:11],s37 offen offset:2048 sc1
dr a[100:103],v5 offset:25600
dr a[104:107],v5 offset:26624
dr a[108:111],v5 offset:27648
s_add_u32 s37,s30,58736640
l4 v[56:59],v6,s[8:11],s37 offen sc1
dr a[112:115],v5 offset:28672
dr a[116:119],v5 offset:29696
dr a[120:123],v5 offset:30720
l4 v[60:63],v6,s[8:11],s37 offen offset:2048 sc1
dr a[124:127],v5 offset:31744
dr a[128:131],v5 offset:32768
dr a[132:135],v5 offset:33792
s_add_u32 s37,s26,58736640
l4 v[64:67],v6,s[8:11],s37 offen sc1
dr a[136:139],v5 offset:34816
dr a[140:143],v5 offset:35840
dr a[144:147],v5 offset:36864
l4 v[68:71],v6,s[8:11],s37 offen offset:2048 sc1
dr a[148:151],v5 offset:37888
dr a[152:155],v5 offset:38912
dr a[156:159],v5 offset:39936
s_add_u32 s37,s30,58753024
l4 v[72:75],v6,s[8:11],s37 offen sc1
dr a[160:163],v5 offset:40960
dr a[164:167],v5 offset:41984
dr a[168:171],v5 offset:43008
l4 v[76:79],v6,s[8:11],s37 offen offset:2048 sc1
dr a[172:175],v5 offset:44032
dr a[176:179],v5 offset:45056
dr a[180:183],v5 offset:46080
s_add_u32 s37,s26,58753024
l4 v[80:83],v6,s[8:11],s37 offen sc1
dr a[184:187],v5 offset:47104
dr a[188:191],v5 offset:48128
dr a[192:195],v5 offset:49152
l4 v[84:87],v6,s[8:11],s37 offen offset:2048 sc1
dr a[196:199],v5 offset:50176
dr a[200:203],v5 offset:51200
dr a[204:207],v5 offset:52224
s_add_u32 s37,s30,58769408
l4 v[88:91],v6,s[8:11],s37 offen sc1
dr a[208:211],v5 offset:53248
dr a[212:215],v5 offset:54272
dr a[216:219],v5 offset:55296
l4 v[92:95],v6,s[8:11],s37 offen offset:2048 sc1
dr a[220:223],v5 offset:56320
dr a[224:227],v5 offset:57344
dr a[228:231],v5 offset:58368
s_add_u32 s37,s26,58769408
l4 v[96:99],v6,s[8:11],s37 offen sc1
dr a[232:235],v5 offset:59392
dr a[236:239],v5 offset:60416
dr a[240:243],v5 offset:61440
l4 v[100:103],v6,s[8:11],s37 offen offset:2048 sc1
dr a[244:247],v5 offset:62464
dr a[248:251],v5 offset:63488
dr a[252:255],v5 offset:64512
v_bfe_u32 v2,v1,0,1
v_lshlrev_b32 v2,4,v2
v_mov_b32 v3,0x3f80
v_lshlrev_b32 v2,v2,v3
v_bfe_u32 v3,v1,1,3
v_bfe_u32 v7,v1,4,2
v_lshlrev_b32 v7,1,v7
v_sub_u32 v3,v3,v7
v_cmp_eq_u32 vcc,0,v3
s_nop 1
v_cndmask_b32 v12,0,v2,vcc
v_cmp_eq_u32 vcc,1,v3
s_nop 1
v_cndmask_b32 v13,0,v2,vcc
v_mov_b32 v10,0
v_mov_b32 v11,0
v_mov_b32 v14,0
v_mov_b32 v15,0
v_bfe_u32 v7,v1,0,4
v_lshlrev_b32 v7,12,v7
v_bfe_u32 v4,v1,4,2
v_lshl_add_u32 v7,v4,5,v7
wt lgkmcnt(0)
s_add_u32 s37,s31,8
RT_n1:
v_readlane_b32 s36,v9,s37
s_nop 0
s_cmp_ge_u32 s36,4
s_cbranch_scc1 RT_k1
s_cmp_eq_u32 s15,0
s_cbranch_scc1 RT_k1
buffer_load_dword v9,v8,s[8:11],s28 offen sc1
s_sub_u32 s15,s15,1
s_max_i32 s15,s15,0
wt vmcnt(0)
s_branch RT_n1
RT_k1:
s_add_u32 s37,s31,16
RT_n2:
v_readlane_b32 s36,v9,s37
s_nop 0
s_cmp_ge_u32 s36,4
s_cbranch_scc1 RT_k2
s_cmp_eq_u32 s15,0
s_cbranch_scc1 RT_k2
buffer_load_dword v9,v8,s[8:11],s28 offen sc1
s_sub_u32 s15,s15,1
s_max_i32 s15,s15,0
wt vmcnt(0)
s_branch RT_n2
RT_k2:
wt vmcnt(15)
mm v[16:19],a[0:3],v[40:43],0
s_add_u32 s37,s30,59785216
l4 v[104:107],v6,s[8:11],s37 offen sc1
mm v[20:23],a[16:19],v[40:43],0
mm v[24:27],a[32:35],v[40:43],0
l4 v[108:111],v6,s[8:11],s37 offen offset:2048 sc1
mm v[28:31],a[48:51],v[40:43],0
wt vmcnt(16)
mm v[16:19],a[4:7],v[44:47],v[16:19]
s_add_u32 s37,s26,59785216
l4 v[112:115],v6,s[8:11],s37 offen sc1
mm v[20:23],a[20:23],v[44:47],v[20:23]
mm v[24:27],a[36:39],v[44:47],v[24:27]
l4 v[116:119],v6,s[8:11],s37 offen offset:2048 sc1
mm v[28:31],a[52:55],v[44:47],v[28:31]
wt vmcnt(17)
mm v[16:19],a[8:11],v[48:51],v[16:19]
s_add_u32 s37,s30,59768832
l4 v[120:123],v6,s[8:11],s37 offen sc1
mm v[20:23],a[24:27],v[48:51],v[20:23]
mm v[24:27],a[40:43],v[48:51],v[24:27]
l4 v[124:127],v6,s[8:11],s37 offen offset:2048 sc1
mm v[28:31],a[56:59],v[48:51],v[28:31]
wt vmcnt(18)
mm v[16:19],a[12:15],v[52:55],v[16:19]
s_add_u32 s37,s26,59768832
l4 v[128:131],v6,s[8:11],s37 offen sc1
mm v[20:23],a[28:31],v[52:55],v[20:23]
mm v[24:27],a[44:47],v[52:55],v[24:27]
l4 v[132:135],v6,s[8:11],s37 offen offset:2048 sc1
mm v[28:31],a[60:63],v[52:55],v[28:31]
wt vmcnt(19)
mm v[16:19],a[64:67],v[56:59],v[16:19]
s_add_u32 s37,s30,59817984
l4 v[136:139],v6,s[8:11],s37 offen sc1
mm v[20:23],a[80:83],v[56:59],v[20:23]
mm v[24:27],a[96:99],v[56:59],v[24:27]
l4 v[140:143],v6,s[8:11],s37 offen offset:2048 sc1
mm v[28:31],a[112:115],v[56:59],v[28:31]
wt vmcnt(20)
mm v[16:19],a[68:71],v[60:63],v[16:19]
s_add_u32 s37,s26,59817984
l4 v[144:147],v6,s[8:11],s37 offen sc1
mm v[20:23],a[84:87],v[60:63],v[20:23]
mm v[24:27],a[100:103],v[60:63],v[24:27]
l4 v[148:151],v6,s[8:11],s37 offen offset:2048 sc1
mm v[28:31],a[116:119],v[60:63],v[28:31]
wt vmcnt(21)
mm v[16:19],a[72:75],v[64:67],v[16:19]
s_add_u32 s37,s30,59801600
l4 v[152:155],v6,s[8:11],s37 offen sc1
mm v[20:23],a[88:91],v[64:67],v[20:23]
mm v[24:27],a[104:107],v[64:67],v[24:27]
l4 v[156:159],v6,s[8:11],s37 offen offset:2048 sc1
mm v[28:31],a[120:123],v[64:67],v[28:31]
wt vmcnt(22)
mm v[16:19],a[76:79],v[68:71],v[16:19]
s_add_u32 s37,s26,59801600
l4 v[160:163],v6,s[8:11],s37 offen sc1
mm v[20:23],a[92:95],v[68:71],v[20:23]
mm v[24:27],a[108:111],v[68:71],v[24:27]
l4 v[164:167],v6,s[8:11],s37 offen offset:2048 sc1
mm v[28:31],a[124:127],v[68:71],v[28:31]
wt vmcnt(23)
mm v[16:19],a[128:131],v[72:75],v[16:19]
s_add_u32 s37,s30,62914560
l4 v[168:171],v6,s[8:11],s37 offen sc1
mm v[20:23],a[144:147],v[72:75],v[20:23]
mm v[24:27],a[160:163],v[72:75],v[24:27]
l4 v[172:175],v6,s[8:11],s37 offen offset:2048 sc1
mm v[28:31],a[176:179],v[72:75],v[28:31]
wt vmcnt(24)
mm v[16:19],a[132:135],v[76:79],v[16:19]
s_add_u32 s37,s26,62914560
l4 v[176:179],v6,s[8:11],s37 offen sc1
mm v[20:23],a[148:151],v[76:79],v[20:23]
mm v[24:27],a[164:167],v[76:79],v[24:27]
l4 v[180:183],v6,s[8:11],s37 offen offset:2048 sc1
mm v[28:31],a[180:183],v[76:79],v[28:31]
wt vmcnt(25)
mm v[16:19],a[136:139],v[80:83],v[16:19]
s_add_u32 s37,s30,62930944
l4 v[184:187],v6,s[8:11],s37 offen sc1
mm v[20:23],a[152:155],v[80:83],v[20:23]
mm v[24:27],a[168:171],v[80:83],v[24:27]
l4 v[188:191],v6,s[8:11],s37 offen offset:2048 sc1
mm v[28:31],a[184:187],v[80:83],v[28:31]
wt vmcnt(26)
mm v[16:19],a[140:143],v[84:87],v[16:19]
s_add_u32 s37,s26,62930944
l4 v[192:195],v6,s[8:11],s37 offen sc1
mm v[20:23],a[156:159],v[84:87],v[20:23]
mm v[24:27],a[172:175],v[84:87],v[24:27]
l4 v[196:199],v6,s[8:11],s37 offen offset:2048 sc1
mm v[28:31],a[188:191],v[84:87],v[28:31]
wt vmcnt(27)
mm v[16:19],a[192:195],v[88:91],v[16:19]
s_add_u32 s37,s30,62947328
l4 v[200:203],v6,s[8:11],s37 offen sc1
mm v[20:23],a[208:211],v[88:91],v[20:23]
mm v[24:27],a[224:227],v[88:91],v[24:27]
l4 v[204:207],v6,s[8:11],s37 offen offset:2048 sc1
mm v[28:31],a[240:243],v[88:91],v[28:31]
wt vmcnt(28)
mm v[16:19],a[196:199],v[92:95],v[16:19]
s_add_u32 s37,s26,62947328
l4 v[208:211],v6,s[8:11],s37 offen sc1
mm v[20:23],a[212:215],v[92:95],v[20:23]
mm v[24:27],a[228:231],v[92:95],v[24:27]
l4 v[212:215],v6,s[8:11],s37 offen offset:2048 sc1
mm v[28:31],a[244:247],v[92:95],v[28:31]
wt vmcnt(29)
mm v[16:19],a[200:203],v[96:99],v[16:19]
s_add_u32 s37,s30,62963712
l4 v[216:219],v6,s[8:11],s37 offen sc1
mm v[20:23],a[216:219],v[96:99],v[20:23]
mm v[24:27],a[232:235],v[96:99],v[24:27]
l4 v[220:223],v6,s[8:11],s37 offen offset:2048 sc1
mm v[28:31],a[248:251],v[96:99],v[28:31]
wt vmcnt(30)
mm v[16:19],a[204:207],v[100:103],v[16:19]
s_add_u32 s37,s26,62963712
l4 v[224:227],v6,s[8:11],s37 offen sc1
mm v[20:23],a[220:223],v[100:103],v[20:23]
mm v[24:27],a[236:239],v[100:103],v[24:27]
l4 v[228:231],v6,s[8:11],s37 offen offset:2048 sc1
mm v[28:31],a[252:255],v[100:103],v[28:31]
s_add_u32 s37,s29,0
cv v32,v16,v20
cv v34,v17,v21
cv v36,v18,v22
cv v38,v19,v23
s_nop 2
cv v33,v24,v28
cv v35,v25,v29
cv v37,v26,v30
cv v39,v27,v31
w4 v[32:35],v5,s[8:11],s37 offen sc1
w4 v[36:39],v5,s[8:11],s37 offen offset:1024 sc1
wt vmcnt(33)
mm v[16:19],a[0:3],v[104:107],0
mm v[20:23],a[16:19],v[104:107],0
mm v[24:27],a[32:35],v[104:107],0
mm v[28:31],a[48:51],v[104:107],0
wt vmcnt(32)
mm v[16:19],a[4:7],v[108:111],v[16:19]
mm v[20:23],a[20:23],v[108:111],v[20:23]
mm v[24:27],a[36:39],v[108:111],v[24:27]
mm v[28:31],a[52:55],v[108:111],v[28:31]
wt vmcnt(31)
mm v[16:19],a[8:11],v[112:115],v[16:19]
mm v[20:23],a[24:27],v[112:115],v[20:23]
mm v[24:27],a[40:43],v[112:115],v[24:27]
mm v[28:31],a[56:59],v[112:115],v[28:31]
wt vmcnt(30)
mm v[16:19],a[12:15],v[116:119],v[16:19]
mm v[20:23],a[28:31],v[116:119],v[20:23]
mm v[24:27],a[44:47],v[116:119],v[24:27]
mm v[28:31],a[60:63],v[116:119],v[28:31]
wt vmcnt(29)
mm v[16:19],a[64:67],v[120:123],v[16:19]
mm v[20:23],a[80:83],v[120:123],v[20:23]
mm v[24:27],a[96:99],v[120:123],v[24:27]
mm v[28:31],a[112:115],v[120:123],v[28:31]
wt vmcnt(28)
mm v[16:19],a[68:71],v[124:127],v[16:19]
mm v[20:23],a[84:87],v[124:127],v[20:23]
mm v[24:27],a[100:103],v[124:127],v[24:27]
mm v[28:31],a[116:119],v[124:127],v[28:31]
wt vmcnt(27)
mm v[16:19],a[72:75],v[128:131],v[16:19]
mm v[20:23],a[88:91],v[128:131],v[20:23]
mm v[24:27],a[104:107],v[128:131],v[24:27]
mm v[28:31],a[120:123],v[128:131],v[28:31]
wt vmcnt(26)
mm v[16:19],a[76:79],v[132:135],v[16:19]
mm v[20:23],a[92:95],v[132:135],v[20:23]
mm v[24:27],a[108:111],v[132:135],v[24:27]
mm v[28:31],a[124:127],v[132:135],v[28:31]
wt vmcnt(25)
mm v[16:19],a[128:131],v[136:139],v[16:19]
mm v[20:23],a[144:147],v[136:139],v[20:23]
mm v[24:27],a[160:163],v[136:139],v[24:27]
mm v[28:31],a[176:179],v[136:139],v[28:31]
wt vmcnt(24)
mm v[16:19],a[132:135],v[140:143],v[16:19]
mm v[20:23],a[148:151],v[140:143],v[20:23]
mm v[24:27],a[164:167],v[140:143],v[24:27]
mm v[28:31],a[180:183],v[140:143],v[28:31]
wt vmcnt(23)
mm v[16:19],a[136:139],v[144:147],v[16:19]
mm v[20:23],a[152:155],v[144:147],v[20:23]
mm v[24:27],a[168:171],v[144:147],v[24:27]
mm v[28:31],a[184:187],v[144:147],v[28:31]
wt vmcnt(22)
mm v[16:19],a[140:143],v[148:151],v[16:19]
mm v[20:23],a[156:159],v[148:151],v[20:23]
mm v[24:27],a[172:175],v[148:151],v[24:27]
mm v[28:31],a[188:191],v[148:151],v[28:31]
wt vmcnt(21)
mm v[16:19],a[192:195],v[152:155],v[16:19]
mm v[20:23],a[208:211],v[152:155],v[20:23]
mm v[24:27],a[224:227],v[152:155],v[24:27]
mm v[28:31],a[240:243],v[152:155],v[28:31]
wt vmcnt(20)
mm v[16:19],a[196:199],v[156:159],v[16:19]
mm v[20:23],a[212:215],v[156:159],v[20:23]
mm v[24:27],a[228:231],v[156:159],v[24:27]
mm v[28:31],a[244:247],v[156:159],v[28:31]
wt vmcnt(19)
mm v[16:19],a[200:203],v[160:163],v[16:19]
mm v[20:23],a[216:219],v[160:163],v[20:23]
mm v[24:27],a[232:235],v[160:163],v[24:27]
mm v[28:31],a[248:251],v[160:163],v[28:31]
wt vmcnt(18)
mm v[16:19],a[204:207],v[164:167],v[16:19]
mm v[20:23],a[220:223],v[164:167],v[20:23]
mm v[24:27],a[236:239],v[164:167],v[24:27]
mm v[28:31],a[252:255],v[164:167],v[28:31]
s_add_u32 s37,s29,4194304
cv v32,v16,v20
cv v34,v17,v21
cv v36,v18,v22
cv v38,v19,v23
s_nop 2
cv v33,v24,v28
cv v35,v25,v29
cv v37,v26,v30
cv v39,v27,v31
w4 v[32:35],v5,s[8:11],s37 offen sc1
w4 v[36:39],v5,s[8:11],s37 offen offset:1024 sc1
wt vmcnt(19)
mm v[16:19],a[0:3],v[168:171],0
mm v[20:23],a[16:19],v[168:171],0
mm v[24:27],a[32:35],v[168:171],0
mm v[28:31],a[48:51],v[168:171],0
wt vmcnt(18)
mm v[16:19],a[4:7],v[172:175],v[16:19]
mm v[20:23],a[20:23],v[172:175],v[20:23]
mm v[24:27],a[36:39],v[172:175],v[24:27]
mm v[28:31],a[52:55],v[172:175],v[28:31]
wt vmcnt(17)
mm v[16:19],a[8:11],v[176:179],v[16:19]
mm v[20:23],a[24:27],v[176:179],v[20:23]
mm v[24:27],a[40:43],v[176:179],v[24:27]
mm v[28:31],a[56:59],v[176:179],v[28:31]
wt vmcnt(16)
mm v[16:19],a[12:15],v[180:183],v[16:19]
mm v[20:23],a[28:31],v[180:183],v[20:23]
mm v[24:27],a[44:47],v[180:183],v[24:27]
mm v[28:31],a[60:63],v[180:183],v[28:31]
wt vmcnt(15)
mm v[16:19],a[64:67],v[184:187],v[16:19]
mm v[20:23],a[80:83],v[184:187],v[20:23]
mm v[24:27],a[96:99],v[184:187],v[24:27]
mm v[28:31],a[112:115],v[184:187],v[28:31]
wt vmcnt(14)
mm v[16:19],a[68:71],v[188:191],v[16:19]
mm v[20:23],a[84:87],v[188:191],v[20:23]
mm v[24:27],a[100:103],v[188:191],v[24:27]
mm v[28:31],a[116:119],v[188:191],v[28:31]
wt vmcnt(13)
mm v[16:19],a[72:75],v[192:195],v[16:19]
mm v[20:23],a[88:91],v[192:195],v[20:23]
mm v[24:27],a[104:107],v[192:195],v[24:27]
mm v[28:31],a[120:123],v[192:195],v[28:31]
wt vmcnt(12)
mm v[16:19],a[76:79],v[196:199],v[16:19]
mm v[20:23],a[92:95],v[196:199],v[20:23]
mm v[24:27],a[108:111],v[196:199],v[24:27]
mm v[28:31],a[124:127],v[196:199],v[28:31]
wt vmcnt(11)
mm v[16:19],a[128:131],v[200:203],v[16:19]
mm v[20:23],a[144:147],v[200:203],v[20:23]
mm v[24:27],a[160:163],v[200:203],v[24:27]
mm v[28:31],a[176:179],v[200:203],v[28:31]
wt vmcnt(10)
mm v[16:19],a[132:135],v[204:207],v[16:19]
mm v[20:23],a[148:151],v[204:207],v[20:23]
mm v[24:27],a[164:167],v[204:207],v[24:27]
mm v[28:31],a[180:183],v[204:207],v[28:31]
wt vmcnt(9)
mm v[16:19],a[136:139],v[208:211],v[16:19]
mm v[20:23],a[152:155],v[208:211],v[20:23]
mm v[24:27],a[168:171],v[208:211],v[24:27]
mm v[28:31],a[184:187],v[208:211],v[28:31]
wt vmcnt(8)
mm v[16:19],a[140:143],v[212:215],v[16:19]
mm v[20:23],a[156:159],v[212:215],v[20:23]
mm v[24:27],a[172:175],v[212:215],v[24:27]
mm v[28:31],a[188:191],v[212:215],v[28:31]
wt vmcnt(7)
mm v[16:19],a[192:195],v[216:219],v[16:19]
mm v[20:23],a[208:211],v[216:219],v[20:23]
mm v[24:27],a[224:227],v[216:219],v[24:27]
mm v[28:31],a[240:243],v[216:219],v[28:31]
wt vmcnt(6)
mm v[16:19],a[196:199],v[220:223],v[16:19]
mm v[20:23],a[212:215],v[220:223],v[20:23]
mm v[24:27],a[228:231],v[220:223],v[24:27]
mm v[28:31],a[244:247],v[220:223],v[28:31]
wt vmcnt(5)
mm v[16:19],a[200:203],v[224:227],v[16:19]
mm v[20:23],a[216:219],v[224:227],v[20:23]
mm v[24:27],a[232:235],v[224:227],v[24:27]
mm v[28:31],a[248:251],v[224:227],v[28:31]
wt vmcnt(4)
mm v[16:19],a[204:207],v[228:231],v[16:19]
mm v[20:23],a[220:223],v[228:231],v[20:23]
mm v[24:27],a[236:239],v[228:231],v[24:27]
mm v[28:31],a[252:255],v[228:231],v[28:31]
s_add_u32 s37,s29,8388608
cv v32,v16,v20
cv v34,v17,v21
cv v36,v18,v22
cv v38,v19,v23
s_nop 2
cv v33,v24,v28
cv v35,v25,v29
cv v37,v26,v30
cv v39,v27,v31
w4 v[32:35],v5,s[8:11],s37 offen sc1
w4 v[36:39],v5,s[8:11],s37 offen offset:1024 sc1
s_lshl_b32 s39,s21,8
s_lshl_b32 s36,s20,2
s_add_u32 s39,s39,s36
s_add_u32 s39,s39,4214784
wt vmcnt(2)
s_barrier
v_mov_b32 v3,1
s_cmp_eq_u32 s14,3
s_cselect_b32 s39,s39,0x40000000
s_mov_b64 exec,1
buffer_store_dword v3,v5,s[8:11],s39 offen sc1
s_mov_b64 exec,-1
s_add_u32 s37,s31,24
RT_n3:
v_readlane_b32 s36,v9,s37
s_nop 0
s_cmp_ge_u32 s36,4
s_cbranch_scc1 RT_k3
s_cmp_eq_u32 s15,0
s_cbranch_scc1 RT_k3
buffer_load_dword v9,v8,s[8:11],s28 offen sc1
s_sub_u32 s15,s15,1
s_max_i32 s15,s15,0
wt vmcnt(0)
s_branch RT_n3
RT_k3:
s_add_u32 s37,s30,63979520
l4 v[40:43],v6,s[8:11],s37 offen sc1
l4 v[44:47],v6,s[8:11],s37 offen offset:2048 sc1
s_add_u32 s37,s26,63979520
l4 v[48:51],v6,s[8:11],s37 offen sc1
l4 v[52:55],v6,s[8:11],s37 offen offset:2048 sc1
s_add_u32 s37,s30,63963136
l4 v[56:59],v6,s[8:11],s37 offen sc1
l4 v[60:63],v6,s[8:11],s37 offen offset:2048 sc1
s_add_u32 s37,s26,63963136
l4 v[64:67],v6,s[8:11],s37 offen sc1
l4 v[68:71],v6,s[8:11],s37 offen offset:2048 sc1
s_add_u32 s37,s30,64012288
l4 v[72:75],v6,s[8:11],s37 offen sc1
l4 v[76:79],v6,s[8:11],s37 offen offset:2048 sc1
s_add_u32 s37,s26,64012288
l4 v[80:83],v6,s[8:11],s37 offen sc1
l4 v[84:87],v6,s[8:11],s37 offen offset:2048 sc1
s_add_u32 s37,s30,63995904
l4 v[88:91],v6,s[8:11],s37 offen sc1
l4 v[92:95],v6,s[8:11],s37 offen offset:2048 sc1
s_add_u32 s37,s26,63995904
l4 v[96:99],v6,s[8:11],s37 offen sc1
l4 v[100:103],v6,s[8:11],s37 offen offset:2048 sc1
wt vmcnt(15)
mm v[16:19],a[0:3],v[40:43],0
mm v[20:23],a[16:19],v[40:43],0
mm v[24:27],a[32:35],v[40:43],0
mm v[28:31],a[48:51],v[40:43],0
wt vmcnt(14)
mm v[16:19],a[4:7],v[44:47],v[16:19]
mm v[20:23],a[20:23],v[44:47],v[20:23]
mm v[24:27],a[36:39],v[44:47],v[24:27]
mm v[28:31],a[52:55],v[44:47],v[28:31]
wt vmcnt(13)
mm v[16:19],a[8:11],v[48:51],v[16:19]
mm v[20:23],a[24:27],v[48:51],v[20:23]
mm v[24:27],a[40:43],v[48:51],v[24:27]
mm v[28:31],a[56:59],v[48:51],v[28:31]
wt vmcnt(12)
mm v[16:19],a[12:15],v[52:55],v[16:19]
mm v[20:23],a[28:31],v[52:55],v[20:23]
mm v[24:27],a[44:47],v[52:55],v[24:27]
mm v[28:31],a[60:63],v[52:55],v[28:31]
wt vmcnt(11)
mm v[16:19],a[64:67],v[56:59],v[16:19]
mm v[20:23],a[80:83],v[56:59],v[20:23]
mm v[24:27],a[96:99],v[56:59],v[24:27]
mm v[28:31],a[112:115],v[56:59],v[28:31]
wt vmcnt(10)
mm v[16:19],a[68:71],v[60:63],v[16:19]
mm v[20:23],a[84:87],v[60:63],v[20:23]
mm v[24:27],a[100:103],v[60:63],v[24:27]
mm v[28:31],a[116:119],v[60:63],v[28:31]
wt vmcnt(9)
mm v[16:19],a[72:75],v[64:67],v[16:19]
mm v[20:23],a[88:91],v[64:67],v[20:23]
mm v[24:27],a[104:107],v[64:67],v[24:27]
mm v[28:31],a[120:123],v[64:67],v[28:31]
wt vmcnt(8)
mm v[16:19],a[76:79],v[68:71],v[16:19]
mm v[20:23],a[92:95],v[68:71],v[20:23]
mm v[24:27],a[108:111],v[68:71],v[24:27]
mm v[28:31],a[124:127],v[68:71],v[28:31]
wt vmcnt(7)
mm v[16:19],a[128:131],v[72:75],v[16:19]
mm v[20:23],a[144:147],v[72:75],v[20:23]
mm v[24:27],a[160:163],v[72:75],v[24:27]
mm v[28:31],a[176:179],v[72:75],v[28:31]
wt vmcnt(6)
mm v[16:19],a[132:135],v[76:79],v[16:19]
mm v[20:23],a[148:151],v[76:79],v[20:23]
mm v[24:27],a[164:167],v[76:79],v[24:27]
mm v[28:31],a[180:183],v[76:79],v[28:31]
wt vmcnt(5)
mm v[16:19],a[136:139],v[80:83],v[16:19]
mm v[20:23],a[152:155],v[80:83],v[20:23]
mm v[24:27],a[168:171],v[80:83],v[24:27]
mm v[28:31],a[184:187],v[80:83],v[28:31]
wt vmcnt(4)
mm v[16:19],a[140:143],v[84:87],v[16:19]
mm v[20:23],a[156:159],v[84:87],v[20:23]
mm v[24:27],a[172:175],v[84:87],v[24:27]
mm v[28:31],a[188:191],v[84:87],v[28:31]
wt vmcnt(3)
mm v[16:19],a[192:195],v[88:91],v[16:19]
mm v[20:23],a[208:211],v[88:91],v[20:23]
mm v[24:27],a[224:227],v[88:91],v[24:27]
mm v[28:31],a[240:243],v[88:91],v[28:31]
wt vmcnt(2)
mm v[16:19],a[196:199],v[92:95],v[16:19]
mm v[20:23],a[212:215],v[92:95],v[20:23]
mm v[24:27],a[228:231],v[92:95],v[24:27]
mm v[28:31],a[244:247],v[92:95],v[28:31]
wt vmcnt(1)
mm v[16:19],a[200:203],v[96:99],v[16:19]
mm v[20:23],a[216:219],v[96:99],v[20:23]
mm v[24:27],a[232:235],v[96:99],v[24:27]
mm v[28:31],a[248:251],v[96:99],v[28:31]
wt vmcnt(0)
mm v[16:19],a[204:207],v[100:103],v[16:19]
mm v[20:23],a[220:223],v[100:103],v[20:23]
mm v[24:27],a[236:239],v[100:103],v[24:27]
mm v[28:31],a[252:255],v[100:103],v[28:31]
s_add_u32 s37,s29,12582912
cv v32,v16,v20
cv v34,v17,v21
cv v36,v18,v22
cv v38,v19,v23
s_nop 2
cv v33,v24,v28
cv v35,v25,v29
cv v37,v26,v30
cv v39,v27,v31
w4 v[32:35],v5,s[8:11],s37 offen sc1
w4 v[36:39],v5,s[8:11],s37 offen offset:1024 sc1
s_lshl_b32 s38,s21,8
s_add_u32 s38,s38,4214784
s_lshl_b32 s39,s20,2
s_lshl_b32 s36,s38,0
s_add_u32 s39,s39,s36
s_add_u32 s39,s39,128
v_bfe_u32 v2,v1,0,3
v_lshlrev_b32 v2,2,v2
s_mov_b32 s34,0x800000
s_mov_b32 s35,0x20000
s_lshl3_add_u32 s40,s14,s20
s_cmp_eq_u32 s14,1
s_cselect_b32 s41,128,0
s_add_u32 s38,s38,s41
v_mov_b32 v3,1
wt vmcnt(0)
s_barrier
s_cmp_eq_u32 s14,3
s_cbranch_scc0 RT_q
s_mov_b64 exec,1
buffer_store_dword v3,v2,s[8:11],s39 offen sc1
s_mov_b64 exec,-1
RT_q:
s_cmp_ge_u32 s14,2
s_cbranch_scc1 RT_end
s_lshl_b32 s29,s40,19
s_and_b32 s36,s29,0xffe00000
s_add_u32 s29,s29,s36
s_lshl_b32 s41,s21,15
s_lshl_b32 s36,s57,13
s_add_u32 s41,s41,s36
s_add_u32 s41,s41,167772160
s_add_u32 s29,s29,s41
s_lshl_b32 s30,s40,16
s_lshl_b32 s36,s21,7
s_add_u32 s30,s30,s36
s_add_u32 s30,s30,7340032
RT_p:
buffer_load_dword v3,v2,s[8:11],s38 offen sc1
s_sub_u32 s15,s15,1
s_max_i32 s15,s15,0
wt vmcnt(0)
v_cmp_ne_u32 vcc,1,v3
s_cbranch_vccz RT_pk
s_cmp_lg_u32 s15,0
s_cbranch_scc1 RT_p
RT_pk:
s_add_u32 s37,s29,0
l4 v[40:43],v5,s[8:11],s37 offen sc1
l4 v[44:47],v5,s[8:11],s37 offen offset:1024 sc1
l4 v[48:51],v5,s[8:11],s37 offen offset:2048 sc1
l4 v[52:55],v5,s[8:11],s37 offen offset:3072 sc1
s_add_u32 s37,s29,4096
l4 v[56:59],v5,s[8:11],s37 offen sc1
l4 v[60:63],v5,s[8:11],s37 offen offset:1024 sc1
l4 v[64:67],v5,s[8:11],s37 offen offset:2048 sc1
l4 v[68:71],v5,s[8:11],s37 offen offset:3072 sc1
s_add_u32 s37,s29,16384
l4 v[72:75],v5,s[8:11],s37 offen sc1
l4 v[76:79],v5,s[8:11],s37 offen offset:1024 sc1
l4 v[80:83],v5,s[8:11],s37 offen offset:2048 sc1
l4 v[84:87],v5,s[8:11],s37 offen offset:3072 sc1
s_add_u32 s37,s29,20480
l4 v[88:91],v5,s[8:11],s37 offen sc1
l4 v[92:95],v5,s[8:11],s37 offen offset:1024 sc1
l4 v[96:99],v5,s[8:11],s37 offen offset:2048 sc1
l4 v[100:103],v5,s[8:11],s37 offen offset:3072 sc1
wt vmcnt(15)
mm v[16:19],v[12:15],v[40:43],0
mm v[20:23],v[10:13],v[40:43],0
wt vmcnt(14)
mm v[24:27],v[12:15],v[44:47],0
mm v[28:31],v[10:13],v[44:47],0
wt vmcnt(13)
mm v[16:19],v[12:15],v[48:51],v[16:19]
mm v[20:23],v[10:13],v[48:51],v[20:23]
wt vmcnt(12)
mm v[24:27],v[12:15],v[52:55],v[24:27]
mm v[28:31],v[10:13],v[52:55],v[28:31]
wt vmcnt(11)
mm v[16:19],v[12:15],v[56:59],v[16:19]
mm v[20:23],v[10:13],v[56:59],v[20:23]
wt vmcnt(10)
mm v[24:27],v[12:15],v[60:63],v[24:27]
mm v[28:31],v[10:13],v[60:63],v[28:31]
wt vmcnt(9)
mm v[16:19],v[12:15],v[64:67],v[16:19]
mm v[20:23],v[10:13],v[64:67],v[20:23]
wt vmcnt(8)
mm v[24:27],v[12:15],v[68:71],v[24:27]
mm v[28:31],v[10:13],v[68:71],v[28:31]
wt vmcnt(7)
mm v[16:19],v[12:15],v[72:75],v[16:19]
mm v[20:23],v[10:13],v[72:75],v[20:23]
wt vmcnt(6)
mm v[24:27],v[12:15],v[76:79],v[24:27]
mm v[28:31],v[10:13],v[76:79],v[28:31]
wt vmcnt(5)
mm v[16:19],v[12:15],v[80:83],v[16:19]
mm v[20:23],v[10:13],v[80:83],v[20:23]
wt vmcnt(4)
mm v[24:27],v[12:15],v[84:87],v[24:27]
mm v[28:31],v[10:13],v[84:87],v[28:31]
wt vmcnt(3)
mm v[16:19],v[12:15],v[88:91],v[16:19]
mm v[20:23],v[10:13],v[88:91],v[20:23]
wt vmcnt(2)
mm v[24:27],v[12:15],v[92:95],v[24:27]
mm v[28:31],v[10:13],v[92:95],v[28:31]
wt vmcnt(1)
mm v[16:19],v[12:15],v[96:99],v[16:19]
mm v[20:23],v[10:13],v[96:99],v[20:23]
wt vmcnt(0)
mm v[24:27],v[12:15],v[100:103],v[24:27]
mm v[28:31],v[10:13],v[100:103],v[28:31]
cv v32,v16,v17
cv v33,v18,v19
cv v34,v20,v21
cv v35,v22,v23
cv v36,v24,v25
cv v37,v26,v27
s_nop 1
cv v38,v28,v29
cv v39,v30,v31
w4 v[32:35],v7,s[32:35],s30 offen offset:0
w4 v[36:39],v7,s[32:35],s30 offen offset:16
RT_end:
s_endpgm
L_Rslow:
wt vmcnt(0)
R_kv0s:
v_readfirstlane_b32 s18,v225
s_nop 0
s_and_b32 s36,s18,0xff
s_cmp_ge_u32 s36,8
s_cbranch_scc1 R_kv0ks
s_cmp_eq_u32 s15,0
s_cbranch_scc1 R_kv0ks
buffer_load_dword v225,v224,s[8:11],s19 offen sc1
s_sub_u32 s15,s15,1
s_max_i32 s15,s15,0
wt vmcnt(0)
s_branch R_kv0s
R_kv0ks:
s_xor_b32 s36,s7,0
v_xor_b32 v12,s36,v12
v_xor_b32 v13,s36,v13
s_xor_b32 s88,s88,s36
s_xor_b32 s89,s89,s36
s_bitcmp1_b32 s14,0
s_cselect_b32 s36,0,s36
v_xor_b32 v11,s36,v11
s_mov_b32 s29,0
l4 v[72:75],v12,s[8:11],s29 offen sc1
l4 v[76:79],v12,s[8:11],s29 offen offset:2048 sc1
l4 v[80:83],v13,s[8:11],s29 offen sc1
l4 v[84:87],v13,s[8:11],s29 offen offset:2048 sc1
l4 v[88:91],v12,s[8:11],s29 offen offset:128 sc1
l4 v[92:95],v12,s[8:11],s29 offen offset:2176 sc1
l4 v[96:99],v13,s[8:11],s29 offen offset:128 sc1
l4 v[100:103],v13,s[8:11],s29 offen offset:2176 sc1
l4 v[104:107],v11,s[8:11],s29 offen sc1
l4 v[108:111],v11,s[8:11],s29 offen offset:256 sc1
v_mov_b64 v[112:113],0
v_mov_b64 v[114:115],0
v_mov_b64 v[116:117],0
v_mov_b64 v[118:119],0
v_mov_b64 v[120:121],0
v_mov_b64 v[122:123],0
v_mov_b64 v[124:125],0
v_mov_b64 v[126:127],0
v_mov_b64 v[128:129],0
v_mov_b64 v[130:131],0
v_mov_b64 v[132:133],0
v_mov_b64 v[134:135],0
v_mov_b64 v[136:137],0
v_mov_b64 v[138:139],0
v_mov_b64 v[140:141],0
v_mov_b64 v[142:143],0
v_mov_b64 v[144:145],0
v_mov_b64 v[146:147],0
v_mov_b64 v[148:149],0
v_mov_b64 v[150:151],0
v_mov_b64 v[152:153],0
v_mov_b64 v[154:155],0
v_mov_b64 v[156:157],0
v_mov_b64 v[158:159],0
v_mov_b64 v[160:161],0
v_mov_b64 v[162:163],0
v_mov_b64 v[164:165],0
v_mov_b64 v[166:167],0
v_mov_b64 v[168:169],0
v_mov_b64 v[170:171],0
s_mov_b32 s29,524288
wt vmcnt(9)
mm v[188:191],v[72:75],a[192:195],0
mm v[192:195],v[72:75],a[208:211],0
mm v[196:199],v[72:75],a[224:227],0
mm v[200:203],v[72:75],a[240:243],0
l4 v[72:75],v12,s[8:11],s29 offen sc1
wt vmcnt(9)
mm v[188:191],v[76:79],a[196:199],v[188:191]
mm v[192:195],v[76:79],a[212:215],v[192:195]
mm v[196:199],v[76:79],a[228:231],v[196:199]
mm v[200:203],v[76:79],a[244:247],v[200:203]
l4 v[76:79],v12,s[8:11],s29 offen offset:2048 sc1
wt vmcnt(9)
mm v[188:191],v[80:83],a[200:203],v[188:191]
mm v[192:195],v[80:83],a[216:219],v[192:195]
mm v[196:199],v[80:83],a[232:235],v[196:199]
mm v[200:203],v[80:83],a[248:251],v[200:203]
l4 v[80:83],v13,s[8:11],s29 offen sc1
wt vmcnt(9)
mm v[188:191],v[84:87],a[204:207],v[188:191]
mm v[192:195],v[84:87],a[220:223],v[192:195]
mm v[196:199],v[84:87],a[236:239],v[196:199]
mm v[200:203],v[84:87],a[252:255],v[200:203]
l4 v[84:87],v13,s[8:11],s29 offen offset:2048 sc1
wt vmcnt(9)
mm v[204:207],v[88:91],a[192:195],0
mm v[208:211],v[88:91],a[208:211],0
mm v[212:215],v[88:91],a[224:227],0
mm v[216:219],v[88:91],a[240:243],0
l4 v[88:91],v12,s[8:11],s29 offen offset:128 sc1
wt vmcnt(9)
mm v[204:207],v[92:95],a[196:199],v[204:207]
mm v[208:211],v[92:95],a[212:215],v[208:211]
mm v[212:215],v[92:95],a[228:231],v[212:215]
mm v[216:219],v[92:95],a[244:247],v[216:219]
l4 v[92:95],v12,s[8:11],s29 offen offset:2176 sc1
wt vmcnt(9)
mm v[204:207],v[96:99],a[200:203],v[204:207]
mm v[208:211],v[96:99],a[216:219],v[208:211]
mm v[212:215],v[96:99],a[232:235],v[212:215]
mm v[216:219],v[96:99],a[248:251],v[216:219]
l4 v[96:99],v13,s[8:11],s29 offen offset:128 sc1
wt vmcnt(9)
mm v[204:207],v[100:103],a[204:207],v[204:207]
mm v[208:211],v[100:103],a[220:223],v[208:211]
mm v[212:215],v[100:103],a[236:239],v[212:215]
mm v[216:219],v[100:103],a[252:255],v[216:219]
l4 v[100:103],v13,s[8:11],s29 offen offset:2176 sc1
cv v40,v188,v189
cv v41,v190,v191
cv v48,v192,v193
cv v49,v194,v195
cv v56,v196,v197
cv v57,v198,v199
cv v64,v200,v201
cv v65,v202,v203
cv v44,v204,v205
cv v45,v206,v207
cv v52,v208,v209
cv v53,v210,v211
cv v60,v212,v213
cv v61,v214,v215
cv v68,v216,v217
cv v69,v218,v219
v_mov_b64 v[188:189],v[228:229]
v_mov_b64 v[190:191],v[230:231]
v_mov_b64 v[192:193],v[232:233]
v_mov_b64 v[194:195],v[234:235]
v_mov_b64 v[196:197],v[236:237]
v_mov_b64 v[198:199],v[238:239]
v_mov_b64 v[200:201],v[240:241]
v_mov_b64 v[202:203],v[242:243]
s_mov_b32 s24,0
s_mov_b32 s25,0
s_mov_b32 s26,0x80000
s_mov_b32 s27,0x100000
s_mov_b32 s28,524288
s_mov_b32 s29,1048576
s_mov_b32 s30,1572864
s_mov_b32 s31,0
s_lshl_b32 s36,s57,13
v_add_u32 v9,s36,v9
v_add_u32 v10,s36,v10
v_mov_b32 v253,1
v_add_u32 v14,s36,v14
s_add_u32 s98,s98,s36
s_mov_b32 s97,1
v_mov_b32 v244,1
ds_write_b32 v245,v244
s_mov_b64 s[44:45],0
s_mov_b64 s[46:47],0
s_mov_b64 s[48:49],0
s_mov_b64 s[50:51],0
s_bitcmp1_b32 s14,0
s_cselect_b32 s37,s36,0
v_add_u32 v11,s37,v11
s_mov_b32 s86,1
wt lgkmcnt(0)
s_mov_b32 s58,0
s_cmp_eq_u32 s14,1
s_cbranch_scc1 R_cw0s1
s_cmp_eq_u32 s14,2
s_cbranch_scc1 R_cw0s2
s_cmp_eq_u32 s14,3
s_cbranch_scc1 R_cw0s3
s_branch R_cw0s0
R_cr0s0:
s_cmp_eq_u32 s58,0
s_cbranch_scc1 R_cg0s0
l4 v[188:191],v2,s[8:11],s25 offen sc1
l4 v[192:195],v2,s[8:11],s25 offen offset:1024 sc1
l4 v[196:199],v2,s[8:11],s25 offen offset:2048 sc1
l4 v[200:203],v2,s[8:11],s25 offen offset:3072 sc1
s_sub_u32 s15,s15,1
s_max_i32 s15,s15,0
s_mov_b32 s58,s15
v_mov_b64 v[112:113],0
v_mov_b64 v[114:115],0
v_mov_b64 v[116:117],0
v_mov_b64 v[118:119],0
v_mov_b64 v[120:121],0
v_mov_b64 v[122:123],0
v_mov_b64 v[124:125],0
v_mov_b64 v[126:127],0
v_mov_b64 v[128:129],0
v_mov_b64 v[130:131],0
v_mov_b64 v[132:133],0
v_mov_b64 v[134:135],0
s_branch R_cw0s0
R_cr1s0:
s_cmp_eq_u32 s58,0
s_cbranch_scc1 R_cg1s0
l4 v[192:195],v2,s[8:11],s25 offen offset:1024 sc1
l4 v[196:199],v2,s[8:11],s25 offen offset:2048 sc1
l4 v[200:203],v2,s[8:11],s25 offen offset:3072 sc1
s_sub_u32 s15,s15,1
s_max_i32 s15,s15,0
s_mov_b32 s58,s15
wt vmcnt(2)
v_max3_u32 v246,v192,v193,v194
v_max_u32 v246,v246,v195
v_cmp_eq_u32 vcc,-1,v246
s_cbranch_vccz R_cg1s0
s_branch R_cr1s0
R_cr2s0:
s_cmp_eq_u32 s58,0
s_cbranch_scc1 R_cg2s0
l4 v[196:199],v2,s[8:11],s25 offen offset:2048 sc1
l4 v[200:203],v2,s[8:11],s25 offen offset:3072 sc1
s_sub_u32 s15,s15,1
s_max_i32 s15,s15,0
s_mov_b32 s58,s15
wt vmcnt(1)
v_max3_u32 v246,v196,v197,v198
v_max_u32 v246,v246,v199
v_cmp_eq_u32 vcc,-1,v246
s_cbranch_vccz R_cg2s0
s_branch R_cr2s0
R_cr3s0:
s_cmp_eq_u32 s58,0
s_cbranch_scc1 R_cg3s0
l4 v[200:203],v2,s[8:11],s25 offen offset:3072 sc1
s_sub_u32 s15,s15,1
s_max_i32 s15,s15,0
s_mov_b32 s58,s15
wt vmcnt(0)
v_max3_u32 v246,v200,v201,v202
v_max_u32 v246,v246,v203
v_cmp_eq_u32 vcc,-1,v246
s_cbranch_vccz R_cg3s0
s_branch R_cr3s0
R_steps0:
s_add_u32 s24,s24,1
s_add_u32 s86,s86,1
v_mov_b32 v253,s86
s_lshl_b32 s97,1,s24
v_mov_b32 v244,s97
s_mov_b32 s28,s29
s_mov_b32 s29,s30
s_add_u32 s30,s24,3
s_min_u32 s30,s30,63
s_lshl_b32 s30,s30,19
s_and_b32 s95,s30,0xffe00000
s_add_u32 s30,s30,s95
s_add_u32 s31,s31,0x10000
s_add_u32 s26,s26,0x80000
s_and_b32 s26,s26,0x180000
s_xor_b32 s27,s25,0x100000
s_mov_b32 s58,s15
v_mov_b64 v[136:137],0
v_mov_b64 v[138:139],0
v_mov_b64 v[140:141],0
v_mov_b64 v[142:143],0
v_mov_b64 v[144:145],0
v_mov_b64 v[146:147],0
v_mov_b64 v[148:149],0
v_mov_b64 v[150:151],0
v_mov_b64 v[152:153],0
v_mov_b64 v[154:155],0
v_mov_b64 v[156:157],0
v_mov_b64 v[158:159],0
v_mov_b64 v[160:161],0
v_mov_b64 v[162:163],0
v_mov_b64 v[164:165],0
v_mov_b64 v[166:167],0
v_mov_b64 v[168:169],0
v_mov_b64 v[170:171],0
cv v44,v204,v205
cv v45,v206,v207
cv v52,v208,v209
cv v53,v210,v211
cv v60,v212,v213
cv v61,v214,v215
cv v68,v216,v217
cv v69,v218,v219
s_nop 14
l4 v[188:191],v2,s[8:11],s25 offen sc1
s_nop 5
l4 v[192:195],v2,s[8:11],s25 offen offset:1024 sc1
s_nop 5
l4 v[196:199],v2,s[8:11],s25 offen offset:2048 sc1
s_nop 5
l4 v[200:203],v2,s[8:11],s25 offen offset:3072 sc1
R_cw0s0:
wt vmcnt(3)
ms v[128:131],v[188:191],a[128:135],v23
v_max3_u32 v246,v188,v189,v190
v_max_u32 v246,v246,v191
ms v[132:135],v[188:191],a[160:167],v23
v_cmp_eq_u32 vcc,-1,v246
ms v[112:115],v[188:191],a[0:7],v23
wt vmcnt(2)
v_max3_u32 v247,v192,v193,v194
ms v[116:119],v[188:191],a[32:39],v23
v_max_u32 v247,v247,v195
s_cbranch_vccnz R_cr0s0
R_cg0s0:
v_cmp_eq_u32 vcc,-1,v247
ms v[120:123],v[188:191],a[64:71],v23
ms v[124:127],v[188:191],a[96:103],v23
s_cbranch_vccnz R_cr1s0
R_cg1s0:
ms v[128:131],v[192:195],a[136:143],v23
wt vmcnt(1)
ms v[132:135],v[192:195],a[168:175],v23
v_max3_u32 v246,v196,v197,v198
ms v[112:115],v[192:195],a[8:15],v23
v_max_u32 v246,v246,v199
ms v[116:119],v[192:195],a[40:47],v23
v_cmp_eq_u32 vcc,-1,v246
ms v[120:123],v[192:195],a[72:79],v23
ms v[124:127],v[192:195],a[104:111],v23
s_cbranch_vccnz R_cr2s0
R_cg2s0:
ms v[128:131],v[196:199],a[144:151],v23
wt vmcnt(0)
ms v[132:135],v[196:199],a[176:183],v23
v_max3_u32 v246,v200,v201,v202
ms v[112:115],v[196:199],a[16:23],v23
v_max_u32 v246,v246,v203
ms v[116:119],v[196:199],a[48:55],v23
v_cmp_eq_u32 vcc,-1,v246
ms v[120:123],v[196:199],a[80:87],v23
ms v[124:127],v[196:199],a[112:119],v23
s_cbranch_vccnz R_cr3s0
R_cg3s0:
ms v[128:131],v[200:203],a[152:159],v23
ms v[132:135],v[200:203],a[184:191],v23
ms v[112:115],v[200:203],a[24:31],v23
pa v[228:229],v[128:129],v[130:131]
ms v[116:119],v[200:203],a[56:63],v23
pa v[230:231],v[132:133],v[134:135]
ms v[120:123],v[200:203],a[88:95],v23
ds_write2_b32 v17,v228,v230 offset0:0 offset1:1
ms v[124:127],v[200:203],a[120:127],v23
ds_write2_b32 v17,v229,v231 offset0:32 offset1:33
pa v[220:221],v[112:113],v[114:115]
pa v[222:223],v[116:117],v[118:119]
ds_write2_b32 v15,v220,v222 offset0:0 offset1:1
ds_write2_b32 v15,v221,v223 offset0:32 offset1:33
buffer_store_dword v253,v252,s[8:11],0 offen sc1
pa v[224:225],v[120:121],v[122:123]
s_nop 0
pa v[226:227],v[124:125],v[126:127]
ds_write2_b32 v16,v224,v226 offset0:0 offset1:1
ds_write2_b32 v16,v225,v227 offset0:32 offset1:33
s_cmp_eq_u32 s24,63
wt lgkmcnt(4)
s_barrier
buffer_load_dword v248,v250,s[8:11],0 offen offset:1024 sc1
wt lgkmcnt(0)
s_barrier
dr v[188:191],v18 offset:0
dr v[192:195],v19 offset:0
dr v[196:199],v18 offset:1024
dr v[200:203],v19 offset:1024
dr v[204:207],v18 offset:2048
dr v[208:211],v19 offset:2048
dr v[212:215],v18 offset:3072
dr v[216:219],v19 offset:3072
buffer_load_dword v248,v250,s[8:11],0 offen offset:2048 sc1
wt lgkmcnt(4)
pa v[188:189],v[188:189],v[196:197]
pa v[190:191],v[190:191],v[198:199]
pa v[192:193],v[192:193],v[200:201]
pa v[194:195],v[194:195],v[202:203]
buffer_load_dword v248,v250,s[8:11],0 offen offset:3072 sc1
wt lgkmcnt(2)
pa v[188:189],v[188:189],v[204:205]
pa v[190:191],v[190:191],v[206:207]
pa v[192:193],v[192:193],v[208:209]
pa v[194:195],v[194:195],v[210:211]
wt lgkmcnt(1)
pa v[188:189],v[188:189],v[212:213]
pa v[190:191],v[190:191],v[214:215]
cv v172,v188,v189
cv v173,v190,v191
v_cmp_gt_i32 vcc,s86,v248
wt lgkmcnt(0)
pa v[192:193],v[192:193],v[216:217]
pa v[194:195],v[194:195],v[218:219]
cv v174,v192,v193
cv v175,v194,v195
s_cbranch_scc1 R_lasts0
buffer_load_dword v248,v250,s[8:11],0 offen sc1
mm v[224:227],v[104:107],v[172:175],0
l4 v[232:235],v6,s[8:11],s25 offen sc1
mm v[228:231],v[108:111],v[172:175],0
l4 v[236:239],v6,s[8:11],s25 offen offset:1024 sc1
mm v[220:223],v[172:175],v[172:175],0
buffer_load_dword v248,v250,s[8:11],0 offen offset:1024 sc1
cv v240,v224,v225
cv v241,v226,v227
s_nop 0
cv v242,v228,v229
cv v243,v230,v231
w4 v[240:243],v7,s[8:11],s25 offen sc1
s_nop 0
cv v246,v220,v221
cv v247,v222,v223
buffer_store_dwordx2 v[246:247],v8,s[8:11],s25 offen sc1
s_cbranch_vccnz R_nvs0
v_mov_b64 v[112:113],0
v_mov_b64 v[114:115],0
v_mov_b64 v[116:117],0
v_mov_b64 v[118:119],0
v_mov_b64 v[120:121],0
v_mov_b64 v[122:123],0
v_mov_b64 v[124:125],0
v_mov_b64 v[126:127],0
v_mov_b64 v[128:129],0
v_mov_b64 v[130:131],0
v_mov_b64 v[132:133],0
v_mov_b64 v[134:135],0
s_nop 15
s_nop 1
R_nvjs0:
l4 v[188:191],v4,s[8:11],s25 offen sc1
l4 v[192:195],v4,s[8:11],s25 offen offset:1024 sc1
buffer_load_dwordx2 v[196:197],v5,s[8:11],s25 offen sc1
wt vmcnt(3)
R_aw0s0:
ms v[136:139],v[232:235],a[192:199],v23
v_max3_u32 v246,v232,v233,v234
ms v[136:139],v[236:239],a[200:207],v23
v_max3_u32 v247,v235,v236,v237
ms v[140:143],v[232:235],a[208:215],v23
v_max3_u32 v246,v246,v238,v239
ms v[140:143],v[236:239],a[216:223],v23
v_max_u32 v246,v246,v247
ms v[144:147],v[232:235],a[224:231],v23
v_cmp_eq_u32 vcc,-1,v246
ms v[144:147],v[236:239],a[232:239],v23
pa v[136:137],v[136:137],v[138:139]
ms v[148:151],v[232:235],a[240:247],v23
cv v42,v136,v137
ms v[148:151],v[236:239],a[248:255],v23
s_cbranch_vccnz R_ar0s0
R_ag0s0:
cv v46,v136,v137
pa v[140:141],v[140:141],v[142:143]
wt vmcnt(2)
mm v[200:203],v[180:183],v[188:191],0
wt vmcnt(1)
mm v[200:203],v[184:187],v[192:195],v[200:203]
wt vmcnt(0)
mh v[240:243],v[26:27],v[196:197],0
cv v50,v140,v141
cv v54,v140,v141
pa v[144:145],v[144:145],v[146:147]
cv v58,v144,v145
cv v62,v144,v145
v_max3_f32 v198,v200,v201,v202
pa v[148:149],v[148:149],v[150:151]
cv v66,v148,v149
v_cmp_u_f32 vcc,v200,v240
v_max3_f32 v198,v198,v203,v240
R_ag1s0:
v_mul_f32 v224,s54,v203
cv v70,v148,v149
v_max_f32_dpp v198,v198,v198 quad_perm:[2,3,0,1] row_mask:0xf bank_mask:0xf
v_mul_f32 v199,s54,v198
v_mul_f32 v198,s54,v198
v_mul_f32 v220,s54,v200
v_mul_f32 v221,s54,v201
s_cbranch_vccnz R_ar1s0
R_ah1s0:
v_permlane16_swap_b32 v198,v199
v_max_f32 v246,v198,v199
v_max_f32 v247,v198,v199
ds_sub_rtn_u32 v226,v245,v28
v_mul_f32 v223,s54,v202
v_permlane32_swap_b32 v246,v247
v_max_f32 v198,v246,v247
v_sub_f32 v220,v220,v198
v_sub_f32 v221,v221,v198
v_exp_f32 v220,v220
v_mul_f32 v222,s54,v240
v_sub_f32 v222,v222,v198
v_exp_f32 v221,v221
v_sub_f32 v223,v223,v198
v_exp_f32 v222,v222
v_sub_f32 v224,v224,v198
v_exp_f32 v223,v223
cv v176,v220,v221
v_exp_f32 v224,v224
cv v177,v222,0
cv v179,v222,0
cv v178,v223,v224
wt lgkmcnt(0)
v_lshl_add_u32 v226,v226,30,v14
buffer_store_dword v244,v226,s[8:11],0 offen sc1
ms v[152:155],v[176:179],v[32:39],v24
l4 v[104:107],v11,s[8:11],s28 offen sc1
ms v[156:159],v[176:179],v[40:47],v24
l4 v[108:111],v11,s[8:11],s28 offen offset:256 sc1
ms v[160:163],v[176:179],v[48:55],v24
pa v[236:237],v[152:153],v[154:155]
ms v[164:167],v[176:179],v[56:63],v24
v_rcp_f32 v236,v236
ms v[168:171],v[176:179],v[64:71],v24
v_rcp_f32 v237,v237
pa v[156:157],v[156:157],v[158:159]
v_mul_f32 v228,v156,v236
v_mul_f32 v232,v157,v237
pa v[160:161],v[160:161],v[162:163]
v_mul_f32 v229,v160,v236
v_mul_f32 v233,v161,v237
pa v[164:165],v[164:165],v[166:167]
v_mul_f32 v230,v164,v236
v_mul_f32 v234,v165,v237
pa v[168:169],v[168:169],v[170:171]
v_mul_f32 v231,v168,v236
ds_write_b128 v20,v[228:231]
v_mul_f32 v235,v169,v237
ds_write_b128 v21,v[232:235] offset:256
l4 v[96:99],v13,s[8:11],s28 offen offset:128 sc1
l4 v[100:103],v13,s[8:11],s28 offen offset:2176 sc1
w4 v[172:175],v25,s[8:11],s31 offen sc1
wt lgkmcnt(0)
s_barrier
dr v[220:223],v22 offset:0
dr v[224:227],v22 offset:2048
dr v[228:231],v22 offset:4096
dr v[232:235],v22 offset:6144
wt lgkmcnt(2)
pa v[220:221],v[220:221],v[224:225]
pa v[222:223],v[222:223],v[226:227]
wt lgkmcnt(1)
pa v[220:221],v[220:221],v[228:229]
pa v[222:223],v[222:223],v[230:231]
wt lgkmcnt(0)
pa v[220:221],v[220:221],v[232:233]
pa v[222:223],v[222:223],v[234:235]
cv v224,v220,v221
cv v225,v222,v223
buffer_store_dwordx2 v[224:225],v9,s[8:11],s25 offen sc1
mm v[188:191],v[72:75],a[192:195],0
mm v[192:195],v[72:75],a[208:211],0
mm v[196:199],v[72:75],a[224:227],0
mm v[200:203],v[72:75],a[240:243],0
l4 v[72:75],v12,s[8:11],s29 offen sc1
mm v[188:191],v[76:79],a[196:199],v[188:191]
mm v[192:195],v[76:79],a[212:215],v[192:195]
mm v[196:199],v[76:79],a[228:231],v[196:199]
mm v[200:203],v[76:79],a[244:247],v[200:203]
l4 v[76:79],v12,s[8:11],s29 offen offset:2048 sc1
mm v[188:191],v[80:83],a[200:203],v[188:191]
mm v[192:195],v[80:83],a[216:219],v[192:195]
mm v[196:199],v[80:83],a[232:235],v[196:199]
mm v[200:203],v[80:83],a[248:251],v[200:203]
l4 v[80:83],v13,s[8:11],s29 offen sc1
s_barrier
s_nop 3
l4 v[236:239],v10,s[8:11],s25 offen sc1
mm v[188:191],v[84:87],a[204:207],v[188:191]
mm v[192:195],v[84:87],a[220:223],v[192:195]
mm v[196:199],v[84:87],a[236:239],v[196:199]
mm v[200:203],v[84:87],a[252:255],v[200:203]
l4 v[84:87],v13,s[8:11],s29 offen offset:2048 sc1
mm v[204:207],v[88:91],a[192:195],0
mm v[208:211],v[88:91],a[208:211],0
cv v40,v188,v189
mm v[212:215],v[88:91],a[224:227],0
cv v41,v190,v191
mm v[216:219],v[88:91],a[240:243],0
cv v48,v192,v193
l4 v[88:91],v12,s[8:11],s29 offen offset:128 sc1
mm v[204:207],v[92:95],a[196:199],v[204:207]
cv v49,v194,v195
mm v[208:211],v[92:95],a[212:215],v[208:211]
cv v56,v196,v197
mm v[212:215],v[92:95],a[228:231],v[212:215]
cv v57,v198,v199
mm v[216:219],v[92:95],a[244:247],v[216:219]
cv v64,v200,v201
l4 v[92:95],v12,s[8:11],s29 offen offset:2176 sc1
wt vmcnt(9)
mm v[204:207],v[96:99],a[200:203],v[204:207]
cv v65,v202,v203
mm v[208:211],v[96:99],a[216:219],v[208:211]
mm v[212:215],v[96:99],a[232:235],v[212:215]
mm v[216:219],v[96:99],a[248:251],v[216:219]
mm v[204:207],v[100:103],a[204:207],v[204:207]
mm v[208:211],v[100:103],a[220:223],v[208:211]
mm v[212:215],v[100:103],a[236:239],v[212:215]
mm v[216:219],v[100:103],a[252:255],v[216:219]
s_mov_b32 s59,s25
s_mov_b32 s25,s26
wt vmcnt(3)
mm v[228:231],v[180:183],v[236:239],0
s_add_u32 s36,s88,s30
s_buffer_load_dwordx2 s[100:101],s[8:11],s36 offset:60
s_buffer_load_dwordx2 s[100:101],s[8:11],s36 offset:188
s_buffer_load_dwordx2 s[100:101],s[8:11],s36 offset:316
s_buffer_load_dwordx2 s[100:101],s[8:11],s36 offset:444
s_nop 2
v_cmp_u_f32 vcc,v228,v228
v_add_f32_dpp v228,v228,v228 row_ror:8 row_mask:0xf bank_mask:0xf
v_add_f32_dpp v229,v229,v229 row_ror:8 row_mask:0xf bank_mask:0xf
v_add_f32_dpp v230,v230,v230 row_ror:8 row_mask:0xf bank_mask:0xf
v_add_f32_dpp v231,v231,v231 row_ror:8 row_mask:0xf bank_mask:0xf
cv v232,v228,v229
cv v233,v230,v231
s_cbranch_vccnz R_brs0
R_bgs0:
buffer_store_dwordx2 v[232:233],v3,s[8:11],s25 offen sc1
s_branch R_steps0
R_lasts0:
w4 v[172:175],v25,s[8:11],s31 offen sc1
s_branch R_fins
R_nvs0:
v_cmp_gt_i32 vcc,s86,v248
buffer_load_dword v248,v250,s[8:11],0 offen offset:2048 sc1
s_cbranch_vccnz R_nws0
l4 v[232:235],v6,s[8:11],s25 offen sc1
l4 v[236:239],v6,s[8:11],s25 offen offset:1024 sc1
v_mov_b64 v[112:113],0
v_mov_b64 v[114:115],0
v_mov_b64 v[116:117],0
v_mov_b64 v[118:119],0
v_mov_b64 v[120:121],0
v_mov_b64 v[122:123],0
v_mov_b64 v[124:125],0
v_mov_b64 v[126:127],0
v_mov_b64 v[128:129],0
v_mov_b64 v[130:131],0
v_mov_b64 v[132:133],0
v_mov_b64 v[134:135],0
s_nop 15
s_nop 1
s_branch R_nvjs0
R_nws0:
s_mov_b64 exec,0xffff
s_min_u32 s94,s15,1000
R_fas0:
v_cmp_gt_i32 vcc,s86,v248
buffer_load_dword v248,v250,s[8:11],0 offen offset:3072 sc1
s_cbranch_vccz R_fas0_ok
v_cmp_gt_i32 vcc,s86,v248
s_cbranch_vccz R_fas0_ok
v_cmp_gt_i32 vcc,s86,v248
s_cbranch_vccz R_fas0_ok
v_cmp_gt_i32 vcc,s86,v248
buffer_load_dword v248,v250,s[8:11],0 offen sc1
s_cbranch_vccz R_fas0_ok
v_cmp_gt_i32 vcc,s86,v248
s_cbranch_vccz R_fas0_ok
v_cmp_gt_i32 vcc,s86,v248
s_cbranch_vccz R_fas0_ok
v_cmp_gt_i32 vcc,s86,v248
buffer_load_dword v248,v250,s[8:11],0 offen offset:1024 sc1
s_cbranch_vccz R_fas0_ok
v_cmp_gt_i32 vcc,s86,v248
s_cbranch_vccz R_fas0_ok
v_cmp_gt_i32 vcc,s86,v248
s_cbranch_vccz R_fas0_ok
v_cmp_gt_i32 vcc,s86,v248
buffer_load_dword v248,v250,s[8:11],0 offen offset:2048 sc1
s_cbranch_vccz R_fas0_ok
v_cmp_gt_i32 vcc,s86,v248
s_cbranch_vccz R_fas0_ok
v_cmp_gt_i32 vcc,s86,v248
s_cbranch_vccz R_fas0_ok
s_sub_u32 s94,s94,1
s_cbranch_scc0 R_fas0
R_fas0_ok:
s_mov_b64 exec,-1
l4 v[232:235],v6,s[8:11],s25 offen sc1
l4 v[236:239],v6,s[8:11],s25 offen offset:1024 sc1
v_mov_b64 v[112:113],0
v_mov_b64 v[114:115],0
v_mov_b64 v[116:117],0
v_mov_b64 v[118:119],0
v_mov_b64 v[120:121],0
v_mov_b64 v[122:123],0
v_mov_b64 v[124:125],0
v_mov_b64 v[126:127],0
v_mov_b64 v[128:129],0
v_mov_b64 v[130:131],0
v_mov_b64 v[132:133],0
v_mov_b64 v[134:135],0
s_nop 15
s_nop 15
s_branch R_nvjs0
R_ar0s0:
s_cmp_eq_u32 s15,0
s_cbranch_scc1 R_ag0s0
l4 v[232:235],v6,s[8:11],s25 offen sc1
l4 v[236:239],v6,s[8:11],s25 offen offset:1024 sc1
l4 v[188:191],v4,s[8:11],s25 offen sc1
l4 v[192:195],v4,s[8:11],s25 offen offset:1024 sc1
buffer_load_dwordx2 v[196:197],v5,s[8:11],s25 offen sc1
s_sub_u32 s15,s15,1
s_max_i32 s15,s15,0
v_mov_b64 v[136:137],0
v_mov_b64 v[138:139],0
v_mov_b64 v[140:141],0
v_mov_b64 v[142:143],0
v_mov_b64 v[144:145],0
v_mov_b64 v[146:147],0
v_mov_b64 v[148:149],0
v_mov_b64 v[150:151],0
wt vmcnt(0)
s_branch R_aw0s0
R_ar1s0:
s_cmp_eq_u32 s15,0
s_cbranch_scc1 R_ah1s0
l4 v[188:191],v4,s[8:11],s25 offen sc1
l4 v[192:195],v4,s[8:11],s25 offen offset:1024 sc1
buffer_load_dwordx2 v[196:197],v5,s[8:11],s25 offen sc1
s_sub_u32 s15,s15,1
s_max_i32 s15,s15,0
wt vmcnt(2)
mm v[200:203],v[180:183],v[188:191],0
wt vmcnt(1)
mm v[200:203],v[184:187],v[192:195],v[200:203]
wt vmcnt(0)
mh v[240:243],v[26:27],v[196:197],0
s_nop 3
v_max3_f32 v198,v200,v201,v202
s_nop 2
v_cmp_u_f32 vcc,v200,v240
v_max3_f32 v198,v198,v203,v240
s_branch R_ag1s0
R_brs0:
R_br2s0:
s_cmp_eq_u32 s15,0
s_cbranch_scc1 R_bgs0
l4 v[236:239],v10,s[8:11],s59 offen sc1
R_br3s0:
s_sub_u32 s15,s15,1
s_max_i32 s15,s15,0
wt vmcnt(0)
mm v[228:231],v[180:183],v[236:239],0
s_nop 7
v_cmp_u_f32 vcc,v228,v228
v_add_f32_dpp v228,v228,v228 row_ror:8 row_mask:0xf bank_mask:0xf
v_add_f32_dpp v229,v229,v229 row_ror:8 row_mask:0xf bank_mask:0xf
v_add_f32_dpp v230,v230,v230 row_ror:8 row_mask:0xf bank_mask:0xf
v_add_f32_dpp v231,v231,v231 row_ror:8 row_mask:0xf bank_mask:0xf
cv v232,v228,v229
cv v233,v230,v231
s_cbranch_vccz R_bgs0
s_branch R_br2s0
R_cr0s1:
s_cmp_eq_u32 s58,0
s_cbranch_scc1 R_cg0s1
l4 v[188:191],v2,s[8:11],s25 offen sc1
l4 v[192:195],v2,s[8:11],s25 offen offset:1024 sc1
l4 v[196:199],v2,s[8:11],s25 offen offset:2048 sc1
l4 v[200:203],v2,s[8:11],s25 offen offset:3072 sc1
s_sub_u32 s15,s15,1
s_max_i32 s15,s15,0
s_mov_b32 s58,s15
v_mov_b64 v[112:113],0
v_mov_b64 v[114:115],0
v_mov_b64 v[116:117],0
v_mov_b64 v[118:119],0
v_mov_b64 v[120:121],0
v_mov_b64 v[122:123],0
v_mov_b64 v[124:125],0
v_mov_b64 v[126:127],0
v_mov_b64 v[128:129],0
v_mov_b64 v[130:131],0
v_mov_b64 v[132:133],0
v_mov_b64 v[134:135],0
s_branch R_cw0s1
R_cr1s1:
s_cmp_eq_u32 s58,0
s_cbranch_scc1 R_cg1s1
l4 v[192:195],v2,s[8:11],s25 offen offset:1024 sc1
l4 v[196:199],v2,s[8:11],s25 offen offset:2048 sc1
l4 v[200:203],v2,s[8:11],s25 offen offset:3072 sc1
s_sub_u32 s15,s15,1
s_max_i32 s15,s15,0
s_mov_b32 s58,s15
wt vmcnt(2)
v_max3_u32 v246,v192,v193,v194
v_max_u32 v246,v246,v195
v_cmp_eq_u32 vcc,-1,v246
s_cbranch_vccz R_cg1s1
s_branch R_cr1s1
R_cr2s1:
s_cmp_eq_u32 s58,0
s_cbranch_scc1 R_cg2s1
l4 v[196:199],v2,s[8:11],s25 offen offset:2048 sc1
l4 v[200:203],v2,s[8:11],s25 offen offset:3072 sc1
s_sub_u32 s15,s15,1
s_max_i32 s15,s15,0
s_mov_b32 s58,s15
wt vmcnt(1)
v_max3_u32 v246,v196,v197,v198
v_max_u32 v246,v246,v199
v_cmp_eq_u32 vcc,-1,v246
s_cbranch_vccz R_cg2s1
s_branch R_cr2s1
R_cr3s1:
s_cmp_eq_u32 s58,0
s_cbranch_scc1 R_cg3s1
l4 v[200:203],v2,s[8:11],s25 offen offset:3072 sc1
s_sub_u32 s15,s15,1
s_max_i32 s15,s15,0
s_mov_b32 s58,s15
wt vmcnt(0)
v_max3_u32 v246,v200,v201,v202
v_max_u32 v246,v246,v203
v_cmp_eq_u32 vcc,-1,v246
s_cbranch_vccz R_cg3s1
s_branch R_cr3s1
R_steps1:
s_add_u32 s24,s24,1
s_add_u32 s86,s86,1
v_mov_b32 v253,s86
s_lshl_b32 s97,1,s24
v_mov_b32 v244,s97
s_mov_b32 s28,s29
s_mov_b32 s29,s30
s_add_u32 s30,s24,3
s_min_u32 s30,s30,63
s_lshl_b32 s30,s30,19
s_and_b32 s95,s30,0xffe00000
s_add_u32 s30,s30,s95
s_add_u32 s31,s31,0x10000
s_add_u32 s26,s26,0x80000
s_and_b32 s26,s26,0x180000
s_xor_b32 s27,s25,0x100000
s_mov_b32 s58,s15
v_mov_b64 v[136:137],0
v_mov_b64 v[138:139],0
v_mov_b64 v[140:141],0
v_mov_b64 v[142:143],0
v_mov_b64 v[144:145],0
v_mov_b64 v[146:147],0
v_mov_b64 v[148:149],0
v_mov_b64 v[150:151],0
v_mov_b64 v[152:153],0
v_mov_b64 v[154:155],0
v_mov_b64 v[156:157],0
v_mov_b64 v[158:159],0
v_mov_b64 v[160:161],0
v_mov_b64 v[162:163],0
v_mov_b64 v[164:165],0
v_mov_b64 v[166:167],0
v_mov_b64 v[168:169],0
v_mov_b64 v[170:171],0
cv v44,v204,v205
cv v45,v206,v207
cv v52,v208,v209
cv v53,v210,v211
cv v60,v212,v213
cv v61,v214,v215
cv v68,v216,v217
cv v69,v218,v219
s_nop 14
l4 v[188:191],v2,s[8:11],s25 offen sc1
s_nop 5
l4 v[192:195],v2,s[8:11],s25 offen offset:1024 sc1
s_nop 5
l4 v[196:199],v2,s[8:11],s25 offen offset:2048 sc1
s_nop 5
l4 v[200:203],v2,s[8:11],s25 offen offset:3072 sc1
R_cw0s1:
wt vmcnt(3)
ms v[128:131],v[188:191],a[128:135],v23
v_max3_u32 v246,v188,v189,v190
v_max_u32 v246,v246,v191
ms v[132:135],v[188:191],a[160:167],v23
v_cmp_eq_u32 vcc,-1,v246
ms v[112:115],v[188:191],a[0:7],v23
wt vmcnt(2)
v_max3_u32 v247,v192,v193,v194
ms v[116:119],v[188:191],a[32:39],v23
v_max_u32 v247,v247,v195
s_cbranch_vccnz R_cr0s1
R_cg0s1:
v_cmp_eq_u32 vcc,-1,v247
ms v[120:123],v[188:191],a[64:71],v23
ms v[124:127],v[188:191],a[96:103],v23
s_cbranch_vccnz R_cr1s1
R_cg1s1:
ms v[128:131],v[192:195],a[136:143],v23
wt vmcnt(1)
ms v[132:135],v[192:195],a[168:175],v23
v_max3_u32 v246,v196,v197,v198
ms v[112:115],v[192:195],a[8:15],v23
v_max_u32 v246,v246,v199
ms v[116:119],v[192:195],a[40:47],v23
v_cmp_eq_u32 vcc,-1,v246
ms v[120:123],v[192:195],a[72:79],v23
ms v[124:127],v[192:195],a[104:111],v23
s_cbranch_vccnz R_cr2s1
R_cg2s1:
ms v[128:131],v[196:199],a[144:151],v23
wt vmcnt(0)
ms v[132:135],v[196:199],a[176:183],v23
v_max3_u32 v246,v200,v201,v202
ms v[112:115],v[196:199],a[16:23],v23
v_max_u32 v246,v246,v203
ms v[116:119],v[196:199],a[48:55],v23
v_cmp_eq_u32 vcc,-1,v246
ms v[120:123],v[196:199],a[80:87],v23
ms v[124:127],v[196:199],a[112:119],v23
s_cbranch_vccnz R_cr3s1
R_cg3s1:
ms v[128:131],v[200:203],a[152:159],v23
ms v[132:135],v[200:203],a[184:191],v23
ms v[112:115],v[200:203],a[24:31],v23
pa v[228:229],v[128:129],v[130:131]
ms v[116:119],v[200:203],a[56:63],v23
pa v[230:231],v[132:133],v[134:135]
ms v[120:123],v[200:203],a[88:95],v23
ds_write2_b32 v17,v228,v230 offset0:0 offset1:1
ms v[124:127],v[200:203],a[120:127],v23
ds_write2_b32 v17,v229,v231 offset0:32 offset1:33
pa v[220:221],v[112:113],v[114:115]
pa v[222:223],v[116:117],v[118:119]
ds_write2_b32 v15,v220,v222 offset0:0 offset1:1
ds_write2_b32 v15,v221,v223 offset0:32 offset1:33
buffer_store_dword v253,v252,s[8:11],0 offen sc1
pa v[224:225],v[120:121],v[122:123]
s_nop 0
pa v[226:227],v[124:125],v[126:127]
ds_write2_b32 v16,v224,v226 offset0:0 offset1:1
ds_write2_b32 v16,v225,v227 offset0:32 offset1:33
s_cmp_eq_u32 s24,63
wt lgkmcnt(4)
s_barrier
buffer_load_dword v248,v250,s[8:11],0 offen offset:1024 sc1
wt lgkmcnt(0)
s_barrier
s_cbranch_scc1 R_fins
s_mov_b64 exec,0xffff
s_min_u32 s94,s15,1000
R_fas1:
v_cmp_gt_i32 vcc,s86,v248
buffer_load_dword v248,v250,s[8:11],0 offen offset:2048 sc1
s_cbranch_vccz R_fas1_ok
v_cmp_gt_i32 vcc,s86,v248
s_cbranch_vccz R_fas1_ok
v_cmp_gt_i32 vcc,s86,v248
s_cbranch_vccz R_fas1_ok
v_cmp_gt_i32 vcc,s86,v248
buffer_load_dword v248,v250,s[8:11],0 offen offset:3072 sc1
s_cbranch_vccz R_fas1_ok
v_cmp_gt_i32 vcc,s86,v248
s_cbranch_vccz R_fas1_ok
v_cmp_gt_i32 vcc,s86,v248
s_cbranch_vccz R_fas1_ok
v_cmp_gt_i32 vcc,s86,v248
buffer_load_dword v248,v250,s[8:11],0 offen sc1
s_cbranch_vccz R_fas1_ok
v_cmp_gt_i32 vcc,s86,v248
s_cbranch_vccz R_fas1_ok
v_cmp_gt_i32 vcc,s86,v248
s_cbranch_vccz R_fas1_ok
v_cmp_gt_i32 vcc,s86,v248
buffer_load_dword v248,v250,s[8:11],0 offen offset:1024 sc1
s_cbranch_vccz R_fas1_ok
v_cmp_gt_i32 vcc,s86,v248
s_cbranch_vccz R_fas1_ok
v_cmp_gt_i32 vcc,s86,v248
s_cbranch_vccz R_fas1_ok
s_sub_u32 s94,s94,1
s_cbranch_scc0 R_fas1
R_fas1_ok:
s_mov_b64 exec,-1
v_mov_b64 v[112:113],0
v_mov_b64 v[114:115],0
v_mov_b64 v[116:117],0
v_mov_b64 v[118:119],0
v_mov_b64 v[120:121],0
v_mov_b64 v[122:123],0
l4 v[232:235],v6,s[8:11],s25 offen sc1
l4 v[236:239],v6,s[8:11],s25 offen offset:1024 sc1
v_mov_b64 v[124:125],0
v_mov_b64 v[126:127],0
v_mov_b64 v[128:129],0
v_mov_b64 v[130:131],0
v_mov_b64 v[132:133],0
v_mov_b64 v[134:135],0
s_nop 15
s_nop 15
s_nop 15
s_nop 1
l4 v[188:191],v4,s[8:11],s25 offen sc1
l4 v[192:195],v4,s[8:11],s25 offen offset:1024 sc1
buffer_load_dwordx2 v[196:197],v5,s[8:11],s25 offen sc1
w4 v[28:31],v7,s[8:11],s27 offen sc1
w4 v[28:31],v8,s[8:11],s27 offen sc1
wt vmcnt(5)
R_aw0s1:
ms v[136:139],v[232:235],a[192:199],v23
v_max3_u32 v246,v232,v233,v234
ms v[136:139],v[236:239],a[200:207],v23
v_max3_u32 v247,v235,v236,v237
ms v[140:143],v[232:235],a[208:215],v23
v_max3_u32 v246,v246,v238,v239
ms v[140:143],v[236:239],a[216:223],v23
v_max_u32 v246,v246,v247
ms v[144:147],v[232:235],a[224:231],v23
v_cmp_eq_u32 vcc,-1,v246
ms v[144:147],v[236:239],a[232:239],v23
pa v[136:137],v[136:137],v[138:139]
ms v[148:151],v[232:235],a[240:247],v23
cv v42,v136,v137
ms v[148:151],v[236:239],a[248:255],v23
s_cbranch_vccnz R_ar0s1
R_ag0s1:
cv v46,v136,v137
pa v[140:141],v[140:141],v[142:143]
wt vmcnt(4)
mm v[200:203],v[180:183],v[188:191],0
wt vmcnt(3)
mm v[200:203],v[184:187],v[192:195],v[200:203]
wt vmcnt(2)
mh v[240:243],v[26:27],v[196:197],0
cv v50,v140,v141
cv v54,v140,v141
pa v[144:145],v[144:145],v[146:147]
cv v58,v144,v145
cv v62,v144,v145
v_max3_f32 v198,v200,v201,v202
pa v[148:149],v[148:149],v[150:151]
cv v66,v148,v149
v_cmp_u_f32 vcc,v200,v240
v_max3_f32 v198,v198,v203,v240
R_ag1s1:
v_mul_f32 v224,s54,v203
cv v70,v148,v149
v_max_f32_dpp v198,v198,v198 quad_perm:[2,3,0,1] row_mask:0xf bank_mask:0xf
v_mul_f32 v199,s54,v198
v_mul_f32 v198,s54,v198
v_mul_f32 v220,s54,v200
v_mul_f32 v221,s54,v201
s_cbranch_vccnz R_ar1s1
R_ah1s1:
v_permlane16_swap_b32 v198,v199
v_max_f32 v246,v198,v199
v_max_f32 v247,v198,v199
ds_sub_rtn_u32 v226,v245,v28
v_mul_f32 v223,s54,v202
v_permlane32_swap_b32 v246,v247
v_max_f32 v198,v246,v247
v_sub_f32 v220,v220,v198
v_sub_f32 v221,v221,v198
v_exp_f32 v220,v220
v_mul_f32 v222,s54,v240
v_sub_f32 v222,v222,v198
v_exp_f32 v221,v221
v_sub_f32 v223,v223,v198
v_exp_f32 v222,v222
v_sub_f32 v224,v224,v198
v_exp_f32 v223,v223
cv v176,v220,v221
v_exp_f32 v224,v224
cv v177,v222,0
cv v179,v222,0
cv v178,v223,v224
wt lgkmcnt(0)
v_lshl_add_u32 v226,v226,30,v14
buffer_store_dword v244,v226,s[8:11],0 offen sc1
ms v[152:155],v[176:179],v[32:39],v24
l4 v[96:99],v13,s[8:11],s28 offen offset:128 sc1
ms v[156:159],v[176:179],v[40:47],v24
l4 v[100:103],v13,s[8:11],s28 offen offset:2176 sc1
ms v[160:163],v[176:179],v[48:55],v24
pa v[236:237],v[152:153],v[154:155]
ms v[164:167],v[176:179],v[56:63],v24
v_rcp_f32 v236,v236
ms v[168:171],v[176:179],v[64:71],v24
v_rcp_f32 v237,v237
pa v[156:157],v[156:157],v[158:159]
v_mul_f32 v228,v156,v236
v_mul_f32 v232,v157,v237
pa v[160:161],v[160:161],v[162:163]
v_mul_f32 v229,v160,v236
v_mul_f32 v233,v161,v237
pa v[164:165],v[164:165],v[166:167]
v_mul_f32 v230,v164,v236
v_mul_f32 v234,v165,v237
pa v[168:169],v[168:169],v[170:171]
v_mul_f32 v231,v168,v236
ds_write_b128 v20,v[228:231]
v_mul_f32 v235,v169,v237
ds_write_b128 v21,v[232:235] offset:256
w4 v[28:31],v11,s[8:11],s27 offen sc1
buffer_store_dword v253,v0,s[8:11],0 offen sc1
wt lgkmcnt(0)
s_barrier
dr v[220:223],v22 offset:0
dr v[224:227],v22 offset:2048
dr v[228:231],v22 offset:4096
dr v[232:235],v22 offset:6144
wt lgkmcnt(2)
pa v[220:221],v[220:221],v[224:225]
pa v[222:223],v[222:223],v[226:227]
wt lgkmcnt(1)
pa v[220:221],v[220:221],v[228:229]
pa v[222:223],v[222:223],v[230:231]
wt lgkmcnt(0)
pa v[220:221],v[220:221],v[232:233]
pa v[222:223],v[222:223],v[234:235]
cv v224,v220,v221
cv v225,v222,v223
buffer_store_dwordx2 v[224:225],v9,s[8:11],s25 offen sc1
mm v[188:191],v[72:75],a[192:195],0
mm v[192:195],v[72:75],a[208:211],0
mm v[196:199],v[72:75],a[224:227],0
mm v[200:203],v[72:75],a[240:243],0
l4 v[72:75],v12,s[8:11],s29 offen sc1
mm v[188:191],v[76:79],a[196:199],v[188:191]
mm v[192:195],v[76:79],a[212:215],v[192:195]
mm v[196:199],v[76:79],a[228:231],v[196:199]
mm v[200:203],v[76:79],a[244:247],v[200:203]
l4 v[76:79],v12,s[8:11],s29 offen offset:2048 sc1
mm v[188:191],v[80:83],a[200:203],v[188:191]
mm v[192:195],v[80:83],a[216:219],v[192:195]
mm v[196:199],v[80:83],a[232:235],v[196:199]
mm v[200:203],v[80:83],a[248:251],v[200:203]
l4 v[80:83],v13,s[8:11],s29 offen sc1
s_barrier
s_nop 3
l4 v[236:239],v10,s[8:11],s25 offen sc1
mm v[188:191],v[84:87],a[204:207],v[188:191]
mm v[192:195],v[84:87],a[220:223],v[192:195]
mm v[196:199],v[84:87],a[236:239],v[196:199]
mm v[200:203],v[84:87],a[252:255],v[200:203]
l4 v[84:87],v13,s[8:11],s29 offen offset:2048 sc1
mm v[204:207],v[88:91],a[192:195],0
mm v[208:211],v[88:91],a[208:211],0
cv v40,v188,v189
mm v[212:215],v[88:91],a[224:227],0
cv v41,v190,v191
mm v[216:219],v[88:91],a[240:243],0
cv v48,v192,v193
l4 v[88:91],v12,s[8:11],s29 offen offset:128 sc1
mm v[204:207],v[92:95],a[196:199],v[204:207]
cv v49,v194,v195
mm v[208:211],v[92:95],a[212:215],v[208:211]
cv v56,v196,v197
mm v[212:215],v[92:95],a[228:231],v[212:215]
cv v57,v198,v199
mm v[216:219],v[92:95],a[244:247],v[216:219]
cv v64,v200,v201
l4 v[92:95],v12,s[8:11],s29 offen offset:2176 sc1
wt vmcnt(10)
mm v[204:207],v[96:99],a[200:203],v[204:207]
cv v65,v202,v203
mm v[208:211],v[96:99],a[216:219],v[208:211]
mm v[212:215],v[96:99],a[232:235],v[212:215]
mm v[216:219],v[96:99],a[248:251],v[216:219]
mm v[204:207],v[100:103],a[204:207],v[204:207]
mm v[208:211],v[100:103],a[220:223],v[208:211]
mm v[212:215],v[100:103],a[236:239],v[212:215]
mm v[216:219],v[100:103],a[252:255],v[216:219]
s_mov_b32 s59,s25
s_mov_b32 s25,s26
wt vmcnt(3)
mm v[228:231],v[180:183],v[236:239],0
s_add_u32 s36,s88,s30
s_buffer_load_dwordx2 s[100:101],s[8:11],s36 offset:60
s_buffer_load_dwordx2 s[100:101],s[8:11],s36 offset:188
s_buffer_load_dwordx2 s[100:101],s[8:11],s36 offset:316
s_buffer_load_dwordx2 s[100:101],s[8:11],s36 offset:444
s_nop 2
v_cmp_u_f32 vcc,v228,v228
v_add_f32_dpp v228,v228,v228 row_ror:8 row_mask:0xf bank_mask:0xf
v_add_f32_dpp v229,v229,v229 row_ror:8 row_mask:0xf bank_mask:0xf
v_add_f32_dpp v230,v230,v230 row_ror:8 row_mask:0xf bank_mask:0xf
v_add_f32_dpp v231,v231,v231 row_ror:8 row_mask:0xf bank_mask:0xf
cv v232,v228,v229
cv v233,v230,v231
s_cbranch_vccnz R_brs1
R_bgs1:
buffer_store_dwordx2 v[232:233],v3,s[8:11],s25 offen sc1
s_branch R_steps1
R_ar0s1:
s_cmp_eq_u32 s15,0
s_cbranch_scc1 R_ag0s1
l4 v[232:235],v6,s[8:11],s25 offen sc1
l4 v[236:239],v6,s[8:11],s25 offen offset:1024 sc1
l4 v[188:191],v4,s[8:11],s25 offen sc1
l4 v[192:195],v4,s[8:11],s25 offen offset:1024 sc1
buffer_load_dwordx2 v[196:197],v5,s[8:11],s25 offen sc1
s_sub_u32 s15,s15,1
s_max_i32 s15,s15,0
v_mov_b64 v[136:137],0
v_mov_b64 v[138:139],0
v_mov_b64 v[140:141],0
v_mov_b64 v[142:143],0
v_mov_b64 v[144:145],0
v_mov_b64 v[146:147],0
v_mov_b64 v[148:149],0
v_mov_b64 v[150:151],0
wt vmcnt(0)
s_branch R_aw0s1
R_ar1s1:
s_cmp_eq_u32 s15,0
s_cbranch_scc1 R_ah1s1
l4 v[188:191],v4,s[8:11],s25 offen sc1
l4 v[192:195],v4,s[8:11],s25 offen offset:1024 sc1
buffer_load_dwordx2 v[196:197],v5,s[8:11],s25 offen sc1
s_sub_u32 s15,s15,1
s_max_i32 s15,s15,0
wt vmcnt(2)
mm v[200:203],v[180:183],v[188:191],0
wt vmcnt(1)
mm v[200:203],v[184:187],v[192:195],v[200:203]
wt vmcnt(0)
mh v[240:243],v[26:27],v[196:197],0
s_nop 3
v_max3_f32 v198,v200,v201,v202
s_nop 2
v_cmp_u_f32 vcc,v200,v240
v_max3_f32 v198,v198,v203,v240
s_branch R_ag1s1
R_brs1:
R_br2s1:
s_cmp_eq_u32 s15,0
s_cbranch_scc1 R_bgs1
l4 v[236:239],v10,s[8:11],s59 offen sc1
R_br3s1:
s_sub_u32 s15,s15,1
s_max_i32 s15,s15,0
wt vmcnt(0)
mm v[228:231],v[180:183],v[236:239],0
s_nop 7
v_cmp_u_f32 vcc,v228,v228
v_add_f32_dpp v228,v228,v228 row_ror:8 row_mask:0xf bank_mask:0xf
v_add_f32_dpp v229,v229,v229 row_ror:8 row_mask:0xf bank_mask:0xf
v_add_f32_dpp v230,v230,v230 row_ror:8 row_mask:0xf bank_mask:0xf
v_add_f32_dpp v231,v231,v231 row_ror:8 row_mask:0xf bank_mask:0xf
cv v232,v228,v229
cv v233,v230,v231
s_cbranch_vccz R_bgs1
s_branch R_br2s1
R_cr0s2:
s_cmp_eq_u32 s58,0
s_cbranch_scc1 R_cg0s2
l4 v[188:191],v2,s[8:11],s25 offen sc1
l4 v[192:195],v2,s[8:11],s25 offen offset:1024 sc1
l4 v[196:199],v2,s[8:11],s25 offen offset:2048 sc1
l4 v[200:203],v2,s[8:11],s25 offen offset:3072 sc1
s_sub_u32 s15,s15,1
s_max_i32 s15,s15,0
s_mov_b32 s58,s15
v_mov_b64 v[112:113],0
v_mov_b64 v[114:115],0
v_mov_b64 v[116:117],0
v_mov_b64 v[118:119],0
v_mov_b64 v[120:121],0
v_mov_b64 v[122:123],0
v_mov_b64 v[124:125],0
v_mov_b64 v[126:127],0
v_mov_b64 v[128:129],0
v_mov_b64 v[130:131],0
v_mov_b64 v[132:133],0
v_mov_b64 v[134:135],0
s_branch R_cw0s2
R_cr1s2:
s_cmp_eq_u32 s58,0
s_cbranch_scc1 R_cg1s2
l4 v[192:195],v2,s[8:11],s25 offen offset:1024 sc1
l4 v[196:199],v2,s[8:11],s25 offen offset:2048 sc1
l4 v[200:203],v2,s[8:11],s25 offen offset:3072 sc1
s_sub_u32 s15,s15,1
s_max_i32 s15,s15,0
s_mov_b32 s58,s15
wt vmcnt(2)
v_max3_u32 v246,v192,v193,v194
v_max_u32 v246,v246,v195
v_cmp_eq_u32 vcc,-1,v246
s_cbranch_vccz R_cg1s2
s_branch R_cr1s2
R_cr2s2:
s_cmp_eq_u32 s58,0
s_cbranch_scc1 R_cg2s2
l4 v[196:199],v2,s[8:11],s25 offen offset:2048 sc1
l4 v[200:203],v2,s[8:11],s25 offen offset:3072 sc1
s_sub_u32 s15,s15,1
s_max_i32 s15,s15,0
s_mov_b32 s58,s15
wt vmcnt(1)
v_max3_u32 v246,v196,v197,v198
v_max_u32 v246,v246,v199
v_cmp_eq_u32 vcc,-1,v246
s_cbranch_vccz R_cg2s2
s_branch R_cr2s2
R_cr3s2:
s_cmp_eq_u32 s58,0
s_cbranch_scc1 R_cg3s2
l4 v[200:203],v2,s[8:11],s25 offen offset:3072 sc1
s_sub_u32 s15,s15,1
s_max_i32 s15,s15,0
s_mov_b32 s58,s15
wt vmcnt(0)
v_max3_u32 v246,v200,v201,v202
v_max_u32 v246,v246,v203
v_cmp_eq_u32 vcc,-1,v246
s_cbranch_vccz R_cg3s2
s_branch R_cr3s2
R_steps2:
s_add_u32 s24,s24,1
s_add_u32 s86,s86,1
v_mov_b32 v253,s86
s_lshl_b32 s97,1,s24
v_mov_b32 v244,s97
s_mov_b32 s28,s29
s_mov_b32 s29,s30
s_add_u32 s30,s24,3
s_min_u32 s30,s30,63
s_lshl_b32 s30,s30,19
s_and_b32 s95,s30,0xffe00000
s_add_u32 s30,s30,s95
s_add_u32 s31,s31,0x10000
s_add_u32 s26,s26,0x80000
s_and_b32 s26,s26,0x180000
s_xor_b32 s27,s25,0x100000
s_mov_b32 s58,s15
v_mov_b64 v[136:137],0
v_mov_b64 v[138:139],0
v_mov_b64 v[140:141],0
v_mov_b64 v[142:143],0
v_mov_b64 v[144:145],0
v_mov_b64 v[146:147],0
v_mov_b64 v[148:149],0
v_mov_b64 v[150:151],0
v_mov_b64 v[152:153],0
v_mov_b64 v[154:155],0
v_mov_b64 v[156:157],0
v_mov_b64 v[158:159],0
v_mov_b64 v[160:161],0
v_mov_b64 v[162:163],0
v_mov_b64 v[164:165],0
v_mov_b64 v[166:167],0
v_mov_b64 v[168:169],0
v_mov_b64 v[170:171],0
cv v44,v204,v205
cv v45,v206,v207
cv v52,v208,v209
cv v53,v210,v211
cv v60,v212,v213
cv v61,v214,v215
cv v68,v216,v217
cv v69,v218,v219
s_nop 14
l4 v[188:191],v2,s[8:11],s25 offen sc1
s_nop 5
l4 v[192:195],v2,s[8:11],s25 offen offset:1024 sc1
s_nop 5
l4 v[196:199],v2,s[8:11],s25 offen offset:2048 sc1
s_nop 5
l4 v[200:203],v2,s[8:11],s25 offen offset:3072 sc1
R_cw0s2:
wt vmcnt(3)
ms v[128:131],v[188:191],a[128:135],v23
v_max3_u32 v246,v188,v189,v190
v_max_u32 v246,v246,v191
ms v[132:135],v[188:191],a[160:167],v23
v_cmp_eq_u32 vcc,-1,v246
ms v[112:115],v[188:191],a[0:7],v23
wt vmcnt(2)
v_max3_u32 v247,v192,v193,v194
ms v[116:119],v[188:191],a[32:39],v23
v_max_u32 v247,v247,v195
s_cbranch_vccnz R_cr0s2
R_cg0s2:
v_cmp_eq_u32 vcc,-1,v247
ms v[120:123],v[188:191],a[64:71],v23
ms v[124:127],v[188:191],a[96:103],v23
s_cbranch_vccnz R_cr1s2
R_cg1s2:
ms v[128:131],v[192:195],a[136:143],v23
wt vmcnt(1)
ms v[132:135],v[192:195],a[168:175],v23
v_max3_u32 v246,v196,v197,v198
ms v[112:115],v[192:195],a[8:15],v23
v_max_u32 v246,v246,v199
ms v[116:119],v[192:195],a[40:47],v23
v_cmp_eq_u32 vcc,-1,v246
ms v[120:123],v[192:195],a[72:79],v23
ms v[124:127],v[192:195],a[104:111],v23
s_cbranch_vccnz R_cr2s2
R_cg2s2:
ms v[128:131],v[196:199],a[144:151],v23
wt vmcnt(0)
ms v[132:135],v[196:199],a[176:183],v23
v_max3_u32 v246,v200,v201,v202
ms v[112:115],v[196:199],a[16:23],v23
v_max_u32 v246,v246,v203
ms v[116:119],v[196:199],a[48:55],v23
v_cmp_eq_u32 vcc,-1,v246
ms v[120:123],v[196:199],a[80:87],v23
ms v[124:127],v[196:199],a[112:119],v23
s_cbranch_vccnz R_cr3s2
R_cg3s2:
ms v[128:131],v[200:203],a[152:159],v23
ms v[132:135],v[200:203],a[184:191],v23
ms v[112:115],v[200:203],a[24:31],v23
pa v[228:229],v[128:129],v[130:131]
ms v[116:119],v[200:203],a[56:63],v23
pa v[230:231],v[132:133],v[134:135]
ms v[120:123],v[200:203],a[88:95],v23
ds_write2_b32 v17,v228,v230 offset0:0 offset1:1
ms v[124:127],v[200:203],a[120:127],v23
ds_write2_b32 v17,v229,v231 offset0:32 offset1:33
pa v[220:221],v[112:113],v[114:115]
pa v[222:223],v[116:117],v[118:119]
ds_write2_b32 v15,v220,v222 offset0:0 offset1:1
ds_write2_b32 v15,v221,v223 offset0:32 offset1:33
buffer_store_dword v253,v252,s[8:11],0 offen sc1
pa v[224:225],v[120:121],v[122:123]
s_nop 0
pa v[226:227],v[124:125],v[126:127]
ds_write2_b32 v16,v224,v226 offset0:0 offset1:1
ds_write2_b32 v16,v225,v227 offset0:32 offset1:33
s_cmp_eq_u32 s24,63
wt lgkmcnt(4)
s_barrier
buffer_load_dword v248,v250,s[8:11],0 offen offset:1024 sc1
wt lgkmcnt(0)
s_barrier
s_cbranch_scc1 R_lasts2
s_mov_b64 exec,0xffff
s_min_u32 s94,s15,1000
R_fas2:
v_cmp_gt_i32 vcc,s86,v248
buffer_load_dword v248,v250,s[8:11],0 offen offset:2048 sc1
s_cbranch_vccz R_fas2_ok
v_cmp_gt_i32 vcc,s86,v248
s_cbranch_vccz R_fas2_ok
v_cmp_gt_i32 vcc,s86,v248
s_cbranch_vccz R_fas2_ok
v_cmp_gt_i32 vcc,s86,v248
buffer_load_dword v248,v250,s[8:11],0 offen offset:3072 sc1
s_cbranch_vccz R_fas2_ok
v_cmp_gt_i32 vcc,s86,v248
s_cbranch_vccz R_fas2_ok
v_cmp_gt_i32 vcc,s86,v248
s_cbranch_vccz R_fas2_ok
v_cmp_gt_i32 vcc,s86,v248
buffer_load_dword v248,v250,s[8:11],0 offen sc1
s_cbranch_vccz R_fas2_ok
v_cmp_gt_i32 vcc,s86,v248
s_cbranch_vccz R_fas2_ok
v_cmp_gt_i32 vcc,s86,v248
s_cbranch_vccz R_fas2_ok
v_cmp_gt_i32 vcc,s86,v248
buffer_load_dword v248,v250,s[8:11],0 offen offset:1024 sc1
s_cbranch_vccz R_fas2_ok
v_cmp_gt_i32 vcc,s86,v248
s_cbranch_vccz R_fas2_ok
v_cmp_gt_i32 vcc,s86,v248
s_cbranch_vccz R_fas2_ok
s_sub_u32 s94,s94,1
s_cbranch_scc0 R_fas2
R_fas2_ok:
s_mov_b64 exec,-1
ds_read_b32 v204,v18 offset:0
ds_read_b32 v208,v18 offset:1024
ds_read_b32 v212,v18 offset:2048
ds_read_b32 v216,v18 offset:3072
ds_read_b32 v205,v18 offset:128
ds_read_b32 v209,v18 offset:1152
l4 v[232:235],v6,s[8:11],s25 offen sc1
l4 v[236:239],v6,s[8:11],s25 offen offset:1024 sc1
ds_read_b32 v213,v18 offset:2176
ds_read_b32 v217,v18 offset:3200
ds_read_b32 v206,v19 offset:256
ds_read_b32 v210,v19 offset:1280
ds_read_b32 v214,v19 offset:2304
ds_read_b32 v218,v19 offset:3328
ds_read_b32 v207,v19 offset:384
ds_read_b32 v211,v19 offset:1408
ds_read_b32 v215,v19 offset:2432
ds_read_b32 v219,v19 offset:3456
v_mov_b64 v[112:113],0
v_mov_b64 v[114:115],0
v_mov_b64 v[116:117],0
v_mov_b64 v[118:119],0
v_mov_b64 v[120:121],0
v_mov_b64 v[122:123],0
v_mov_b64 v[124:125],0
v_mov_b64 v[126:127],0
v_mov_b64 v[128:129],0
v_mov_b64 v[130:131],0
v_mov_b64 v[132:133],0
v_mov_b64 v[134:135],0
s_nop 15
s_nop 15
s_nop 1
l4 v[188:191],v4,s[8:11],s25 offen sc1
l4 v[192:195],v4,s[8:11],s25 offen offset:1024 sc1
buffer_load_dwordx2 v[196:197],v5,s[8:11],s25 offen sc1
wt lgkmcnt(0)
pa v[204:205],v[204:205],v[208:209]
pa v[206:207],v[206:207],v[210:211]
pa v[204:205],v[204:205],v[212:213]
pa v[206:207],v[206:207],v[214:215]
pa v[204:205],v[204:205],v[216:217]
pa v[206:207],v[206:207],v[218:219]
cv v172,v204,v205
cv v173,v206,v207
wt vmcnt(3)
R_aw0s2:
ms v[136:139],v[232:235],a[192:199],v23
v_max3_u32 v246,v232,v233,v234
ms v[136:139],v[236:239],a[200:207],v23
v_max3_u32 v247,v235,v236,v237
ms v[140:143],v[232:235],a[208:215],v23
v_max3_u32 v246,v246,v238,v239
ms v[140:143],v[236:239],a[216:223],v23
v_max_u32 v246,v246,v247
ms v[144:147],v[232:235],a[224:231],v23
v_cmp_eq_u32 vcc,-1,v246
ms v[144:147],v[236:239],a[232:239],v23
pa v[136:137],v[136:137],v[138:139]
ms v[148:151],v[232:235],a[240:247],v23
cv v42,v136,v137
ms v[148:151],v[236:239],a[248:255],v23
s_cbranch_vccnz R_ar0s2
R_ag0s2:
cv v46,v136,v137
pa v[140:141],v[140:141],v[142:143]
wt vmcnt(2)
mm v[200:203],v[180:183],v[188:191],0
wt vmcnt(1)
mm v[200:203],v[184:187],v[192:195],v[200:203]
wt vmcnt(0)
mh v[240:243],v[26:27],v[196:197],0
cv v50,v140,v141
cv v54,v140,v141
pa v[144:145],v[144:145],v[146:147]
cv v58,v144,v145
cv v62,v144,v145
v_max3_f32 v198,v200,v201,v202
pa v[148:149],v[148:149],v[150:151]
cv v66,v148,v149
v_cmp_u_f32 vcc,v200,v240
v_max3_f32 v198,v198,v203,v240
R_ag1s2:
v_mul_f32 v224,s54,v203
cv v70,v148,v149
v_max_f32_dpp v198,v198,v198 quad_perm:[2,3,0,1] row_mask:0xf bank_mask:0xf
v_mul_f32 v199,s54,v198
v_mul_f32 v198,s54,v198
v_mul_f32 v220,s54,v200
v_mul_f32 v221,s54,v201
s_cbranch_vccnz R_ar1s2
R_ah1s2:
v_permlane16_swap_b32 v198,v199
v_max_f32 v246,v198,v199
v_max_f32 v247,v198,v199
ds_sub_rtn_u32 v226,v245,v28
v_mul_f32 v223,s54,v202
v_permlane32_swap_b32 v246,v247
v_max_f32 v198,v246,v247
v_sub_f32 v220,v220,v198
v_sub_f32 v221,v221,v198
v_exp_f32 v220,v220
v_mul_f32 v222,s54,v240
v_sub_f32 v222,v222,v198
v_exp_f32 v221,v221
v_sub_f32 v223,v223,v198
v_exp_f32 v222,v222
v_sub_f32 v224,v224,v198
v_exp_f32 v223,v223
cv v176,v220,v221
v_exp_f32 v224,v224
cv v177,v222,0
cv v179,v222,0
cv v178,v223,v224
wt lgkmcnt(0)
v_lshl_add_u32 v226,v226,30,v14
buffer_store_dword v244,v226,s[8:11],0 offen sc1
ms v[152:155],v[176:179],v[32:39],v24
l4 v[96:99],v13,s[8:11],s28 offen offset:128 sc1
ms v[156:159],v[176:179],v[40:47],v24
l4 v[100:103],v13,s[8:11],s28 offen offset:2176 sc1
ms v[160:163],v[176:179],v[48:55],v24
pa v[236:237],v[152:153],v[154:155]
ms v[164:167],v[176:179],v[56:63],v24
v_rcp_f32 v236,v236
ms v[168:171],v[176:179],v[64:71],v24
v_rcp_f32 v237,v237
pa v[156:157],v[156:157],v[158:159]
v_mul_f32 v228,v156,v236
v_mul_f32 v232,v157,v237
pa v[160:161],v[160:161],v[162:163]
v_mul_f32 v229,v160,v236
v_mul_f32 v233,v161,v237
pa v[164:165],v[164:165],v[166:167]
v_mul_f32 v230,v164,v236
v_mul_f32 v234,v165,v237
pa v[168:169],v[168:169],v[170:171]
v_mul_f32 v231,v168,v236
ds_write_b128 v20,v[228:231]
v_mul_f32 v235,v169,v237
ds_write_b128 v21,v[232:235] offset:256
buffer_store_dwordx2 v[172:173],v25,s[8:11],s31 offen sc1
wt lgkmcnt(0)
s_barrier
s_buffer_load_dwordx2 s[44:45],s[8:11],s98 glc
s_buffer_load_dwordx2 s[46:47],s[8:11],s98 offset:65536 glc
mm v[188:191],v[72:75],a[192:195],0
mm v[192:195],v[72:75],a[208:211],0
mm v[196:199],v[72:75],a[224:227],0
mm v[200:203],v[72:75],a[240:243],0
mm v[188:191],v[76:79],a[196:199],v[188:191]
mm v[192:195],v[76:79],a[212:215],v[192:195]
mm v[196:199],v[76:79],a[228:231],v[196:199]
mm v[200:203],v[76:79],a[244:247],v[200:203]
mm v[188:191],v[80:83],a[200:203],v[188:191]
s_buffer_load_dwordx2 s[44:45],s[8:11],s98 glc
s_buffer_load_dwordx2 s[46:47],s[8:11],s98 offset:65536 glc
mm v[192:195],v[80:83],a[216:219],v[192:195]
mm v[196:199],v[80:83],a[232:235],v[196:199]
mm v[200:203],v[80:83],a[248:251],v[200:203]
mm v[188:191],v[84:87],a[204:207],v[188:191]
mm v[192:195],v[84:87],a[220:223],v[192:195]
mm v[196:199],v[84:87],a[236:239],v[196:199]
mm v[200:203],v[84:87],a[252:255],v[200:203]
l4 v[72:75],v12,s[8:11],s29 offen sc1
l4 v[76:79],v12,s[8:11],s29 offen offset:2048 sc1
mm v[204:207],v[88:91],a[192:195],0
mm v[208:211],v[88:91],a[208:211],0
cv v40,v188,v189
s_buffer_load_dwordx2 s[44:45],s[8:11],s98 glc
s_buffer_load_dwordx2 s[46:47],s[8:11],s98 offset:65536 glc
mm v[212:215],v[88:91],a[224:227],0
cv v41,v190,v191
mm v[216:219],v[88:91],a[240:243],0
cv v48,v192,v193
l4 v[80:83],v13,s[8:11],s29 offen sc1
l4 v[84:87],v13,s[8:11],s29 offen offset:2048 sc1
mm v[204:207],v[92:95],a[196:199],v[204:207]
cv v49,v194,v195
s_min_u32 s94,s15,2000
R_fbs2:
s_and_b64 s[36:37],s[44:45],s[46:47]
s_and_b32 s36,s36,s37
s_and_b32 s36,s36,s97
s_cbranch_scc1 R_fbs2_ok
s_nop 1
s_and_b64 s[36:37],s[44:45],s[46:47]
s_and_b32 s36,s36,s37
s_and_b32 s36,s36,s97
s_cbranch_scc1 R_fbs2_ok
s_nop 1
s_and_b64 s[36:37],s[44:45],s[46:47]
s_and_b32 s36,s36,s37
s_and_b32 s36,s36,s97
s_cbranch_scc1 R_fbs2_ok
s_nop 1
s_and_b64 s[36:37],s[44:45],s[46:47]
s_and_b32 s36,s36,s37
s_and_b32 s36,s36,s97
s_cbranch_scc1 R_fbs2_ok
s_nop 1
s_buffer_load_dwordx2 s[44:45],s[8:11],s98 glc
s_buffer_load_dwordx2 s[46:47],s[8:11],s98 offset:65536 glc
s_sub_u32 s94,s94,1
s_cbranch_scc0 R_fbs2
R_fbs2_ok:
s_barrier
s_nop 3
l4 v[236:239],v10,s[8:11],s25 offen sc1
mm v[208:211],v[92:95],a[212:215],v[208:211]
cv v56,v196,v197
mm v[212:215],v[92:95],a[228:231],v[212:215]
cv v57,v198,v199
mm v[216:219],v[92:95],a[244:247],v[216:219]
cv v64,v200,v201
l4 v[88:91],v12,s[8:11],s29 offen offset:128 sc1
l4 v[92:95],v12,s[8:11],s29 offen offset:2176 sc1
wt vmcnt(8)
mm v[204:207],v[96:99],a[200:203],v[204:207]
cv v65,v202,v203
mm v[208:211],v[96:99],a[216:219],v[208:211]
mm v[212:215],v[96:99],a[232:235],v[212:215]
mm v[216:219],v[96:99],a[248:251],v[216:219]
mm v[204:207],v[100:103],a[204:207],v[204:207]
mm v[208:211],v[100:103],a[220:223],v[208:211]
mm v[212:215],v[100:103],a[236:239],v[212:215]
mm v[216:219],v[100:103],a[252:255],v[216:219]
s_mov_b32 s59,s25
s_mov_b32 s25,s26
wt vmcnt(2)
mm v[228:231],v[180:183],v[236:239],0
s_add_u32 s36,s88,s30
s_buffer_load_dwordx2 s[100:101],s[8:11],s36 offset:60
s_buffer_load_dwordx2 s[100:101],s[8:11],s36 offset:188
s_buffer_load_dwordx2 s[100:101],s[8:11],s36 offset:316
s_buffer_load_dwordx2 s[100:101],s[8:11],s36 offset:444
s_nop 2
v_cmp_u_f32 vcc,v228,v228
v_add_f32_dpp v228,v228,v228 row_ror:8 row_mask:0xf bank_mask:0xf
v_add_f32_dpp v229,v229,v229 row_ror:8 row_mask:0xf bank_mask:0xf
v_add_f32_dpp v230,v230,v230 row_ror:8 row_mask:0xf bank_mask:0xf
v_add_f32_dpp v231,v231,v231 row_ror:8 row_mask:0xf bank_mask:0xf
cv v232,v228,v229
cv v233,v230,v231
s_cbranch_vccnz R_brs2
R_bgs2:
buffer_store_dwordx2 v[232:233],v3,s[8:11],s25 offen sc1
s_branch R_steps2
R_lasts2:
ds_read_b32 v204,v18 offset:0
ds_read_b32 v208,v18 offset:1024
ds_read_b32 v212,v18 offset:2048
ds_read_b32 v216,v18 offset:3072
ds_read_b32 v205,v18 offset:128
ds_read_b32 v209,v18 offset:1152
ds_read_b32 v213,v18 offset:2176
ds_read_b32 v217,v18 offset:3200
ds_read_b32 v206,v19 offset:256
ds_read_b32 v210,v19 offset:1280
ds_read_b32 v214,v19 offset:2304
ds_read_b32 v218,v19 offset:3328
ds_read_b32 v207,v19 offset:384
ds_read_b32 v211,v19 offset:1408
ds_read_b32 v215,v19 offset:2432
ds_read_b32 v219,v19 offset:3456
wt lgkmcnt(0)
pa v[204:205],v[204:205],v[208:209]
pa v[206:207],v[206:207],v[210:211]
pa v[204:205],v[204:205],v[212:213]
pa v[206:207],v[206:207],v[214:215]
pa v[204:205],v[204:205],v[216:217]
pa v[206:207],v[206:207],v[218:219]
cv v172,v204,v205
cv v173,v206,v207
buffer_store_dwordx2 v[172:173],v25,s[8:11],s31 offen sc1
s_branch R_fins
R_ar0s2:
s_cmp_eq_u32 s15,0
s_cbranch_scc1 R_ag0s2
l4 v[232:235],v6,s[8:11],s25 offen sc1
l4 v[236:239],v6,s[8:11],s25 offen offset:1024 sc1
l4 v[188:191],v4,s[8:11],s25 offen sc1
l4 v[192:195],v4,s[8:11],s25 offen offset:1024 sc1
buffer_load_dwordx2 v[196:197],v5,s[8:11],s25 offen sc1
s_sub_u32 s15,s15,1
s_max_i32 s15,s15,0
v_mov_b64 v[136:137],0
v_mov_b64 v[138:139],0
v_mov_b64 v[140:141],0
v_mov_b64 v[142:143],0
v_mov_b64 v[144:145],0
v_mov_b64 v[146:147],0
v_mov_b64 v[148:149],0
v_mov_b64 v[150:151],0
wt vmcnt(0)
s_branch R_aw0s2
R_ar1s2:
s_cmp_eq_u32 s15,0
s_cbranch_scc1 R_ah1s2
l4 v[188:191],v4,s[8:11],s25 offen sc1
l4 v[192:195],v4,s[8:11],s25 offen offset:1024 sc1
buffer_load_dwordx2 v[196:197],v5,s[8:11],s25 offen sc1
s_sub_u32 s15,s15,1
s_max_i32 s15,s15,0
wt vmcnt(2)
mm v[200:203],v[180:183],v[188:191],0
wt vmcnt(1)
mm v[200:203],v[184:187],v[192:195],v[200:203]
wt vmcnt(0)
mh v[240:243],v[26:27],v[196:197],0
s_nop 3
v_max3_f32 v198,v200,v201,v202
s_nop 2
v_cmp_u_f32 vcc,v200,v240
v_max3_f32 v198,v198,v203,v240
s_branch R_ag1s2
R_brs2:
R_br2s2:
s_cmp_eq_u32 s15,0
s_cbranch_scc1 R_bgs2
l4 v[236:239],v10,s[8:11],s59 offen sc1
R_br3s2:
s_sub_u32 s15,s15,1
s_max_i32 s15,s15,0
wt vmcnt(0)
mm v[228:231],v[180:183],v[236:239],0
s_nop 7
v_cmp_u_f32 vcc,v228,v228
v_add_f32_dpp v228,v228,v228 row_ror:8 row_mask:0xf bank_mask:0xf
v_add_f32_dpp v229,v229,v229 row_ror:8 row_mask:0xf bank_mask:0xf
v_add_f32_dpp v230,v230,v230 row_ror:8 row_mask:0xf bank_mask:0xf
v_add_f32_dpp v231,v231,v231 row_ror:8 row_mask:0xf bank_mask:0xf
cv v232,v228,v229
cv v233,v230,v231
s_cbranch_vccz R_bgs2
s_branch R_br2s2
R_cr0s3:
s_cmp_eq_u32 s58,0
s_cbranch_scc1 R_cg0s3
l4 v[188:191],v2,s[8:11],s25 offen sc1
l4 v[192:195],v2,s[8:11],s25 offen offset:1024 sc1
l4 v[196:199],v2,s[8:11],s25 offen offset:2048 sc1
l4 v[200:203],v2,s[8:11],s25 offen offset:3072 sc1
s_sub_u32 s15,s15,1
s_max_i32 s15,s15,0
s_mov_b32 s58,s15
v_mov_b64 v[112:113],0
v_mov_b64 v[114:115],0
v_mov_b64 v[116:117],0
v_mov_b64 v[118:119],0
v_mov_b64 v[120:121],0
v_mov_b64 v[122:123],0
v_mov_b64 v[124:125],0
v_mov_b64 v[126:127],0
v_mov_b64 v[128:129],0
v_mov_b64 v[130:131],0
v_mov_b64 v[132:133],0
v_mov_b64 v[134:135],0
s_branch R_cw0s3
R_cr1s3:
s_cmp_eq_u32 s58,0
s_cbranch_scc1 R_cg1s3
l4 v[192:195],v2,s[8:11],s25 offen offset:1024 sc1
l4 v[196:199],v2,s[8:11],s25 offen offset:2048 sc1
l4 v[200:203],v2,s[8:11],s25 offen offset:3072 sc1
s_sub_u32 s15,s15,1
s_max_i32 s15,s15,0
s_mov_b32 s58,s15
wt vmcnt(2)
v_max3_u32 v246,v192,v193,v194
v_max_u32 v246,v246,v195
v_cmp_eq_u32 vcc,-1,v246
s_cbranch_vccz R_cg1s3
s_branch R_cr1s3
R_cr2s3:
s_cmp_eq_u32 s58,0
s_cbranch_scc1 R_cg2s3
l4 v[196:199],v2,s[8:11],s25 offen offset:2048 sc1
l4 v[200:203],v2,s[8:11],s25 offen offset:3072 sc1
s_sub_u32 s15,s15,1
s_max_i32 s15,s15,0
s_mov_b32 s58,s15
wt vmcnt(1)
v_max3_u32 v246,v196,v197,v198
v_max_u32 v246,v246,v199
v_cmp_eq_u32 vcc,-1,v246
s_cbranch_vccz R_cg2s3
s_branch R_cr2s3
R_cr3s3:
s_cmp_eq_u32 s58,0
s_cbranch_scc1 R_cg3s3
l4 v[200:203],v2,s[8:11],s25 offen offset:3072 sc1
s_sub_u32 s15,s15,1
s_max_i32 s15,s15,0
s_mov_b32 s58,s15
wt vmcnt(0)
v_max3_u32 v246,v200,v201,v202
v_max_u32 v246,v246,v203
v_cmp_eq_u32 vcc,-1,v246
s_cbranch_vccz R_cg3s3
s_branch R_cr3s3
R_steps3:
s_add_u32 s24,s24,1
s_add_u32 s86,s86,1
v_mov_b32 v253,s86
s_lshl_b32 s97,1,s24
v_mov_b32 v244,s97
s_mov_b32 s28,s29
s_mov_b32 s29,s30
s_add_u32 s30,s24,3
s_min_u32 s30,s30,63
s_lshl_b32 s30,s30,19
s_and_b32 s95,s30,0xffe00000
s_add_u32 s30,s30,s95
s_add_u32 s31,s31,0x10000
s_add_u32 s26,s26,0x80000
s_and_b32 s26,s26,0x180000
s_xor_b32 s27,s25,0x100000
s_mov_b32 s58,s15
v_mov_b64 v[136:137],0
v_mov_b64 v[138:139],0
v_mov_b64 v[140:141],0
v_mov_b64 v[142:143],0
v_mov_b64 v[144:145],0
v_mov_b64 v[146:147],0
v_mov_b64 v[148:149],0
v_mov_b64 v[150:151],0
v_mov_b64 v[152:153],0
v_mov_b64 v[154:155],0
v_mov_b64 v[156:157],0
v_mov_b64 v[158:159],0
v_mov_b64 v[160:161],0
v_mov_b64 v[162:163],0
v_mov_b64 v[164:165],0
v_mov_b64 v[166:167],0
v_mov_b64 v[168:169],0
v_mov_b64 v[170:171],0
cv v44,v204,v205
cv v45,v206,v207
cv v52,v208,v209
cv v53,v210,v211
cv v60,v212,v213
cv v61,v214,v215
cv v68,v216,v217
cv v69,v218,v219
s_nop 14
l4 v[188:191],v2,s[8:11],s25 offen sc1
s_nop 5
l4 v[192:195],v2,s[8:11],s25 offen offset:1024 sc1
s_nop 5
l4 v[196:199],v2,s[8:11],s25 offen offset:2048 sc1
s_nop 5
l4 v[200:203],v2,s[8:11],s25 offen offset:3072 sc1
R_cw0s3:
wt vmcnt(3)
ms v[128:131],v[188:191],a[128:135],v23
v_max3_u32 v246,v188,v189,v190
v_max_u32 v246,v246,v191
ms v[132:135],v[188:191],a[160:167],v23
v_cmp_eq_u32 vcc,-1,v246
ms v[112:115],v[188:191],a[0:7],v23
wt vmcnt(2)
v_max3_u32 v247,v192,v193,v194
ms v[116:119],v[188:191],a[32:39],v23
v_max_u32 v247,v247,v195
s_cbranch_vccnz R_cr0s3
R_cg0s3:
v_cmp_eq_u32 vcc,-1,v247
ms v[120:123],v[188:191],a[64:71],v23
ms v[124:127],v[188:191],a[96:103],v23
s_cbranch_vccnz R_cr1s3
R_cg1s3:
ms v[128:131],v[192:195],a[136:143],v23
wt vmcnt(1)
ms v[132:135],v[192:195],a[168:175],v23
v_max3_u32 v246,v196,v197,v198
ms v[112:115],v[192:195],a[8:15],v23
v_max_u32 v246,v246,v199
ms v[116:119],v[192:195],a[40:47],v23
v_cmp_eq_u32 vcc,-1,v246
ms v[120:123],v[192:195],a[72:79],v23
ms v[124:127],v[192:195],a[104:111],v23
s_cbranch_vccnz R_cr2s3
R_cg2s3:
ms v[128:131],v[196:199],a[144:151],v23
wt vmcnt(0)
ms v[132:135],v[196:199],a[176:183],v23
v_max3_u32 v246,v200,v201,v202
ms v[112:115],v[196:199],a[16:23],v23
v_max_u32 v246,v246,v203
ms v[116:119],v[196:199],a[48:55],v23
v_cmp_eq_u32 vcc,-1,v246
ms v[120:123],v[196:199],a[80:87],v23
ms v[124:127],v[196:199],a[112:119],v23
s_cbranch_vccnz R_cr3s3
R_cg3s3:
ms v[128:131],v[200:203],a[152:159],v23
ms v[132:135],v[200:203],a[184:191],v23
ms v[112:115],v[200:203],a[24:31],v23
pa v[228:229],v[128:129],v[130:131]
ms v[116:119],v[200:203],a[56:63],v23
pa v[230:231],v[132:133],v[134:135]
ms v[120:123],v[200:203],a[88:95],v23
ds_write2_b32 v17,v228,v230 offset0:0 offset1:1
ms v[124:127],v[200:203],a[120:127],v23
ds_write2_b32 v17,v229,v231 offset0:32 offset1:33
pa v[220:221],v[112:113],v[114:115]
pa v[222:223],v[116:117],v[118:119]
ds_write2_b32 v15,v220,v222 offset0:0 offset1:1
ds_write2_b32 v15,v221,v223 offset0:32 offset1:33
buffer_store_dword v253,v252,s[8:11],0 offen sc1
pa v[224:225],v[120:121],v[122:123]
s_nop 0
pa v[226:227],v[124:125],v[126:127]
ds_write2_b32 v16,v224,v226 offset0:0 offset1:1
ds_write2_b32 v16,v225,v227 offset0:32 offset1:33
s_cmp_eq_u32 s24,63
wt lgkmcnt(4)
s_barrier
dr v[204:207],v18 offset:0
dr v[208:211],v18 offset:1024
dr v[212:215],v18 offset:2048
dr v[216:219],v18 offset:3072
buffer_load_dword v248,v250,s[8:11],0 offen offset:1024 sc1
wt lgkmcnt(4)
s_barrier
buffer_load_dword v248,v250,s[8:11],0 offen offset:2048 sc1
wt lgkmcnt(2)
pa v[204:205],v[204:205],v[208:209]
pa v[206:207],v[206:207],v[210:211]
wt lgkmcnt(1)
pa v[204:205],v[204:205],v[212:213]
pa v[206:207],v[206:207],v[214:215]
wt lgkmcnt(0)
pa v[204:205],v[204:205],v[216:217]
pa v[206:207],v[206:207],v[218:219]
cv v208,v204,v205
cv v209,v206,v207
buffer_store_dwordx2 v[208:209],v7,s[8:11],s25 offen sc1
s_cbranch_scc1 R_fins
s_mov_b64 exec,0xffff
s_min_u32 s94,s15,1000
R_fas3:
v_cmp_gt_i32 vcc,s86,v248
buffer_load_dword v248,v250,s[8:11],0 offen offset:3072 sc1
s_cbranch_vccz R_fas3_ok
v_cmp_gt_i32 vcc,s86,v248
s_cbranch_vccz R_fas3_ok
v_cmp_gt_i32 vcc,s86,v248
s_cbranch_vccz R_fas3_ok
v_cmp_gt_i32 vcc,s86,v248
buffer_load_dword v248,v250,s[8:11],0 offen sc1
s_cbranch_vccz R_fas3_ok
v_cmp_gt_i32 vcc,s86,v248
s_cbranch_vccz R_fas3_ok
v_cmp_gt_i32 vcc,s86,v248
s_cbranch_vccz R_fas3_ok
v_cmp_gt_i32 vcc,s86,v248
buffer_load_dword v248,v250,s[8:11],0 offen offset:1024 sc1
s_cbranch_vccz R_fas3_ok
v_cmp_gt_i32 vcc,s86,v248
s_cbranch_vccz R_fas3_ok
v_cmp_gt_i32 vcc,s86,v248
s_cbranch_vccz R_fas3_ok
v_cmp_gt_i32 vcc,s86,v248
buffer_load_dword v248,v250,s[8:11],0 offen offset:2048 sc1
s_cbranch_vccz R_fas3_ok
v_cmp_gt_i32 vcc,s86,v248
s_cbranch_vccz R_fas3_ok
v_cmp_gt_i32 vcc,s86,v248
s_cbranch_vccz R_fas3_ok
s_sub_u32 s94,s94,1
s_cbranch_scc0 R_fas3
R_fas3_ok:
s_mov_b64 exec,-1
v_mov_b64 v[112:113],0
v_mov_b64 v[114:115],0
v_mov_b64 v[116:117],0
v_mov_b64 v[118:119],0
v_mov_b64 v[120:121],0
v_mov_b64 v[122:123],0
l4 v[232:235],v6,s[8:11],s25 offen sc1
l4 v[236:239],v6,s[8:11],s25 offen offset:1024 sc1
v_mov_b64 v[124:125],0
v_mov_b64 v[126:127],0
v_mov_b64 v[128:129],0
v_mov_b64 v[130:131],0
v_mov_b64 v[132:133],0
v_mov_b64 v[134:135],0
s_nop 15
s_nop 15
s_nop 15
s_nop 1
l4 v[188:191],v4,s[8:11],s25 offen sc1
l4 v[192:195],v4,s[8:11],s25 offen offset:1024 sc1
buffer_load_dwordx2 v[196:197],v5,s[8:11],s25 offen sc1
s_and_b32 s36,s18,0xff
s_cmp_ge_u32 s36,8
s_cbranch_scc0 R_kvcs3
R_kvks3:
wt vmcnt(3)
R_aw0s3:
ms v[136:139],v[232:235],a[192:199],v23
v_max3_u32 v246,v232,v233,v234
ms v[136:139],v[236:239],a[200:207],v23
v_max3_u32 v247,v235,v236,v237
ms v[140:143],v[232:235],a[208:215],v23
v_max3_u32 v246,v246,v238,v239
ms v[140:143],v[236:239],a[216:223],v23
v_max_u32 v246,v246,v247
ms v[144:147],v[232:235],a[224:231],v23
v_cmp_eq_u32 vcc,-1,v246
ms v[144:147],v[236:239],a[232:239],v23
pa v[136:137],v[136:137],v[138:139]
ms v[148:151],v[232:235],a[240:247],v23
cv v42,v136,v137
ms v[148:151],v[236:239],a[248:255],v23
s_cbranch_vccnz R_ar0s3
R_ag0s3:
cv v46,v136,v137
pa v[140:141],v[140:141],v[142:143]
wt vmcnt(2)
mm v[200:203],v[180:183],v[188:191],0
wt vmcnt(1)
mm v[200:203],v[184:187],v[192:195],v[200:203]
wt vmcnt(0)
mh v[240:243],v[26:27],v[196:197],0
cv v50,v140,v141
cv v54,v140,v141
pa v[144:145],v[144:145],v[146:147]
cv v58,v144,v145
cv v62,v144,v145
v_max3_f32 v198,v200,v201,v202
pa v[148:149],v[148:149],v[150:151]
cv v66,v148,v149
v_cmp_u_f32 vcc,v200,v240
v_max3_f32 v198,v198,v203,v240
R_ag1s3:
v_mul_f32 v224,s54,v203
cv v70,v148,v149
v_max_f32_dpp v198,v198,v198 quad_perm:[2,3,0,1] row_mask:0xf bank_mask:0xf
v_mul_f32 v199,s54,v198
v_mul_f32 v198,s54,v198
v_mul_f32 v220,s54,v200
v_mul_f32 v221,s54,v201
s_cbranch_vccnz R_ar1s3
R_ah1s3:
v_permlane16_swap_b32 v198,v199
v_max_f32 v246,v198,v199
v_max_f32 v247,v198,v199
ds_sub_rtn_u32 v226,v245,v28
v_mul_f32 v223,s54,v202
v_permlane32_swap_b32 v246,v247
v_max_f32 v198,v246,v247
v_sub_f32 v220,v220,v198
v_sub_f32 v221,v221,v198
v_exp_f32 v220,v220
v_mul_f32 v222,s54,v240
v_sub_f32 v222,v222,v198
v_exp_f32 v221,v221
v_sub_f32 v223,v223,v198
v_exp_f32 v222,v222
v_sub_f32 v224,v224,v198
v_exp_f32 v223,v223
cv v176,v220,v221
v_exp_f32 v224,v224
cv v177,v222,0
cv v179,v222,0
cv v178,v223,v224
wt lgkmcnt(0)
v_lshl_add_u32 v226,v226,30,v14
buffer_store_dword v244,v226,s[8:11],0 offen sc1
ms v[152:155],v[176:179],v[32:39],v24
l4 v[96:99],v13,s[8:11],s28 offen offset:128 sc1
ms v[156:159],v[176:179],v[40:47],v24
l4 v[100:103],v13,s[8:11],s28 offen offset:2176 sc1
ms v[160:163],v[176:179],v[48:55],v24
pa v[236:237],v[152:153],v[154:155]
ms v[164:167],v[176:179],v[56:63],v24
v_rcp_f32 v236,v236
ms v[168:171],v[176:179],v[64:71],v24
v_rcp_f32 v237,v237
pa v[156:157],v[156:157],v[158:159]
v_mul_f32 v228,v156,v236
v_mul_f32 v232,v157,v237
pa v[160:161],v[160:161],v[162:163]
v_mul_f32 v229,v160,v236
v_mul_f32 v233,v161,v237
pa v[164:165],v[164:165],v[166:167]
v_mul_f32 v230,v164,v236
v_mul_f32 v234,v165,v237
pa v[168:169],v[168:169],v[170:171]
v_mul_f32 v231,v168,v236
ds_write_b128 v20,v[228:231]
v_mul_f32 v235,v169,v237
ds_write_b128 v21,v[232:235] offset:256
w4 v[28:31],v11,s[8:11],s27 offen sc1
wt lgkmcnt(0)
s_barrier
s_buffer_load_dwordx2 s[44:45],s[8:11],s98 glc
s_buffer_load_dwordx2 s[46:47],s[8:11],s98 offset:65536 glc
mm v[188:191],v[72:75],a[192:195],0
mm v[192:195],v[72:75],a[208:211],0
mm v[196:199],v[72:75],a[224:227],0
mm v[200:203],v[72:75],a[240:243],0
mm v[188:191],v[76:79],a[196:199],v[188:191]
mm v[192:195],v[76:79],a[212:215],v[192:195]
mm v[196:199],v[76:79],a[228:231],v[196:199]
mm v[200:203],v[76:79],a[244:247],v[200:203]
mm v[188:191],v[80:83],a[200:203],v[188:191]
s_buffer_load_dwordx2 s[44:45],s[8:11],s98 glc
s_buffer_load_dwordx2 s[46:47],s[8:11],s98 offset:65536 glc
mm v[192:195],v[80:83],a[216:219],v[192:195]
mm v[196:199],v[80:83],a[232:235],v[196:199]
mm v[200:203],v[80:83],a[248:251],v[200:203]
mm v[188:191],v[84:87],a[204:207],v[188:191]
mm v[192:195],v[84:87],a[220:223],v[192:195]
mm v[196:199],v[84:87],a[236:239],v[196:199]
mm v[200:203],v[84:87],a[252:255],v[200:203]
l4 v[72:75],v12,s[8:11],s29 offen sc1
l4 v[76:79],v12,s[8:11],s29 offen offset:2048 sc1
mm v[204:207],v[88:91],a[192:195],0
mm v[208:211],v[88:91],a[208:211],0
cv v40,v188,v189
s_buffer_load_dwordx2 s[44:45],s[8:11],s98 glc
s_buffer_load_dwordx2 s[46:47],s[8:11],s98 offset:65536 glc
mm v[212:215],v[88:91],a[224:227],0
cv v41,v190,v191
mm v[216:219],v[88:91],a[240:243],0
cv v48,v192,v193
l4 v[80:83],v13,s[8:11],s29 offen sc1
l4 v[84:87],v13,s[8:11],s29 offen offset:2048 sc1
mm v[204:207],v[92:95],a[196:199],v[204:207]
cv v49,v194,v195
s_min_u32 s94,s15,2000
R_fbs3:
s_and_b64 s[36:37],s[44:45],s[46:47]
s_and_b32 s36,s36,s37
s_and_b32 s36,s36,s97
s_cbranch_scc1 R_fbs3_ok
s_nop 1
s_and_b64 s[36:37],s[44:45],s[46:47]
s_and_b32 s36,s36,s37
s_and_b32 s36,s36,s97
s_cbranch_scc1 R_fbs3_ok
s_nop 1
s_and_b64 s[36:37],s[44:45],s[46:47]
s_and_b32 s36,s36,s37
s_and_b32 s36,s36,s97
s_cbranch_scc1 R_fbs3_ok
s_nop 1
s_and_b64 s[36:37],s[44:45],s[46:47]
s_and_b32 s36,s36,s37
s_and_b32 s36,s36,s97
s_cbranch_scc1 R_fbs3_ok
s_nop 1
s_buffer_load_dwordx2 s[44:45],s[8:11],s98 glc
s_buffer_load_dwordx2 s[46:47],s[8:11],s98 offset:65536 glc
s_sub_u32 s94,s94,1
s_cbranch_scc0 R_fbs3
R_fbs3_ok:
s_barrier
s_nop 3
l4 v[236:239],v10,s[8:11],s25 offen sc1
mm v[208:211],v[92:95],a[212:215],v[208:211]
cv v56,v196,v197
s_add_u32 s19,s24,4
mm v[212:215],v[92:95],a[228:231],v[212:215]
cv v57,v198,v199
s_min_u32 s19,s19,63
mm v[216:219],v[92:95],a[244:247],v[216:219]
cv v64,v200,v201
s_lshr_b32 s19,s19,2
l4 v[88:91],v12,s[8:11],s29 offen offset:128 sc1
l4 v[92:95],v12,s[8:11],s29 offen offset:2176 sc1
wt vmcnt(8)
mm v[204:207],v[96:99],a[200:203],v[204:207]
cv v65,v202,v203
s_lshl3_add_u32 s19,s19,s20
mm v[208:211],v[96:99],a[216:219],v[208:211]
s_lshl_b32 s19,s19,8
mm v[212:215],v[96:99],a[232:235],v[212:215]
s_add_u32 s19,s19,4227072
mm v[216:219],v[96:99],a[248:251],v[216:219]
mm v[204:207],v[100:103],a[204:207],v[204:207]
mm v[208:211],v[100:103],a[220:223],v[208:211]
mm v[212:215],v[100:103],a[236:239],v[212:215]
mm v[216:219],v[100:103],a[252:255],v[216:219]
s_mov_b32 s59,s25
s_mov_b32 s25,s26
s_and_b32 s36,s24,3
s_cbranch_scc1 R_kvns3
s_buffer_load_dword s18,s[8:11],s19 glc
R_kvns3:
wt vmcnt(2)
mm v[228:231],v[180:183],v[236:239],0
s_add_u32 s36,s88,s30
s_buffer_load_dwordx2 s[100:101],s[8:11],s36 offset:60
s_buffer_load_dwordx2 s[100:101],s[8:11],s36 offset:188
s_buffer_load_dwordx2 s[100:101],s[8:11],s36 offset:316
s_buffer_load_dwordx2 s[100:101],s[8:11],s36 offset:444
s_nop 2
v_cmp_u_f32 vcc,v228,v228
v_add_f32_dpp v228,v228,v228 row_ror:8 row_mask:0xf bank_mask:0xf
v_add_f32_dpp v229,v229,v229 row_ror:8 row_mask:0xf bank_mask:0xf
v_add_f32_dpp v230,v230,v230 row_ror:8 row_mask:0xf bank_mask:0xf
v_add_f32_dpp v231,v231,v231 row_ror:8 row_mask:0xf bank_mask:0xf
cv v232,v228,v229
cv v233,v230,v231
s_cbranch_vccnz R_brs3
R_bgs3:
buffer_store_dwordx2 v[232:233],v3,s[8:11],s25 offen sc1
s_branch R_steps3
R_kvcs3:
s_cmp_eq_u32 s15,0
s_cbranch_scc1 R_kvks3
s_sleep 4
s_buffer_load_dword s18,s[8:11],s19 glc
s_sub_u32 s15,s15,1
s_max_i32 s15,s15,0
wt lgkmcnt(0)
s_and_b32 s36,s18,0xff
s_cmp_ge_u32 s36,8
s_cbranch_scc0 R_kvcs3
s_branch R_kvks3
R_ar0s3:
s_cmp_eq_u32 s15,0
s_cbranch_scc1 R_ag0s3
l4 v[232:235],v6,s[8:11],s25 offen sc1
l4 v[236:239],v6,s[8:11],s25 offen offset:1024 sc1
l4 v[188:191],v4,s[8:11],s25 offen sc1
l4 v[192:195],v4,s[8:11],s25 offen offset:1024 sc1
buffer_load_dwordx2 v[196:197],v5,s[8:11],s25 offen sc1
s_sub_u32 s15,s15,1
s_max_i32 s15,s15,0
v_mov_b64 v[136:137],0
v_mov_b64 v[138:139],0
v_mov_b64 v[140:141],0
v_mov_b64 v[142:143],0
v_mov_b64 v[144:145],0
v_mov_b64 v[146:147],0
v_mov_b64 v[148:149],0
v_mov_b64 v[150:151],0
wt vmcnt(0)
s_branch R_aw0s3
R_ar1s3:
s_cmp_eq_u32 s15,0
s_cbranch_scc1 R_ah1s3
l4 v[188:191],v4,s[8:11],s25 offen sc1
l4 v[192:195],v4,s[8:11],s25 offen offset:1024 sc1
buffer_load_dwordx2 v[196:197],v5,s[8:11],s25 offen sc1
s_sub_u32 s15,s15,1
s_max_i32 s15,s15,0
wt vmcnt(2)
mm v[200:203],v[180:183],v[188:191],0
wt vmcnt(1)
mm v[200:203],v[184:187],v[192:195],v[200:203]
wt vmcnt(0)
mh v[240:243],v[26:27],v[196:197],0
s_nop 3
v_max3_f32 v198,v200,v201,v202
s_nop 2
v_cmp_u_f32 vcc,v200,v240
v_max3_f32 v198,v198,v203,v240
s_branch R_ag1s3
R_brs3:
R_br2s3:
s_cmp_eq_u32 s15,0
s_cbranch_scc1 R_bgs3
l4 v[236:239],v10,s[8:11],s59 offen sc1
R_br3s3:
s_sub_u32 s15,s15,1
s_max_i32 s15,s15,0
wt vmcnt(0)
mm v[228:231],v[180:183],v[236:239],0
s_nop 7
v_cmp_u_f32 vcc,v228,v228
v_add_f32_dpp v228,v228,v228 row_ror:8 row_mask:0xf bank_mask:0xf
v_add_f32_dpp v229,v229,v229 row_ror:8 row_mask:0xf bank_mask:0xf
v_add_f32_dpp v230,v230,v230 row_ror:8 row_mask:0xf bank_mask:0xf
v_add_f32_dpp v231,v231,v231 row_ror:8 row_mask:0xf bank_mask:0xf
cv v232,v228,v229
cv v233,v230,v231
s_cbranch_vccz R_bgs3
s_branch R_br2s3
R_fins:
wt vmcnt(0) lgkmcnt(0)
s_barrier
s_cmp_eq_u32 s14,0
s_cbranch_scc0 R_l3s
s_lshl_b32 s36,s20,8
s_add_u32 s36,s36,4196352
v_mov_b32 v188,0
v_mov_b32 v189,1
s_mov_b64 exec,1
buffer_atomic_add v189,v188,s[8:11],s36 offen sc1
s_mov_b64 exec,-1
R_l3s:
s_branch L_Rtail
L_exit:
s_endpgm
L_G:
s_load_dwordx2 s[60:61],s[0:1],0
s_load_dwordx4 s[48:51],s[0:1],16
s_load_dwordx4 s[52:55],s[0:1],32
s_load_dwordx2 s[70:71],s[0:1],56
s_load_dwordx4 s[72:75],s[0:1],64
s_load_dwordx2 s[36:37],s[0:1],80
s_getpc_b64 s[18:19]
G_pc:
s_add_u32 s18,s18,G_table-G_pc
s_addc_u32 s19,s19,0
s_sub_u32 s56,s12,4
s_lshl_b32 s56,s56,5
s_add_u32 s56,s56,s13
s_mul_i32 s56,s56,320
s_add_u32 s18,s18,s56
s_addc_u32 s19,s19,0
s_load_dwordx8 s[20:27],s[18:19],0
s_add_u32 s18,s18,32
s_addc_u32 s19,s19,0
s_lshr_b32 s76,s14,1
s_and_b32 s77,s14,1
s_mov_b32 s38,0x800000
s_mov_b32 s39,0x20000
s_mov_b32 s31,0x20000
s_mov_b32 s35,0x20000
s_mov_b32 s80,1069066811
s_mov_b32 s81,0x358637bd
wt lgkmcnt(0)
s_mov_b64 s[62:63],s[48:49]
s_mov_b64 s[64:65],s[50:51]
s_mov_b64 s[66:67],s[52:53]
s_mov_b64 s[68:69],s[54:55]
s_mov_b64 s[28:29],s[60:61]
s_mov_b32 s30,0x400000
s_mov_b64 s[32:33],s[62:63]
s_mov_b32 s34,0x800000
v_mov_b64 v[2:3],0
v_mov_b64 v[4:5],0
v_mov_b64 v[6:7],0
v_mov_b64 v[8:9],0
v_mov_b64 v[10:11],0
v_mov_b64 v[12:13],0
v_mov_b64 v[14:15],0
v_mov_b64 v[16:17],0
v_mov_b64 v[18:19],0
v_mov_b64 v[20:21],0
v_mov_b64 v[22:23],0
v_mov_b64 v[24:25],0
v_mov_b64 v[26:27],0
v_mov_b64 v[28:29],0
v_mov_b64 v[38:39],0
v_bfe_u32 v28,v1,4,2
v_lshlrev_b32 v28,9,v28
v_bfe_u32 v30,v1,0,4
v_lshl_add_u32 v28,v30,4,v28
v_mov_b32 v44,0
s_lshr_b32 s101,s2,31
s_branch G_have
G_next:
v_mov_b32 v44,0
s_load_dwordx8 s[20:27],s[18:19],0
s_add_u32 s18,s18,32
s_addc_u32 s19,s19,0
wt lgkmcnt(0)
G_have:
s_mov_b32 s78,s20
s_and_b32 s20,s20,0xff
s_cmp_eq_u32 s20,0
s_cbranch_scc1 G_end
s_cmp_eq_u32 s20,4
s_cbranch_scc1 G_nowait
s_cmp_eq_u32 s25,0
s_cbranch_scc1 G_nowait
v_mov_b32 v30,0
v_mov_b32 v31,v44
s_branch G_w_1
G_w:
buffer_load_dword v31,v30,s[8:11],s24 offen sc1
s_sub_u32 s15,s15,1
s_max_i32 s15,s15,0
wt vmcnt(0)
G_w_1:
v_readfirstlane_b32 s58,v31
s_nop 0
s_and_b32 s58,s58,255
s_cmp_ge_u32 s58,s25
s_cbranch_scc1 G_w_ok
s_cmp_eq_u32 s15,0
s_cbranch_scc1 G_w_ok
s_sleep 2
s_branch G_w
G_w_ok:
G_nowait:
s_mov_b32 s40,s21
s_mov_b32 s41,s22
s_mov_b32 s42,8
s_cmp_eq_u32 s20,9
s_cbranch_scc1 G_next
s_cmp_eq_u32 s20,8
s_cbranch_scc1 G_red
s_cmp_eq_u32 s20,5
s_cbranch_scc1 G_g3
s_cmp_eq_u32 s20,6
s_cbranch_scc1 G_tail
s_cmp_eq_u32 s20,7
s_cbranch_scc1 G_g3
s_cmp_eq_u32 s20,10
s_cbranch_scc1 G_att
s_mov_b32 s47,8192
s_mov_b32 s34,0x800000
s_cmp_ge_u32 s20,3
s_cselect_b64 s[28:29],s[70:71],s[60:61]
s_cselect_b32 s47,6144,s47
s_cselect_b32 s34,0x600000,s34
s_cselect_b64 s[32:33],s[72:73],s[62:63]
s_cselect_b32 s48,0,s27
s_and_b32 s48,s48,3
s_cmp_eq_u32 s48,1
s_cselect_b64 s[32:33],s[64:65],s[32:33]
s_cmp_eq_u32 s48,2
s_cselect_b64 s[32:33],s[66:67],s[32:33]
s_cmp_eq_u32 s20,3
s_cbranch_scc1 G_bkv
s_cmp_eq_u32 s20,1
s_cbranch_scc0 G_g1f
s_mov_b32 s42,4
s_lshl_b32 s48,s14,4
v_bfe_u32 v30,v1,4,2
v_add_u32 v30,s48,v30
v_mul_lo_u32 v30,v30,s47
v_bfe_u32 v31,v1,0,1
v_lshlrev_b32 v31,4,v31
v_add_u32 v30,v30,v31
v_bfe_u32 v31,v1,1,3
v_bfe_u32 v32,v1,4,2
v_xor_b32 v31,v31,v32
v_xor_b32 v32,0,v31
v_lshl_add_u32 v32,v32,5,v30
s_mul_i32 s48,s47,0
s_sub_u32 s48,s48,0
v_add_u32 v10,s48,v32
v_xor_b32 v32,0,v31
v_lshl_add_u32 v32,v32,5,v30
s_mul_i32 s48,s47,4
s_sub_u32 s48,s48,1024
v_add_u32 v11,s48,v32
v_xor_b32 v32,4,v31
v_lshl_add_u32 v32,v32,5,v30
s_mul_i32 s48,s47,8
s_sub_u32 s48,s48,2048
v_add_u32 v12,s48,v32
v_xor_b32 v32,4,v31
v_lshl_add_u32 v32,v32,5,v30
s_mul_i32 s48,s47,12
s_sub_u32 s48,s48,3072
v_add_u32 v13,s48,v32
s_lshl_b32 s46,s47,6
s_mul_i32 s44,s14,4096
s_add_u32 s44,s44,65536
v_bfe_u32 v30,v1,4,2
v_lshlrev_b32 v30,11,v30
v_bfe_u32 v32,v1,2,2
v_lshl_add_u32 v30,v32,8,v30
v_bfe_u32 v32,v1,0,2
v_lshl_add_u32 v30,v32,3,v30
v_add_u32 v30,65536,v30
v_bfe_u32 v31,v1,2,2
v_bfe_u32 v32,v1,4,1
v_lshl_add_u32 v31,v32,2,v31
s_mul_i32 s48,s77,4
v_xor_b32 v31,s48,v31
v_xor_b32 v32,0,v31
v_lshl_add_u32 v20,v32,5,v30
v_xor_b32 v32,1,v31
v_lshl_add_u32 v21,v32,5,v30
v_xor_b32 v32,2,v31
v_lshl_add_u32 v22,v32,5,v30
v_xor_b32 v32,3,v31
v_lshl_add_u32 v23,v32,5,v30
s_mul_i32 s43,s14,4096
s_mul_i32 s48,s14,65536
v_bfe_u32 v30,v1,3,3
v_lshlrev_b32 v30,11,v30
v_add_u32 v30,s48,v30
v_bfe_u32 v31,v1,0,3
v_bfe_u32 v32,v1,4,2
v_xor_b32 v31,v31,v32
v_xor_b32 v32,0,v31
v_lshl_add_u32 v32,v32,4,v30
v_add_u32 v2,0,v32
v_xor_b32 v32,4,v31
v_lshl_add_u32 v32,v32,4,v30
v_add_u32 v3,15360,v32
v_xor_b32 v32,0,v31
v_lshl_add_u32 v32,v32,4,v30
v_add_u32 v4,30720,v32
v_xor_b32 v32,4,v31
v_lshl_add_u32 v32,v32,4,v30
v_add_u32 v5,46080,v32
s_mul_i32 s48,s76,8192
v_bfe_u32 v30,v1,0,4
v_lshlrev_b32 v30,7,v30
v_add_u32 v30,s48,v30
v_bfe_u32 v31,v1,1,3
v_bfe_u32 v32,v1,4,2
v_xor_b32 v31,v31,v32
v_xor_b32 v32,0,v31
v_lshl_add_u32 v18,v32,4,v30
v_xor_b32 v32,4,v31
v_lshl_add_u32 v19,v32,4,v30
s_barrier
s_add_u32 m0,s43,0
s_nop 0
l4 v2,s[28:31],s40 offen lds
l4 v3,s[28:31],s40 offen offset:1024 lds
l4 v4,s[28:31],s40 offen offset:2048 lds
l4 v5,s[28:31],s40 offen offset:3072 lds
s_add_u32 s40,s40,128
s_add_u32 m0,s44,0
s_nop 0
l4 v10,s[32:35],s41 offen lds
l4 v11,s[32:35],s41 offen offset:1024 lds
l4 v12,s[32:35],s41 offen offset:2048 lds
l4 v13,s[32:35],s41 offen offset:3072 lds
s_add_u32 s41,s41,s46
s_add_u32 m0,s43,16384
s_nop 0
l4 v2,s[28:31],s40 offen lds
l4 v3,s[28:31],s40 offen offset:1024 lds
l4 v4,s[28:31],s40 offen offset:2048 lds
l4 v5,s[28:31],s40 offen offset:3072 lds
s_add_u32 s40,s40,128
s_add_u32 m0,s44,16384
s_nop 0
l4 v10,s[32:35],s41 offen lds
l4 v11,s[32:35],s41 offen offset:1024 lds
l4 v12,s[32:35],s41 offen offset:2048 lds
l4 v13,s[32:35],s41 offen offset:3072 lds
s_add_u32 s41,s41,s46
s_add_u32 m0,s43,32768
s_nop 0
l4 v2,s[28:31],s40 offen lds
l4 v3,s[28:31],s40 offen offset:1024 lds
l4 v4,s[28:31],s40 offen offset:2048 lds
l4 v5,s[28:31],s40 offen offset:3072 lds
s_add_u32 s40,s40,128
s_add_u32 m0,s44,32768
s_nop 0
l4 v10,s[32:35],s41 offen lds
l4 v11,s[32:35],s41 offen offset:1024 lds
l4 v12,s[32:35],s41 offen offset:2048 lds
l4 v13,s[32:35],s41 offen offset:3072 lds
s_add_u32 s41,s41,s46
s_add_u32 m0,s43,49152
s_nop 0
l4 v2,s[28:31],s40 offen lds
l4 v3,s[28:31],s40 offen offset:1024 lds
l4 v4,s[28:31],s40 offen offset:2048 lds
l4 v5,s[28:31],s40 offen offset:3072 lds
s_add_u32 s40,s40,128
s_add_u32 m0,s44,49152
s_nop 0
l4 v10,s[32:35],s41 offen lds
l4 v11,s[32:35],s41 offen offset:1024 lds
l4 v12,s[32:35],s41 offen offset:2048 lds
l4 v13,s[32:35],s41 offen offset:3072 lds
s_add_u32 s41,s41,s46
s_and_b32 s50,s13,15
s_and_b32 s48,s21,0xfffff000
s_lshl_b32 s50,s50,14
s_lshl_b32 s49,s14,12
s_add_u32 s50,s50,s49
s_lshl_b32 s49,s48,0
s_add_u32 s50,s50,s49
s_sub_u32 s48,s12,4
s_lshl_b32 s48,s48,7
s_lshl_b32 s49,s13,2
s_add_u32 s48,s48,s49
s_lshl_b32 s49,s14,0
s_add_u32 s48,s48,s49
s_mul_i32 s48,s48,3072
s_add_u32 s48,s48,520192
s_bitcmp1_b32 s27,3
s_cselect_b32 s50,s50,0x40000000
s_cselect_b32 s48,s48,0x40000000
v_mov_b32 v39,s50
v_mov_b32 v40,s48
v_cmp_gt_u32 vcc,32,v1
s_nop 1
v_cndmask_b32 v39,v40,v39,vcc
v_lshl_add_u32 v39,v1,7,v39
s_bfm_b64 exec,56,0
buffer_load_dword v40,v39,s[28:31],0 offen offset:0
s_mov_b64 exec,-1
s_mov_b64 s[90:91],s[20:21]
s_mov_b64 s[92:93],s[22:23]
s_mov_b64 s[94:95],s[24:25]
s_mov_b64 s[96:97],s[26:27]
s_load_dwordx8 s[20:27],s[18:19],0
s_add_u32 s18,s18,32
s_addc_u32 s19,s19,0
wt vmcnt(25)
s_barrier
s_add_u32 s48,s14,s4
s_cmp_eq_u32 s48,0
s_cbranch_scc0 G_reg
s_mov_b32 s49,0x100
s_mov_b32 s99,1
s_lshl_b32 s48,1,s13
s_lshl_b32 s50,s12,5
v_mov_b32 v32,s48
v_mov_b32 v33,s49
v_mov_b32 v30,s50
s_mov_b64 exec,1
global_atomic_add_x2 v[254:255],v30,v[32:33],s[16:17] sc0 sc1
s_mov_b64 exec,-1
G_reg:
dt v[96:97],v20 offset:0
dt v[98:99],v20 offset:1024
dr v[64:67],v18 offset:0
dt v[100:101],v21 offset:0
dt v[102:103],v21 offset:1024
dr v[68:71],v18 offset:2048
dt v[104:105],v22 offset:0
dt v[106:107],v22 offset:1024
dr v[72:75],v18 offset:4096
dt v[108:109],v23 offset:0
dt v[110:111],v23 offset:1024
dr v[76:79],v18 offset:6144
wt lgkmcnt(0)
mm a[0:3],v[96:99],v[64:67],0
dt v[160:161],v20 offset:8192
mm a[4:7],v[100:103],v[64:67],0
dt v[162:163],v20 offset:9216
mm a[8:11],v[104:107],v[64:67],0
dr v[128:131],v19 offset:0
mm a[12:15],v[108:111],v[64:67],0
dt v[164:165],v21 offset:8192
mm a[28:31],v[108:111],v[68:71],0
dt v[166:167],v21 offset:9216
mm a[24:27],v[104:107],v[68:71],0
dr v[132:135],v19 offset:2048
mm a[20:23],v[100:103],v[68:71],0
dt v[168:169],v22 offset:8192
mm a[16:19],v[96:99],v[68:71],0
dt v[170:171],v22 offset:9216
mm a[32:35],v[96:99],v[72:75],0
dr v[136:139],v19 offset:4096
mm a[36:39],v[100:103],v[72:75],0
dt v[172:173],v23 offset:8192
mm a[40:43],v[104:107],v[72:75],0
dt v[174:175],v23 offset:9216
mm a[44:47],v[108:111],v[72:75],0
dr v[140:143],v19 offset:6144
mm a[60:63],v[108:111],v[76:79],0
mm a[56:59],v[104:107],v[76:79],0
mm a[52:55],v[100:103],v[76:79],0
mm a[48:51],v[96:99],v[76:79],0
wt vmcnt(16) lgkmcnt(0)
s_barrier
mm a[0:3],v[160:163],v[128:131],a[0:3]
dt v[96:97],v20 offset:16384
mm a[4:7],v[164:167],v[128:131],a[4:7]
dt v[98:99],v20 offset:17408
s_add_u32 m0,s43,0
s_nop 0
l4 v2,s[28:31],s40 offen lds
mm a[8:11],v[168:171],v[128:131],a[8:11]
dr v[64:67],v18 offset:16384
mm a[12:15],v[172:175],v[128:131],a[12:15]
dt v[100:101],v21 offset:16384
mm a[28:31],v[172:175],v[132:135],a[28:31]
dt v[102:103],v21 offset:17408
l4 v3,s[28:31],s40 offen offset:1024 lds
mm a[24:27],v[168:171],v[132:135],a[24:27]
dr v[68:71],v18 offset:18432
mm a[20:23],v[164:167],v[132:135],a[20:23]
dt v[104:105],v22 offset:16384
mm a[16:19],v[160:163],v[132:135],a[16:19]
dt v[106:107],v22 offset:17408
mm a[32:35],v[160:163],v[136:139],a[32:35]
dr v[72:75],v18 offset:20480
l4 v4,s[28:31],s40 offen offset:2048 lds
mm a[36:39],v[164:167],v[136:139],a[36:39]
dt v[108:109],v23 offset:16384
mm a[40:43],v[168:171],v[136:139],a[40:43]
dt v[110:111],v23 offset:17408
mm a[44:47],v[172:175],v[136:139],a[44:47]
dr v[76:79],v18 offset:22528
l4 v5,s[28:31],s40 offen offset:3072 lds
s_add_u32 s40,s40,128
mm a[60:63],v[172:175],v[140:143],a[60:63]
mm a[56:59],v[168:171],v[140:143],a[56:59]
mm a[52:55],v[164:167],v[140:143],a[52:55]
mm a[48:51],v[160:163],v[140:143],a[48:51]
wt lgkmcnt(0)
mm a[0:3],v[96:99],v[64:67],a[0:3]
dt v[160:161],v20 offset:24576
mm a[4:7],v[100:103],v[64:67],a[4:7]
dt v[162:163],v20 offset:25600
s_add_u32 m0,s44,0
s_nop 0
l4 v10,s[32:35],s41 offen lds
mm a[8:11],v[104:107],v[64:67],a[8:11]
dr v[128:131],v19 offset:16384
mm a[12:15],v[108:111],v[64:67],a[12:15]
dt v[164:165],v21 offset:24576
mm a[28:31],v[108:111],v[68:71],a[28:31]
dt v[166:167],v21 offset:25600
l4 v11,s[32:35],s41 offen offset:1024 lds
mm a[24:27],v[104:107],v[68:71],a[24:27]
dr v[132:135],v19 offset:18432
mm a[20:23],v[100:103],v[68:71],a[20:23]
dt v[168:169],v22 offset:24576
mm a[16:19],v[96:99],v[68:71],a[16:19]
dt v[170:171],v22 offset:25600
mm a[32:35],v[96:99],v[72:75],a[32:35]
dr v[136:139],v19 offset:20480
l4 v12,s[32:35],s41 offen offset:2048 lds
mm a[36:39],v[100:103],v[72:75],a[36:39]
dt v[172:173],v23 offset:24576
mm a[40:43],v[104:107],v[72:75],a[40:43]
dt v[174:175],v23 offset:25600
mm a[44:47],v[108:111],v[72:75],a[44:47]
dr v[140:143],v19 offset:22528
l4 v13,s[32:35],s41 offen offset:3072 lds
s_add_u32 s41,s41,s46
mm a[60:63],v[108:111],v[76:79],a[60:63]
mm a[56:59],v[104:107],v[76:79],a[56:59]
mm a[52:55],v[100:103],v[76:79],a[52:55]
mm a[48:51],v[96:99],v[76:79],a[48:51]
wt vmcnt(16) lgkmcnt(0)
s_barrier
mm a[0:3],v[160:163],v[128:131],a[0:3]
dt v[96:97],v20 offset:32768
mm a[4:7],v[164:167],v[128:131],a[4:7]
dt v[98:99],v20 offset:33792
s_add_u32 m0,s43,16384
s_nop 0
l4 v2,s[28:31],s40 offen lds
mm a[8:11],v[168:171],v[128:131],a[8:11]
dr v[64:67],v18 offset:32768
mm a[12:15],v[172:175],v[128:131],a[12:15]
dt v[100:101],v21 offset:32768
mm a[28:31],v[172:175],v[132:135],a[28:31]
dt v[102:103],v21 offset:33792
l4 v3,s[28:31],s40 offen offset:1024 lds
mm a[24:27],v[168:171],v[132:135],a[24:27]
dr v[68:71],v18 offset:34816
mm a[20:23],v[164:167],v[132:135],a[20:23]
dt v[104:105],v22 offset:32768
mm a[16:19],v[160:163],v[132:135],a[16:19]
dt v[106:107],v22 offset:33792
mm a[32:35],v[160:163],v[136:139],a[32:35]
dr v[72:75],v18 offset:36864
l4 v4,s[28:31],s40 offen offset:2048 lds
mm a[36:39],v[164:167],v[136:139],a[36:39]
dt v[108:109],v23 offset:32768
mm a[40:43],v[168:171],v[136:139],a[40:43]
dt v[110:111],v23 offset:33792
mm a[44:47],v[172:175],v[136:139],a[44:47]
dr v[76:79],v18 offset:38912
l4 v5,s[28:31],s40 offen offset:3072 lds
s_add_u32 s40,s40,128
mm a[60:63],v[172:175],v[140:143],a[60:63]
mm a[56:59],v[168:171],v[140:143],a[56:59]
mm a[52:55],v[164:167],v[140:143],a[52:55]
mm a[48:51],v[160:163],v[140:143],a[48:51]
wt lgkmcnt(0)
mm a[0:3],v[96:99],v[64:67],a[0:3]
dt v[160:161],v20 offset:40960
mm a[4:7],v[100:103],v[64:67],a[4:7]
dt v[162:163],v20 offset:41984
s_add_u32 m0,s44,16384
s_nop 0
l4 v10,s[32:35],s41 offen lds
mm a[8:11],v[104:107],v[64:67],a[8:11]
dr v[128:131],v19 offset:32768
mm a[12:15],v[108:111],v[64:67],a[12:15]
dt v[164:165],v21 offset:40960
mm a[28:31],v[108:111],v[68:71],a[28:31]
dt v[166:167],v21 offset:41984
l4 v11,s[32:35],s41 offen offset:1024 lds
mm a[24:27],v[104:107],v[68:71],a[24:27]
dr v[132:135],v19 offset:34816
mm a[20:23],v[100:103],v[68:71],a[20:23]
dt v[168:169],v22 offset:40960
mm a[16:19],v[96:99],v[68:71],a[16:19]
dt v[170:171],v22 offset:41984
mm a[32:35],v[96:99],v[72:75],a[32:35]
dr v[136:139],v19 offset:36864
l4 v12,s[32:35],s41 offen offset:2048 lds
mm a[36:39],v[100:103],v[72:75],a[36:39]
dt v[172:173],v23 offset:40960
mm a[40:43],v[104:107],v[72:75],a[40:43]
dt v[174:175],v23 offset:41984
mm a[44:47],v[108:111],v[72:75],a[44:47]
dr v[140:143],v19 offset:38912
l4 v13,s[32:35],s41 offen offset:3072 lds
s_add_u32 s41,s41,s46
mm a[60:63],v[108:111],v[76:79],a[60:63]
mm a[56:59],v[104:107],v[76:79],a[56:59]
mm a[52:55],v[100:103],v[76:79],a[52:55]
mm a[48:51],v[96:99],v[76:79],a[48:51]
wt vmcnt(16) lgkmcnt(0)
s_barrier
mm a[0:3],v[160:163],v[128:131],a[0:3]
dt v[96:97],v20 offset:49152
mm a[4:7],v[164:167],v[128:131],a[4:7]
dt v[98:99],v20 offset:50176
s_add_u32 m0,s43,32768
s_nop 0
l4 v2,s[28:31],s40 offen lds
mm a[8:11],v[168:171],v[128:131],a[8:11]
dr v[64:67],v18 offset:49152
mm a[12:15],v[172:175],v[128:131],a[12:15]
dt v[100:101],v21 offset:49152
mm a[28:31],v[172:175],v[132:135],a[28:31]
dt v[102:103],v21 offset:50176
l4 v3,s[28:31],s40 offen offset:1024 lds
mm a[24:27],v[168:171],v[132:135],a[24:27]
dr v[68:71],v18 offset:51200
mm a[20:23],v[164:167],v[132:135],a[20:23]
dt v[104:105],v22 offset:49152
mm a[16:19],v[160:163],v[132:135],a[16:19]
dt v[106:107],v22 offset:50176
mm a[32:35],v[160:163],v[136:139],a[32:35]
dr v[72:75],v18 offset:53248
l4 v4,s[28:31],s40 offen offset:2048 lds
mm a[36:39],v[164:167],v[136:139],a[36:39]
dt v[108:109],v23 offset:49152
mm a[40:43],v[168:171],v[136:139],a[40:43]
dt v[110:111],v23 offset:50176
mm a[44:47],v[172:175],v[136:139],a[44:47]
dr v[76:79],v18 offset:55296
l4 v5,s[28:31],s40 offen offset:3072 lds
s_add_u32 s40,s40,128
mm a[60:63],v[172:175],v[140:143],a[60:63]
mm a[56:59],v[168:171],v[140:143],a[56:59]
mm a[52:55],v[164:167],v[140:143],a[52:55]
mm a[48:51],v[160:163],v[140:143],a[48:51]
wt lgkmcnt(0)
mm a[0:3],v[96:99],v[64:67],a[0:3]
dt v[160:161],v20 offset:57344
mm a[4:7],v[100:103],v[64:67],a[4:7]
dt v[162:163],v20 offset:58368
s_add_u32 m0,s44,32768
s_nop 0
l4 v10,s[32:35],s41 offen lds
mm a[8:11],v[104:107],v[64:67],a[8:11]
dr v[128:131],v19 offset:49152
mm a[12:15],v[108:111],v[64:67],a[12:15]
dt v[164:165],v21 offset:57344
mm a[28:31],v[108:111],v[68:71],a[28:31]
dt v[166:167],v21 offset:58368
l4 v11,s[32:35],s41 offen offset:1024 lds
mm a[24:27],v[104:107],v[68:71],a[24:27]
dr v[132:135],v19 offset:51200
mm a[20:23],v[100:103],v[68:71],a[20:23]
dt v[168:169],v22 offset:57344
mm a[16:19],v[96:99],v[68:71],a[16:19]
dt v[170:171],v22 offset:58368
mm a[32:35],v[96:99],v[72:75],a[32:35]
dr v[136:139],v19 offset:53248
l4 v12,s[32:35],s41 offen offset:2048 lds
mm a[36:39],v[100:103],v[72:75],a[36:39]
dt v[172:173],v23 offset:57344
mm a[40:43],v[104:107],v[72:75],a[40:43]
dt v[174:175],v23 offset:58368
mm a[44:47],v[108:111],v[72:75],a[44:47]
dr v[140:143],v19 offset:55296
l4 v13,s[32:35],s41 offen offset:3072 lds
s_add_u32 s41,s41,s46
mm a[60:63],v[108:111],v[76:79],a[60:63]
mm a[56:59],v[104:107],v[76:79],a[56:59]
mm a[52:55],v[100:103],v[76:79],a[52:55]
mm a[48:51],v[96:99],v[76:79],a[48:51]
wt vmcnt(16) lgkmcnt(0)
s_barrier
mm a[0:3],v[160:163],v[128:131],a[0:3]
dt v[96:97],v20 offset:0
mm a[4:7],v[164:167],v[128:131],a[4:7]
dt v[98:99],v20 offset:1024
s_add_u32 m0,s43,49152
s_nop 0
l4 v2,s[28:31],s40 offen lds
mm a[8:11],v[168:171],v[128:131],a[8:11]
dr v[64:67],v18 offset:0
mm a[12:15],v[172:175],v[128:131],a[12:15]
dt v[100:101],v21 offset:0
mm a[28:31],v[172:175],v[132:135],a[28:31]
dt v[102:103],v21 offset:1024
l4 v3,s[28:31],s40 offen offset:1024 lds
mm a[24:27],v[168:171],v[132:135],a[24:27]
dr v[68:71],v18 offset:2048
mm a[20:23],v[164:167],v[132:135],a[20:23]
dt v[104:105],v22 offset:0
mm a[16:19],v[160:163],v[132:135],a[16:19]
dt v[106:107],v22 offset:1024
mm a[32:35],v[160:163],v[136:139],a[32:35]
dr v[72:75],v18 offset:4096
l4 v4,s[28:31],s40 offen offset:2048 lds
mm a[36:39],v[164:167],v[136:139],a[36:39]
dt v[108:109],v23 offset:0
mm a[40:43],v[168:171],v[136:139],a[40:43]
dt v[110:111],v23 offset:1024
mm a[44:47],v[172:175],v[136:139],a[44:47]
dr v[76:79],v18 offset:6144
l4 v5,s[28:31],s40 offen offset:3072 lds
s_add_u32 s40,s40,128
mm a[60:63],v[172:175],v[140:143],a[60:63]
mm a[56:59],v[168:171],v[140:143],a[56:59]
mm a[52:55],v[164:167],v[140:143],a[52:55]
mm a[48:51],v[160:163],v[140:143],a[48:51]
wt lgkmcnt(0)
s_sub_u32 s42,s42,2
G1H_k:
mm a[0:3],v[96:99],v[64:67],a[0:3]
dt v[160:161],v20 offset:8192
mm a[4:7],v[100:103],v[64:67],a[4:7]
dt v[162:163],v20 offset:9216
s_add_u32 m0,s44,49152
s_nop 0
l4 v10,s[32:35],s41 offen lds
mm a[8:11],v[104:107],v[64:67],a[8:11]
dr v[128:131],v19 offset:0
mm a[12:15],v[108:111],v[64:67],a[12:15]
dt v[164:165],v21 offset:8192
mm a[28:31],v[108:111],v[68:71],a[28:31]
dt v[166:167],v21 offset:9216
l4 v11,s[32:35],s41 offen offset:1024 lds
mm a[24:27],v[104:107],v[68:71],a[24:27]
dr v[132:135],v19 offset:2048
mm a[20:23],v[100:103],v[68:71],a[20:23]
dt v[168:169],v22 offset:8192
mm a[16:19],v[96:99],v[68:71],a[16:19]
dt v[170:171],v22 offset:9216
mm a[32:35],v[96:99],v[72:75],a[32:35]
dr v[136:139],v19 offset:4096
l4 v12,s[32:35],s41 offen offset:2048 lds
mm a[36:39],v[100:103],v[72:75],a[36:39]
dt v[172:173],v23 offset:8192
mm a[40:43],v[104:107],v[72:75],a[40:43]
dt v[174:175],v23 offset:9216
mm a[44:47],v[108:111],v[72:75],a[44:47]
dr v[140:143],v19 offset:6144
l4 v13,s[32:35],s41 offen offset:3072 lds
s_add_u32 s41,s41,s46
mm a[60:63],v[108:111],v[76:79],a[60:63]
mm a[56:59],v[104:107],v[76:79],a[56:59]
mm a[52:55],v[100:103],v[76:79],a[52:55]
mm a[48:51],v[96:99],v[76:79],a[48:51]
wt vmcnt(16) lgkmcnt(0)
s_barrier
mm a[0:3],v[160:163],v[128:131],a[0:3]
dt v[96:97],v20 offset:16384
mm a[4:7],v[164:167],v[128:131],a[4:7]
dt v[98:99],v20 offset:17408
s_add_u32 m0,s43,0
s_nop 0
l4 v2,s[28:31],s40 offen lds
mm a[8:11],v[168:171],v[128:131],a[8:11]
dr v[64:67],v18 offset:16384
mm a[12:15],v[172:175],v[128:131],a[12:15]
dt v[100:101],v21 offset:16384
mm a[28:31],v[172:175],v[132:135],a[28:31]
dt v[102:103],v21 offset:17408
l4 v3,s[28:31],s40 offen offset:1024 lds
mm a[24:27],v[168:171],v[132:135],a[24:27]
dr v[68:71],v18 offset:18432
mm a[20:23],v[164:167],v[132:135],a[20:23]
dt v[104:105],v22 offset:16384
mm a[16:19],v[160:163],v[132:135],a[16:19]
dt v[106:107],v22 offset:17408
mm a[32:35],v[160:163],v[136:139],a[32:35]
dr v[72:75],v18 offset:20480
l4 v4,s[28:31],s40 offen offset:2048 lds
mm a[36:39],v[164:167],v[136:139],a[36:39]
dt v[108:109],v23 offset:16384
mm a[40:43],v[168:171],v[136:139],a[40:43]
dt v[110:111],v23 offset:17408
mm a[44:47],v[172:175],v[136:139],a[44:47]
dr v[76:79],v18 offset:22528
l4 v5,s[28:31],s40 offen offset:3072 lds
s_add_u32 s40,s40,128
mm a[60:63],v[172:175],v[140:143],a[60:63]
mm a[56:59],v[168:171],v[140:143],a[56:59]
mm a[52:55],v[164:167],v[140:143],a[52:55]
mm a[48:51],v[160:163],v[140:143],a[48:51]
wt lgkmcnt(0)
mm a[0:3],v[96:99],v[64:67],a[0:3]
dt v[160:161],v20 offset:24576
mm a[4:7],v[100:103],v[64:67],a[4:7]
dt v[162:163],v20 offset:25600
s_add_u32 m0,s44,0
s_nop 0
l4 v10,s[32:35],s41 offen lds
mm a[8:11],v[104:107],v[64:67],a[8:11]
dr v[128:131],v19 offset:16384
mm a[12:15],v[108:111],v[64:67],a[12:15]
dt v[164:165],v21 offset:24576
mm a[28:31],v[108:111],v[68:71],a[28:31]
dt v[166:167],v21 offset:25600
l4 v11,s[32:35],s41 offen offset:1024 lds
mm a[24:27],v[104:107],v[68:71],a[24:27]
dr v[132:135],v19 offset:18432
mm a[20:23],v[100:103],v[68:71],a[20:23]
dt v[168:169],v22 offset:24576
mm a[16:19],v[96:99],v[68:71],a[16:19]
dt v[170:171],v22 offset:25600
mm a[32:35],v[96:99],v[72:75],a[32:35]
dr v[136:139],v19 offset:20480
l4 v12,s[32:35],s41 offen offset:2048 lds
mm a[36:39],v[100:103],v[72:75],a[36:39]
dt v[172:173],v23 offset:24576
mm a[40:43],v[104:107],v[72:75],a[40:43]
dt v[174:175],v23 offset:25600
mm a[44:47],v[108:111],v[72:75],a[44:47]
dr v[140:143],v19 offset:22528
l4 v13,s[32:35],s41 offen offset:3072 lds
s_add_u32 s41,s41,s46
mm a[60:63],v[108:111],v[76:79],a[60:63]
mm a[56:59],v[104:107],v[76:79],a[56:59]
mm a[52:55],v[100:103],v[76:79],a[52:55]
mm a[48:51],v[96:99],v[76:79],a[48:51]
wt vmcnt(16) lgkmcnt(0)
s_barrier
mm a[0:3],v[160:163],v[128:131],a[0:3]
dt v[96:97],v20 offset:32768
mm a[4:7],v[164:167],v[128:131],a[4:7]
dt v[98:99],v20 offset:33792
s_add_u32 m0,s43,16384
s_nop 0
l4 v2,s[28:31],s40 offen lds
mm a[8:11],v[168:171],v[128:131],a[8:11]
dr v[64:67],v18 offset:32768
mm a[12:15],v[172:175],v[128:131],a[12:15]
dt v[100:101],v21 offset:32768
mm a[28:31],v[172:175],v[132:135],a[28:31]
dt v[102:103],v21 offset:33792
l4 v3,s[28:31],s40 offen offset:1024 lds
mm a[24:27],v[168:171],v[132:135],a[24:27]
dr v[68:71],v18 offset:34816
mm a[20:23],v[164:167],v[132:135],a[20:23]
dt v[104:105],v22 offset:32768
mm a[16:19],v[160:163],v[132:135],a[16:19]
dt v[106:107],v22 offset:33792
mm a[32:35],v[160:163],v[136:139],a[32:35]
dr v[72:75],v18 offset:36864
l4 v4,s[28:31],s40 offen offset:2048 lds
mm a[36:39],v[164:167],v[136:139],a[36:39]
dt v[108:109],v23 offset:32768
mm a[40:43],v[168:171],v[136:139],a[40:43]
dt v[110:111],v23 offset:33792
mm a[44:47],v[172:175],v[136:139],a[44:47]
dr v[76:79],v18 offset:38912
l4 v5,s[28:31],s40 offen offset:3072 lds
s_add_u32 s40,s40,128
mm a[60:63],v[172:175],v[140:143],a[60:63]
mm a[56:59],v[168:171],v[140:143],a[56:59]
mm a[52:55],v[164:167],v[140:143],a[52:55]
mm a[48:51],v[160:163],v[140:143],a[48:51]
wt lgkmcnt(0)
mm a[0:3],v[96:99],v[64:67],a[0:3]
dt v[160:161],v20 offset:40960
mm a[4:7],v[100:103],v[64:67],a[4:7]
dt v[162:163],v20 offset:41984
s_add_u32 m0,s44,16384
s_nop 0
l4 v10,s[32:35],s41 offen lds
mm a[8:11],v[104:107],v[64:67],a[8:11]
dr v[128:131],v19 offset:32768
mm a[12:15],v[108:111],v[64:67],a[12:15]
dt v[164:165],v21 offset:40960
mm a[28:31],v[108:111],v[68:71],a[28:31]
dt v[166:167],v21 offset:41984
l4 v11,s[32:35],s41 offen offset:1024 lds
mm a[24:27],v[104:107],v[68:71],a[24:27]
dr v[132:135],v19 offset:34816
mm a[20:23],v[100:103],v[68:71],a[20:23]
dt v[168:169],v22 offset:40960
mm a[16:19],v[96:99],v[68:71],a[16:19]
dt v[170:171],v22 offset:41984
mm a[32:35],v[96:99],v[72:75],a[32:35]
dr v[136:139],v19 offset:36864
l4 v12,s[32:35],s41 offen offset:2048 lds
mm a[36:39],v[100:103],v[72:75],a[36:39]
dt v[172:173],v23 offset:40960
mm a[40:43],v[104:107],v[72:75],a[40:43]
dt v[174:175],v23 offset:41984
mm a[44:47],v[108:111],v[72:75],a[44:47]
dr v[140:143],v19 offset:38912
l4 v13,s[32:35],s41 offen offset:3072 lds
s_add_u32 s41,s41,s46
mm a[60:63],v[108:111],v[76:79],a[60:63]
mm a[56:59],v[104:107],v[76:79],a[56:59]
mm a[52:55],v[100:103],v[76:79],a[52:55]
mm a[48:51],v[96:99],v[76:79],a[48:51]
wt vmcnt(16) lgkmcnt(0)
s_barrier
mm a[0:3],v[160:163],v[128:131],a[0:3]
dt v[96:97],v20 offset:49152
mm a[4:7],v[164:167],v[128:131],a[4:7]
dt v[98:99],v20 offset:50176
s_add_u32 m0,s43,32768
s_nop 0
l4 v2,s[28:31],s40 offen lds
mm a[8:11],v[168:171],v[128:131],a[8:11]
dr v[64:67],v18 offset:49152
mm a[12:15],v[172:175],v[128:131],a[12:15]
dt v[100:101],v21 offset:49152
mm a[28:31],v[172:175],v[132:135],a[28:31]
dt v[102:103],v21 offset:50176
l4 v3,s[28:31],s40 offen offset:1024 lds
mm a[24:27],v[168:171],v[132:135],a[24:27]
dr v[68:71],v18 offset:51200
mm a[20:23],v[164:167],v[132:135],a[20:23]
dt v[104:105],v22 offset:49152
mm a[16:19],v[160:163],v[132:135],a[16:19]
dt v[106:107],v22 offset:50176
mm a[32:35],v[160:163],v[136:139],a[32:35]
dr v[72:75],v18 offset:53248
l4 v4,s[28:31],s40 offen offset:2048 lds
mm a[36:39],v[164:167],v[136:139],a[36:39]
dt v[108:109],v23 offset:49152
mm a[40:43],v[168:171],v[136:139],a[40:43]
dt v[110:111],v23 offset:50176
mm a[44:47],v[172:175],v[136:139],a[44:47]
dr v[76:79],v18 offset:55296
l4 v5,s[28:31],s40 offen offset:3072 lds
s_add_u32 s40,s40,128
mm a[60:63],v[172:175],v[140:143],a[60:63]
mm a[56:59],v[168:171],v[140:143],a[56:59]
mm a[52:55],v[164:167],v[140:143],a[52:55]
mm a[48:51],v[160:163],v[140:143],a[48:51]
wt lgkmcnt(0)
mm a[0:3],v[96:99],v[64:67],a[0:3]
dt v[160:161],v20 offset:57344
mm a[4:7],v[100:103],v[64:67],a[4:7]
dt v[162:163],v20 offset:58368
s_add_u32 m0,s44,32768
s_nop 0
l4 v10,s[32:35],s41 offen lds
mm a[8:11],v[104:107],v[64:67],a[8:11]
dr v[128:131],v19 offset:49152
mm a[12:15],v[108:111],v[64:67],a[12:15]
dt v[164:165],v21 offset:57344
mm a[28:31],v[108:111],v[68:71],a[28:31]
dt v[166:167],v21 offset:58368
l4 v11,s[32:35],s41 offen offset:1024 lds
mm a[24:27],v[104:107],v[68:71],a[24:27]
dr v[132:135],v19 offset:51200
mm a[20:23],v[100:103],v[68:71],a[20:23]
dt v[168:169],v22 offset:57344
mm a[16:19],v[96:99],v[68:71],a[16:19]
dt v[170:171],v22 offset:58368
mm a[32:35],v[96:99],v[72:75],a[32:35]
dr v[136:139],v19 offset:53248
l4 v12,s[32:35],s41 offen offset:2048 lds
mm a[36:39],v[100:103],v[72:75],a[36:39]
dt v[172:173],v23 offset:57344
mm a[40:43],v[104:107],v[72:75],a[40:43]
dt v[174:175],v23 offset:58368
mm a[44:47],v[108:111],v[72:75],a[44:47]
dr v[140:143],v19 offset:55296
l4 v13,s[32:35],s41 offen offset:3072 lds
s_add_u32 s41,s41,s46
mm a[60:63],v[108:111],v[76:79],a[60:63]
mm a[56:59],v[104:107],v[76:79],a[56:59]
mm a[52:55],v[100:103],v[76:79],a[52:55]
mm a[48:51],v[96:99],v[76:79],a[48:51]
wt vmcnt(16) lgkmcnt(0)
s_barrier
mm a[0:3],v[160:163],v[128:131],a[0:3]
dt v[96:97],v20 offset:0
mm a[4:7],v[164:167],v[128:131],a[4:7]
dt v[98:99],v20 offset:1024
s_add_u32 m0,s43,49152
s_nop 0
l4 v2,s[28:31],s40 offen lds
mm a[8:11],v[168:171],v[128:131],a[8:11]
dr v[64:67],v18 offset:0
mm a[12:15],v[172:175],v[128:131],a[12:15]
dt v[100:101],v21 offset:0
mm a[28:31],v[172:175],v[132:135],a[28:31]
dt v[102:103],v21 offset:1024
l4 v3,s[28:31],s40 offen offset:1024 lds
mm a[24:27],v[168:171],v[132:135],a[24:27]
dr v[68:71],v18 offset:2048
mm a[20:23],v[164:167],v[132:135],a[20:23]
dt v[104:105],v22 offset:0
mm a[16:19],v[160:163],v[132:135],a[16:19]
dt v[106:107],v22 offset:1024
mm a[32:35],v[160:163],v[136:139],a[32:35]
dr v[72:75],v18 offset:4096
l4 v4,s[28:31],s40 offen offset:2048 lds
mm a[36:39],v[164:167],v[136:139],a[36:39]
dt v[108:109],v23 offset:0
mm a[40:43],v[168:171],v[136:139],a[40:43]
dt v[110:111],v23 offset:1024
mm a[44:47],v[172:175],v[136:139],a[44:47]
dr v[76:79],v18 offset:6144
l4 v5,s[28:31],s40 offen offset:3072 lds
s_add_u32 s40,s40,128
mm a[60:63],v[172:175],v[140:143],a[60:63]
mm a[56:59],v[168:171],v[140:143],a[56:59]
mm a[52:55],v[164:167],v[140:143],a[52:55]
mm a[48:51],v[160:163],v[140:143],a[48:51]
wt lgkmcnt(0)
s_sub_u32 s42,s42,1
s_cmp_lg_u32 s42,0
s_cbranch_scc1 G1H_k
mm a[0:3],v[96:99],v[64:67],a[0:3]
dt v[160:161],v20 offset:8192
mm a[4:7],v[100:103],v[64:67],a[4:7]
dt v[162:163],v20 offset:9216
s_add_u32 m0,s44,49152
s_nop 0
l4 v10,s[32:35],s41 offen lds
mm a[8:11],v[104:107],v[64:67],a[8:11]
dr v[128:131],v19 offset:0
mm a[12:15],v[108:111],v[64:67],a[12:15]
dt v[164:165],v21 offset:8192
mm a[28:31],v[108:111],v[68:71],a[28:31]
dt v[166:167],v21 offset:9216
l4 v11,s[32:35],s41 offen offset:1024 lds
mm a[24:27],v[104:107],v[68:71],a[24:27]
dr v[132:135],v19 offset:2048
mm a[20:23],v[100:103],v[68:71],a[20:23]
dt v[168:169],v22 offset:8192
mm a[16:19],v[96:99],v[68:71],a[16:19]
dt v[170:171],v22 offset:9216
mm a[32:35],v[96:99],v[72:75],a[32:35]
dr v[136:139],v19 offset:4096
l4 v12,s[32:35],s41 offen offset:2048 lds
mm a[36:39],v[100:103],v[72:75],a[36:39]
dt v[172:173],v23 offset:8192
mm a[40:43],v[104:107],v[72:75],a[40:43]
dt v[174:175],v23 offset:9216
mm a[44:47],v[108:111],v[72:75],a[44:47]
dr v[140:143],v19 offset:6144
l4 v13,s[32:35],s41 offen offset:3072 lds
s_add_u32 s41,s41,s46
mm a[60:63],v[108:111],v[76:79],a[60:63]
mm a[56:59],v[104:107],v[76:79],a[56:59]
mm a[52:55],v[100:103],v[76:79],a[52:55]
mm a[48:51],v[96:99],v[76:79],a[48:51]
wt vmcnt(16) lgkmcnt(0)
s_barrier
mm a[0:3],v[160:163],v[128:131],a[0:3]
dt v[96:97],v20 offset:16384
mm a[4:7],v[164:167],v[128:131],a[4:7]
dt v[98:99],v20 offset:17408
mm a[8:11],v[168:171],v[128:131],a[8:11]
dr v[64:67],v18 offset:16384
mm a[12:15],v[172:175],v[128:131],a[12:15]
dt v[100:101],v21 offset:16384
mm a[28:31],v[172:175],v[132:135],a[28:31]
dt v[102:103],v21 offset:17408
mm a[24:27],v[168:171],v[132:135],a[24:27]
dr v[68:71],v18 offset:18432
mm a[20:23],v[164:167],v[132:135],a[20:23]
dt v[104:105],v22 offset:16384
mm a[16:19],v[160:163],v[132:135],a[16:19]
dt v[106:107],v22 offset:17408
mm a[32:35],v[160:163],v[136:139],a[32:35]
dr v[72:75],v18 offset:20480
mm a[36:39],v[164:167],v[136:139],a[36:39]
dt v[108:109],v23 offset:16384
mm a[40:43],v[168:171],v[136:139],a[40:43]
dt v[110:111],v23 offset:17408
mm a[44:47],v[172:175],v[136:139],a[44:47]
dr v[76:79],v18 offset:22528
mm a[60:63],v[172:175],v[140:143],a[60:63]
mm a[56:59],v[168:171],v[140:143],a[56:59]
mm a[52:55],v[164:167],v[140:143],a[52:55]
mm a[48:51],v[160:163],v[140:143],a[48:51]
wt lgkmcnt(0)
mm a[0:3],v[96:99],v[64:67],a[0:3]
dt v[160:161],v20 offset:24576
mm a[4:7],v[100:103],v[64:67],a[4:7]
dt v[162:163],v20 offset:25600
mm a[8:11],v[104:107],v[64:67],a[8:11]
dr v[128:131],v19 offset:16384
mm a[12:15],v[108:111],v[64:67],a[12:15]
dt v[164:165],v21 offset:24576
mm a[28:31],v[108:111],v[68:71],a[28:31]
dt v[166:167],v21 offset:25600
mm a[24:27],v[104:107],v[68:71],a[24:27]
dr v[132:135],v19 offset:18432
mm a[20:23],v[100:103],v[68:71],a[20:23]
dt v[168:169],v22 offset:24576
mm a[16:19],v[96:99],v[68:71],a[16:19]
dt v[170:171],v22 offset:25600
mm a[32:35],v[96:99],v[72:75],a[32:35]
dr v[136:139],v19 offset:20480
mm a[36:39],v[100:103],v[72:75],a[36:39]
dt v[172:173],v23 offset:24576
mm a[40:43],v[104:107],v[72:75],a[40:43]
dt v[174:175],v23 offset:25600
mm a[44:47],v[108:111],v[72:75],a[44:47]
dr v[140:143],v19 offset:22528
mm a[60:63],v[108:111],v[76:79],a[60:63]
mm a[56:59],v[104:107],v[76:79],a[56:59]
mm a[52:55],v[100:103],v[76:79],a[52:55]
mm a[48:51],v[96:99],v[76:79],a[48:51]
wt vmcnt(8) lgkmcnt(0)
s_barrier
mm a[0:3],v[160:163],v[128:131],a[0:3]
dt v[96:97],v20 offset:32768
mm a[4:7],v[164:167],v[128:131],a[4:7]
dt v[98:99],v20 offset:33792
mm a[8:11],v[168:171],v[128:131],a[8:11]
dr v[64:67],v18 offset:32768
mm a[12:15],v[172:175],v[128:131],a[12:15]
dt v[100:101],v21 offset:32768
mm a[28:31],v[172:175],v[132:135],a[28:31]
dt v[102:103],v21 offset:33792
mm a[24:27],v[168:171],v[132:135],a[24:27]
dr v[68:71],v18 offset:34816
mm a[20:23],v[164:167],v[132:135],a[20:23]
dt v[104:105],v22 offset:32768
mm a[16:19],v[160:163],v[132:135],a[16:19]
dt v[106:107],v22 offset:33792
mm a[32:35],v[160:163],v[136:139],a[32:35]
dr v[72:75],v18 offset:36864
mm a[36:39],v[164:167],v[136:139],a[36:39]
dt v[108:109],v23 offset:32768
mm a[40:43],v[168:171],v[136:139],a[40:43]
dt v[110:111],v23 offset:33792
mm a[44:47],v[172:175],v[136:139],a[44:47]
dr v[76:79],v18 offset:38912
mm a[60:63],v[172:175],v[140:143],a[60:63]
mm a[56:59],v[168:171],v[140:143],a[56:59]
mm a[52:55],v[164:167],v[140:143],a[52:55]
mm a[48:51],v[160:163],v[140:143],a[48:51]
wt lgkmcnt(0)
mm a[0:3],v[96:99],v[64:67],a[0:3]
dt v[160:161],v20 offset:40960
mm a[4:7],v[100:103],v[64:67],a[4:7]
dt v[162:163],v20 offset:41984
mm a[8:11],v[104:107],v[64:67],a[8:11]
dr v[128:131],v19 offset:32768
mm a[12:15],v[108:111],v[64:67],a[12:15]
dt v[164:165],v21 offset:40960
mm a[28:31],v[108:111],v[68:71],a[28:31]
dt v[166:167],v21 offset:41984
mm a[24:27],v[104:107],v[68:71],a[24:27]
dr v[132:135],v19 offset:34816
mm a[20:23],v[100:103],v[68:71],a[20:23]
dt v[168:169],v22 offset:40960
mm a[16:19],v[96:99],v[68:71],a[16:19]
dt v[170:171],v22 offset:41984
mm a[32:35],v[96:99],v[72:75],a[32:35]
dr v[136:139],v19 offset:36864
mm a[36:39],v[100:103],v[72:75],a[36:39]
dt v[172:173],v23 offset:40960
mm a[40:43],v[104:107],v[72:75],a[40:43]
dt v[174:175],v23 offset:41984
mm a[44:47],v[108:111],v[72:75],a[44:47]
dr v[140:143],v19 offset:38912
mm a[60:63],v[108:111],v[76:79],a[60:63]
mm a[56:59],v[104:107],v[76:79],a[56:59]
mm a[52:55],v[100:103],v[76:79],a[52:55]
mm a[48:51],v[96:99],v[76:79],a[48:51]
wt vmcnt(0) lgkmcnt(0)
s_barrier
mm a[0:3],v[160:163],v[128:131],a[0:3]
dt v[96:97],v20 offset:49152
mm a[4:7],v[164:167],v[128:131],a[4:7]
dt v[98:99],v20 offset:50176
mm a[8:11],v[168:171],v[128:131],a[8:11]
dr v[64:67],v18 offset:49152
mm a[12:15],v[172:175],v[128:131],a[12:15]
dt v[100:101],v21 offset:49152
mm a[28:31],v[172:175],v[132:135],a[28:31]
dt v[102:103],v21 offset:50176
mm a[24:27],v[168:171],v[132:135],a[24:27]
dr v[68:71],v18 offset:51200
mm a[20:23],v[164:167],v[132:135],a[20:23]
dt v[104:105],v22 offset:49152
mm a[16:19],v[160:163],v[132:135],a[16:19]
dt v[106:107],v22 offset:50176
mm a[32:35],v[160:163],v[136:139],a[32:35]
dr v[72:75],v18 offset:53248
mm a[36:39],v[164:167],v[136:139],a[36:39]
dt v[108:109],v23 offset:49152
mm a[40:43],v[168:171],v[136:139],a[40:43]
dt v[110:111],v23 offset:50176
mm a[44:47],v[172:175],v[136:139],a[44:47]
dr v[76:79],v18 offset:55296
mm a[60:63],v[172:175],v[140:143],a[60:63]
mm a[56:59],v[168:171],v[140:143],a[56:59]
mm a[52:55],v[164:167],v[140:143],a[52:55]
mm a[48:51],v[160:163],v[140:143],a[48:51]
wt lgkmcnt(0)
mm a[0:3],v[96:99],v[64:67],a[0:3]
dt v[160:161],v20 offset:57344
mm a[4:7],v[100:103],v[64:67],a[4:7]
dt v[162:163],v20 offset:58368
mm a[8:11],v[104:107],v[64:67],a[8:11]
dr v[128:131],v19 offset:49152
mm a[12:15],v[108:111],v[64:67],a[12:15]
dt v[164:165],v21 offset:57344
mm a[28:31],v[108:111],v[68:71],a[28:31]
dt v[166:167],v21 offset:58368
mm a[24:27],v[104:107],v[68:71],a[24:27]
dr v[132:135],v19 offset:51200
mm a[20:23],v[100:103],v[68:71],a[20:23]
dt v[168:169],v22 offset:57344
mm a[16:19],v[96:99],v[68:71],a[16:19]
dt v[170:171],v22 offset:58368
mm a[32:35],v[96:99],v[72:75],a[32:35]
dr v[136:139],v19 offset:53248
mm a[36:39],v[100:103],v[72:75],a[36:39]
dt v[172:173],v23 offset:57344
mm a[40:43],v[104:107],v[72:75],a[40:43]
dt v[174:175],v23 offset:58368
mm a[44:47],v[108:111],v[72:75],a[44:47]
dr v[140:143],v19 offset:55296
mm a[60:63],v[108:111],v[76:79],a[60:63]
mm a[56:59],v[104:107],v[76:79],a[56:59]
mm a[52:55],v[100:103],v[76:79],a[52:55]
mm a[48:51],v[96:99],v[76:79],a[48:51]
wt lgkmcnt(0)
mm a[0:3],v[160:163],v[128:131],a[0:3]
mm a[4:7],v[164:167],v[128:131],a[4:7]
mm a[8:11],v[168:171],v[128:131],a[8:11]
mm a[12:15],v[172:175],v[128:131],a[12:15]
mm a[28:31],v[172:175],v[132:135],a[28:31]
mm a[24:27],v[168:171],v[132:135],a[24:27]
mm a[20:23],v[164:167],v[132:135],a[20:23]
mm a[16:19],v[160:163],v[132:135],a[16:19]
mm a[32:35],v[160:163],v[136:139],a[32:35]
mm a[36:39],v[164:167],v[136:139],a[36:39]
mm a[40:43],v[168:171],v[136:139],a[40:43]
mm a[44:47],v[172:175],v[136:139],a[44:47]
mm a[60:63],v[172:175],v[140:143],a[60:63]
mm a[56:59],v[168:171],v[140:143],a[56:59]
mm a[52:55],v[164:167],v[140:143],a[52:55]
mm a[48:51],v[160:163],v[140:143],a[48:51]
s_cmp_lg_u32 s4,0
s_cbranch_scc1 GV1_ok
GV1:
v_and_b32 v30,7,v1
v_lshlrev_b32 v30,5,v30
global_load_dwordx2 v[32:33],v30,s[16:17] sc1
GV1_1:
s_sub_u32 s15,s15,1
s_max_i32 s15,s15,0
s_mov_b32 s48,0
wt vmcnt(0)
v_readlane_b32 s49,v33,0
s_nop 0
s_lshr_b32 s49,s49,8
s_add_u32 s48,s48,s49
v_readlane_b32 s49,v33,1
s_nop 0
s_lshr_b32 s49,s49,8
s_add_u32 s48,s48,s49
v_readlane_b32 s49,v33,2
s_nop 0
s_lshr_b32 s49,s49,8
s_add_u32 s48,s48,s49
v_readlane_b32 s49,v33,3
s_nop 0
s_lshr_b32 s49,s49,8
s_add_u32 s48,s48,s49
v_readlane_b32 s49,v33,4
s_nop 0
s_lshr_b32 s49,s49,8
s_add_u32 s48,s48,s49
v_readlane_b32 s49,v33,5
s_nop 0
s_lshr_b32 s49,s49,8
s_add_u32 s48,s48,s49
v_readlane_b32 s49,v33,6
s_nop 0
s_lshr_b32 s49,s49,8
s_add_u32 s48,s48,s49
v_readlane_b32 s49,v33,7
s_nop 0
s_lshr_b32 s49,s49,8
s_add_u32 s48,s48,s49
s_and_b32 s49,s48,0x3ff
s_cmp_ge_u32 s49,256
s_cbranch_scc1 GV1_all
s_cmp_eq_u32 s15,0
s_cbranch_scc1 GV1_all
s_sleep 2
s_branch GV1
GV1_all:
s_mov_b32 s4,1
s_lshr_b32 s48,s48,10
s_cmp_gt_u32 s48,512
s_cselect_b32 s5,1,0
s_xor_b32 s7,s5,1
s_lshl_b32 s7,s7,13
v_bfe_u32 v31,v33,8,10
v_cmp_ne_u32 s[50:51],32,v31
v_and_b32 v31,0xff,v33
v_cmp_ne_u32 s[52:53],0,v31
v_cmp_ne_u32 vcc,-1,v32
s_or_b64 s[52:53],s[52:53],s[50:51]
s_or_b64 vcc,vcc,s[52:53]
s_cbranch_vccz GV1_ok
v_mov_b32 v30,163784
wt vmcnt(0) lgkmcnt(0)
s_cmp_eq_u32 s99,1
s_cbranch_scc0 GV1_t
s_mov_b64 exec,1
ds_write_b32 v30,v255
s_mov_b64 exec,-1
wt lgkmcnt(0)
GV1_t:
s_barrier
ds_read_b32 v31,v30
wt lgkmcnt(0)
v_readfirstlane_b32 s13,v31
s_nop 0
s_bfe_u32 s13,s13,0x50008
s_cmp_eq_u64 s[50:51],0
s_cbranch_scc1 L_role
s_mov_b32 s3,1
s_and_b32 s12,s2,7
s_lshr_b32 s13,s2,3
s_branch L_role
GV1_ok:
v_mov_b32 v45,0
buffer_load_dword v44,v45,s[8:11],s24 offen sc1
s_lshl_b32 s48,s76,20
s_lshl_b32 s49,s77,12
s_add_u32 s48,s48,s49
s_lshl_b32 s49,s93,0
s_add_u32 s48,s48,s49
s_xor_b32 s48,s48,s7
ar v192,a0
ar v193,a1
ar v194,a2
ar v195,a3
ar v196,a4
ar v197,a5
ar v198,a6
ar v199,a7
cv v200,v192,v193
cv v201,v194,v195
cv v202,v196,v197
cv v203,v198,v199
w4 v[200:203],v28,s[8:11],s48 offen sc1
ar v204,a8
ar v205,a9
ar v206,a10
ar v207,a11
ar v208,a12
ar v209,a13
ar v210,a14
ar v211,a15
cv v212,v204,v205
cv v213,v206,v207
cv v214,v208,v209
cv v215,v210,v211
w4 v[212:215],v28,s[8:11],s48 offen offset:2048 sc1
ar v216,a16
ar v217,a17
ar v218,a18
ar v219,a19
ar v220,a20
ar v221,a21
ar v222,a22
ar v223,a23
cv v224,v216,v217
cv v225,v218,v219
cv v226,v220,v221
cv v227,v222,v223
w4 v[224:227],v28,s[8:11],s48 offen offset:256 sc1
ar v228,a24
ar v229,a25
ar v230,a26
ar v231,a27
ar v232,a28
ar v233,a29
ar v234,a30
ar v235,a31
cv v236,v228,v229
cv v237,v230,v231
cv v238,v232,v233
cv v239,v234,v235
w4 v[236:239],v28,s[8:11],s48 offen offset:2304 sc1
s_add_u32 s48,s48,524288
ar v192,a32
ar v193,a33
ar v194,a34
ar v195,a35
ar v196,a36
ar v197,a37
ar v198,a38
ar v199,a39
cv v200,v192,v193
cv v201,v194,v195
cv v202,v196,v197
cv v203,v198,v199
w4 v[200:203],v28,s[8:11],s48 offen sc1
ar v204,a40
ar v205,a41
ar v206,a42
ar v207,a43
ar v208,a44
ar v209,a45
ar v210,a46
ar v211,a47
cv v212,v204,v205
cv v213,v206,v207
cv v214,v208,v209
cv v215,v210,v211
w4 v[212:215],v28,s[8:11],s48 offen offset:2048 sc1
ar v216,a48
ar v217,a49
ar v218,a50
ar v219,a51
ar v220,a52
ar v221,a53
ar v222,a54
ar v223,a55
cv v224,v216,v217
cv v225,v218,v219
cv v226,v220,v221
cv v227,v222,v223
w4 v[224:227],v28,s[8:11],s48 offen offset:256 sc1
ar v228,a56
ar v229,a57
ar v230,a58
ar v231,a59
ar v232,a60
ar v233,a61
ar v234,a62
ar v235,a63
cv v236,v228,v229
cv v237,v230,v231
cv v238,v232,v233
cv v239,v234,v235
w4 v[236:239],v28,s[8:11],s48 offen offset:2304 sc1
s_add_u32 s48,s48,524288
s_and_b32 s50,s97,3
s_cselect_b32 s50,1,256
wt vmcnt(0)
s_barrier
s_cmp_eq_u32 s14,0
s_cbranch_scc0 G1H_s
v_mul_u32_u24 v30,0,v1
v_mov_b32 v31,s50
s_mov_b64 exec,1
buffer_atomic_add v31,v30,s[8:11],s96 offen sc1
s_mov_b64 exec,-1
G1H_s:
s_branch G_have
G_red:
s_mov_b64 s[32:33],s[68:69]
s_mov_b32 s34,0x800000
s_lshl_b32 s50,s22,18
s_lshl_b32 s49,s14,16
s_add_u32 s50,s50,s49
s_add_u32 s50,s50,256
v_bfe_u32 v33,v1,4,2
v_lshlrev_b32 v33,11,v33
v_bfe_u32 v32,v1,0,4
v_lshl_add_u32 v33,v32,4,v33
v_add_u32 v33,s50,v33
s_lshl_b32 s50,s22,16
s_lshl_b32 s49,s14,14
s_add_u32 s50,s50,s49
s_add_u32 s50,s50,201326592
v_bfe_u32 v34,v1,4,2
v_lshlrev_b32 v34,9,v34
v_bfe_u32 v32,v1,0,4
v_lshl_add_u32 v34,v32,4,v34
v_add_u32 v34,s50,v34
s_mov_b32 s50,0
l4 a[0:3],v33,s[32:35],s50 offen offset:0
l4 a[4:7],v33,s[32:35],s50 offen offset:1024
s_mov_b32 s50,8192
l4 a[8:11],v33,s[32:35],s50 offen offset:0
l4 a[12:15],v33,s[32:35],s50 offen offset:1024
s_mov_b32 s50,16384
l4 a[16:19],v33,s[32:35],s50 offen offset:0
l4 a[20:23],v33,s[32:35],s50 offen offset:1024
s_mov_b32 s50,24576
l4 a[24:27],v33,s[32:35],s50 offen offset:0
l4 a[28:31],v33,s[32:35],s50 offen offset:1024
s_mov_b32 s50,32768
l4 a[32:35],v33,s[32:35],s50 offen offset:0
l4 a[36:39],v33,s[32:35],s50 offen offset:1024
s_mov_b32 s50,40960
l4 a[40:43],v33,s[32:35],s50 offen offset:0
l4 a[44:47],v33,s[32:35],s50 offen offset:1024
s_mov_b32 s50,49152
l4 a[48:51],v33,s[32:35],s50 offen offset:0
l4 a[52:55],v33,s[32:35],s50 offen offset:1024
s_mov_b32 s50,57344
l4 a[56:59],v33,s[32:35],s50 offen offset:0
l4 a[60:63],v33,s[32:35],s50 offen offset:1024
s_cmp_eq_u32 s14,3
s_cbranch_scc1 G_red_done
s_lshl_b32 s48,s14,11
v_bfe_u32 v31,v1,0,6
v_lshlrev_b32 v31,4,v31
v_add_u32 v30,s48,v31
s_mov_b32 s48,s21
l4 v[64:67],v30,s[8:11],s48 offen sc1
l4 v[68:71],v30,s[8:11],s48 offen offset:1024 sc1
s_add_u32 s48,s48,196608
l4 v[72:75],v30,s[8:11],s48 offen sc1
l4 v[76:79],v30,s[8:11],s48 offen offset:1024 sc1
s_add_u32 s48,s48,196608
l4 v[80:83],v30,s[8:11],s48 offen sc1
l4 v[84:87],v30,s[8:11],s48 offen offset:1024 sc1
s_add_u32 s48,s48,196608
l4 v[88:91],v30,s[8:11],s48 offen sc1
l4 v[92:95],v30,s[8:11],s48 offen offset:1024 sc1
s_add_u32 s48,s48,196608
l4 v[96:99],v30,s[8:11],s48 offen sc1
l4 v[100:103],v30,s[8:11],s48 offen offset:1024 sc1
s_add_u32 s48,s48,196608
l4 v[104:107],v30,s[8:11],s48 offen sc1
l4 v[108:111],v30,s[8:11],s48 offen offset:1024 sc1
s_add_u32 s48,s48,196608
l4 v[112:115],v30,s[8:11],s48 offen sc1
l4 v[116:119],v30,s[8:11],s48 offen offset:1024 sc1
s_add_u32 s48,s48,196608
l4 v[120:123],v30,s[8:11],s48 offen sc1
l4 v[124:127],v30,s[8:11],s48 offen offset:1024 sc1
s_add_u32 s48,s48,196608
l4 v[128:131],v30,s[8:11],s48 offen sc1
l4 v[132:135],v30,s[8:11],s48 offen offset:1024 sc1
s_add_u32 s48,s48,196608
l4 v[136:139],v30,s[8:11],s48 offen sc1
l4 v[140:143],v30,s[8:11],s48 offen offset:1024 sc1
s_add_u32 s48,s48,196608
l4 v[144:147],v30,s[8:11],s48 offen sc1
l4 v[148:151],v30,s[8:11],s48 offen offset:1024 sc1
s_add_u32 s48,s48,196608
l4 v[152:155],v30,s[8:11],s48 offen sc1
l4 v[156:159],v30,s[8:11],s48 offen offset:1024 sc1
s_add_u32 s48,s48,196608
l4 v[160:163],v30,s[8:11],s48 offen sc1
l4 v[164:167],v30,s[8:11],s48 offen offset:1024 sc1
s_add_u32 s48,s48,196608
l4 v[168:171],v30,s[8:11],s48 offen sc1
l4 v[172:175],v30,s[8:11],s48 offen offset:1024 sc1
s_add_u32 s48,s48,196608
l4 v[176:179],v30,s[8:11],s48 offen sc1
l4 v[180:183],v30,s[8:11],s48 offen offset:1024 sc1
s_add_u32 s48,s48,196608
l4 v[184:187],v30,s[8:11],s48 offen sc1
l4 v[188:191],v30,s[8:11],s48 offen offset:1024 sc1
s_add_u32 s48,s48,196608
wt vmcnt(28)
pa v[64:65],v[64:65],v[72:73]
pa v[66:67],v[66:67],v[74:75]
pa v[68:69],v[68:69],v[76:77]
pa v[70:71],v[70:71],v[78:79]
wt vmcnt(26)
pa v[64:65],v[64:65],v[80:81]
pa v[66:67],v[66:67],v[82:83]
pa v[68:69],v[68:69],v[84:85]
pa v[70:71],v[70:71],v[86:87]
wt vmcnt(24)
pa v[64:65],v[64:65],v[88:89]
pa v[66:67],v[66:67],v[90:91]
pa v[68:69],v[68:69],v[92:93]
pa v[70:71],v[70:71],v[94:95]
wt vmcnt(22)
pa v[64:65],v[64:65],v[96:97]
pa v[66:67],v[66:67],v[98:99]
pa v[68:69],v[68:69],v[100:101]
pa v[70:71],v[70:71],v[102:103]
wt vmcnt(20)
pa v[64:65],v[64:65],v[104:105]
pa v[66:67],v[66:67],v[106:107]
pa v[68:69],v[68:69],v[108:109]
pa v[70:71],v[70:71],v[110:111]
wt vmcnt(18)
pa v[64:65],v[64:65],v[112:113]
pa v[66:67],v[66:67],v[114:115]
pa v[68:69],v[68:69],v[116:117]
pa v[70:71],v[70:71],v[118:119]
wt vmcnt(16)
pa v[64:65],v[64:65],v[120:121]
pa v[66:67],v[66:67],v[122:123]
pa v[68:69],v[68:69],v[124:125]
pa v[70:71],v[70:71],v[126:127]
wt vmcnt(14)
pa v[64:65],v[64:65],v[128:129]
pa v[66:67],v[66:67],v[130:131]
pa v[68:69],v[68:69],v[132:133]
pa v[70:71],v[70:71],v[134:135]
wt vmcnt(12)
pa v[64:65],v[64:65],v[136:137]
pa v[66:67],v[66:67],v[138:139]
pa v[68:69],v[68:69],v[140:141]
pa v[70:71],v[70:71],v[142:143]
wt vmcnt(10)
pa v[64:65],v[64:65],v[144:145]
pa v[66:67],v[66:67],v[146:147]
pa v[68:69],v[68:69],v[148:149]
pa v[70:71],v[70:71],v[150:151]
wt vmcnt(8)
pa v[64:65],v[64:65],v[152:153]
pa v[66:67],v[66:67],v[154:155]
pa v[68:69],v[68:69],v[156:157]
pa v[70:71],v[70:71],v[158:159]
wt vmcnt(6)
pa v[64:65],v[64:65],v[160:161]
pa v[66:67],v[66:67],v[162:163]
pa v[68:69],v[68:69],v[164:165]
pa v[70:71],v[70:71],v[166:167]
wt vmcnt(4)
pa v[64:65],v[64:65],v[168:169]
pa v[66:67],v[66:67],v[170:171]
pa v[68:69],v[68:69],v[172:173]
pa v[70:71],v[70:71],v[174:175]
wt vmcnt(2)
pa v[64:65],v[64:65],v[176:177]
pa v[66:67],v[66:67],v[178:179]
pa v[68:69],v[68:69],v[180:181]
pa v[70:71],v[70:71],v[182:183]
wt vmcnt(0)
pa v[64:65],v[64:65],v[184:185]
pa v[66:67],v[66:67],v[186:187]
pa v[68:69],v[68:69],v[188:189]
pa v[70:71],v[70:71],v[190:191]
cv v192,v64,v65
cv v193,v66,v67
cv v194,v68,v69
cv v195,v70,v71
s_lshl_b32 s48,s14,10
s_lshl_b32 s49,s23,0
s_add_u32 s48,s48,s49
w4 v[192:195],v31,s[8:11],s48 offen sc1
G_red_done:
wt vmcnt(1)
s_mov_b32 s50,0
w4 a[0:3],v34,s[8:11],s50 offen sc1
s_mov_b32 s50,2097152
w4 a[4:7],v34,s[8:11],s50 offen sc1
s_mov_b32 s50,2048
w4 a[8:11],v34,s[8:11],s50 offen sc1
s_mov_b32 s50,2099200
w4 a[12:15],v34,s[8:11],s50 offen sc1
s_mov_b32 s50,4096
w4 a[16:19],v34,s[8:11],s50 offen sc1
s_mov_b32 s50,2101248
w4 a[20:23],v34,s[8:11],s50 offen sc1
s_mov_b32 s50,6144
w4 a[24:27],v34,s[8:11],s50 offen sc1
s_mov_b32 s50,2103296
w4 a[28:31],v34,s[8:11],s50 offen sc1
s_mov_b32 s50,8192
w4 a[32:35],v34,s[8:11],s50 offen sc1
s_mov_b32 s50,2105344
w4 a[36:39],v34,s[8:11],s50 offen sc1
s_mov_b32 s50,10240
w4 a[40:43],v34,s[8:11],s50 offen sc1
s_mov_b32 s50,2107392
w4 a[44:47],v34,s[8:11],s50 offen sc1
s_mov_b32 s50,12288
w4 a[48:51],v34,s[8:11],s50 offen sc1
s_mov_b32 s50,2109440
w4 a[52:55],v34,s[8:11],s50 offen sc1
s_mov_b32 s50,14336
w4 a[56:59],v34,s[8:11],s50 offen sc1
wt vmcnt(15)
s_mov_b32 s50,2111488
w4 a[60:63],v34,s[8:11],s50 offen sc1
wt vmcnt(0)
s_barrier
s_cmp_eq_u32 s14,0
s_cbranch_scc0 G_red_s
v_mul_u32_u24 v30,s27,v1
v_mov_b32 v31,1
s_mov_b64 exec,3
buffer_atomic_add v31,v30,s[8:11],s26 offen sc1
s_mov_b64 exec,-1
G_red_s:
s_branch G_next
G_att:
s_barrier
s_lshl2_add_u32 s92,s22,s14
s_mov_b32 s90,s21
s_mov_b32 s94,0
v_mul_u32_u24 v30,s27,v1
v_add_u32 v30,s21,v30
v_mov_b32 v31,s21
v_cmp_gt_u32 vcc,s23,v30
s_nop 1
v_cndmask_b32 v30,v31,v30,vcc
v_lshrrev_b32 v30,2,v30
v_lshlrev_b32 v30,11,v30
s_lshl_b32 s48,s22,8
s_add_u32 s48,s48,4227072
s_lshl_b32 s95,s22,8
s_add_u32 s95,s95,4194304
s_buffer_load_dword s58,s[8:11],s95 glc
s_buffer_load_dword s59,s[8:11],s95 offset:2048 glc
GA_w:
buffer_load_dword v31,v30,s[8:11],s48 offen sc1
v_bfe_u32 v33,v1,0,6
v_lshlrev_b32 v33,4,v33
v_bfe_u32 v34,v1,4,2
v_lshlrev_b32 v34,7,v34
v_bfe_u32 v32,v1,0,3
v_lshl_add_u32 v34,v32,4,v34
v_bfe_u32 v35,v1,2,2
v_lshlrev_b32 v35,7,v35
v_bfe_u32 v32,v1,0,2
v_lshl_add_u32 v35,v32,4,v35
v_bfe_u32 v32,v1,4,1
v_lshl_add_u32 v35,v32,3,v35
s_lshl_b32 s51,s14,14
v_bfe_u32 v36,v1,0,2
v_lshlrev_b32 v36,9,v36
v_bfe_u32 v32,v1,4,2
v_lshl_add_u32 v36,v32,6,v36
v_bfe_u32 v32,v1,2,2
v_lshl_add_u32 v36,v32,4,v36
v_add_u32 v36,s51,v36
s_sub_u32 s15,s15,1
s_max_i32 s15,s15,0
s_movk_i32 s49,1032
wt vmcnt(0) lgkmcnt(0)
v_cmp_ne_u32 vcc,s49,v31
s_cbranch_vccz GA_wk
s_cmp_eq_u32 s15,0
s_cbranch_scc1 GA_wk
s_sleep 2
s_branch GA_w
GA_wk:
s_lshl_b32 s96,s90,19
s_and_b32 s49,s96,0xffe00000
s_add_u32 s96,s96,s49
s_lshl_b32 s49,s92,14
s_add_u32 s96,s96,s49
s_add_u32 s52,s96,83886080
s_add_u32 s53,s96,16777216
s_xor_b32 s52,s52,s7
s_xor_b32 s53,s53,s7
l4 a[0:3],v28,s[8:11],s52 offen sc1
l4 a[32:35],v28,s[8:11],s53 offen sc1
l4 a[16:19],v28,s[8:11],s52 offen offset:256 sc1
l4 a[48:51],v28,s[8:11],s53 offen offset:256 sc1
l4 a[4:7],v28,s[8:11],s52 offen offset:2048 sc1
l4 a[36:39],v28,s[8:11],s53 offen offset:2048 sc1
l4 a[20:23],v28,s[8:11],s52 offen offset:2304 sc1
l4 a[52:55],v28,s[8:11],s53 offen offset:2304 sc1
s_add_u32 s52,s96,83890176
s_add_u32 s53,s96,16781312
s_xor_b32 s52,s52,s7
s_xor_b32 s53,s53,s7
l4 a[8:11],v28,s[8:11],s52 offen sc1
l4 a[40:43],v28,s[8:11],s53 offen sc1
l4 a[24:27],v28,s[8:11],s52 offen offset:256 sc1
l4 a[56:59],v28,s[8:11],s53 offen offset:256 sc1
l4 a[12:15],v28,s[8:11],s52 offen offset:2048 sc1
l4 a[44:47],v28,s[8:11],s53 offen offset:2048 sc1
l4 a[28:31],v28,s[8:11],s52 offen offset:2304 sc1
l4 a[60:63],v28,s[8:11],s53 offen offset:2304 sc1
s_add_u32 m0,s51,0
s_add_u32 s52,s96,18882560
s_xor_b32 s52,s52,s7
l4 v33,s[8:11],s52 offen sc1 lds
l4 v33,s[8:11],s52 offen offset:1024 sc1 lds
l4 v33,s[8:11],s52 offen offset:2048 sc1 lds
l4 v33,s[8:11],s52 offen offset:3072 sc1 lds
s_add_u32 m0,s51,4096
s_add_u32 s52,s96,18886656
s_xor_b32 s52,s52,s7
l4 v33,s[8:11],s52 offen sc1 lds
l4 v33,s[8:11],s52 offen offset:1024 sc1 lds
l4 v33,s[8:11],s52 offen offset:2048 sc1 lds
l4 v33,s[8:11],s52 offen offset:3072 sc1 lds
v_bfe_u32 v30,v1,4,2
v_lshlrev_b32 v30,2,v30
v_bfe_u32 v31,v1,0,4
v_sub_u32 v30,v31,v30
v_mov_b32 v37,0xff800000
v_mov_b32 v41,1
v_mov_b32 v40,0x7ffffff0
v_cmp_le_i32 s[82:83],0,v30
v_cmp_le_i32 s[84:85],1,v30
v_cmp_le_i32 s[86:87],2,v30
v_cmp_le_i32 s[88:89],3,v30
s_mov_b32 s54,-1
s_mov_b32 s55,0
s_mov_b32 s56,0x3e0293ee
s_mov_b32 s91,s90
s_branch GA_late1
GA_it0:
wt vmcnt(8) lgkmcnt(0)
dt v[194:195],v36 offset:0
dt v[196:197],v36 offset:256
dt v[198:199],v36 offset:8
dt v[200:201],v36 offset:264
dt v[202:203],v36 offset:2048
dt v[204:205],v36 offset:2304
dt v[206:207],v36 offset:2056
dt v[208:209],v36 offset:2312
dt v[210:211],v36 offset:4096
dt v[212:213],v36 offset:4352
dt v[214:215],v36 offset:4104
dt v[216:217],v36 offset:4360
dt v[218:219],v36 offset:6144
dt v[220:221],v36 offset:6400
dt v[222:223],v36 offset:6152
dt v[224:225],v36 offset:6408
s_add_u32 s91,s90,s27
s_lshl_b32 s96,s91,19
s_and_b32 s49,s96,0xffe00000
s_add_u32 s96,s96,s49
s_lshl_b32 s49,s92,14
s_add_u32 s96,s96,s49
s_lshl_b32 s97,s91,16
s_lshl_b32 s49,s92,11
s_add_u32 s97,s97,s49
s_add_u32 s52,s91,2
s_cmp_ge_u32 s59,16
s_cselect_b32 s49,99,s58
s_cmp_ge_u32 s49,s52
s_cselect_b32 s93,s91,0
s_cselect_b32 s97,s97,0x40000000
s_cmp_lt_u32 s91,s23
s_cselect_b32 s96,s96,0x40000000
s_cselect_b32 s97,s97,0x40000000
mm v[160:163],a[64:67],a[0:3],0
mm v[164:167],a[32:35],a[0:3],0
s_add_u32 s52,s96,83886080
s_add_u32 s53,s96,16777216
s_xor_b32 s52,s52,s7
s_xor_b32 s53,s53,s7
l4 a[96:99],v28,s[8:11],s52 offen sc1
mm v[172:175],a[64:67],a[16:19],0
mm v[176:179],a[32:35],a[16:19],0
l4 a[128:131],v28,s[8:11],s53 offen sc1
mm v[180:183],a[48:51],a[16:19],0
mm v[160:163],a[68:71],a[4:7],v[160:163]
l4 a[112:115],v28,s[8:11],s52 offen offset:256 sc1
mm v[164:167],a[36:39],a[4:7],v[164:167]
mm v[172:175],a[68:71],a[20:23],v[172:175]
l4 a[144:147],v28,s[8:11],s53 offen offset:256 sc1
mm v[176:179],a[36:39],a[20:23],v[176:179]
mm v[180:183],a[52:55],a[20:23],v[180:183]
l4 a[100:103],v28,s[8:11],s52 offen offset:2048 sc1
mm v[160:163],a[72:75],a[8:11],v[160:163]
mm v[164:167],a[40:43],a[8:11],v[164:167]
l4 a[132:135],v28,s[8:11],s53 offen offset:2048 sc1
mm v[172:175],a[72:75],a[24:27],v[172:175]
mm v[176:179],a[40:43],a[24:27],v[176:179]
l4 a[116:119],v28,s[8:11],s52 offen offset:2304 sc1
mm v[180:183],a[56:59],a[24:27],v[180:183]
mm v[160:163],a[76:79],a[12:15],v[160:163]
l4 a[148:151],v28,s[8:11],s53 offen offset:2304 sc1
mm v[164:167],a[44:47],a[12:15],v[164:167]
mm v[172:175],a[76:79],a[28:31],v[172:175]
s_add_u32 s52,s96,83890176
s_add_u32 s53,s96,16781312
s_xor_b32 s52,s52,s7
s_xor_b32 s53,s53,s7
l4 a[104:107],v28,s[8:11],s52 offen sc1
mm v[176:179],a[44:47],a[28:31],v[176:179]
mm v[180:183],a[60:63],a[28:31],v[180:183]
l4 a[136:139],v28,s[8:11],s53 offen sc1
v_cndmask_b32 v160,v37,v160,s[54:55]
v_cndmask_b32 v161,v37,v161,s[54:55]
v_cndmask_b32 v162,v37,v162,s[54:55]
v_cndmask_b32 v163,v37,v163,s[54:55]
v_cndmask_b32 v164,v37,v164,s[82:83]
v_cndmask_b32 v165,v37,v165,s[84:85]
v_cndmask_b32 v166,v37,v166,s[86:87]
v_cndmask_b32 v167,v37,v167,s[88:89]
l4 a[120:123],v28,s[8:11],s52 offen offset:256 sc1
v_cndmask_b32 v172,v37,v172,s[54:55]
v_cndmask_b32 v173,v37,v173,s[54:55]
v_cndmask_b32 v174,v37,v174,s[54:55]
v_cndmask_b32 v175,v37,v175,s[54:55]
v_cndmask_b32 v180,v37,v180,s[82:83]
v_cndmask_b32 v181,v37,v181,s[84:85]
v_cndmask_b32 v182,v37,v182,s[86:87]
v_cndmask_b32 v183,v37,v183,s[88:89]
l4 a[152:155],v28,s[8:11],s53 offen offset:256 sc1
v_max3_f32 v226,v160,v161,v162
v_max3_f32 v226,v226,v163,v164
v_max3_f32 v226,v226,v165,v166
v_max_f32 v226,v226,v167
v_max3_f32 v227,v172,v173,v174
v_max3_f32 v227,v227,v175,v176
v_max3_f32 v227,v227,v177,v178
l4 a[108:111],v28,s[8:11],s52 offen offset:2048 sc1
v_max3_f32 v227,v227,v179,v180
v_max3_f32 v227,v227,v181,v182
v_max_f32 v227,v227,v183
v_mov_b32 v228,v226
v_mov_b32 v229,v227
s_nop 0
v_permlane16_swap_b32 v226,v228
v_permlane16_swap_b32 v227,v229
l4 a[140:143],v28,s[8:11],s53 offen offset:2048 sc1
v_max_f32 v226,v226,v228
v_max_f32 v227,v227,v229
v_mov_b32 v228,v226
v_mov_b32 v229,v227
s_nop 0
v_permlane32_swap_b32 v226,v228
v_permlane32_swap_b32 v227,v229
l4 a[124:127],v28,s[8:11],s52 offen offset:2304 sc1
v_max_f32 v226,v226,v228
v_max_f32 v227,v227,v229
pa v[160:161],v[160:161],v[226:227] op_sel:[0,0] op_sel_hi:[1,0] neg_lo:[0,1] neg_hi:[0,1]
pa v[162:163],v[162:163],v[226:227] op_sel:[0,0] op_sel_hi:[1,0] neg_lo:[0,1] neg_hi:[0,1]
pa v[164:165],v[164:165],v[226:227] op_sel:[0,0] op_sel_hi:[1,0] neg_lo:[0,1] neg_hi:[0,1]
pa v[166:167],v[166:167],v[226:227] op_sel:[0,0] op_sel_hi:[1,0] neg_lo:[0,1] neg_hi:[0,1]
pm v[160:161],v[160:161],s[56:57] op_sel_hi:[1,0]
l4 a[156:159],v28,s[8:11],s53 offen offset:2304 sc1
pm v[162:163],v[162:163],s[56:57] op_sel_hi:[1,0]
pm v[164:165],v[164:165],s[56:57] op_sel_hi:[1,0]
pm v[166:167],v[166:167],s[56:57] op_sel_hi:[1,0]
v_exp_f32 v160,v160
v_exp_f32 v161,v161
v_exp_f32 v162,v162
s_add_u32 m0,s51,8192
s_add_u32 s52,s96,18882560
s_xor_b32 s52,s52,s7
l4 v33,s[8:11],s52 offen sc1 lds
v_exp_f32 v163,v163
v_exp_f32 v164,v164
v_exp_f32 v165,v165
v_exp_f32 v166,v166
l4 v33,s[8:11],s52 offen offset:1024 sc1 lds
v_exp_f32 v167,v167
pa v[172:173],v[172:173],v[226:227] op_sel:[0,1] op_sel_hi:[1,1] neg_lo:[0,1] neg_hi:[0,1]
pa v[174:175],v[174:175],v[226:227] op_sel:[0,1] op_sel_hi:[1,1] neg_lo:[0,1] neg_hi:[0,1]
pa v[176:177],v[176:177],v[226:227] op_sel:[0,1] op_sel_hi:[1,1] neg_lo:[0,1] neg_hi:[0,1]
pa v[178:179],v[178:179],v[226:227] op_sel:[0,1] op_sel_hi:[1,1] neg_lo:[0,1] neg_hi:[0,1]
pa v[180:181],v[180:181],v[226:227] op_sel:[0,1] op_sel_hi:[1,1] neg_lo:[0,1] neg_hi:[0,1]
l4 v33,s[8:11],s52 offen offset:2048 sc1 lds
pa v[182:183],v[182:183],v[226:227] op_sel:[0,1] op_sel_hi:[1,1] neg_lo:[0,1] neg_hi:[0,1]
pm v[172:173],v[172:173],s[56:57] op_sel_hi:[1,0]
pm v[174:175],v[174:175],s[56:57] op_sel_hi:[1,0]
pm v[176:177],v[176:177],s[56:57] op_sel_hi:[1,0]
pm v[178:179],v[178:179],s[56:57] op_sel_hi:[1,0]
pm v[180:181],v[180:181],s[56:57] op_sel_hi:[1,0]
pm v[182:183],v[182:183],s[56:57] op_sel_hi:[1,0]
v_exp_f32 v172,v172
l4 v33,s[8:11],s52 offen offset:3072 sc1 lds
v_exp_f32 v173,v173
v_exp_f32 v174,v174
v_exp_f32 v175,v175
v_exp_f32 v176,v176
s_add_u32 m0,s51,12288
s_add_u32 s52,s96,18886656
s_xor_b32 s52,s52,s7
l4 v33,s[8:11],s52 offen sc1 lds
v_exp_f32 v177,v177
v_exp_f32 v178,v178
v_exp_f32 v179,v179
v_exp_f32 v180,v180
l4 v33,s[8:11],s52 offen offset:1024 sc1 lds
v_exp_f32 v181,v181
v_exp_f32 v182,v182
v_exp_f32 v183,v183
cv v186,v160,v161
l4 v33,s[8:11],s52 offen offset:2048 sc1 lds
cv v187,v162,v163
cv v184,v164,v165
cv v185,v166,v167
cv v192,v172,v173
cv v193,v174,v175
cv v188,v176,v177
cv v189,v178,v179
cv v190,v180,v181
l4 v33,s[8:11],s52 offen offset:3072 sc1 lds
cv v191,v182,v183
pa v[160:161],v[160:161],v[162:163]
pa v[160:161],v[160:161],v[164:165]
pa v[160:161],v[160:161],v[166:167]
v_add_f32 v230,v160,v161
pa v[172:173],v[172:173],v[174:175]
pa v[172:173],v[172:173],v[176:177]
s_add_u32 s52,s97,8388608
l4 a[160:163],v34,s[8:11],s52 offen sc1
pa v[172:173],v[172:173],v[178:179]
pa v[172:173],v[172:173],v[180:181]
pa v[172:173],v[172:173],v[182:183]
v_add_f32 v231,v172,v173
wt lgkmcnt(0)
s_buffer_load_dword s58,s[8:11],s95 glc
s_buffer_load_dword s59,s[8:11],s95 offset:2048 glc
mh v[64:67],a[80:81],v[186:187],0
v_mov_b32 v228,v230
l4 a[164:167],v34,s[8:11],s52 offen offset:512 sc1
v_mov_b32 v229,v231
mh v[68:71],a[80:81],v[192:193],0
v_permlane16_swap_b32 v230,v228
l4 a[168:171],v34,s[8:11],s52 offen offset:1024 sc1
v_permlane16_swap_b32 v231,v229
mh v[64:67],v[194:195],v[184:185],v[64:67]
v_add_f32 v230,v230,v228
l4 a[172:175],v34,s[8:11],s52 offen offset:1536 sc1
v_add_f32 v231,v231,v229
mm v[68:71],v[194:197],v[188:191],v[68:71]
v_mov_b32 v228,v230
s_add_u32 s52,s97,12582912
buffer_load_dwordx2 a[176:177],v35,s[8:11],s52 offen sc1
v_mov_b32 v229,v231
mh v[72:75],a[82:83],v[186:187],0
v_permlane32_swap_b32 v230,v228
buffer_load_dwordx2 a[178:179],v35,s[8:11],s52 offen offset:64 sc1
v_permlane32_swap_b32 v231,v229
mh v[76:79],a[82:83],v[192:193],0
v_add_f32 v230,v230,v228
buffer_load_dwordx2 a[180:181],v35,s[8:11],s52 offen offset:512 sc1
v_add_f32 v231,v231,v229
mh v[72:75],v[198:199],v[184:185],v[72:75]
v_rcp_f32 v230,v230
buffer_load_dwordx2 a[182:183],v35,s[8:11],s52 offen offset:576 sc1
v_rcp_f32 v231,v231
mm v[76:79],v[198:201],v[188:191],v[76:79]
buffer_load_dwordx2 a[184:185],v35,s[8:11],s52 offen offset:1024 sc1
buffer_load_dwordx2 a[186:187],v35,s[8:11],s52 offen offset:1088 sc1
buffer_load_dwordx2 a[188:189],v35,s[8:11],s52 offen offset:1536 sc1
mh v[80:83],a[84:85],v[186:187],0
buffer_load_dwordx2 a[190:191],v35,s[8:11],s52 offen offset:1600 sc1
wt vmcnt(36)
buffer_atomic_add v41,v40,s[8:11],s94 offen sc1
s_lshl_b32 s48,s90,19
mh v[84:87],a[84:85],v[192:193],0
s_and_b32 s49,s48,0xffe00000
s_add_u32 s48,s48,s49
s_lshl_b32 s49,s92,14
mh v[80:83],v[202:203],v[184:185],v[80:83]
s_add_u32 s48,s48,s49
s_and_b32 s49,s90,2
s_lshl_b32 s49,s49,13
mm v[84:87],v[202:205],v[188:191],v[84:87]
s_and_b32 s53,s90,1
s_lshl_b32 s53,s53,12
s_or_b32 s53,s53,s49
mh v[88:91],a[86:87],v[186:187],0
s_xor_b32 s53,s53,s7
s_lshl_b32 s49,s90,2
s_lshl_b32 s50,s22,8
mh v[92:95],a[86:87],v[192:193],0
s_add_u32 s49,s49,s50
s_add_u32 s49,s49,4210688
s_lshr_b32 s50,s90,2
mh v[88:91],v[206:207],v[184:185],v[88:91]
s_lshl_b32 s50,s50,8
s_add_u32 s50,s50,4206592
v_writelane_b32 v40,s49,0
mm v[92:95],v[206:209],v[188:191],v[92:95]
v_writelane_b32 v40,s50,1
s_lshr_b32 s50,s90,1
s_lshl_b32 s50,s50,8
mh v[96:99],a[88:89],v[186:187],0
s_add_u32 s50,s50,4218880
v_writelane_b32 v40,s50,2
s_mov_b32 s94,0
mh v[100:103],a[88:89],v[192:193],0
s_add_u32 s52,s48,85991424
s_xor_b32 s52,s52,s53
pm v[64:65],v[64:65],v[230:231] op_sel:[0,0] op_sel_hi:[1,0]
pm v[66:67],v[66:67],v[230:231] op_sel:[0,0] op_sel_hi:[1,0]
mh v[96:99],v[210:211],v[184:185],v[96:99]
cv v232,v64,v65
cv v233,v66,v67
pm v[72:73],v[72:73],v[230:231] op_sel:[0,0] op_sel_hi:[1,0]
mm v[100:103],v[210:213],v[188:191],v[100:103]
pm v[74:75],v[74:75],v[230:231] op_sel:[0,0] op_sel_hi:[1,0]
cv v234,v72,v73
cv v235,v74,v75
mh v[104:107],a[90:91],v[186:187],0
w4 v[232:235],v28,s[8:11],s52 offen sc1
pm v[68:69],v[68:69],v[230:231] op_sel:[0,1] op_sel_hi:[1,1]
pm v[70:71],v[70:71],v[230:231] op_sel:[0,1] op_sel_hi:[1,1]
mh v[108:111],a[90:91],v[192:193],0
cv v236,v68,v69
cv v237,v70,v71
pm v[76:77],v[76:77],v[230:231] op_sel:[0,1] op_sel_hi:[1,1]
mh v[104:107],v[214:215],v[184:185],v[104:107]
pm v[78:79],v[78:79],v[230:231] op_sel:[0,1] op_sel_hi:[1,1]
cv v238,v76,v77
cv v239,v78,v79
mm v[108:111],v[214:217],v[188:191],v[108:111]
w4 v[236:239],v28,s[8:11],s52 offen offset:256 sc1
pm v[80:81],v[80:81],v[230:231] op_sel:[0,0] op_sel_hi:[1,0]
pm v[82:83],v[82:83],v[230:231] op_sel:[0,0] op_sel_hi:[1,0]
mh v[112:115],a[92:93],v[186:187],0
cv v240,v80,v81
cv v241,v82,v83
pm v[88:89],v[88:89],v[230:231] op_sel:[0,0] op_sel_hi:[1,0]
mh v[116:119],a[92:93],v[192:193],0
pm v[90:91],v[90:91],v[230:231] op_sel:[0,0] op_sel_hi:[1,0]
cv v242,v88,v89
cv v243,v90,v91
mh v[112:115],v[218:219],v[184:185],v[112:115]
w4 v[240:243],v28,s[8:11],s52 offen offset:2048 sc1
pm v[84:85],v[84:85],v[230:231] op_sel:[0,1] op_sel_hi:[1,1]
pm v[86:87],v[86:87],v[230:231] op_sel:[0,1] op_sel_hi:[1,1]
mm v[116:119],v[218:221],v[188:191],v[116:119]
cv v244,v84,v85
cv v245,v86,v87
pm v[92:93],v[92:93],v[230:231] op_sel:[0,1] op_sel_hi:[1,1]
mh v[120:123],a[94:95],v[186:187],0
pm v[94:95],v[94:95],v[230:231] op_sel:[0,1] op_sel_hi:[1,1]
cv v246,v92,v93
cv v247,v94,v95
mh v[124:127],a[94:95],v[192:193],0
w4 v[244:247],v28,s[8:11],s52 offen offset:2304 sc1
s_add_u32 s52,s48,85995520
s_xor_b32 s52,s52,s53
pm v[96:97],v[96:97],v[230:231] op_sel:[0,0] op_sel_hi:[1,0]
mh v[120:123],v[222:223],v[184:185],v[120:123]
pm v[98:99],v[98:99],v[230:231] op_sel:[0,0] op_sel_hi:[1,0]
cv v232,v96,v97
cv v233,v98,v99
mm v[124:127],v[222:225],v[188:191],v[124:127]
pm v[104:105],v[104:105],v[230:231] op_sel:[0,0] op_sel_hi:[1,0]
pm v[106:107],v[106:107],v[230:231] op_sel:[0,0] op_sel_hi:[1,0]
cv v234,v104,v105
cv v235,v106,v107
w4 v[232:235],v28,s[8:11],s52 offen sc1
pm v[100:101],v[100:101],v[230:231] op_sel:[0,1] op_sel_hi:[1,1]
pm v[102:103],v[102:103],v[230:231] op_sel:[0,1] op_sel_hi:[1,1]
cv v236,v100,v101
cv v237,v102,v103
pm v[108:109],v[108:109],v[230:231] op_sel:[0,1] op_sel_hi:[1,1]
pm v[110:111],v[110:111],v[230:231] op_sel:[0,1] op_sel_hi:[1,1]
cv v238,v108,v109
cv v239,v110,v111
w4 v[236:239],v28,s[8:11],s52 offen offset:256 sc1
pm v[112:113],v[112:113],v[230:231] op_sel:[0,0] op_sel_hi:[1,0]
pm v[114:115],v[114:115],v[230:231] op_sel:[0,0] op_sel_hi:[1,0]
cv v240,v112,v113
cv v241,v114,v115
pm v[120:121],v[120:121],v[230:231] op_sel:[0,0] op_sel_hi:[1,0]
pm v[122:123],v[122:123],v[230:231] op_sel:[0,0] op_sel_hi:[1,0]
cv v242,v120,v121
cv v243,v122,v123
w4 v[240:243],v28,s[8:11],s52 offen offset:2048 sc1
pm v[116:117],v[116:117],v[230:231] op_sel:[0,1] op_sel_hi:[1,1]
pm v[118:119],v[118:119],v[230:231] op_sel:[0,1] op_sel_hi:[1,1]
cv v244,v116,v117
cv v245,v118,v119
pm v[124:125],v[124:125],v[230:231] op_sel:[0,1] op_sel_hi:[1,1]
pm v[126:127],v[126:127],v[230:231] op_sel:[0,1] op_sel_hi:[1,1]
cv v246,v124,v125
cv v247,v126,v127
w4 v[244:247],v28,s[8:11],s52 offen offset:2304 sc1
s_mov_b32 s90,s91
s_cmp_lt_u32 s91,s23
s_cbranch_scc0 GA_end
s_cmp_lg_u32 s93,0
s_cbranch_scc1 GA_it1
wt vmcnt(0) lgkmcnt(0)
buffer_atomic_add v41,v40,s[8:11],s94 offen sc1
s_mov_b32 s94,0x40000000
GA_late0:
s_add_u32 s52,s91,2
s_cmp_ge_u32 s59,16
s_cselect_b32 s49,99,s58
s_cmp_ge_u32 s49,s52
s_cbranch_scc1 GA_go0
s_cmp_eq_u32 s15,0
s_cbranch_scc1 GA_go0
s_sleep 4
s_buffer_load_dword s58,s[8:11],s95 glc
s_buffer_load_dword s59,s[8:11],s95 offset:2048 glc
s_sub_u32 s15,s15,1
wt lgkmcnt(0)
s_branch GA_late0
GA_go0:
s_lshl_b32 s97,s91,16
s_lshl_b32 s49,s92,11
s_add_u32 s97,s97,s49
s_add_u32 s52,s97,8388608
l4 a[160:163],v34,s[8:11],s52 offen sc1
l4 a[164:167],v34,s[8:11],s52 offen offset:512 sc1
l4 a[168:171],v34,s[8:11],s52 offen offset:1024 sc1
l4 a[172:175],v34,s[8:11],s52 offen offset:1536 sc1
s_add_u32 s52,s97,12582912
buffer_load_dwordx2 a[176:177],v35,s[8:11],s52 offen sc1
buffer_load_dwordx2 a[178:179],v35,s[8:11],s52 offen offset:64 sc1
buffer_load_dwordx2 a[180:181],v35,s[8:11],s52 offen offset:512 sc1
buffer_load_dwordx2 a[182:183],v35,s[8:11],s52 offen offset:576 sc1
buffer_load_dwordx2 a[184:185],v35,s[8:11],s52 offen offset:1024 sc1
buffer_load_dwordx2 a[186:187],v35,s[8:11],s52 offen offset:1088 sc1
buffer_load_dwordx2 a[188:189],v35,s[8:11],s52 offen offset:1536 sc1
buffer_load_dwordx2 a[190:191],v35,s[8:11],s52 offen offset:1600 sc1
wt vmcnt(0)
s_branch GA_it1
GA_it1:
wt vmcnt(8) lgkmcnt(0)
dt v[194:195],v36 offset:8192
dt v[196:197],v36 offset:8448
dt v[198:199],v36 offset:8200
dt v[200:201],v36 offset:8456
dt v[202:203],v36 offset:10240
dt v[204:205],v36 offset:10496
dt v[206:207],v36 offset:10248
dt v[208:209],v36 offset:10504
dt v[210:211],v36 offset:12288
dt v[212:213],v36 offset:12544
dt v[214:215],v36 offset:12296
dt v[216:217],v36 offset:12552
dt v[218:219],v36 offset:14336
dt v[220:221],v36 offset:14592
dt v[222:223],v36 offset:14344
dt v[224:225],v36 offset:14600
s_add_u32 s91,s90,s27
s_lshl_b32 s96,s91,19
s_and_b32 s49,s96,0xffe00000
s_add_u32 s96,s96,s49
s_lshl_b32 s49,s92,14
s_add_u32 s96,s96,s49
s_lshl_b32 s97,s91,16
s_lshl_b32 s49,s92,11
s_add_u32 s97,s97,s49
s_add_u32 s52,s91,2
s_cmp_ge_u32 s59,16
s_cselect_b32 s49,99,s58
s_cmp_ge_u32 s49,s52
s_cselect_b32 s93,s91,0
s_cselect_b32 s97,s97,0x40000000
s_cmp_lt_u32 s91,s23
s_cselect_b32 s96,s96,0x40000000
s_cselect_b32 s97,s97,0x40000000
mm v[160:163],a[160:163],a[96:99],0
mm v[164:167],a[128:131],a[96:99],0
s_add_u32 s52,s96,83886080
s_add_u32 s53,s96,16777216
s_xor_b32 s52,s52,s7
s_xor_b32 s53,s53,s7
l4 a[0:3],v28,s[8:11],s52 offen sc1
mm v[172:175],a[160:163],a[112:115],0
mm v[176:179],a[128:131],a[112:115],0
l4 a[32:35],v28,s[8:11],s53 offen sc1
mm v[180:183],a[144:147],a[112:115],0
mm v[160:163],a[164:167],a[100:103],v[160:163]
l4 a[16:19],v28,s[8:11],s52 offen offset:256 sc1
mm v[164:167],a[132:135],a[100:103],v[164:167]
mm v[172:175],a[164:167],a[116:119],v[172:175]
l4 a[48:51],v28,s[8:11],s53 offen offset:256 sc1
mm v[176:179],a[132:135],a[116:119],v[176:179]
mm v[180:183],a[148:151],a[116:119],v[180:183]
l4 a[4:7],v28,s[8:11],s52 offen offset:2048 sc1
mm v[160:163],a[168:171],a[104:107],v[160:163]
mm v[164:167],a[136:139],a[104:107],v[164:167]
l4 a[36:39],v28,s[8:11],s53 offen offset:2048 sc1
mm v[172:175],a[168:171],a[120:123],v[172:175]
mm v[176:179],a[136:139],a[120:123],v[176:179]
l4 a[20:23],v28,s[8:11],s52 offen offset:2304 sc1
mm v[180:183],a[152:155],a[120:123],v[180:183]
mm v[160:163],a[172:175],a[108:111],v[160:163]
l4 a[52:55],v28,s[8:11],s53 offen offset:2304 sc1
mm v[164:167],a[140:143],a[108:111],v[164:167]
mm v[172:175],a[172:175],a[124:127],v[172:175]
s_add_u32 s52,s96,83890176
s_add_u32 s53,s96,16781312
s_xor_b32 s52,s52,s7
s_xor_b32 s53,s53,s7
l4 a[8:11],v28,s[8:11],s52 offen sc1
mm v[176:179],a[140:143],a[124:127],v[176:179]
mm v[180:183],a[156:159],a[124:127],v[180:183]
l4 a[40:43],v28,s[8:11],s53 offen sc1
v_cndmask_b32 v160,v37,v160,s[54:55]
v_cndmask_b32 v161,v37,v161,s[54:55]
v_cndmask_b32 v162,v37,v162,s[54:55]
v_cndmask_b32 v163,v37,v163,s[54:55]
v_cndmask_b32 v164,v37,v164,s[82:83]
v_cndmask_b32 v165,v37,v165,s[84:85]
v_cndmask_b32 v166,v37,v166,s[86:87]
v_cndmask_b32 v167,v37,v167,s[88:89]
l4 a[24:27],v28,s[8:11],s52 offen offset:256 sc1
v_cndmask_b32 v172,v37,v172,s[54:55]
v_cndmask_b32 v173,v37,v173,s[54:55]
v_cndmask_b32 v174,v37,v174,s[54:55]
v_cndmask_b32 v175,v37,v175,s[54:55]
v_cndmask_b32 v180,v37,v180,s[82:83]
v_cndmask_b32 v181,v37,v181,s[84:85]
v_cndmask_b32 v182,v37,v182,s[86:87]
v_cndmask_b32 v183,v37,v183,s[88:89]
l4 a[56:59],v28,s[8:11],s53 offen offset:256 sc1
v_max3_f32 v226,v160,v161,v162
v_max3_f32 v226,v226,v163,v164
v_max3_f32 v226,v226,v165,v166
v_max_f32 v226,v226,v167
v_max3_f32 v227,v172,v173,v174
v_max3_f32 v227,v227,v175,v176
v_max3_f32 v227,v227,v177,v178
l4 a[12:15],v28,s[8:11],s52 offen offset:2048 sc1
v_max3_f32 v227,v227,v179,v180
v_max3_f32 v227,v227,v181,v182
v_max_f32 v227,v227,v183
v_mov_b32 v228,v226
v_mov_b32 v229,v227
s_nop 0
v_permlane16_swap_b32 v226,v228
v_permlane16_swap_b32 v227,v229
l4 a[44:47],v28,s[8:11],s53 offen offset:2048 sc1
v_max_f32 v226,v226,v228
v_max_f32 v227,v227,v229
v_mov_b32 v228,v226
v_mov_b32 v229,v227
s_nop 0
v_permlane32_swap_b32 v226,v228
v_permlane32_swap_b32 v227,v229
l4 a[28:31],v28,s[8:11],s52 offen offset:2304 sc1
v_max_f32 v226,v226,v228
v_max_f32 v227,v227,v229
pa v[160:161],v[160:161],v[226:227] op_sel:[0,0] op_sel_hi:[1,0] neg_lo:[0,1] neg_hi:[0,1]
pa v[162:163],v[162:163],v[226:227] op_sel:[0,0] op_sel_hi:[1,0] neg_lo:[0,1] neg_hi:[0,1]
pa v[164:165],v[164:165],v[226:227] op_sel:[0,0] op_sel_hi:[1,0] neg_lo:[0,1] neg_hi:[0,1]
pa v[166:167],v[166:167],v[226:227] op_sel:[0,0] op_sel_hi:[1,0] neg_lo:[0,1] neg_hi:[0,1]
pm v[160:161],v[160:161],s[56:57] op_sel_hi:[1,0]
l4 a[60:63],v28,s[8:11],s53 offen offset:2304 sc1
pm v[162:163],v[162:163],s[56:57] op_sel_hi:[1,0]
pm v[164:165],v[164:165],s[56:57] op_sel_hi:[1,0]
pm v[166:167],v[166:167],s[56:57] op_sel_hi:[1,0]
v_exp_f32 v160,v160
v_exp_f32 v161,v161
v_exp_f32 v162,v162
s_add_u32 m0,s51,0
s_add_u32 s52,s96,18882560
s_xor_b32 s52,s52,s7
l4 v33,s[8:11],s52 offen sc1 lds
v_exp_f32 v163,v163
v_exp_f32 v164,v164
v_exp_f32 v165,v165
v_exp_f32 v166,v166
l4 v33,s[8:11],s52 offen offset:1024 sc1 lds
v_exp_f32 v167,v167
pa v[172:173],v[172:173],v[226:227] op_sel:[0,1] op_sel_hi:[1,1] neg_lo:[0,1] neg_hi:[0,1]
pa v[174:175],v[174:175],v[226:227] op_sel:[0,1] op_sel_hi:[1,1] neg_lo:[0,1] neg_hi:[0,1]
pa v[176:177],v[176:177],v[226:227] op_sel:[0,1] op_sel_hi:[1,1] neg_lo:[0,1] neg_hi:[0,1]
pa v[178:179],v[178:179],v[226:227] op_sel:[0,1] op_sel_hi:[1,1] neg_lo:[0,1] neg_hi:[0,1]
pa v[180:181],v[180:181],v[226:227] op_sel:[0,1] op_sel_hi:[1,1] neg_lo:[0,1] neg_hi:[0,1]
l4 v33,s[8:11],s52 offen offset:2048 sc1 lds
pa v[182:183],v[182:183],v[226:227] op_sel:[0,1] op_sel_hi:[1,1] neg_lo:[0,1] neg_hi:[0,1]
pm v[172:173],v[172:173],s[56:57] op_sel_hi:[1,0]
pm v[174:175],v[174:175],s[56:57] op_sel_hi:[1,0]
pm v[176:177],v[176:177],s[56:57] op_sel_hi:[1,0]
pm v[178:179],v[178:179],s[56:57] op_sel_hi:[1,0]
pm v[180:181],v[180:181],s[56:57] op_sel_hi:[1,0]
pm v[182:183],v[182:183],s[56:57] op_sel_hi:[1,0]
v_exp_f32 v172,v172
l4 v33,s[8:11],s52 offen offset:3072 sc1 lds
v_exp_f32 v173,v173
v_exp_f32 v174,v174
v_exp_f32 v175,v175
v_exp_f32 v176,v176
s_add_u32 m0,s51,4096
s_add_u32 s52,s96,18886656
s_xor_b32 s52,s52,s7
l4 v33,s[8:11],s52 offen sc1 lds
v_exp_f32 v177,v177
v_exp_f32 v178,v178
v_exp_f32 v179,v179
v_exp_f32 v180,v180
l4 v33,s[8:11],s52 offen offset:1024 sc1 lds
v_exp_f32 v181,v181
v_exp_f32 v182,v182
v_exp_f32 v183,v183
cv v186,v160,v161
l4 v33,s[8:11],s52 offen offset:2048 sc1 lds
cv v187,v162,v163
cv v184,v164,v165
cv v185,v166,v167
cv v192,v172,v173
cv v193,v174,v175
cv v188,v176,v177
cv v189,v178,v179
cv v190,v180,v181
l4 v33,s[8:11],s52 offen offset:3072 sc1 lds
cv v191,v182,v183
pa v[160:161],v[160:161],v[162:163]
pa v[160:161],v[160:161],v[164:165]
pa v[160:161],v[160:161],v[166:167]
v_add_f32 v230,v160,v161
pa v[172:173],v[172:173],v[174:175]
pa v[172:173],v[172:173],v[176:177]
s_add_u32 s52,s97,8388608
l4 a[64:67],v34,s[8:11],s52 offen sc1
pa v[172:173],v[172:173],v[178:179]
pa v[172:173],v[172:173],v[180:181]
pa v[172:173],v[172:173],v[182:183]
v_add_f32 v231,v172,v173
wt lgkmcnt(0)
s_buffer_load_dword s58,s[8:11],s95 glc
s_buffer_load_dword s59,s[8:11],s95 offset:2048 glc
mh v[64:67],a[176:177],v[186:187],0
v_mov_b32 v228,v230
l4 a[68:71],v34,s[8:11],s52 offen offset:512 sc1
v_mov_b32 v229,v231
mh v[68:71],a[176:177],v[192:193],0
v_permlane16_swap_b32 v230,v228
l4 a[72:75],v34,s[8:11],s52 offen offset:1024 sc1
v_permlane16_swap_b32 v231,v229
mh v[64:67],v[194:195],v[184:185],v[64:67]
v_add_f32 v230,v230,v228
l4 a[76:79],v34,s[8:11],s52 offen offset:1536 sc1
v_add_f32 v231,v231,v229
mm v[68:71],v[194:197],v[188:191],v[68:71]
v_mov_b32 v228,v230
s_add_u32 s52,s97,12582912
buffer_load_dwordx2 a[80:81],v35,s[8:11],s52 offen sc1
v_mov_b32 v229,v231
mh v[72:75],a[178:179],v[186:187],0
v_permlane32_swap_b32 v230,v228
buffer_load_dwordx2 a[82:83],v35,s[8:11],s52 offen offset:64 sc1
v_permlane32_swap_b32 v231,v229
mh v[76:79],a[178:179],v[192:193],0
v_add_f32 v230,v230,v228
buffer_load_dwordx2 a[84:85],v35,s[8:11],s52 offen offset:512 sc1
v_add_f32 v231,v231,v229
mh v[72:75],v[198:199],v[184:185],v[72:75]
v_rcp_f32 v230,v230
buffer_load_dwordx2 a[86:87],v35,s[8:11],s52 offen offset:576 sc1
v_rcp_f32 v231,v231
mm v[76:79],v[198:201],v[188:191],v[76:79]
buffer_load_dwordx2 a[88:89],v35,s[8:11],s52 offen offset:1024 sc1
buffer_load_dwordx2 a[90:91],v35,s[8:11],s52 offen offset:1088 sc1
buffer_load_dwordx2 a[92:93],v35,s[8:11],s52 offen offset:1536 sc1
mh v[80:83],a[180:181],v[186:187],0
buffer_load_dwordx2 a[94:95],v35,s[8:11],s52 offen offset:1600 sc1
wt vmcnt(36)
buffer_atomic_add v41,v40,s[8:11],s94 offen sc1
s_lshl_b32 s48,s90,19
mh v[84:87],a[180:181],v[192:193],0
s_and_b32 s49,s48,0xffe00000
s_add_u32 s48,s48,s49
s_lshl_b32 s49,s92,14
mh v[80:83],v[202:203],v[184:185],v[80:83]
s_add_u32 s48,s48,s49
s_and_b32 s49,s90,2
s_lshl_b32 s49,s49,13
mm v[84:87],v[202:205],v[188:191],v[84:87]
s_and_b32 s53,s90,1
s_lshl_b32 s53,s53,12
s_or_b32 s53,s53,s49
mh v[88:91],a[182:183],v[186:187],0
s_xor_b32 s53,s53,s7
s_lshl_b32 s49,s90,2
s_lshl_b32 s50,s22,8
mh v[92:95],a[182:183],v[192:193],0
s_add_u32 s49,s49,s50
s_add_u32 s49,s49,4210688
s_lshr_b32 s50,s90,2
mh v[88:91],v[206:207],v[184:185],v[88:91]
s_lshl_b32 s50,s50,8
s_add_u32 s50,s50,4206592
v_writelane_b32 v40,s49,0
mm v[92:95],v[206:209],v[188:191],v[92:95]
v_writelane_b32 v40,s50,1
s_lshr_b32 s50,s90,1
s_lshl_b32 s50,s50,8
mh v[96:99],a[184:185],v[186:187],0
s_add_u32 s50,s50,4218880
v_writelane_b32 v40,s50,2
s_mov_b32 s94,0
mh v[100:103],a[184:185],v[192:193],0
s_add_u32 s52,s48,85991424
s_xor_b32 s52,s52,s53
pm v[64:65],v[64:65],v[230:231] op_sel:[0,0] op_sel_hi:[1,0]
pm v[66:67],v[66:67],v[230:231] op_sel:[0,0] op_sel_hi:[1,0]
mh v[96:99],v[210:211],v[184:185],v[96:99]
cv v232,v64,v65
cv v233,v66,v67
pm v[72:73],v[72:73],v[230:231] op_sel:[0,0] op_sel_hi:[1,0]
mm v[100:103],v[210:213],v[188:191],v[100:103]
pm v[74:75],v[74:75],v[230:231] op_sel:[0,0] op_sel_hi:[1,0]
cv v234,v72,v73
cv v235,v74,v75
mh v[104:107],a[186:187],v[186:187],0
w4 v[232:235],v28,s[8:11],s52 offen sc1
pm v[68:69],v[68:69],v[230:231] op_sel:[0,1] op_sel_hi:[1,1]
pm v[70:71],v[70:71],v[230:231] op_sel:[0,1] op_sel_hi:[1,1]
mh v[108:111],a[186:187],v[192:193],0
cv v236,v68,v69
cv v237,v70,v71
pm v[76:77],v[76:77],v[230:231] op_sel:[0,1] op_sel_hi:[1,1]
mh v[104:107],v[214:215],v[184:185],v[104:107]
pm v[78:79],v[78:79],v[230:231] op_sel:[0,1] op_sel_hi:[1,1]
cv v238,v76,v77
cv v239,v78,v79
mm v[108:111],v[214:217],v[188:191],v[108:111]
w4 v[236:239],v28,s[8:11],s52 offen offset:256 sc1
pm v[80:81],v[80:81],v[230:231] op_sel:[0,0] op_sel_hi:[1,0]
pm v[82:83],v[82:83],v[230:231] op_sel:[0,0] op_sel_hi:[1,0]
mh v[112:115],a[188:189],v[186:187],0
cv v240,v80,v81
cv v241,v82,v83
pm v[88:89],v[88:89],v[230:231] op_sel:[0,0] op_sel_hi:[1,0]
mh v[116:119],a[188:189],v[192:193],0
pm v[90:91],v[90:91],v[230:231] op_sel:[0,0] op_sel_hi:[1,0]
cv v242,v88,v89
cv v243,v90,v91
mh v[112:115],v[218:219],v[184:185],v[112:115]
w4 v[240:243],v28,s[8:11],s52 offen offset:2048 sc1
pm v[84:85],v[84:85],v[230:231] op_sel:[0,1] op_sel_hi:[1,1]
pm v[86:87],v[86:87],v[230:231] op_sel:[0,1] op_sel_hi:[1,1]
mm v[116:119],v[218:221],v[188:191],v[116:119]
cv v244,v84,v85
cv v245,v86,v87
pm v[92:93],v[92:93],v[230:231] op_sel:[0,1] op_sel_hi:[1,1]
mh v[120:123],a[190:191],v[186:187],0
pm v[94:95],v[94:95],v[230:231] op_sel:[0,1] op_sel_hi:[1,1]
cv v246,v92,v93
cv v247,v94,v95
mh v[124:127],a[190:191],v[192:193],0
w4 v[244:247],v28,s[8:11],s52 offen offset:2304 sc1
s_add_u32 s52,s48,85995520
s_xor_b32 s52,s52,s53
pm v[96:97],v[96:97],v[230:231] op_sel:[0,0] op_sel_hi:[1,0]
mh v[120:123],v[222:223],v[184:185],v[120:123]
pm v[98:99],v[98:99],v[230:231] op_sel:[0,0] op_sel_hi:[1,0]
cv v232,v96,v97
cv v233,v98,v99
mm v[124:127],v[222:225],v[188:191],v[124:127]
pm v[104:105],v[104:105],v[230:231] op_sel:[0,0] op_sel_hi:[1,0]
pm v[106:107],v[106:107],v[230:231] op_sel:[0,0] op_sel_hi:[1,0]
cv v234,v104,v105
cv v235,v106,v107
w4 v[232:235],v28,s[8:11],s52 offen sc1
pm v[100:101],v[100:101],v[230:231] op_sel:[0,1] op_sel_hi:[1,1]
pm v[102:103],v[102:103],v[230:231] op_sel:[0,1] op_sel_hi:[1,1]
cv v236,v100,v101
cv v237,v102,v103
pm v[108:109],v[108:109],v[230:231] op_sel:[0,1] op_sel_hi:[1,1]
pm v[110:111],v[110:111],v[230:231] op_sel:[0,1] op_sel_hi:[1,1]
cv v238,v108,v109
cv v239,v110,v111
w4 v[236:239],v28,s[8:11],s52 offen offset:256 sc1
pm v[112:113],v[112:113],v[230:231] op_sel:[0,0] op_sel_hi:[1,0]
pm v[114:115],v[114:115],v[230:231] op_sel:[0,0] op_sel_hi:[1,0]
cv v240,v112,v113
cv v241,v114,v115
pm v[120:121],v[120:121],v[230:231] op_sel:[0,0] op_sel_hi:[1,0]
pm v[122:123],v[122:123],v[230:231] op_sel:[0,0] op_sel_hi:[1,0]
cv v242,v120,v121
cv v243,v122,v123
w4 v[240:243],v28,s[8:11],s52 offen offset:2048 sc1
pm v[116:117],v[116:117],v[230:231] op_sel:[0,1] op_sel_hi:[1,1]
pm v[118:119],v[118:119],v[230:231] op_sel:[0,1] op_sel_hi:[1,1]
cv v244,v116,v117
cv v245,v118,v119
pm v[124:125],v[124:125],v[230:231] op_sel:[0,1] op_sel_hi:[1,1]
pm v[126:127],v[126:127],v[230:231] op_sel:[0,1] op_sel_hi:[1,1]
cv v246,v124,v125
cv v247,v126,v127
w4 v[244:247],v28,s[8:11],s52 offen offset:2304 sc1
s_mov_b32 s90,s91
s_cmp_lt_u32 s91,s23
s_cbranch_scc0 GA_end
s_cmp_lg_u32 s93,0
s_cbranch_scc1 GA_it0
wt vmcnt(0) lgkmcnt(0)
buffer_atomic_add v41,v40,s[8:11],s94 offen sc1
s_mov_b32 s94,0x40000000
GA_late1:
s_add_u32 s52,s91,2
s_cmp_ge_u32 s59,16
s_cselect_b32 s49,99,s58
s_cmp_ge_u32 s49,s52
s_cbranch_scc1 GA_go1
s_cmp_eq_u32 s15,0
s_cbranch_scc1 GA_go1
s_sleep 4
s_buffer_load_dword s58,s[8:11],s95 glc
s_buffer_load_dword s59,s[8:11],s95 offset:2048 glc
s_sub_u32 s15,s15,1
wt lgkmcnt(0)
s_branch GA_late1
GA_go1:
s_lshl_b32 s97,s91,16
s_lshl_b32 s49,s92,11
s_add_u32 s97,s97,s49
s_add_u32 s52,s97,8388608
l4 a[64:67],v34,s[8:11],s52 offen sc1
l4 a[68:71],v34,s[8:11],s52 offen offset:512 sc1
l4 a[72:75],v34,s[8:11],s52 offen offset:1024 sc1
l4 a[76:79],v34,s[8:11],s52 offen offset:1536 sc1
s_add_u32 s52,s97,12582912
buffer_load_dwordx2 a[80:81],v35,s[8:11],s52 offen sc1
buffer_load_dwordx2 a[82:83],v35,s[8:11],s52 offen offset:64 sc1
buffer_load_dwordx2 a[84:85],v35,s[8:11],s52 offen offset:512 sc1
buffer_load_dwordx2 a[86:87],v35,s[8:11],s52 offen offset:576 sc1
buffer_load_dwordx2 a[88:89],v35,s[8:11],s52 offen offset:1024 sc1
buffer_load_dwordx2 a[90:91],v35,s[8:11],s52 offen offset:1088 sc1
buffer_load_dwordx2 a[92:93],v35,s[8:11],s52 offen offset:1536 sc1
buffer_load_dwordx2 a[94:95],v35,s[8:11],s52 offen offset:1600 sc1
wt vmcnt(0)
s_branch GA_it0
GA_end:
wt vmcnt(0) lgkmcnt(0)
buffer_atomic_add v41,v40,s[8:11],s94 offen sc1
s_branch G_next
G_g3:
s_mov_b32 s34,0x800000
s_mov_b32 s57,0x80000
s_cmp_eq_u32 s27,0
s_cselect_b64 s[32:33],s[74:75],s[68:69]
s_cselect_b32 s34,0x200000,s34
s_cselect_b32 s42,4,16
s_cselect_b32 s57,0x20000,s57
s_mov_b32 s47,2048
s_cmp_eq_u32 s27,2
s_cselect_b64 s[32:33],s[8:9],s[32:33]
s_cselect_b32 s34,s10,s34
s_cselect_b32 s47,512,s47
s_lshl_b32 s48,s14,4
v_bfe_u32 v30,v1,4,2
v_add_u32 v30,s48,v30
v_mul_lo_u32 v30,v30,s47
v_bfe_u32 v31,v1,0,1
v_lshlrev_b32 v31,4,v31
v_add_u32 v30,v30,v31
v_bfe_u32 v31,v1,1,3
v_bfe_u32 v32,v1,4,2
v_xor_b32 v31,v31,v32
v_xor_b32 v32,0,v31
v_lshl_add_u32 v32,v32,5,v30
s_mul_i32 s48,s47,0
s_sub_u32 s48,s48,0
v_add_u32 v10,s48,v32
v_xor_b32 v32,4,v31
v_lshl_add_u32 v32,v32,5,v30
s_mul_i32 s48,s47,4
s_sub_u32 s48,s48,1024
v_add_u32 v11,s48,v32
v_xor_b32 v32,0,v31
v_lshl_add_u32 v32,v32,5,v30
s_mul_i32 s48,s47,8
s_sub_u32 s48,s48,2048
v_add_u32 v12,s48,v32
v_xor_b32 v32,4,v31
v_lshl_add_u32 v32,v32,5,v30
s_mul_i32 s48,s47,12
s_sub_u32 s48,s48,3072
v_add_u32 v13,s48,v32
s_lshl_b32 s46,s47,6
s_mul_i32 s44,s14,4096
s_add_u32 s44,s44,65536
v_bfe_u32 v30,v1,4,2
v_lshlrev_b32 v30,10,v30
v_bfe_u32 v32,v1,2,2
v_lshl_add_u32 v30,v32,8,v30
v_bfe_u32 v32,v1,0,2
v_lshl_add_u32 v30,v32,3,v30
v_add_u32 v30,65536,v30
v_bfe_u32 v31,v1,2,2
v_bfe_u32 v32,v1,4,1
v_lshl_add_u32 v31,v32,2,v31
s_mul_i32 s48,s77,4
v_xor_b32 v31,s48,v31
v_xor_b32 v32,0,v31
v_lshl_add_u32 v20,v32,5,v30
v_xor_b32 v32,1,v31
v_lshl_add_u32 v21,v32,5,v30
v_xor_b32 v32,2,v31
v_lshl_add_u32 v22,v32,5,v30
v_xor_b32 v32,3,v31
v_lshl_add_u32 v23,v32,5,v30
s_cmp_eq_u32 s20,7
s_cbranch_scc1 G_g3s
s_mul_i32 s43,s14,4096
s_mul_i32 s48,s14,s57
v_bfe_u32 v2,v1,0,6
v_lshlrev_b32 v2,4,v2
v_add_u32 v2,s48,v2
s_mul_i32 s48,s76,8192
v_add_u32 v18,s48,v28
s_and_b32 s49,s14,2
s_lshl_b32 s49,s49,13
s_and_b32 s45,s14,1
s_lshl_b32 s45,s45,12
s_or_b32 s45,s45,s49
s_xor_b32 s45,s45,s7
s_barrier
s_add_u32 m0,s43,0
s_xor_b32 s79,s40,s45
l4 v2,s[8:11],s79 offen sc1 lds
l4 v2,s[8:11],s79 offen offset:1024 sc1 lds
l4 v2,s[8:11],s79 offen offset:2048 sc1 lds
l4 v2,s[8:11],s79 offen offset:3072 sc1 lds
s_add_u32 s40,s40,4096
s_add_u32 m0,s44,0
s_nop 0
l4 v10,s[32:35],s41 offen sc1 lds
l4 v11,s[32:35],s41 offen offset:1024 sc1 lds
l4 v12,s[32:35],s41 offen offset:2048 sc1 lds
l4 v13,s[32:35],s41 offen offset:3072 sc1 lds
s_add_u32 s41,s41,s46
s_add_u32 m0,s43,16384
s_xor_b32 s79,s40,s45
l4 v2,s[8:11],s79 offen sc1 lds
l4 v2,s[8:11],s79 offen offset:1024 sc1 lds
l4 v2,s[8:11],s79 offen offset:2048 sc1 lds
l4 v2,s[8:11],s79 offen offset:3072 sc1 lds
s_add_u32 s40,s40,12288
s_add_u32 m0,s44,16384
s_nop 0
l4 v10,s[32:35],s41 offen sc1 lds
l4 v11,s[32:35],s41 offen offset:1024 sc1 lds
l4 v12,s[32:35],s41 offen offset:2048 sc1 lds
l4 v13,s[32:35],s41 offen offset:3072 sc1 lds
s_add_u32 s41,s41,s46
s_add_u32 m0,s43,32768
s_xor_b32 s79,s40,s45
l4 v2,s[8:11],s79 offen sc1 lds
l4 v2,s[8:11],s79 offen offset:1024 sc1 lds
l4 v2,s[8:11],s79 offen offset:2048 sc1 lds
l4 v2,s[8:11],s79 offen offset:3072 sc1 lds
s_add_u32 s40,s40,4096
s_add_u32 m0,s44,32768
s_nop 0
l4 v10,s[32:35],s41 offen sc1 lds
l4 v11,s[32:35],s41 offen offset:1024 sc1 lds
l4 v12,s[32:35],s41 offen offset:2048 sc1 lds
l4 v13,s[32:35],s41 offen offset:3072 sc1 lds
s_add_u32 s41,s41,s46
s_add_u32 m0,s43,49152
s_xor_b32 s79,s40,s45
l4 v2,s[8:11],s79 offen sc1 lds
l4 v2,s[8:11],s79 offen offset:1024 sc1 lds
l4 v2,s[8:11],s79 offen offset:2048 sc1 lds
l4 v2,s[8:11],s79 offen offset:3072 sc1 lds
s_add_u32 s40,s40,12288
s_add_u32 m0,s44,49152
s_nop 0
l4 v10,s[32:35],s41 offen sc1 lds
l4 v11,s[32:35],s41 offen offset:1024 sc1 lds
l4 v12,s[32:35],s41 offen offset:2048 sc1 lds
l4 v13,s[32:35],s41 offen offset:3072 sc1 lds
s_add_u32 s41,s41,s46
s_mov_b64 s[90:91],s[20:21]
s_mov_b64 s[92:93],s[22:23]
s_mov_b64 s[94:95],s[24:25]
s_mov_b64 s[96:97],s[26:27]
s_load_dwordx8 s[20:27],s[18:19],0
s_add_u32 s18,s18,32
s_addc_u32 s19,s19,0
wt vmcnt(24)
s_barrier
s_cmp_eq_u32 s14,0
s_cselect_b32 s48,s101,0
s_cmp_eq_u32 s48,0
s_cbranch_scc1 G3_ls
v_mul_u32_u24 v30,2048,v1
v_mov_b32 v31,s48
s_mov_b64 exec,3
buffer_atomic_add v31,v30,s[8:11],s100 offen sc1
s_mov_b64 exec,-1
G3_ls:
s_mov_b32 s101,0
dt v[96:97],v20 offset:0
dt v[98:99],v20 offset:4096
dr v[64:67],v18 offset:0
dt v[100:101],v21 offset:0
dt v[102:103],v21 offset:4096
dr v[68:71],v18 offset:256
dt v[104:105],v22 offset:0
dt v[106:107],v22 offset:4096
dr v[72:75],v18 offset:4096
dt v[108:109],v23 offset:0
dt v[110:111],v23 offset:4096
dr v[76:79],v18 offset:4352
wt lgkmcnt(0)
mm a[0:3],v[96:99],v[64:67],0
dt v[160:161],v20 offset:8192
mm a[4:7],v[100:103],v[64:67],0
dt v[162:163],v20 offset:12288
mm a[8:11],v[104:107],v[64:67],0
dr v[128:131],v18 offset:2048
mm a[12:15],v[108:111],v[64:67],0
dt v[164:165],v21 offset:8192
mm a[28:31],v[108:111],v[68:71],0
dt v[166:167],v21 offset:12288
mm a[24:27],v[104:107],v[68:71],0
dr v[132:135],v18 offset:2304
mm a[20:23],v[100:103],v[68:71],0
dt v[168:169],v22 offset:8192
mm a[16:19],v[96:99],v[68:71],0
dt v[170:171],v22 offset:12288
mm a[32:35],v[96:99],v[72:75],0
dr v[136:139],v18 offset:6144
mm a[36:39],v[100:103],v[72:75],0
dt v[172:173],v23 offset:8192
mm a[40:43],v[104:107],v[72:75],0
dt v[174:175],v23 offset:12288
mm a[44:47],v[108:111],v[72:75],0
dr v[140:143],v18 offset:6400
mm a[60:63],v[108:111],v[76:79],0
mm a[56:59],v[104:107],v[76:79],0
mm a[52:55],v[100:103],v[76:79],0
mm a[48:51],v[96:99],v[76:79],0
wt vmcnt(16) lgkmcnt(0)
s_barrier
mm a[0:3],v[160:163],v[128:131],a[0:3]
dt v[96:97],v20 offset:16384
mm a[4:7],v[164:167],v[128:131],a[4:7]
dt v[98:99],v20 offset:20480
s_add_u32 m0,s43,0
s_xor_b32 s79,s40,s45
l4 v2,s[8:11],s79 offen sc1 lds
mm a[8:11],v[168:171],v[128:131],a[8:11]
dr v[64:67],v18 offset:16384
mm a[12:15],v[172:175],v[128:131],a[12:15]
dt v[100:101],v21 offset:16384
mm a[28:31],v[172:175],v[132:135],a[28:31]
dt v[102:103],v21 offset:20480
l4 v2,s[8:11],s79 offen offset:1024 sc1 lds
mm a[24:27],v[168:171],v[132:135],a[24:27]
dr v[68:71],v18 offset:16640
mm a[20:23],v[164:167],v[132:135],a[20:23]
dt v[104:105],v22 offset:16384
mm a[16:19],v[160:163],v[132:135],a[16:19]
dt v[106:107],v22 offset:20480
mm a[32:35],v[160:163],v[136:139],a[32:35]
dr v[72:75],v18 offset:20480
l4 v2,s[8:11],s79 offen offset:2048 sc1 lds
mm a[36:39],v[164:167],v[136:139],a[36:39]
dt v[108:109],v23 offset:16384
mm a[40:43],v[168:171],v[136:139],a[40:43]
dt v[110:111],v23 offset:20480
mm a[44:47],v[172:175],v[136:139],a[44:47]
dr v[76:79],v18 offset:20736
l4 v2,s[8:11],s79 offen offset:3072 sc1 lds
s_add_u32 s40,s40,4096
mm a[60:63],v[172:175],v[140:143],a[60:63]
mm a[56:59],v[168:171],v[140:143],a[56:59]
mm a[52:55],v[164:167],v[140:143],a[52:55]
mm a[48:51],v[160:163],v[140:143],a[48:51]
wt lgkmcnt(0)
mm a[0:3],v[96:99],v[64:67],a[0:3]
dt v[160:161],v20 offset:24576
mm a[4:7],v[100:103],v[64:67],a[4:7]
dt v[162:163],v20 offset:28672
s_add_u32 m0,s44,0
s_nop 0
l4 v10,s[32:35],s41 offen sc1 lds
mm a[8:11],v[104:107],v[64:67],a[8:11]
dr v[128:131],v18 offset:18432
mm a[12:15],v[108:111],v[64:67],a[12:15]
dt v[164:165],v21 offset:24576
mm a[28:31],v[108:111],v[68:71],a[28:31]
dt v[166:167],v21 offset:28672
l4 v11,s[32:35],s41 offen offset:1024 sc1 lds
mm a[24:27],v[104:107],v[68:71],a[24:27]
dr v[132:135],v18 offset:18688
mm a[20:23],v[100:103],v[68:71],a[20:23]
dt v[168:169],v22 offset:24576
mm a[16:19],v[96:99],v[68:71],a[16:19]
dt v[170:171],v22 offset:28672
mm a[32:35],v[96:99],v[72:75],a[32:35]
dr v[136:139],v18 offset:22528
l4 v12,s[32:35],s41 offen offset:2048 sc1 lds
mm a[36:39],v[100:103],v[72:75],a[36:39]
dt v[172:173],v23 offset:24576
mm a[40:43],v[104:107],v[72:75],a[40:43]
dt v[174:175],v23 offset:28672
mm a[44:47],v[108:111],v[72:75],a[44:47]
dr v[140:143],v18 offset:22784
l4 v13,s[32:35],s41 offen offset:3072 sc1 lds
s_add_u32 s41,s41,s46
mm a[60:63],v[108:111],v[76:79],a[60:63]
mm a[56:59],v[104:107],v[76:79],a[56:59]
mm a[52:55],v[100:103],v[76:79],a[52:55]
mm a[48:51],v[96:99],v[76:79],a[48:51]
wt vmcnt(16) lgkmcnt(0)
s_barrier
mm a[0:3],v[160:163],v[128:131],a[0:3]
dt v[96:97],v20 offset:32768
mm a[4:7],v[164:167],v[128:131],a[4:7]
dt v[98:99],v20 offset:36864
s_add_u32 m0,s43,16384
s_xor_b32 s79,s40,s45
l4 v2,s[8:11],s79 offen sc1 lds
mm a[8:11],v[168:171],v[128:131],a[8:11]
dr v[64:67],v18 offset:32768
mm a[12:15],v[172:175],v[128:131],a[12:15]
dt v[100:101],v21 offset:32768
mm a[28:31],v[172:175],v[132:135],a[28:31]
dt v[102:103],v21 offset:36864
l4 v2,s[8:11],s79 offen offset:1024 sc1 lds
mm a[24:27],v[168:171],v[132:135],a[24:27]
dr v[68:71],v18 offset:33024
mm a[20:23],v[164:167],v[132:135],a[20:23]
dt v[104:105],v22 offset:32768
mm a[16:19],v[160:163],v[132:135],a[16:19]
dt v[106:107],v22 offset:36864
mm a[32:35],v[160:163],v[136:139],a[32:35]
dr v[72:75],v18 offset:36864
l4 v2,s[8:11],s79 offen offset:2048 sc1 lds
mm a[36:39],v[164:167],v[136:139],a[36:39]
dt v[108:109],v23 offset:32768
mm a[40:43],v[168:171],v[136:139],a[40:43]
dt v[110:111],v23 offset:36864
mm a[44:47],v[172:175],v[136:139],a[44:47]
dr v[76:79],v18 offset:37120
l4 v2,s[8:11],s79 offen offset:3072 sc1 lds
s_add_u32 s40,s40,12288
mm a[60:63],v[172:175],v[140:143],a[60:63]
mm a[56:59],v[168:171],v[140:143],a[56:59]
mm a[52:55],v[164:167],v[140:143],a[52:55]
mm a[48:51],v[160:163],v[140:143],a[48:51]
wt lgkmcnt(0)
mm a[0:3],v[96:99],v[64:67],a[0:3]
dt v[160:161],v20 offset:40960
mm a[4:7],v[100:103],v[64:67],a[4:7]
dt v[162:163],v20 offset:45056
s_add_u32 m0,s44,16384
s_nop 0
l4 v10,s[32:35],s41 offen sc1 lds
mm a[8:11],v[104:107],v[64:67],a[8:11]
dr v[128:131],v18 offset:34816
mm a[12:15],v[108:111],v[64:67],a[12:15]
dt v[164:165],v21 offset:40960
mm a[28:31],v[108:111],v[68:71],a[28:31]
dt v[166:167],v21 offset:45056
l4 v11,s[32:35],s41 offen offset:1024 sc1 lds
mm a[24:27],v[104:107],v[68:71],a[24:27]
dr v[132:135],v18 offset:35072
mm a[20:23],v[100:103],v[68:71],a[20:23]
dt v[168:169],v22 offset:40960
mm a[16:19],v[96:99],v[68:71],a[16:19]
dt v[170:171],v22 offset:45056
mm a[32:35],v[96:99],v[72:75],a[32:35]
dr v[136:139],v18 offset:38912
l4 v12,s[32:35],s41 offen offset:2048 sc1 lds
mm a[36:39],v[100:103],v[72:75],a[36:39]
dt v[172:173],v23 offset:40960
mm a[40:43],v[104:107],v[72:75],a[40:43]
dt v[174:175],v23 offset:45056
mm a[44:47],v[108:111],v[72:75],a[44:47]
dr v[140:143],v18 offset:39168
l4 v13,s[32:35],s41 offen offset:3072 sc1 lds
s_add_u32 s41,s41,s46
mm a[60:63],v[108:111],v[76:79],a[60:63]
mm a[56:59],v[104:107],v[76:79],a[56:59]
mm a[52:55],v[100:103],v[76:79],a[52:55]
mm a[48:51],v[96:99],v[76:79],a[48:51]
wt vmcnt(16) lgkmcnt(0)
s_barrier
mm a[0:3],v[160:163],v[128:131],a[0:3]
dt v[96:97],v20 offset:49152
mm a[4:7],v[164:167],v[128:131],a[4:7]
dt v[98:99],v20 offset:53248
s_add_u32 m0,s43,32768
s_xor_b32 s79,s40,s45
l4 v2,s[8:11],s79 offen sc1 lds
mm a[8:11],v[168:171],v[128:131],a[8:11]
dr v[64:67],v18 offset:49152
mm a[12:15],v[172:175],v[128:131],a[12:15]
dt v[100:101],v21 offset:49152
mm a[28:31],v[172:175],v[132:135],a[28:31]
dt v[102:103],v21 offset:53248
l4 v2,s[8:11],s79 offen offset:1024 sc1 lds
mm a[24:27],v[168:171],v[132:135],a[24:27]
dr v[68:71],v18 offset:49408
mm a[20:23],v[164:167],v[132:135],a[20:23]
dt v[104:105],v22 offset:49152
mm a[16:19],v[160:163],v[132:135],a[16:19]
dt v[106:107],v22 offset:53248
mm a[32:35],v[160:163],v[136:139],a[32:35]
dr v[72:75],v18 offset:53248
l4 v2,s[8:11],s79 offen offset:2048 sc1 lds
mm a[36:39],v[164:167],v[136:139],a[36:39]
dt v[108:109],v23 offset:49152
mm a[40:43],v[168:171],v[136:139],a[40:43]
dt v[110:111],v23 offset:53248
mm a[44:47],v[172:175],v[136:139],a[44:47]
dr v[76:79],v18 offset:53504
l4 v2,s[8:11],s79 offen offset:3072 sc1 lds
s_add_u32 s40,s40,4096
mm a[60:63],v[172:175],v[140:143],a[60:63]
mm a[56:59],v[168:171],v[140:143],a[56:59]
mm a[52:55],v[164:167],v[140:143],a[52:55]
mm a[48:51],v[160:163],v[140:143],a[48:51]
wt lgkmcnt(0)
mm a[0:3],v[96:99],v[64:67],a[0:3]
dt v[160:161],v20 offset:57344
mm a[4:7],v[100:103],v[64:67],a[4:7]
dt v[162:163],v20 offset:61440
s_add_u32 m0,s44,32768
s_nop 0
l4 v10,s[32:35],s41 offen sc1 lds
mm a[8:11],v[104:107],v[64:67],a[8:11]
dr v[128:131],v18 offset:51200
mm a[12:15],v[108:111],v[64:67],a[12:15]
dt v[164:165],v21 offset:57344
mm a[28:31],v[108:111],v[68:71],a[28:31]
dt v[166:167],v21 offset:61440
l4 v11,s[32:35],s41 offen offset:1024 sc1 lds
mm a[24:27],v[104:107],v[68:71],a[24:27]
dr v[132:135],v18 offset:51456
mm a[20:23],v[100:103],v[68:71],a[20:23]
dt v[168:169],v22 offset:57344
mm a[16:19],v[96:99],v[68:71],a[16:19]
dt v[170:171],v22 offset:61440
mm a[32:35],v[96:99],v[72:75],a[32:35]
dr v[136:139],v18 offset:55296
l4 v12,s[32:35],s41 offen offset:2048 sc1 lds
mm a[36:39],v[100:103],v[72:75],a[36:39]
dt v[172:173],v23 offset:57344
mm a[40:43],v[104:107],v[72:75],a[40:43]
dt v[174:175],v23 offset:61440
mm a[44:47],v[108:111],v[72:75],a[44:47]
dr v[140:143],v18 offset:55552
l4 v13,s[32:35],s41 offen offset:3072 sc1 lds
s_add_u32 s41,s41,s46
mm a[60:63],v[108:111],v[76:79],a[60:63]
mm a[56:59],v[104:107],v[76:79],a[56:59]
mm a[52:55],v[100:103],v[76:79],a[52:55]
mm a[48:51],v[96:99],v[76:79],a[48:51]
wt vmcnt(16) lgkmcnt(0)
s_barrier
mm a[0:3],v[160:163],v[128:131],a[0:3]
dt v[96:97],v20 offset:0
mm a[4:7],v[164:167],v[128:131],a[4:7]
dt v[98:99],v20 offset:4096
s_add_u32 m0,s43,49152
s_xor_b32 s79,s40,s45
l4 v2,s[8:11],s79 offen sc1 lds
mm a[8:11],v[168:171],v[128:131],a[8:11]
dr v[64:67],v18 offset:0
mm a[12:15],v[172:175],v[128:131],a[12:15]
dt v[100:101],v21 offset:0
mm a[28:31],v[172:175],v[132:135],a[28:31]
dt v[102:103],v21 offset:4096
l4 v2,s[8:11],s79 offen offset:1024 sc1 lds
mm a[24:27],v[168:171],v[132:135],a[24:27]
dr v[68:71],v18 offset:256
mm a[20:23],v[164:167],v[132:135],a[20:23]
dt v[104:105],v22 offset:0
mm a[16:19],v[160:163],v[132:135],a[16:19]
dt v[106:107],v22 offset:4096
mm a[32:35],v[160:163],v[136:139],a[32:35]
dr v[72:75],v18 offset:4096
l4 v2,s[8:11],s79 offen offset:2048 sc1 lds
mm a[36:39],v[164:167],v[136:139],a[36:39]
dt v[108:109],v23 offset:0
mm a[40:43],v[168:171],v[136:139],a[40:43]
dt v[110:111],v23 offset:4096
mm a[44:47],v[172:175],v[136:139],a[44:47]
dr v[76:79],v18 offset:4352
l4 v2,s[8:11],s79 offen offset:3072 sc1 lds
s_add_u32 s40,s40,12288
mm a[60:63],v[172:175],v[140:143],a[60:63]
mm a[56:59],v[168:171],v[140:143],a[56:59]
mm a[52:55],v[164:167],v[140:143],a[52:55]
mm a[48:51],v[160:163],v[140:143],a[48:51]
wt lgkmcnt(0)
s_sub_u32 s42,s42,2
G3_k:
mm a[0:3],v[96:99],v[64:67],a[0:3]
dt v[160:161],v20 offset:8192
mm a[4:7],v[100:103],v[64:67],a[4:7]
dt v[162:163],v20 offset:12288
s_add_u32 m0,s44,49152
s_nop 0
l4 v10,s[32:35],s41 offen sc1 lds
mm a[8:11],v[104:107],v[64:67],a[8:11]
dr v[128:131],v18 offset:2048
mm a[12:15],v[108:111],v[64:67],a[12:15]
dt v[164:165],v21 offset:8192
mm a[28:31],v[108:111],v[68:71],a[28:31]
dt v[166:167],v21 offset:12288
l4 v11,s[32:35],s41 offen offset:1024 sc1 lds
mm a[24:27],v[104:107],v[68:71],a[24:27]
dr v[132:135],v18 offset:2304
mm a[20:23],v[100:103],v[68:71],a[20:23]
dt v[168:169],v22 offset:8192
mm a[16:19],v[96:99],v[68:71],a[16:19]
dt v[170:171],v22 offset:12288
mm a[32:35],v[96:99],v[72:75],a[32:35]
dr v[136:139],v18 offset:6144
l4 v12,s[32:35],s41 offen offset:2048 sc1 lds
mm a[36:39],v[100:103],v[72:75],a[36:39]
dt v[172:173],v23 offset:8192
mm a[40:43],v[104:107],v[72:75],a[40:43]
dt v[174:175],v23 offset:12288
mm a[44:47],v[108:111],v[72:75],a[44:47]
dr v[140:143],v18 offset:6400
l4 v13,s[32:35],s41 offen offset:3072 sc1 lds
s_add_u32 s41,s41,s46
mm a[60:63],v[108:111],v[76:79],a[60:63]
mm a[56:59],v[104:107],v[76:79],a[56:59]
mm a[52:55],v[100:103],v[76:79],a[52:55]
mm a[48:51],v[96:99],v[76:79],a[48:51]
wt vmcnt(16) lgkmcnt(0)
s_barrier
mm a[0:3],v[160:163],v[128:131],a[0:3]
dt v[96:97],v20 offset:16384
mm a[4:7],v[164:167],v[128:131],a[4:7]
dt v[98:99],v20 offset:20480
s_add_u32 m0,s43,0
s_xor_b32 s79,s40,s45
l4 v2,s[8:11],s79 offen sc1 lds
mm a[8:11],v[168:171],v[128:131],a[8:11]
dr v[64:67],v18 offset:16384
mm a[12:15],v[172:175],v[128:131],a[12:15]
dt v[100:101],v21 offset:16384
mm a[28:31],v[172:175],v[132:135],a[28:31]
dt v[102:103],v21 offset:20480
l4 v2,s[8:11],s79 offen offset:1024 sc1 lds
mm a[24:27],v[168:171],v[132:135],a[24:27]
dr v[68:71],v18 offset:16640
mm a[20:23],v[164:167],v[132:135],a[20:23]
dt v[104:105],v22 offset:16384
mm a[16:19],v[160:163],v[132:135],a[16:19]
dt v[106:107],v22 offset:20480
mm a[32:35],v[160:163],v[136:139],a[32:35]
dr v[72:75],v18 offset:20480
l4 v2,s[8:11],s79 offen offset:2048 sc1 lds
mm a[36:39],v[164:167],v[136:139],a[36:39]
dt v[108:109],v23 offset:16384
mm a[40:43],v[168:171],v[136:139],a[40:43]
dt v[110:111],v23 offset:20480
mm a[44:47],v[172:175],v[136:139],a[44:47]
dr v[76:79],v18 offset:20736
l4 v2,s[8:11],s79 offen offset:3072 sc1 lds
s_add_u32 s40,s40,4096
mm a[60:63],v[172:175],v[140:143],a[60:63]
mm a[56:59],v[168:171],v[140:143],a[56:59]
mm a[52:55],v[164:167],v[140:143],a[52:55]
mm a[48:51],v[160:163],v[140:143],a[48:51]
wt lgkmcnt(0)
mm a[0:3],v[96:99],v[64:67],a[0:3]
dt v[160:161],v20 offset:24576
mm a[4:7],v[100:103],v[64:67],a[4:7]
dt v[162:163],v20 offset:28672
s_add_u32 m0,s44,0
s_nop 0
l4 v10,s[32:35],s41 offen sc1 lds
mm a[8:11],v[104:107],v[64:67],a[8:11]
dr v[128:131],v18 offset:18432
mm a[12:15],v[108:111],v[64:67],a[12:15]
dt v[164:165],v21 offset:24576
mm a[28:31],v[108:111],v[68:71],a[28:31]
dt v[166:167],v21 offset:28672
l4 v11,s[32:35],s41 offen offset:1024 sc1 lds
mm a[24:27],v[104:107],v[68:71],a[24:27]
dr v[132:135],v18 offset:18688
mm a[20:23],v[100:103],v[68:71],a[20:23]
dt v[168:169],v22 offset:24576
mm a[16:19],v[96:99],v[68:71],a[16:19]
dt v[170:171],v22 offset:28672
mm a[32:35],v[96:99],v[72:75],a[32:35]
dr v[136:139],v18 offset:22528
l4 v12,s[32:35],s41 offen offset:2048 sc1 lds
mm a[36:39],v[100:103],v[72:75],a[36:39]
dt v[172:173],v23 offset:24576
mm a[40:43],v[104:107],v[72:75],a[40:43]
dt v[174:175],v23 offset:28672
mm a[44:47],v[108:111],v[72:75],a[44:47]
dr v[140:143],v18 offset:22784
l4 v13,s[32:35],s41 offen offset:3072 sc1 lds
s_add_u32 s41,s41,s46
mm a[60:63],v[108:111],v[76:79],a[60:63]
mm a[56:59],v[104:107],v[76:79],a[56:59]
mm a[52:55],v[100:103],v[76:79],a[52:55]
mm a[48:51],v[96:99],v[76:79],a[48:51]
wt vmcnt(16) lgkmcnt(0)
s_barrier
mm a[0:3],v[160:163],v[128:131],a[0:3]
dt v[96:97],v20 offset:32768
mm a[4:7],v[164:167],v[128:131],a[4:7]
dt v[98:99],v20 offset:36864
s_add_u32 m0,s43,16384
s_xor_b32 s79,s40,s45
l4 v2,s[8:11],s79 offen sc1 lds
mm a[8:11],v[168:171],v[128:131],a[8:11]
dr v[64:67],v18 offset:32768
mm a[12:15],v[172:175],v[128:131],a[12:15]
dt v[100:101],v21 offset:32768
mm a[28:31],v[172:175],v[132:135],a[28:31]
dt v[102:103],v21 offset:36864
l4 v2,s[8:11],s79 offen offset:1024 sc1 lds
mm a[24:27],v[168:171],v[132:135],a[24:27]
dr v[68:71],v18 offset:33024
mm a[20:23],v[164:167],v[132:135],a[20:23]
dt v[104:105],v22 offset:32768
mm a[16:19],v[160:163],v[132:135],a[16:19]
dt v[106:107],v22 offset:36864
mm a[32:35],v[160:163],v[136:139],a[32:35]
dr v[72:75],v18 offset:36864
l4 v2,s[8:11],s79 offen offset:2048 sc1 lds
mm a[36:39],v[164:167],v[136:139],a[36:39]
dt v[108:109],v23 offset:32768
mm a[40:43],v[168:171],v[136:139],a[40:43]
dt v[110:111],v23 offset:36864
mm a[44:47],v[172:175],v[136:139],a[44:47]
dr v[76:79],v18 offset:37120
l4 v2,s[8:11],s79 offen offset:3072 sc1 lds
s_add_u32 s40,s40,12288
mm a[60:63],v[172:175],v[140:143],a[60:63]
mm a[56:59],v[168:171],v[140:143],a[56:59]
mm a[52:55],v[164:167],v[140:143],a[52:55]
mm a[48:51],v[160:163],v[140:143],a[48:51]
wt lgkmcnt(0)
mm a[0:3],v[96:99],v[64:67],a[0:3]
dt v[160:161],v20 offset:40960
mm a[4:7],v[100:103],v[64:67],a[4:7]
dt v[162:163],v20 offset:45056
s_add_u32 m0,s44,16384
s_nop 0
l4 v10,s[32:35],s41 offen sc1 lds
mm a[8:11],v[104:107],v[64:67],a[8:11]
dr v[128:131],v18 offset:34816
mm a[12:15],v[108:111],v[64:67],a[12:15]
dt v[164:165],v21 offset:40960
mm a[28:31],v[108:111],v[68:71],a[28:31]
dt v[166:167],v21 offset:45056
l4 v11,s[32:35],s41 offen offset:1024 sc1 lds
mm a[24:27],v[104:107],v[68:71],a[24:27]
dr v[132:135],v18 offset:35072
mm a[20:23],v[100:103],v[68:71],a[20:23]
dt v[168:169],v22 offset:40960
mm a[16:19],v[96:99],v[68:71],a[16:19]
dt v[170:171],v22 offset:45056
mm a[32:35],v[96:99],v[72:75],a[32:35]
dr v[136:139],v18 offset:38912
l4 v12,s[32:35],s41 offen offset:2048 sc1 lds
mm a[36:39],v[100:103],v[72:75],a[36:39]
dt v[172:173],v23 offset:40960
mm a[40:43],v[104:107],v[72:75],a[40:43]
dt v[174:175],v23 offset:45056
mm a[44:47],v[108:111],v[72:75],a[44:47]
dr v[140:143],v18 offset:39168
l4 v13,s[32:35],s41 offen offset:3072 sc1 lds
s_add_u32 s41,s41,s46
mm a[60:63],v[108:111],v[76:79],a[60:63]
mm a[56:59],v[104:107],v[76:79],a[56:59]
mm a[52:55],v[100:103],v[76:79],a[52:55]
mm a[48:51],v[96:99],v[76:79],a[48:51]
wt vmcnt(16) lgkmcnt(0)
s_barrier
mm a[0:3],v[160:163],v[128:131],a[0:3]
dt v[96:97],v20 offset:49152
mm a[4:7],v[164:167],v[128:131],a[4:7]
dt v[98:99],v20 offset:53248
s_add_u32 m0,s43,32768
s_xor_b32 s79,s40,s45
l4 v2,s[8:11],s79 offen sc1 lds
mm a[8:11],v[168:171],v[128:131],a[8:11]
dr v[64:67],v18 offset:49152
mm a[12:15],v[172:175],v[128:131],a[12:15]
dt v[100:101],v21 offset:49152
mm a[28:31],v[172:175],v[132:135],a[28:31]
dt v[102:103],v21 offset:53248
l4 v2,s[8:11],s79 offen offset:1024 sc1 lds
mm a[24:27],v[168:171],v[132:135],a[24:27]
dr v[68:71],v18 offset:49408
mm a[20:23],v[164:167],v[132:135],a[20:23]
dt v[104:105],v22 offset:49152
mm a[16:19],v[160:163],v[132:135],a[16:19]
dt v[106:107],v22 offset:53248
mm a[32:35],v[160:163],v[136:139],a[32:35]
dr v[72:75],v18 offset:53248
l4 v2,s[8:11],s79 offen offset:2048 sc1 lds
mm a[36:39],v[164:167],v[136:139],a[36:39]
dt v[108:109],v23 offset:49152
mm a[40:43],v[168:171],v[136:139],a[40:43]
dt v[110:111],v23 offset:53248
mm a[44:47],v[172:175],v[136:139],a[44:47]
dr v[76:79],v18 offset:53504
l4 v2,s[8:11],s79 offen offset:3072 sc1 lds
s_add_u32 s40,s40,4096
mm a[60:63],v[172:175],v[140:143],a[60:63]
mm a[56:59],v[168:171],v[140:143],a[56:59]
mm a[52:55],v[164:167],v[140:143],a[52:55]
mm a[48:51],v[160:163],v[140:143],a[48:51]
wt lgkmcnt(0)
mm a[0:3],v[96:99],v[64:67],a[0:3]
dt v[160:161],v20 offset:57344
mm a[4:7],v[100:103],v[64:67],a[4:7]
dt v[162:163],v20 offset:61440
s_add_u32 m0,s44,32768
s_nop 0
l4 v10,s[32:35],s41 offen sc1 lds
mm a[8:11],v[104:107],v[64:67],a[8:11]
dr v[128:131],v18 offset:51200
mm a[12:15],v[108:111],v[64:67],a[12:15]
dt v[164:165],v21 offset:57344
mm a[28:31],v[108:111],v[68:71],a[28:31]
dt v[166:167],v21 offset:61440
l4 v11,s[32:35],s41 offen offset:1024 sc1 lds
mm a[24:27],v[104:107],v[68:71],a[24:27]
dr v[132:135],v18 offset:51456
mm a[20:23],v[100:103],v[68:71],a[20:23]
dt v[168:169],v22 offset:57344
mm a[16:19],v[96:99],v[68:71],a[16:19]
dt v[170:171],v22 offset:61440
mm a[32:35],v[96:99],v[72:75],a[32:35]
dr v[136:139],v18 offset:55296
l4 v12,s[32:35],s41 offen offset:2048 sc1 lds
mm a[36:39],v[100:103],v[72:75],a[36:39]
dt v[172:173],v23 offset:57344
mm a[40:43],v[104:107],v[72:75],a[40:43]
dt v[174:175],v23 offset:61440
mm a[44:47],v[108:111],v[72:75],a[44:47]
dr v[140:143],v18 offset:55552
l4 v13,s[32:35],s41 offen offset:3072 sc1 lds
s_add_u32 s41,s41,s46
mm a[60:63],v[108:111],v[76:79],a[60:63]
mm a[56:59],v[104:107],v[76:79],a[56:59]
mm a[52:55],v[100:103],v[76:79],a[52:55]
mm a[48:51],v[96:99],v[76:79],a[48:51]
wt vmcnt(16) lgkmcnt(0)
s_barrier
mm a[0:3],v[160:163],v[128:131],a[0:3]
dt v[96:97],v20 offset:0
mm a[4:7],v[164:167],v[128:131],a[4:7]
dt v[98:99],v20 offset:4096
s_add_u32 m0,s43,49152
s_xor_b32 s79,s40,s45
l4 v2,s[8:11],s79 offen sc1 lds
mm a[8:11],v[168:171],v[128:131],a[8:11]
dr v[64:67],v18 offset:0
mm a[12:15],v[172:175],v[128:131],a[12:15]
dt v[100:101],v21 offset:0
mm a[28:31],v[172:175],v[132:135],a[28:31]
dt v[102:103],v21 offset:4096
l4 v2,s[8:11],s79 offen offset:1024 sc1 lds
mm a[24:27],v[168:171],v[132:135],a[24:27]
dr v[68:71],v18 offset:256
mm a[20:23],v[164:167],v[132:135],a[20:23]
dt v[104:105],v22 offset:0
mm a[16:19],v[160:163],v[132:135],a[16:19]
dt v[106:107],v22 offset:4096
mm a[32:35],v[160:163],v[136:139],a[32:35]
dr v[72:75],v18 offset:4096
l4 v2,s[8:11],s79 offen offset:2048 sc1 lds
mm a[36:39],v[164:167],v[136:139],a[36:39]
dt v[108:109],v23 offset:0
mm a[40:43],v[168:171],v[136:139],a[40:43]
dt v[110:111],v23 offset:4096
mm a[44:47],v[172:175],v[136:139],a[44:47]
dr v[76:79],v18 offset:4352
l4 v2,s[8:11],s79 offen offset:3072 sc1 lds
s_add_u32 s40,s40,12288
mm a[60:63],v[172:175],v[140:143],a[60:63]
mm a[56:59],v[168:171],v[140:143],a[56:59]
mm a[52:55],v[164:167],v[140:143],a[52:55]
mm a[48:51],v[160:163],v[140:143],a[48:51]
wt lgkmcnt(0)
s_sub_u32 s42,s42,1
s_cmp_lg_u32 s42,0
s_cbranch_scc1 G3_k
mm a[0:3],v[96:99],v[64:67],a[0:3]
dt v[160:161],v20 offset:8192
mm a[4:7],v[100:103],v[64:67],a[4:7]
dt v[162:163],v20 offset:12288
s_add_u32 m0,s44,49152
s_nop 0
l4 v10,s[32:35],s41 offen sc1 lds
mm a[8:11],v[104:107],v[64:67],a[8:11]
dr v[128:131],v18 offset:2048
mm a[12:15],v[108:111],v[64:67],a[12:15]
dt v[164:165],v21 offset:8192
mm a[28:31],v[108:111],v[68:71],a[28:31]
dt v[166:167],v21 offset:12288
l4 v11,s[32:35],s41 offen offset:1024 sc1 lds
mm a[24:27],v[104:107],v[68:71],a[24:27]
dr v[132:135],v18 offset:2304
mm a[20:23],v[100:103],v[68:71],a[20:23]
dt v[168:169],v22 offset:8192
mm a[16:19],v[96:99],v[68:71],a[16:19]
dt v[170:171],v22 offset:12288
mm a[32:35],v[96:99],v[72:75],a[32:35]
dr v[136:139],v18 offset:6144
l4 v12,s[32:35],s41 offen offset:2048 sc1 lds
mm a[36:39],v[100:103],v[72:75],a[36:39]
dt v[172:173],v23 offset:8192
mm a[40:43],v[104:107],v[72:75],a[40:43]
dt v[174:175],v23 offset:12288
mm a[44:47],v[108:111],v[72:75],a[44:47]
dr v[140:143],v18 offset:6400
l4 v13,s[32:35],s41 offen offset:3072 sc1 lds
s_add_u32 s41,s41,s46
mm a[60:63],v[108:111],v[76:79],a[60:63]
mm a[56:59],v[104:107],v[76:79],a[56:59]
mm a[52:55],v[100:103],v[76:79],a[52:55]
mm a[48:51],v[96:99],v[76:79],a[48:51]
wt vmcnt(16) lgkmcnt(0)
s_barrier
mm a[0:3],v[160:163],v[128:131],a[0:3]
dt v[96:97],v20 offset:16384
mm a[4:7],v[164:167],v[128:131],a[4:7]
dt v[98:99],v20 offset:20480
mm a[8:11],v[168:171],v[128:131],a[8:11]
dr v[64:67],v18 offset:16384
mm a[12:15],v[172:175],v[128:131],a[12:15]
dt v[100:101],v21 offset:16384
mm a[28:31],v[172:175],v[132:135],a[28:31]
dt v[102:103],v21 offset:20480
mm a[24:27],v[168:171],v[132:135],a[24:27]
dr v[68:71],v18 offset:16640
mm a[20:23],v[164:167],v[132:135],a[20:23]
dt v[104:105],v22 offset:16384
mm a[16:19],v[160:163],v[132:135],a[16:19]
dt v[106:107],v22 offset:20480
mm a[32:35],v[160:163],v[136:139],a[32:35]
dr v[72:75],v18 offset:20480
mm a[36:39],v[164:167],v[136:139],a[36:39]
dt v[108:109],v23 offset:16384
mm a[40:43],v[168:171],v[136:139],a[40:43]
dt v[110:111],v23 offset:20480
mm a[44:47],v[172:175],v[136:139],a[44:47]
dr v[76:79],v18 offset:20736
mm a[60:63],v[172:175],v[140:143],a[60:63]
mm a[56:59],v[168:171],v[140:143],a[56:59]
mm a[52:55],v[164:167],v[140:143],a[52:55]
mm a[48:51],v[160:163],v[140:143],a[48:51]
wt lgkmcnt(0)
mm a[0:3],v[96:99],v[64:67],a[0:3]
dt v[160:161],v20 offset:24576
mm a[4:7],v[100:103],v[64:67],a[4:7]
dt v[162:163],v20 offset:28672
mm a[8:11],v[104:107],v[64:67],a[8:11]
dr v[128:131],v18 offset:18432
mm a[12:15],v[108:111],v[64:67],a[12:15]
dt v[164:165],v21 offset:24576
mm a[28:31],v[108:111],v[68:71],a[28:31]
dt v[166:167],v21 offset:28672
mm a[24:27],v[104:107],v[68:71],a[24:27]
dr v[132:135],v18 offset:18688
mm a[20:23],v[100:103],v[68:71],a[20:23]
dt v[168:169],v22 offset:24576
mm a[16:19],v[96:99],v[68:71],a[16:19]
dt v[170:171],v22 offset:28672
mm a[32:35],v[96:99],v[72:75],a[32:35]
dr v[136:139],v18 offset:22528
mm a[36:39],v[100:103],v[72:75],a[36:39]
dt v[172:173],v23 offset:24576
mm a[40:43],v[104:107],v[72:75],a[40:43]
dt v[174:175],v23 offset:28672
mm a[44:47],v[108:111],v[72:75],a[44:47]
dr v[140:143],v18 offset:22784
mm a[60:63],v[108:111],v[76:79],a[60:63]
mm a[56:59],v[104:107],v[76:79],a[56:59]
mm a[52:55],v[100:103],v[76:79],a[52:55]
mm a[48:51],v[96:99],v[76:79],a[48:51]
wt vmcnt(8) lgkmcnt(0)
s_barrier
mm a[0:3],v[160:163],v[128:131],a[0:3]
dt v[96:97],v20 offset:32768
mm a[4:7],v[164:167],v[128:131],a[4:7]
dt v[98:99],v20 offset:36864
mm a[8:11],v[168:171],v[128:131],a[8:11]
dr v[64:67],v18 offset:32768
mm a[12:15],v[172:175],v[128:131],a[12:15]
dt v[100:101],v21 offset:32768
mm a[28:31],v[172:175],v[132:135],a[28:31]
dt v[102:103],v21 offset:36864
mm a[24:27],v[168:171],v[132:135],a[24:27]
dr v[68:71],v18 offset:33024
mm a[20:23],v[164:167],v[132:135],a[20:23]
dt v[104:105],v22 offset:32768
mm a[16:19],v[160:163],v[132:135],a[16:19]
dt v[106:107],v22 offset:36864
mm a[32:35],v[160:163],v[136:139],a[32:35]
dr v[72:75],v18 offset:36864
mm a[36:39],v[164:167],v[136:139],a[36:39]
dt v[108:109],v23 offset:32768
mm a[40:43],v[168:171],v[136:139],a[40:43]
dt v[110:111],v23 offset:36864
mm a[44:47],v[172:175],v[136:139],a[44:47]
dr v[76:79],v18 offset:37120
mm a[60:63],v[172:175],v[140:143],a[60:63]
mm a[56:59],v[168:171],v[140:143],a[56:59]
mm a[52:55],v[164:167],v[140:143],a[52:55]
mm a[48:51],v[160:163],v[140:143],a[48:51]
wt lgkmcnt(0)
mm a[0:3],v[96:99],v[64:67],a[0:3]
dt v[160:161],v20 offset:40960
mm a[4:7],v[100:103],v[64:67],a[4:7]
dt v[162:163],v20 offset:45056
mm a[8:11],v[104:107],v[64:67],a[8:11]
dr v[128:131],v18 offset:34816
mm a[12:15],v[108:111],v[64:67],a[12:15]
dt v[164:165],v21 offset:40960
mm a[28:31],v[108:111],v[68:71],a[28:31]
dt v[166:167],v21 offset:45056
mm a[24:27],v[104:107],v[68:71],a[24:27]
dr v[132:135],v18 offset:35072
mm a[20:23],v[100:103],v[68:71],a[20:23]
dt v[168:169],v22 offset:40960
mm a[16:19],v[96:99],v[68:71],a[16:19]
dt v[170:171],v22 offset:45056
mm a[32:35],v[96:99],v[72:75],a[32:35]
dr v[136:139],v18 offset:38912
mm a[36:39],v[100:103],v[72:75],a[36:39]
dt v[172:173],v23 offset:40960
mm a[40:43],v[104:107],v[72:75],a[40:43]
dt v[174:175],v23 offset:45056
mm a[44:47],v[108:111],v[72:75],a[44:47]
dr v[140:143],v18 offset:39168
mm a[60:63],v[108:111],v[76:79],a[60:63]
mm a[56:59],v[104:107],v[76:79],a[56:59]
mm a[52:55],v[100:103],v[76:79],a[52:55]
mm a[48:51],v[96:99],v[76:79],a[48:51]
wt vmcnt(0) lgkmcnt(0)
s_barrier
mm a[0:3],v[160:163],v[128:131],a[0:3]
dt v[96:97],v20 offset:49152
mm a[4:7],v[164:167],v[128:131],a[4:7]
dt v[98:99],v20 offset:53248
mm a[8:11],v[168:171],v[128:131],a[8:11]
dr v[64:67],v18 offset:49152
mm a[12:15],v[172:175],v[128:131],a[12:15]
dt v[100:101],v21 offset:49152
mm a[28:31],v[172:175],v[132:135],a[28:31]
dt v[102:103],v21 offset:53248
mm a[24:27],v[168:171],v[132:135],a[24:27]
dr v[68:71],v18 offset:49408
mm a[20:23],v[164:167],v[132:135],a[20:23]
dt v[104:105],v22 offset:49152
mm a[16:19],v[160:163],v[132:135],a[16:19]
dt v[106:107],v22 offset:53248
mm a[32:35],v[160:163],v[136:139],a[32:35]
dr v[72:75],v18 offset:53248
mm a[36:39],v[164:167],v[136:139],a[36:39]
dt v[108:109],v23 offset:49152
mm a[40:43],v[168:171],v[136:139],a[40:43]
dt v[110:111],v23 offset:53248
mm a[44:47],v[172:175],v[136:139],a[44:47]
dr v[76:79],v18 offset:53504
mm a[60:63],v[172:175],v[140:143],a[60:63]
mm a[56:59],v[168:171],v[140:143],a[56:59]
mm a[52:55],v[164:167],v[140:143],a[52:55]
mm a[48:51],v[160:163],v[140:143],a[48:51]
wt lgkmcnt(0)
mm a[0:3],v[96:99],v[64:67],a[0:3]
dt v[160:161],v20 offset:57344
mm a[4:7],v[100:103],v[64:67],a[4:7]
dt v[162:163],v20 offset:61440
mm a[8:11],v[104:107],v[64:67],a[8:11]
dr v[128:131],v18 offset:51200
mm a[12:15],v[108:111],v[64:67],a[12:15]
dt v[164:165],v21 offset:57344
mm a[28:31],v[108:111],v[68:71],a[28:31]
dt v[166:167],v21 offset:61440
mm a[24:27],v[104:107],v[68:71],a[24:27]
dr v[132:135],v18 offset:51456
mm a[20:23],v[100:103],v[68:71],a[20:23]
dt v[168:169],v22 offset:57344
mm a[16:19],v[96:99],v[68:71],a[16:19]
dt v[170:171],v22 offset:61440
mm a[32:35],v[96:99],v[72:75],a[32:35]
dr v[136:139],v18 offset:55296
mm a[36:39],v[100:103],v[72:75],a[36:39]
dt v[172:173],v23 offset:57344
mm a[40:43],v[104:107],v[72:75],a[40:43]
dt v[174:175],v23 offset:61440
mm a[44:47],v[108:111],v[72:75],a[44:47]
dr v[140:143],v18 offset:55552
mm a[60:63],v[108:111],v[76:79],a[60:63]
mm a[56:59],v[104:107],v[76:79],a[56:59]
mm a[52:55],v[100:103],v[76:79],a[52:55]
mm a[48:51],v[96:99],v[76:79],a[48:51]
wt lgkmcnt(0)
mm a[0:3],v[160:163],v[128:131],a[0:3]
mm a[4:7],v[164:167],v[128:131],a[4:7]
mm a[8:11],v[168:171],v[128:131],a[8:11]
mm a[12:15],v[172:175],v[128:131],a[12:15]
mm a[28:31],v[172:175],v[132:135],a[28:31]
mm a[24:27],v[168:171],v[132:135],a[24:27]
mm a[20:23],v[164:167],v[132:135],a[20:23]
mm a[16:19],v[160:163],v[132:135],a[16:19]
mm a[32:35],v[160:163],v[136:139],a[32:35]
mm a[36:39],v[164:167],v[136:139],a[36:39]
mm a[40:43],v[168:171],v[136:139],a[40:43]
mm a[44:47],v[172:175],v[136:139],a[44:47]
mm a[60:63],v[172:175],v[140:143],a[60:63]
mm a[56:59],v[168:171],v[140:143],a[56:59]
mm a[52:55],v[164:167],v[140:143],a[52:55]
mm a[48:51],v[160:163],v[140:143],a[48:51]
v_mov_b32 v45,0
buffer_load_dword v44,v45,s[8:11],s24 offen sc1
v_bfe_u32 v30,v1,0,4
v_lshlrev_b32 v30,12,v30
v_bfe_u32 v31,v1,4,1
v_lshl_add_u32 v30,v31,5,v30
v_bfe_u32 v31,v1,5,1
v_lshl_add_u32 v30,v31,4,v30
s_mul_i32 s48,s76,262144
s_mul_i32 s49,s77,128
s_add_u32 s48,s48,s49
s_add_u32 s48,s48,s93
ar v192,a0
ar v193,a1
ar v194,a2
ar v195,a3
ar v196,a4
ar v197,a5
ar v198,a6
ar v199,a7
cv v200,v192,v193
cv v201,v194,v195
cv v202,v196,v197
cv v203,v198,v199
ar v204,a8
ar v205,a9
ar v206,a10
ar v207,a11
ar v208,a12
ar v209,a13
ar v210,a14
ar v211,a15
v_permlane16_swap_b32 v200,v202
v_permlane16_swap_b32 v201,v203
w4 v[200:203],v30,s[36:39],s48 offen sc1
cv v212,v204,v205
cv v213,v206,v207
cv v214,v208,v209
cv v215,v210,v211
ar v216,a16
ar v217,a17
ar v218,a18
ar v219,a19
ar v220,a20
ar v221,a21
ar v222,a22
ar v223,a23
v_permlane16_swap_b32 v212,v214
v_permlane16_swap_b32 v213,v215
w4 v[212:215],v30,s[36:39],s48 offen offset:64 sc1
s_add_u32 s48,s48,65536
cv v224,v216,v217
cv v225,v218,v219
cv v226,v220,v221
cv v227,v222,v223
ar v228,a24
ar v229,a25
ar v230,a26
ar v231,a27
ar v232,a28
ar v233,a29
ar v234,a30
ar v235,a31
v_permlane16_swap_b32 v224,v226
v_permlane16_swap_b32 v225,v227
w4 v[224:227],v30,s[36:39],s48 offen sc1
cv v236,v228,v229
cv v237,v230,v231
cv v238,v232,v233
cv v239,v234,v235
ar v192,a32
ar v193,a33
ar v194,a34
ar v195,a35
ar v196,a36
ar v197,a37
ar v198,a38
ar v199,a39
v_permlane16_swap_b32 v236,v238
v_permlane16_swap_b32 v237,v239
w4 v[236:239],v30,s[36:39],s48 offen offset:64 sc1
s_add_u32 s48,s48,65536
cv v200,v192,v193
cv v201,v194,v195
cv v202,v196,v197
cv v203,v198,v199
ar v204,a40
ar v205,a41
ar v206,a42
ar v207,a43
ar v208,a44
ar v209,a45
ar v210,a46
ar v211,a47
v_permlane16_swap_b32 v200,v202
v_permlane16_swap_b32 v201,v203
w4 v[200:203],v30,s[36:39],s48 offen sc1
cv v212,v204,v205
cv v213,v206,v207
cv v214,v208,v209
cv v215,v210,v211
ar v216,a48
ar v217,a49
ar v218,a50
ar v219,a51
ar v220,a52
ar v221,a53
ar v222,a54
ar v223,a55
v_permlane16_swap_b32 v212,v214
v_permlane16_swap_b32 v213,v215
w4 v[212:215],v30,s[36:39],s48 offen offset:64 sc1
s_add_u32 s48,s48,65536
cv v224,v216,v217
cv v225,v218,v219
cv v226,v220,v221
cv v227,v222,v223
ar v228,a56
ar v229,a57
ar v230,a58
ar v231,a59
ar v232,a60
ar v233,a61
ar v234,a62
ar v235,a63
v_permlane16_swap_b32 v224,v226
v_permlane16_swap_b32 v225,v227
w4 v[224:227],v30,s[36:39],s48 offen sc1
cv v236,v228,v229
cv v237,v230,v231
cv v238,v232,v233
cv v239,v234,v235
s_nop 0
v_permlane16_swap_b32 v236,v238
v_permlane16_swap_b32 v237,v239
w4 v[236:239],v30,s[36:39],s48 offen offset:64 sc1
s_add_u32 s48,s48,65536
wt vmcnt(8)
s_branch G_have
G_g3s:
s_mul_i32 s43,s14,2048
s_mul_i32 s48,s76,s57
s_lshl_b32 s49,s77,11
s_add_u32 s48,s48,s49
v_bfe_u32 v2,v1,0,6
v_lshlrev_b32 v2,4,v2
v_add_u32 v2,s48,v2
s_mul_i32 s48,s76,4096
v_add_u32 v18,s48,v28
s_bfe_u32 s48,s40,0x10014
s_lshl1_add_u32 s48,s48,s76
s_and_b32 s49,s48,2
s_lshl_b32 s49,s49,13
s_and_b32 s45,s48,1
s_lshl_b32 s45,s45,12
s_or_b32 s45,s45,s49
s_xor_b32 s45,s45,s7
s_barrier
s_add_u32 m0,s43,0
s_xor_b32 s79,s40,s45
l4 v2,s[8:11],s79 offen sc1 lds
l4 v2,s[8:11],s79 offen offset:1024 sc1 lds
s_add_u32 s40,s40,4096
s_add_u32 m0,s44,0
s_nop 0
l4 v10,s[32:35],s41 offen sc1 lds
l4 v11,s[32:35],s41 offen offset:1024 sc1 lds
l4 v12,s[32:35],s41 offen offset:2048 sc1 lds
l4 v13,s[32:35],s41 offen offset:3072 sc1 lds
s_add_u32 s41,s41,s46
s_add_u32 m0,s43,8192
s_xor_b32 s79,s40,s45
l4 v2,s[8:11],s79 offen sc1 lds
l4 v2,s[8:11],s79 offen offset:1024 sc1 lds
s_add_u32 s40,s40,12288
s_add_u32 m0,s44,16384
s_nop 0
l4 v10,s[32:35],s41 offen sc1 lds
l4 v11,s[32:35],s41 offen offset:1024 sc1 lds
l4 v12,s[32:35],s41 offen offset:2048 sc1 lds
l4 v13,s[32:35],s41 offen offset:3072 sc1 lds
s_add_u32 s41,s41,s46
s_add_u32 m0,s43,16384
s_xor_b32 s79,s40,s45
l4 v2,s[8:11],s79 offen sc1 lds
l4 v2,s[8:11],s79 offen offset:1024 sc1 lds
s_add_u32 s40,s40,4096
s_add_u32 m0,s44,32768
s_nop 0
l4 v10,s[32:35],s41 offen sc1 lds
l4 v11,s[32:35],s41 offen offset:1024 sc1 lds
l4 v12,s[32:35],s41 offen offset:2048 sc1 lds
l4 v13,s[32:35],s41 offen offset:3072 sc1 lds
s_add_u32 s41,s41,s46
s_add_u32 m0,s43,24576
s_xor_b32 s79,s40,s45
l4 v2,s[8:11],s79 offen sc1 lds
l4 v2,s[8:11],s79 offen offset:1024 sc1 lds
s_add_u32 s40,s40,12288
s_add_u32 m0,s44,49152
s_nop 0
l4 v10,s[32:35],s41 offen sc1 lds
l4 v11,s[32:35],s41 offen offset:1024 sc1 lds
l4 v12,s[32:35],s41 offen offset:2048 sc1 lds
l4 v13,s[32:35],s41 offen offset:3072 sc1 lds
s_add_u32 s41,s41,s46
s_mov_b64 s[90:91],s[20:21]
s_mov_b64 s[92:93],s[22:23]
s_mov_b64 s[94:95],s[24:25]
s_mov_b64 s[96:97],s[26:27]
s_load_dwordx8 s[20:27],s[18:19],0
s_add_u32 s18,s18,32
s_addc_u32 s19,s19,0
wt vmcnt(18)
s_barrier
dt v[96:97],v20 offset:0
dt v[98:99],v20 offset:4096
dr v[64:67],v18 offset:0
dt v[100:101],v21 offset:0
dt v[102:103],v21 offset:4096
dr v[68:71],v18 offset:256
dt v[104:105],v22 offset:0
dt v[106:107],v22 offset:4096
dt v[108:109],v23 offset:0
dt v[110:111],v23 offset:4096
wt lgkmcnt(0)
mm a[0:3],v[96:99],v[64:67],0
dt v[160:161],v20 offset:8192
dt v[162:163],v20 offset:12288
mm a[4:7],v[100:103],v[64:67],0
dr v[128:131],v18 offset:2048
dt v[164:165],v21 offset:8192
mm a[8:11],v[104:107],v[64:67],0
dt v[166:167],v21 offset:12288
dr v[132:135],v18 offset:2304
mm a[12:15],v[108:111],v[64:67],0
dt v[168:169],v22 offset:8192
dt v[170:171],v22 offset:12288
mm a[28:31],v[108:111],v[68:71],0
dt v[172:173],v23 offset:8192
dt v[174:175],v23 offset:12288
mm a[24:27],v[104:107],v[68:71],0
mm a[20:23],v[100:103],v[68:71],0
mm a[16:19],v[96:99],v[68:71],0
wt vmcnt(12) lgkmcnt(0)
s_barrier
mm a[0:3],v[160:163],v[128:131],a[0:3]
dt v[96:97],v20 offset:16384
dt v[98:99],v20 offset:20480
mm a[4:7],v[164:167],v[128:131],a[4:7]
dr v[64:67],v18 offset:8192
dt v[100:101],v21 offset:16384
s_add_u32 m0,s43,0
s_xor_b32 s79,s40,s45
l4 v2,s[8:11],s79 offen sc1 lds
mm a[8:11],v[168:171],v[128:131],a[8:11]
dt v[102:103],v21 offset:20480
dr v[68:71],v18 offset:8448
mm a[12:15],v[172:175],v[128:131],a[12:15]
dt v[104:105],v22 offset:16384
dt v[106:107],v22 offset:20480
mm a[28:31],v[172:175],v[132:135],a[28:31]
dt v[108:109],v23 offset:16384
dt v[110:111],v23 offset:20480
l4 v2,s[8:11],s79 offen offset:1024 sc1 lds
s_add_u32 s40,s40,4096
mm a[24:27],v[168:171],v[132:135],a[24:27]
mm a[20:23],v[164:167],v[132:135],a[20:23]
mm a[16:19],v[160:163],v[132:135],a[16:19]
wt lgkmcnt(0)
mm a[0:3],v[96:99],v[64:67],a[0:3]
dt v[160:161],v20 offset:24576
dt v[162:163],v20 offset:28672
mm a[4:7],v[100:103],v[64:67],a[4:7]
dr v[128:131],v18 offset:10240
dt v[164:165],v21 offset:24576
s_add_u32 m0,s44,0
s_nop 0
l4 v10,s[32:35],s41 offen sc1 lds
mm a[8:11],v[104:107],v[64:67],a[8:11]
dt v[166:167],v21 offset:28672
dr v[132:135],v18 offset:10496
l4 v11,s[32:35],s41 offen offset:1024 sc1 lds
mm a[12:15],v[108:111],v[64:67],a[12:15]
dt v[168:169],v22 offset:24576
dt v[170:171],v22 offset:28672
mm a[28:31],v[108:111],v[68:71],a[28:31]
dt v[172:173],v23 offset:24576
dt v[174:175],v23 offset:28672
l4 v12,s[32:35],s41 offen offset:2048 sc1 lds
mm a[24:27],v[104:107],v[68:71],a[24:27]
l4 v13,s[32:35],s41 offen offset:3072 sc1 lds
s_add_u32 s41,s41,s46
mm a[20:23],v[100:103],v[68:71],a[20:23]
mm a[16:19],v[96:99],v[68:71],a[16:19]
wt vmcnt(12) lgkmcnt(0)
s_barrier
mm a[0:3],v[160:163],v[128:131],a[0:3]
dt v[96:97],v20 offset:32768
dt v[98:99],v20 offset:36864
mm a[4:7],v[164:167],v[128:131],a[4:7]
dr v[64:67],v18 offset:16384
dt v[100:101],v21 offset:32768
s_add_u32 m0,s43,8192
s_xor_b32 s79,s40,s45
l4 v2,s[8:11],s79 offen sc1 lds
mm a[8:11],v[168:171],v[128:131],a[8:11]
dt v[102:103],v21 offset:36864
dr v[68:71],v18 offset:16640
mm a[12:15],v[172:175],v[128:131],a[12:15]
dt v[104:105],v22 offset:32768
dt v[106:107],v22 offset:36864
mm a[28:31],v[172:175],v[132:135],a[28:31]
dt v[108:109],v23 offset:32768
dt v[110:111],v23 offset:36864
l4 v2,s[8:11],s79 offen offset:1024 sc1 lds
s_add_u32 s40,s40,12288
mm a[24:27],v[168:171],v[132:135],a[24:27]
mm a[20:23],v[164:167],v[132:135],a[20:23]
mm a[16:19],v[160:163],v[132:135],a[16:19]
wt lgkmcnt(0)
mm a[0:3],v[96:99],v[64:67],a[0:3]
dt v[160:161],v20 offset:40960
dt v[162:163],v20 offset:45056
mm a[4:7],v[100:103],v[64:67],a[4:7]
dr v[128:131],v18 offset:18432
dt v[164:165],v21 offset:40960
s_add_u32 m0,s44,16384
s_nop 0
l4 v10,s[32:35],s41 offen sc1 lds
mm a[8:11],v[104:107],v[64:67],a[8:11]
dt v[166:167],v21 offset:45056
dr v[132:135],v18 offset:18688
l4 v11,s[32:35],s41 offen offset:1024 sc1 lds
mm a[12:15],v[108:111],v[64:67],a[12:15]
dt v[168:169],v22 offset:40960
dt v[170:171],v22 offset:45056
mm a[28:31],v[108:111],v[68:71],a[28:31]
dt v[172:173],v23 offset:40960
dt v[174:175],v23 offset:45056
l4 v12,s[32:35],s41 offen offset:2048 sc1 lds
mm a[24:27],v[104:107],v[68:71],a[24:27]
l4 v13,s[32:35],s41 offen offset:3072 sc1 lds
s_add_u32 s41,s41,s46
mm a[20:23],v[100:103],v[68:71],a[20:23]
mm a[16:19],v[96:99],v[68:71],a[16:19]
wt vmcnt(12) lgkmcnt(0)
s_barrier
mm a[0:3],v[160:163],v[128:131],a[0:3]
dt v[96:97],v20 offset:49152
dt v[98:99],v20 offset:53248
mm a[4:7],v[164:167],v[128:131],a[4:7]
dr v[64:67],v18 offset:24576
dt v[100:101],v21 offset:49152
s_add_u32 m0,s43,16384
s_xor_b32 s79,s40,s45
l4 v2,s[8:11],s79 offen sc1 lds
mm a[8:11],v[168:171],v[128:131],a[8:11]
dt v[102:103],v21 offset:53248
dr v[68:71],v18 offset:24832
mm a[12:15],v[172:175],v[128:131],a[12:15]
dt v[104:105],v22 offset:49152
dt v[106:107],v22 offset:53248
mm a[28:31],v[172:175],v[132:135],a[28:31]
dt v[108:109],v23 offset:49152
dt v[110:111],v23 offset:53248
l4 v2,s[8:11],s79 offen offset:1024 sc1 lds
s_add_u32 s40,s40,4096
mm a[24:27],v[168:171],v[132:135],a[24:27]
mm a[20:23],v[164:167],v[132:135],a[20:23]
mm a[16:19],v[160:163],v[132:135],a[16:19]
wt lgkmcnt(0)
mm a[0:3],v[96:99],v[64:67],a[0:3]
dt v[160:161],v20 offset:57344
dt v[162:163],v20 offset:61440
mm a[4:7],v[100:103],v[64:67],a[4:7]
dr v[128:131],v18 offset:26624
dt v[164:165],v21 offset:57344
s_add_u32 m0,s44,32768
s_nop 0
l4 v10,s[32:35],s41 offen sc1 lds
mm a[8:11],v[104:107],v[64:67],a[8:11]
dt v[166:167],v21 offset:61440
dr v[132:135],v18 offset:26880
l4 v11,s[32:35],s41 offen offset:1024 sc1 lds
mm a[12:15],v[108:111],v[64:67],a[12:15]
dt v[168:169],v22 offset:57344
dt v[170:171],v22 offset:61440
mm a[28:31],v[108:111],v[68:71],a[28:31]
dt v[172:173],v23 offset:57344
dt v[174:175],v23 offset:61440
l4 v12,s[32:35],s41 offen offset:2048 sc1 lds
mm a[24:27],v[104:107],v[68:71],a[24:27]
l4 v13,s[32:35],s41 offen offset:3072 sc1 lds
s_add_u32 s41,s41,s46
mm a[20:23],v[100:103],v[68:71],a[20:23]
mm a[16:19],v[96:99],v[68:71],a[16:19]
wt vmcnt(12) lgkmcnt(0)
s_barrier
mm a[0:3],v[160:163],v[128:131],a[0:3]
dt v[96:97],v20 offset:0
dt v[98:99],v20 offset:4096
mm a[4:7],v[164:167],v[128:131],a[4:7]
dr v[64:67],v18 offset:0
dt v[100:101],v21 offset:0
s_add_u32 m0,s43,24576
s_xor_b32 s79,s40,s45
l4 v2,s[8:11],s79 offen sc1 lds
mm a[8:11],v[168:171],v[128:131],a[8:11]
dt v[102:103],v21 offset:4096
dr v[68:71],v18 offset:256
mm a[12:15],v[172:175],v[128:131],a[12:15]
dt v[104:105],v22 offset:0
dt v[106:107],v22 offset:4096
mm a[28:31],v[172:175],v[132:135],a[28:31]
dt v[108:109],v23 offset:0
dt v[110:111],v23 offset:4096
l4 v2,s[8:11],s79 offen offset:1024 sc1 lds
s_add_u32 s40,s40,12288
mm a[24:27],v[168:171],v[132:135],a[24:27]
mm a[20:23],v[164:167],v[132:135],a[20:23]
mm a[16:19],v[160:163],v[132:135],a[16:19]
wt lgkmcnt(0)
s_sub_u32 s42,s42,2
G3S_k:
mm a[0:3],v[96:99],v[64:67],a[0:3]
dt v[160:161],v20 offset:8192
dt v[162:163],v20 offset:12288
mm a[4:7],v[100:103],v[64:67],a[4:7]
dr v[128:131],v18 offset:2048
dt v[164:165],v21 offset:8192
s_add_u32 m0,s44,49152
s_nop 0
l4 v10,s[32:35],s41 offen sc1 lds
mm a[8:11],v[104:107],v[64:67],a[8:11]
dt v[166:167],v21 offset:12288
dr v[132:135],v18 offset:2304
l4 v11,s[32:35],s41 offen offset:1024 sc1 lds
mm a[12:15],v[108:111],v[64:67],a[12:15]
dt v[168:169],v22 offset:8192
dt v[170:171],v22 offset:12288
mm a[28:31],v[108:111],v[68:71],a[28:31]
dt v[172:173],v23 offset:8192
dt v[174:175],v23 offset:12288
l4 v12,s[32:35],s41 offen offset:2048 sc1 lds
mm a[24:27],v[104:107],v[68:71],a[24:27]
l4 v13,s[32:35],s41 offen offset:3072 sc1 lds
s_add_u32 s41,s41,s46
mm a[20:23],v[100:103],v[68:71],a[20:23]
mm a[16:19],v[96:99],v[68:71],a[16:19]
wt vmcnt(12) lgkmcnt(0)
s_barrier
mm a[0:3],v[160:163],v[128:131],a[0:3]
dt v[96:97],v20 offset:16384
dt v[98:99],v20 offset:20480
mm a[4:7],v[164:167],v[128:131],a[4:7]
dr v[64:67],v18 offset:8192
dt v[100:101],v21 offset:16384
s_add_u32 m0,s43,0
s_xor_b32 s79,s40,s45
l4 v2,s[8:11],s79 offen sc1 lds
mm a[8:11],v[168:171],v[128:131],a[8:11]
dt v[102:103],v21 offset:20480
dr v[68:71],v18 offset:8448
mm a[12:15],v[172:175],v[128:131],a[12:15]
dt v[104:105],v22 offset:16384
dt v[106:107],v22 offset:20480
mm a[28:31],v[172:175],v[132:135],a[28:31]
dt v[108:109],v23 offset:16384
dt v[110:111],v23 offset:20480
l4 v2,s[8:11],s79 offen offset:1024 sc1 lds
s_add_u32 s40,s40,4096
mm a[24:27],v[168:171],v[132:135],a[24:27]
mm a[20:23],v[164:167],v[132:135],a[20:23]
mm a[16:19],v[160:163],v[132:135],a[16:19]
wt lgkmcnt(0)
mm a[0:3],v[96:99],v[64:67],a[0:3]
dt v[160:161],v20 offset:24576
dt v[162:163],v20 offset:28672
mm a[4:7],v[100:103],v[64:67],a[4:7]
dr v[128:131],v18 offset:10240
dt v[164:165],v21 offset:24576
s_add_u32 m0,s44,0
s_nop 0
l4 v10,s[32:35],s41 offen sc1 lds
mm a[8:11],v[104:107],v[64:67],a[8:11]
dt v[166:167],v21 offset:28672
dr v[132:135],v18 offset:10496
l4 v11,s[32:35],s41 offen offset:1024 sc1 lds
mm a[12:15],v[108:111],v[64:67],a[12:15]
dt v[168:169],v22 offset:24576
dt v[170:171],v22 offset:28672
mm a[28:31],v[108:111],v[68:71],a[28:31]
dt v[172:173],v23 offset:24576
dt v[174:175],v23 offset:28672
l4 v12,s[32:35],s41 offen offset:2048 sc1 lds
mm a[24:27],v[104:107],v[68:71],a[24:27]
l4 v13,s[32:35],s41 offen offset:3072 sc1 lds
s_add_u32 s41,s41,s46
mm a[20:23],v[100:103],v[68:71],a[20:23]
mm a[16:19],v[96:99],v[68:71],a[16:19]
wt vmcnt(12) lgkmcnt(0)
s_barrier
mm a[0:3],v[160:163],v[128:131],a[0:3]
dt v[96:97],v20 offset:32768
dt v[98:99],v20 offset:36864
mm a[4:7],v[164:167],v[128:131],a[4:7]
dr v[64:67],v18 offset:16384
dt v[100:101],v21 offset:32768
s_add_u32 m0,s43,8192
s_xor_b32 s79,s40,s45
l4 v2,s[8:11],s79 offen sc1 lds
mm a[8:11],v[168:171],v[128:131],a[8:11]
dt v[102:103],v21 offset:36864
dr v[68:71],v18 offset:16640
mm a[12:15],v[172:175],v[128:131],a[12:15]
dt v[104:105],v22 offset:32768
dt v[106:107],v22 offset:36864
mm a[28:31],v[172:175],v[132:135],a[28:31]
dt v[108:109],v23 offset:32768
dt v[110:111],v23 offset:36864
l4 v2,s[8:11],s79 offen offset:1024 sc1 lds
s_add_u32 s40,s40,12288
mm a[24:27],v[168:171],v[132:135],a[24:27]
mm a[20:23],v[164:167],v[132:135],a[20:23]
mm a[16:19],v[160:163],v[132:135],a[16:19]
wt lgkmcnt(0)
mm a[0:3],v[96:99],v[64:67],a[0:3]
dt v[160:161],v20 offset:40960
dt v[162:163],v20 offset:45056
mm a[4:7],v[100:103],v[64:67],a[4:7]
dr v[128:131],v18 offset:18432
dt v[164:165],v21 offset:40960
s_add_u32 m0,s44,16384
s_nop 0
l4 v10,s[32:35],s41 offen sc1 lds
mm a[8:11],v[104:107],v[64:67],a[8:11]
dt v[166:167],v21 offset:45056
dr v[132:135],v18 offset:18688
l4 v11,s[32:35],s41 offen offset:1024 sc1 lds
mm a[12:15],v[108:111],v[64:67],a[12:15]
dt v[168:169],v22 offset:40960
dt v[170:171],v22 offset:45056
mm a[28:31],v[108:111],v[68:71],a[28:31]
dt v[172:173],v23 offset:40960
dt v[174:175],v23 offset:45056
l4 v12,s[32:35],s41 offen offset:2048 sc1 lds
mm a[24:27],v[104:107],v[68:71],a[24:27]
l4 v13,s[32:35],s41 offen offset:3072 sc1 lds
s_add_u32 s41,s41,s46
mm a[20:23],v[100:103],v[68:71],a[20:23]
mm a[16:19],v[96:99],v[68:71],a[16:19]
wt vmcnt(12) lgkmcnt(0)
s_barrier
mm a[0:3],v[160:163],v[128:131],a[0:3]
dt v[96:97],v20 offset:49152
dt v[98:99],v20 offset:53248
mm a[4:7],v[164:167],v[128:131],a[4:7]
dr v[64:67],v18 offset:24576
dt v[100:101],v21 offset:49152
s_add_u32 m0,s43,16384
s_xor_b32 s79,s40,s45
l4 v2,s[8:11],s79 offen sc1 lds
mm a[8:11],v[168:171],v[128:131],a[8:11]
dt v[102:103],v21 offset:53248
dr v[68:71],v18 offset:24832
mm a[12:15],v[172:175],v[128:131],a[12:15]
dt v[104:105],v22 offset:49152
dt v[106:107],v22 offset:53248
mm a[28:31],v[172:175],v[132:135],a[28:31]
dt v[108:109],v23 offset:49152
dt v[110:111],v23 offset:53248
l4 v2,s[8:11],s79 offen offset:1024 sc1 lds
s_add_u32 s40,s40,4096
mm a[24:27],v[168:171],v[132:135],a[24:27]
mm a[20:23],v[164:167],v[132:135],a[20:23]
mm a[16:19],v[160:163],v[132:135],a[16:19]
wt lgkmcnt(0)
mm a[0:3],v[96:99],v[64:67],a[0:3]
dt v[160:161],v20 offset:57344
dt v[162:163],v20 offset:61440
mm a[4:7],v[100:103],v[64:67],a[4:7]
dr v[128:131],v18 offset:26624
dt v[164:165],v21 offset:57344
s_add_u32 m0,s44,32768
s_nop 0
l4 v10,s[32:35],s41 offen sc1 lds
mm a[8:11],v[104:107],v[64:67],a[8:11]
dt v[166:167],v21 offset:61440
dr v[132:135],v18 offset:26880
l4 v11,s[32:35],s41 offen offset:1024 sc1 lds
mm a[12:15],v[108:111],v[64:67],a[12:15]
dt v[168:169],v22 offset:57344
dt v[170:171],v22 offset:61440
mm a[28:31],v[108:111],v[68:71],a[28:31]
dt v[172:173],v23 offset:57344
dt v[174:175],v23 offset:61440
l4 v12,s[32:35],s41 offen offset:2048 sc1 lds
mm a[24:27],v[104:107],v[68:71],a[24:27]
l4 v13,s[32:35],s41 offen offset:3072 sc1 lds
s_add_u32 s41,s41,s46
mm a[20:23],v[100:103],v[68:71],a[20:23]
mm a[16:19],v[96:99],v[68:71],a[16:19]
wt vmcnt(12) lgkmcnt(0)
s_barrier
mm a[0:3],v[160:163],v[128:131],a[0:3]
dt v[96:97],v20 offset:0
dt v[98:99],v20 offset:4096
mm a[4:7],v[164:167],v[128:131],a[4:7]
dr v[64:67],v18 offset:0
dt v[100:101],v21 offset:0
s_add_u32 m0,s43,24576
s_xor_b32 s79,s40,s45
l4 v2,s[8:11],s79 offen sc1 lds
mm a[8:11],v[168:171],v[128:131],a[8:11]
dt v[102:103],v21 offset:4096
dr v[68:71],v18 offset:256
mm a[12:15],v[172:175],v[128:131],a[12:15]
dt v[104:105],v22 offset:0
dt v[106:107],v22 offset:4096
mm a[28:31],v[172:175],v[132:135],a[28:31]
dt v[108:109],v23 offset:0
dt v[110:111],v23 offset:4096
l4 v2,s[8:11],s79 offen offset:1024 sc1 lds
s_add_u32 s40,s40,12288
mm a[24:27],v[168:171],v[132:135],a[24:27]
mm a[20:23],v[164:167],v[132:135],a[20:23]
mm a[16:19],v[160:163],v[132:135],a[16:19]
wt lgkmcnt(0)
s_sub_u32 s42,s42,1
s_cmp_lg_u32 s42,0
s_cbranch_scc1 G3S_k
mm a[0:3],v[96:99],v[64:67],a[0:3]
dt v[160:161],v20 offset:8192
dt v[162:163],v20 offset:12288
mm a[4:7],v[100:103],v[64:67],a[4:7]
dr v[128:131],v18 offset:2048
dt v[164:165],v21 offset:8192
s_add_u32 m0,s44,49152
s_nop 0
l4 v10,s[32:35],s41 offen sc1 lds
mm a[8:11],v[104:107],v[64:67],a[8:11]
dt v[166:167],v21 offset:12288
dr v[132:135],v18 offset:2304
l4 v11,s[32:35],s41 offen offset:1024 sc1 lds
mm a[12:15],v[108:111],v[64:67],a[12:15]
dt v[168:169],v22 offset:8192
dt v[170:171],v22 offset:12288
mm a[28:31],v[108:111],v[68:71],a[28:31]
dt v[172:173],v23 offset:8192
dt v[174:175],v23 offset:12288
l4 v12,s[32:35],s41 offen offset:2048 sc1 lds
mm a[24:27],v[104:107],v[68:71],a[24:27]
l4 v13,s[32:35],s41 offen offset:3072 sc1 lds
s_add_u32 s41,s41,s46
mm a[20:23],v[100:103],v[68:71],a[20:23]
mm a[16:19],v[96:99],v[68:71],a[16:19]
wt vmcnt(12) lgkmcnt(0)
s_barrier
mm a[0:3],v[160:163],v[128:131],a[0:3]
dt v[96:97],v20 offset:16384
dt v[98:99],v20 offset:20480
mm a[4:7],v[164:167],v[128:131],a[4:7]
dr v[64:67],v18 offset:8192
dt v[100:101],v21 offset:16384
mm a[8:11],v[168:171],v[128:131],a[8:11]
dt v[102:103],v21 offset:20480
dr v[68:71],v18 offset:8448
mm a[12:15],v[172:175],v[128:131],a[12:15]
dt v[104:105],v22 offset:16384
dt v[106:107],v22 offset:20480
mm a[28:31],v[172:175],v[132:135],a[28:31]
dt v[108:109],v23 offset:16384
dt v[110:111],v23 offset:20480
mm a[24:27],v[168:171],v[132:135],a[24:27]
mm a[20:23],v[164:167],v[132:135],a[20:23]
mm a[16:19],v[160:163],v[132:135],a[16:19]
wt lgkmcnt(0)
mm a[0:3],v[96:99],v[64:67],a[0:3]
dt v[160:161],v20 offset:24576
dt v[162:163],v20 offset:28672
mm a[4:7],v[100:103],v[64:67],a[4:7]
dr v[128:131],v18 offset:10240
dt v[164:165],v21 offset:24576
mm a[8:11],v[104:107],v[64:67],a[8:11]
dt v[166:167],v21 offset:28672
dr v[132:135],v18 offset:10496
mm a[12:15],v[108:111],v[64:67],a[12:15]
dt v[168:169],v22 offset:24576
dt v[170:171],v22 offset:28672
mm a[28:31],v[108:111],v[68:71],a[28:31]
dt v[172:173],v23 offset:24576
dt v[174:175],v23 offset:28672
mm a[24:27],v[104:107],v[68:71],a[24:27]
mm a[20:23],v[100:103],v[68:71],a[20:23]
mm a[16:19],v[96:99],v[68:71],a[16:19]
wt vmcnt(6) lgkmcnt(0)
s_barrier
mm a[0:3],v[160:163],v[128:131],a[0:3]
dt v[96:97],v20 offset:32768
dt v[98:99],v20 offset:36864
mm a[4:7],v[164:167],v[128:131],a[4:7]
dr v[64:67],v18 offset:16384
dt v[100:101],v21 offset:32768
mm a[8:11],v[168:171],v[128:131],a[8:11]
dt v[102:103],v21 offset:36864
dr v[68:71],v18 offset:16640
mm a[12:15],v[172:175],v[128:131],a[12:15]
dt v[104:105],v22 offset:32768
dt v[106:107],v22 offset:36864
mm a[28:31],v[172:175],v[132:135],a[28:31]
dt v[108:109],v23 offset:32768
dt v[110:111],v23 offset:36864
mm a[24:27],v[168:171],v[132:135],a[24:27]
mm a[20:23],v[164:167],v[132:135],a[20:23]
mm a[16:19],v[160:163],v[132:135],a[16:19]
wt lgkmcnt(0)
mm a[0:3],v[96:99],v[64:67],a[0:3]
dt v[160:161],v20 offset:40960
dt v[162:163],v20 offset:45056
mm a[4:7],v[100:103],v[64:67],a[4:7]
dr v[128:131],v18 offset:18432
dt v[164:165],v21 offset:40960
mm a[8:11],v[104:107],v[64:67],a[8:11]
dt v[166:167],v21 offset:45056
dr v[132:135],v18 offset:18688
mm a[12:15],v[108:111],v[64:67],a[12:15]
dt v[168:169],v22 offset:40960
dt v[170:171],v22 offset:45056
mm a[28:31],v[108:111],v[68:71],a[28:31]
dt v[172:173],v23 offset:40960
dt v[174:175],v23 offset:45056
mm a[24:27],v[104:107],v[68:71],a[24:27]
mm a[20:23],v[100:103],v[68:71],a[20:23]
mm a[16:19],v[96:99],v[68:71],a[16:19]
wt vmcnt(0) lgkmcnt(0)
s_barrier
mm a[0:3],v[160:163],v[128:131],a[0:3]
dt v[96:97],v20 offset:49152
dt v[98:99],v20 offset:53248
mm a[4:7],v[164:167],v[128:131],a[4:7]
dr v[64:67],v18 offset:24576
dt v[100:101],v21 offset:49152
mm a[8:11],v[168:171],v[128:131],a[8:11]
dt v[102:103],v21 offset:53248
dr v[68:71],v18 offset:24832
mm a[12:15],v[172:175],v[128:131],a[12:15]
dt v[104:105],v22 offset:49152
dt v[106:107],v22 offset:53248
mm a[28:31],v[172:175],v[132:135],a[28:31]
dt v[108:109],v23 offset:49152
dt v[110:111],v23 offset:53248
mm a[24:27],v[168:171],v[132:135],a[24:27]
mm a[20:23],v[164:167],v[132:135],a[20:23]
mm a[16:19],v[160:163],v[132:135],a[16:19]
wt lgkmcnt(0)
mm a[0:3],v[96:99],v[64:67],a[0:3]
dt v[160:161],v20 offset:57344
dt v[162:163],v20 offset:61440
mm a[4:7],v[100:103],v[64:67],a[4:7]
dr v[128:131],v18 offset:26624
dt v[164:165],v21 offset:57344
mm a[8:11],v[104:107],v[64:67],a[8:11]
dt v[166:167],v21 offset:61440
dr v[132:135],v18 offset:26880
mm a[12:15],v[108:111],v[64:67],a[12:15]
dt v[168:169],v22 offset:57344
dt v[170:171],v22 offset:61440
mm a[28:31],v[108:111],v[68:71],a[28:31]
dt v[172:173],v23 offset:57344
dt v[174:175],v23 offset:61440
mm a[24:27],v[104:107],v[68:71],a[24:27]
mm a[20:23],v[100:103],v[68:71],a[20:23]
mm a[16:19],v[96:99],v[68:71],a[16:19]
wt lgkmcnt(0)
mm a[0:3],v[160:163],v[128:131],a[0:3]
mm a[4:7],v[164:167],v[128:131],a[4:7]
mm a[8:11],v[168:171],v[128:131],a[8:11]
mm a[12:15],v[172:175],v[128:131],a[12:15]
mm a[28:31],v[172:175],v[132:135],a[28:31]
mm a[24:27],v[168:171],v[132:135],a[24:27]
mm a[20:23],v[164:167],v[132:135],a[20:23]
mm a[16:19],v[160:163],v[132:135],a[16:19]
v_mov_b32 v45,0
buffer_load_dword v44,v45,s[8:11],s24 offen sc1
v_bfe_u32 v30,v1,0,4
v_lshlrev_b32 v30,12,v30
v_bfe_u32 v31,v1,4,1
v_lshl_add_u32 v30,v31,5,v30
v_bfe_u32 v31,v1,5,1
v_lshl_add_u32 v30,v31,4,v30
s_mul_i32 s48,s76,131072
s_mul_i32 s49,s77,128
s_add_u32 s48,s48,s49
s_add_u32 s48,s48,s93
ar v192,a0
ar v193,a1
ar v194,a2
ar v195,a3
ar v196,a4
ar v197,a5
ar v198,a6
ar v199,a7
cv v200,v192,v193
cv v201,v194,v195
cv v202,v196,v197
cv v203,v198,v199
ar v204,a8
ar v205,a9
ar v206,a10
ar v207,a11
ar v208,a12
ar v209,a13
ar v210,a14
ar v211,a15
v_permlane16_swap_b32 v200,v202
v_permlane16_swap_b32 v201,v203
w4 v[200:203],v30,s[36:39],s48 offen sc1
cv v212,v204,v205
cv v213,v206,v207
cv v214,v208,v209
cv v215,v210,v211
ar v216,a16
ar v217,a17
ar v218,a18
ar v219,a19
ar v220,a20
ar v221,a21
ar v222,a22
ar v223,a23
v_permlane16_swap_b32 v212,v214
v_permlane16_swap_b32 v213,v215
w4 v[212:215],v30,s[36:39],s48 offen offset:64 sc1
s_add_u32 s48,s48,65536
cv v224,v216,v217
cv v225,v218,v219
cv v226,v220,v221
cv v227,v222,v223
ar v228,a24
ar v229,a25
ar v230,a26
ar v231,a27
ar v232,a28
ar v233,a29
ar v234,a30
ar v235,a31
v_permlane16_swap_b32 v224,v226
v_permlane16_swap_b32 v225,v227
w4 v[224:227],v30,s[36:39],s48 offen sc1
cv v236,v228,v229
cv v237,v230,v231
cv v238,v232,v233
cv v239,v234,v235
s_nop 0
v_permlane16_swap_b32 v236,v238
v_permlane16_swap_b32 v237,v239
w4 v[236:239],v30,s[36:39],s48 offen offset:64 sc1
s_add_u32 s48,s48,65536
wt vmcnt(4)
s_branch G_have
G_g1f:
s_lshl_b32 s48,s14,4
v_bfe_u32 v30,v1,5,1
v_add_u32 v30,s48,v30
v_mul_lo_u32 v30,v30,s47
v_bfe_u32 v31,v1,0,1
v_lshlrev_b32 v31,4,v31
v_add_u32 v30,v30,v31
v_bfe_u32 v31,v1,1,4
v_bfe_u32 v32,v1,5,1
v_xor_b32 v31,v31,v32
v_xor_b32 v32,0,v31
v_lshl_add_u32 v32,v32,5,v30
s_mul_i32 s48,s47,0
s_sub_u32 s48,s48,0
v_add_u32 v10,s48,v32
v_xor_b32 v32,2,v31
v_lshl_add_u32 v32,v32,5,v30
s_mul_i32 s48,s47,2
s_sub_u32 s48,s48,1024
v_add_u32 v11,s48,v32
v_xor_b32 v32,0,v31
v_lshl_add_u32 v32,v32,5,v30
s_mul_i32 s48,s47,4
s_sub_u32 s48,s48,2048
v_add_u32 v12,s48,v32
v_xor_b32 v32,2,v31
v_lshl_add_u32 v32,v32,5,v30
s_mul_i32 s48,s47,6
s_sub_u32 s48,s48,3072
v_add_u32 v13,s48,v32
v_xor_b32 v32,4,v31
v_lshl_add_u32 v32,v32,5,v30
s_mul_i32 s48,s47,8
s_sub_u32 s48,s48,0
v_add_u32 v14,s48,v32
v_xor_b32 v32,6,v31
v_lshl_add_u32 v32,v32,5,v30
s_mul_i32 s48,s47,10
s_sub_u32 s48,s48,1024
v_add_u32 v15,s48,v32
v_xor_b32 v32,4,v31
v_lshl_add_u32 v32,v32,5,v30
s_mul_i32 s48,s47,12
s_sub_u32 s48,s48,2048
v_add_u32 v16,s48,v32
v_xor_b32 v32,6,v31
v_lshl_add_u32 v32,v32,5,v30
s_mul_i32 s48,s47,14
s_sub_u32 s48,s48,3072
v_add_u32 v17,s48,v32
s_lshl_b32 s46,s47,6
s_mul_i32 s44,s14,8192
s_add_u32 s44,s44,65536
v_bfe_u32 v30,v1,4,2
v_lshlrev_b32 v30,12,v30
v_bfe_u32 v32,v1,2,2
v_lshl_add_u32 v30,v32,9,v30
v_bfe_u32 v32,v1,0,2
v_lshl_add_u32 v30,v32,3,v30
v_add_u32 v30,65536,v30
v_bfe_u32 v31,v1,2,2
v_bfe_u32 v32,v1,4,1
v_lshl_add_u32 v31,v32,2,v31
s_mul_i32 s48,s77,8
v_xor_b32 v31,s48,v31
v_xor_b32 v32,0,v31
v_lshl_add_u32 v20,v32,5,v30
v_xor_b32 v32,1,v31
v_lshl_add_u32 v21,v32,5,v30
v_xor_b32 v32,2,v31
v_lshl_add_u32 v22,v32,5,v30
v_xor_b32 v32,3,v31
v_lshl_add_u32 v23,v32,5,v30
v_xor_b32 v32,4,v31
v_lshl_add_u32 v24,v32,5,v30
v_xor_b32 v32,5,v31
v_lshl_add_u32 v25,v32,5,v30
v_xor_b32 v32,6,v31
v_lshl_add_u32 v26,v32,5,v30
v_xor_b32 v32,7,v31
v_lshl_add_u32 v27,v32,5,v30
s_mul_i32 s43,s14,8192
s_mul_i32 s48,s14,131072
v_bfe_u32 v30,v1,3,3
v_lshlrev_b32 v30,11,v30
v_add_u32 v30,s48,v30
v_bfe_u32 v31,v1,0,3
v_bfe_u32 v32,v1,4,2
v_xor_b32 v31,v31,v32
v_xor_b32 v32,0,v31
v_lshl_add_u32 v32,v32,4,v30
v_add_u32 v2,0,v32
v_xor_b32 v32,4,v31
v_lshl_add_u32 v32,v32,4,v30
v_add_u32 v3,15360,v32
v_xor_b32 v32,0,v31
v_lshl_add_u32 v32,v32,4,v30
v_add_u32 v4,30720,v32
v_xor_b32 v32,4,v31
v_lshl_add_u32 v32,v32,4,v30
v_add_u32 v5,46080,v32
v_xor_b32 v32,0,v31
v_lshl_add_u32 v32,v32,4,v30
v_add_u32 v6,65536,v32
v_xor_b32 v32,4,v31
v_lshl_add_u32 v32,v32,4,v30
v_add_u32 v7,80896,v32
v_xor_b32 v32,0,v31
v_lshl_add_u32 v32,v32,4,v30
v_add_u32 v8,96256,v32
v_xor_b32 v32,4,v31
v_lshl_add_u32 v32,v32,4,v30
v_add_u32 v9,111616,v32
s_mul_i32 s48,s76,16384
v_bfe_u32 v30,v1,0,4
v_lshlrev_b32 v30,7,v30
v_add_u32 v30,s48,v30
v_bfe_u32 v31,v1,1,3
v_bfe_u32 v32,v1,4,2
v_xor_b32 v31,v31,v32
v_xor_b32 v32,0,v31
v_lshl_add_u32 v18,v32,4,v30
v_xor_b32 v32,4,v31
v_lshl_add_u32 v19,v32,4,v30
s_bfe_u32 s48,s78,0x20008
s_mov_b64 s[84:85],s[60:61]
s_mov_b32 s86,0x400000
s_mov_b32 s87,0x20000
s_mov_b32 s89,8192
s_cmp_eq_u32 s48,1
s_cselect_b64 s[84:85],s[70:71],s[84:85]
s_cselect_b32 s89,16384,s89
s_cmp_eq_u32 s48,2
s_cselect_b64 s[84:85],s[72:73],s[84:85]
s_cselect_b32 s86,0x600000,s86
s_cselect_b32 s89,24576,s89
s_cmp_eq_u32 s48,3
s_cselect_b64 s[84:85],s[74:75],s[84:85]
s_cselect_b32 s86,0x200000,s86
s_bfe_u32 s48,s78,0x80010
s_xor_b32 s48,s48,0xff
s_lshl2_add_u32 s48,s48,s14
s_mul_i32 s48,s48,s89
s_mov_b32 s88,0
v_lshrrev_b32 v38,5,v1
v_lshlrev_b32 v38,29,v38
v_lshl_add_u32 v38,v1,7,v38
v_add_u32 v38,s48,v38
s_barrier
s_add_u32 m0,s43,0
s_nop 0
l4 v2,s[28:31],s40 offen lds
l4 v3,s[28:31],s40 offen offset:1024 lds
l4 v4,s[28:31],s40 offen offset:2048 lds
l4 v5,s[28:31],s40 offen offset:3072 lds
s_add_u32 m0,s43,4096
s_nop 0
l4 v6,s[28:31],s40 offen lds
l4 v7,s[28:31],s40 offen offset:1024 lds
l4 v8,s[28:31],s40 offen offset:2048 lds
l4 v9,s[28:31],s40 offen offset:3072 lds
s_add_u32 s40,s40,128
s_add_u32 m0,s44,0
s_nop 0
l4 v10,s[32:35],s41 offen lds
l4 v11,s[32:35],s41 offen offset:1024 lds
l4 v12,s[32:35],s41 offen offset:2048 lds
l4 v13,s[32:35],s41 offen offset:3072 lds
s_add_u32 m0,s44,4096
s_nop 0
l4 v14,s[32:35],s41 offen lds
l4 v15,s[32:35],s41 offen offset:1024 lds
l4 v16,s[32:35],s41 offen offset:2048 lds
l4 v17,s[32:35],s41 offen offset:3072 lds
s_add_u32 s41,s41,s46
s_add_u32 m0,s43,32768
s_nop 0
l4 v2,s[28:31],s40 offen lds
l4 v3,s[28:31],s40 offen offset:1024 lds
l4 v4,s[28:31],s40 offen offset:2048 lds
l4 v5,s[28:31],s40 offen offset:3072 lds
s_add_u32 m0,s43,36864
s_nop 0
l4 v6,s[28:31],s40 offen lds
l4 v7,s[28:31],s40 offen offset:1024 lds
l4 v8,s[28:31],s40 offen offset:2048 lds
l4 v9,s[28:31],s40 offen offset:3072 lds
s_add_u32 s40,s40,128
s_add_u32 m0,s44,32768
s_nop 0
l4 v10,s[32:35],s41 offen lds
l4 v11,s[32:35],s41 offen offset:1024 lds
l4 v12,s[32:35],s41 offen offset:2048 lds
l4 v13,s[32:35],s41 offen offset:3072 lds
s_add_u32 m0,s44,36864
s_nop 0
l4 v14,s[32:35],s41 offen lds
l4 v15,s[32:35],s41 offen offset:1024 lds
l4 v16,s[32:35],s41 offen offset:2048 lds
l4 v17,s[32:35],s41 offen offset:3072 lds
s_add_u32 s41,s41,s46
s_mov_b64 s[90:91],s[20:21]
s_mov_b64 s[92:93],s[22:23]
s_mov_b64 s[94:95],s[24:25]
s_mov_b64 s[96:97],s[26:27]
s_load_dwordx8 s[20:27],s[18:19],0
s_add_u32 s18,s18,32
s_addc_u32 s19,s19,0
wt vmcnt(16)
s_barrier
dt v[96:97],v20 offset:0
dt v[98:99],v20 offset:2048
dr v[64:67],v18 offset:0
dt v[100:101],v21 offset:0
dt v[102:103],v21 offset:2048
dr v[68:71],v18 offset:2048
dt v[104:105],v22 offset:0
dt v[106:107],v22 offset:2048
dr v[72:75],v18 offset:4096
dt v[108:109],v23 offset:0
dt v[110:111],v23 offset:2048
dr v[76:79],v18 offset:6144
dt v[112:113],v24 offset:0
dt v[114:115],v24 offset:2048
dr v[80:83],v18 offset:8192
dt v[116:117],v25 offset:0
dt v[118:119],v25 offset:2048
dr v[84:87],v18 offset:10240
dt v[120:121],v26 offset:0
dt v[122:123],v26 offset:2048
dr v[88:91],v18 offset:12288
dt v[124:125],v27 offset:0
dt v[126:127],v27 offset:2048
dr v[92:95],v18 offset:14336
wt lgkmcnt(0)
mm a[0:3],v[96:99],v[64:67],0
dt v[160:161],v20 offset:16384
mm a[4:7],v[100:103],v[64:67],0
mm a[8:11],v[104:107],v[64:67],0
dt v[162:163],v20 offset:18432
mm a[12:15],v[108:111],v[64:67],0
mm a[16:19],v[112:115],v[64:67],0
dr v[128:131],v19 offset:0
mm a[20:23],v[116:119],v[64:67],0
mm a[24:27],v[120:123],v[64:67],0
dt v[164:165],v21 offset:16384
mm a[28:31],v[124:127],v[64:67],0
mm a[60:63],v[124:127],v[68:71],0
dt v[166:167],v21 offset:18432
mm a[56:59],v[120:123],v[68:71],0
mm a[52:55],v[116:119],v[68:71],0
dr v[132:135],v19 offset:2048
mm a[48:51],v[112:115],v[68:71],0
mm a[44:47],v[108:111],v[68:71],0
dt v[168:169],v22 offset:16384
mm a[40:43],v[104:107],v[68:71],0
mm a[36:39],v[100:103],v[68:71],0
dt v[170:171],v22 offset:18432
mm a[32:35],v[96:99],v[68:71],0
mm a[64:67],v[96:99],v[72:75],0
dr v[136:139],v19 offset:4096
mm a[68:71],v[100:103],v[72:75],0
mm a[72:75],v[104:107],v[72:75],0
dt v[172:173],v23 offset:16384
mm a[76:79],v[108:111],v[72:75],0
mm a[80:83],v[112:115],v[72:75],0
dt v[174:175],v23 offset:18432
mm a[84:87],v[116:119],v[72:75],0
mm a[88:91],v[120:123],v[72:75],0
dr v[140:143],v19 offset:6144
mm a[92:95],v[124:127],v[72:75],0
mm a[124:127],v[124:127],v[76:79],0
dt v[176:177],v24 offset:16384
mm a[120:123],v[120:123],v[76:79],0
mm a[116:119],v[116:119],v[76:79],0
dt v[178:179],v24 offset:18432
mm a[112:115],v[112:115],v[76:79],0
mm a[108:111],v[108:111],v[76:79],0
dr v[144:147],v19 offset:8192
mm a[104:107],v[104:107],v[76:79],0
mm a[100:103],v[100:103],v[76:79],0
dt v[180:181],v25 offset:16384
mm a[96:99],v[96:99],v[76:79],0
mm a[128:131],v[96:99],v[80:83],0
dt v[182:183],v25 offset:18432
mm a[132:135],v[100:103],v[80:83],0
mm a[136:139],v[104:107],v[80:83],0
dr v[148:151],v19 offset:10240
mm a[140:143],v[108:111],v[80:83],0
mm a[144:147],v[112:115],v[80:83],0
dt v[184:185],v26 offset:16384
mm a[148:151],v[116:119],v[80:83],0
mm a[152:155],v[120:123],v[80:83],0
dt v[186:187],v26 offset:18432
mm a[156:159],v[124:127],v[80:83],0
mm a[188:191],v[124:127],v[84:87],0
dr v[152:155],v19 offset:12288
mm a[184:187],v[120:123],v[84:87],0
mm a[180:183],v[116:119],v[84:87],0
dt v[188:189],v27 offset:16384
mm a[176:179],v[112:115],v[84:87],0
mm a[172:175],v[108:111],v[84:87],0
dt v[190:191],v27 offset:18432
mm a[168:171],v[104:107],v[84:87],0
mm a[164:167],v[100:103],v[84:87],0
dr v[156:159],v19 offset:14336
mm a[160:163],v[96:99],v[84:87],0
mm a[192:195],v[96:99],v[88:91],0
mm a[196:199],v[100:103],v[88:91],0
mm a[200:203],v[104:107],v[88:91],0
mm a[204:207],v[108:111],v[88:91],0
mm a[208:211],v[112:115],v[88:91],0
mm a[212:215],v[116:119],v[88:91],0
mm a[216:219],v[120:123],v[88:91],0
mm a[220:223],v[124:127],v[88:91],0
mm a[252:255],v[124:127],v[92:95],0
mm a[248:251],v[120:123],v[92:95],0
mm a[244:247],v[116:119],v[92:95],0
mm a[240:243],v[112:115],v[92:95],0
mm a[236:239],v[108:111],v[92:95],0
mm a[232:235],v[104:107],v[92:95],0
mm a[228:231],v[100:103],v[92:95],0
mm a[224:227],v[96:99],v[92:95],0
wt vmcnt(0) lgkmcnt(0)
s_barrier
mm a[0:3],v[160:163],v[128:131],a[0:3]
dt v[96:97],v20 offset:32768
s_add_u32 m0,s43,0
mm a[4:7],v[164:167],v[128:131],a[4:7]
l4 v2,s[28:31],s40 offen lds
mm a[8:11],v[168:171],v[128:131],a[8:11]
dt v[98:99],v20 offset:34816
mm a[12:15],v[172:175],v[128:131],a[12:15]
mm a[16:19],v[176:179],v[128:131],a[16:19]
dr v[64:67],v18 offset:32768
mm a[20:23],v[180:183],v[128:131],a[20:23]
l4 v3,s[28:31],s40 offen offset:1024 lds
mm a[24:27],v[184:187],v[128:131],a[24:27]
dt v[100:101],v21 offset:32768
mm a[28:31],v[188:191],v[128:131],a[28:31]
mm a[60:63],v[188:191],v[132:135],a[60:63]
dt v[102:103],v21 offset:34816
mm a[56:59],v[184:187],v[132:135],a[56:59]
l4 v4,s[28:31],s40 offen offset:2048 lds
mm a[52:55],v[180:183],v[132:135],a[52:55]
dr v[68:71],v18 offset:34816
mm a[48:51],v[176:179],v[132:135],a[48:51]
mm a[44:47],v[172:175],v[132:135],a[44:47]
dt v[104:105],v22 offset:32768
mm a[40:43],v[168:171],v[132:135],a[40:43]
l4 v5,s[28:31],s40 offen offset:3072 lds
mm a[36:39],v[164:167],v[132:135],a[36:39]
dt v[106:107],v22 offset:34816
mm a[32:35],v[160:163],v[132:135],a[32:35]
s_add_u32 m0,s43,4096
mm a[64:67],v[160:163],v[136:139],a[64:67]
dr v[72:75],v18 offset:36864
mm a[68:71],v[164:167],v[136:139],a[68:71]
l4 v6,s[28:31],s40 offen lds
mm a[72:75],v[168:171],v[136:139],a[72:75]
dt v[108:109],v23 offset:32768
mm a[76:79],v[172:175],v[136:139],a[76:79]
mm a[80:83],v[176:179],v[136:139],a[80:83]
dt v[110:111],v23 offset:34816
mm a[84:87],v[180:183],v[136:139],a[84:87]
l4 v7,s[28:31],s40 offen offset:1024 lds
mm a[88:91],v[184:187],v[136:139],a[88:91]
dr v[76:79],v18 offset:38912
mm a[92:95],v[188:191],v[136:139],a[92:95]
mm a[124:127],v[188:191],v[140:143],a[124:127]
dt v[112:113],v24 offset:32768
mm a[120:123],v[184:187],v[140:143],a[120:123]
l4 v8,s[28:31],s40 offen offset:2048 lds
mm a[116:119],v[180:183],v[140:143],a[116:119]
dt v[114:115],v24 offset:34816
mm a[112:115],v[176:179],v[140:143],a[112:115]
mm a[108:111],v[172:175],v[140:143],a[108:111]
dr v[80:83],v18 offset:40960
mm a[104:107],v[168:171],v[140:143],a[104:107]
l4 v9,s[28:31],s40 offen offset:3072 lds
mm a[100:103],v[164:167],v[140:143],a[100:103]
dt v[116:117],v25 offset:32768
mm a[96:99],v[160:163],v[140:143],a[96:99]
s_add_u32 s40,s40,128
s_add_u32 m0,s44,0
mm a[128:131],v[160:163],v[144:147],a[128:131]
dt v[118:119],v25 offset:34816
mm a[132:135],v[164:167],v[144:147],a[132:135]
l4 v10,s[32:35],s41 offen lds
mm a[136:139],v[168:171],v[144:147],a[136:139]
dr v[84:87],v18 offset:43008
mm a[140:143],v[172:175],v[144:147],a[140:143]
mm a[144:147],v[176:179],v[144:147],a[144:147]
dt v[120:121],v26 offset:32768
mm a[148:151],v[180:183],v[144:147],a[148:151]
l4 v11,s[32:35],s41 offen offset:1024 lds
mm a[152:155],v[184:187],v[144:147],a[152:155]
dt v[122:123],v26 offset:34816
mm a[156:159],v[188:191],v[144:147],a[156:159]
mm a[188:191],v[188:191],v[148:151],a[188:191]
dr v[88:91],v18 offset:45056
mm a[184:187],v[184:187],v[148:151],a[184:187]
l4 v12,s[32:35],s41 offen offset:2048 lds
mm a[180:183],v[180:183],v[148:151],a[180:183]
dt v[124:125],v27 offset:32768
mm a[176:179],v[176:179],v[148:151],a[176:179]
mm a[172:175],v[172:175],v[148:151],a[172:175]
dt v[126:127],v27 offset:34816
mm a[168:171],v[168:171],v[148:151],a[168:171]
l4 v13,s[32:35],s41 offen offset:3072 lds
mm a[164:167],v[164:167],v[148:151],a[164:167]
dr v[92:95],v18 offset:47104
mm a[160:163],v[160:163],v[148:151],a[160:163]
s_add_u32 m0,s44,4096
mm a[192:195],v[160:163],v[152:155],a[192:195]
l4 v14,s[32:35],s41 offen lds
mm a[196:199],v[164:167],v[152:155],a[196:199]
mm a[200:203],v[168:171],v[152:155],a[200:203]
mm a[204:207],v[172:175],v[152:155],a[204:207]
l4 v15,s[32:35],s41 offen offset:1024 lds
mm a[208:211],v[176:179],v[152:155],a[208:211]
mm a[212:215],v[180:183],v[152:155],a[212:215]
mm a[216:219],v[184:187],v[152:155],a[216:219]
l4 v16,s[32:35],s41 offen offset:2048 lds
mm a[220:223],v[188:191],v[152:155],a[220:223]
mm a[252:255],v[188:191],v[156:159],a[252:255]
mm a[248:251],v[184:187],v[156:159],a[248:251]
l4 v17,s[32:35],s41 offen offset:3072 lds
mm a[244:247],v[180:183],v[156:159],a[244:247]
s_add_u32 s41,s41,s46
mm a[240:243],v[176:179],v[156:159],a[240:243]
mm a[236:239],v[172:175],v[156:159],a[236:239]
wt lgkmcnt(0)
mm a[232:235],v[168:171],v[156:159],a[232:235]
mm a[228:231],v[164:167],v[156:159],a[228:231]
mm a[224:227],v[160:163],v[156:159],a[224:227]
mm a[0:3],v[96:99],v[64:67],a[0:3]
dt v[160:161],v20 offset:49152
mm a[4:7],v[100:103],v[64:67],a[4:7]
mm a[8:11],v[104:107],v[64:67],a[8:11]
dt v[162:163],v20 offset:51200
mm a[12:15],v[108:111],v[64:67],a[12:15]
mm a[16:19],v[112:115],v[64:67],a[16:19]
dr v[128:131],v19 offset:32768
mm a[20:23],v[116:119],v[64:67],a[20:23]
mm a[24:27],v[120:123],v[64:67],a[24:27]
dt v[164:165],v21 offset:49152
mm a[28:31],v[124:127],v[64:67],a[28:31]
mm a[60:63],v[124:127],v[68:71],a[60:63]
dt v[166:167],v21 offset:51200
mm a[56:59],v[120:123],v[68:71],a[56:59]
mm a[52:55],v[116:119],v[68:71],a[52:55]
dr v[132:135],v19 offset:34816
mm a[48:51],v[112:115],v[68:71],a[48:51]
mm a[44:47],v[108:111],v[68:71],a[44:47]
dt v[168:169],v22 offset:49152
mm a[40:43],v[104:107],v[68:71],a[40:43]
mm a[36:39],v[100:103],v[68:71],a[36:39]
dt v[170:171],v22 offset:51200
mm a[32:35],v[96:99],v[68:71],a[32:35]
mm a[64:67],v[96:99],v[72:75],a[64:67]
dr v[136:139],v19 offset:36864
mm a[68:71],v[100:103],v[72:75],a[68:71]
mm a[72:75],v[104:107],v[72:75],a[72:75]
dt v[172:173],v23 offset:49152
mm a[76:79],v[108:111],v[72:75],a[76:79]
mm a[80:83],v[112:115],v[72:75],a[80:83]
dt v[174:175],v23 offset:51200
mm a[84:87],v[116:119],v[72:75],a[84:87]
mm a[88:91],v[120:123],v[72:75],a[88:91]
dr v[140:143],v19 offset:38912
mm a[92:95],v[124:127],v[72:75],a[92:95]
mm a[124:127],v[124:127],v[76:79],a[124:127]
dt v[176:177],v24 offset:49152
mm a[120:123],v[120:123],v[76:79],a[120:123]
mm a[116:119],v[116:119],v[76:79],a[116:119]
dt v[178:179],v24 offset:51200
mm a[112:115],v[112:115],v[76:79],a[112:115]
mm a[108:111],v[108:111],v[76:79],a[108:111]
dr v[144:147],v19 offset:40960
mm a[104:107],v[104:107],v[76:79],a[104:107]
mm a[100:103],v[100:103],v[76:79],a[100:103]
dt v[180:181],v25 offset:49152
mm a[96:99],v[96:99],v[76:79],a[96:99]
mm a[128:131],v[96:99],v[80:83],a[128:131]
dt v[182:183],v25 offset:51200
mm a[132:135],v[100:103],v[80:83],a[132:135]
mm a[136:139],v[104:107],v[80:83],a[136:139]
dr v[148:151],v19 offset:43008
mm a[140:143],v[108:111],v[80:83],a[140:143]
mm a[144:147],v[112:115],v[80:83],a[144:147]
dt v[184:185],v26 offset:49152
mm a[148:151],v[116:119],v[80:83],a[148:151]
mm a[152:155],v[120:123],v[80:83],a[152:155]
dt v[186:187],v26 offset:51200
mm a[156:159],v[124:127],v[80:83],a[156:159]
mm a[188:191],v[124:127],v[84:87],a[188:191]
dr v[152:155],v19 offset:45056
mm a[184:187],v[120:123],v[84:87],a[184:187]
mm a[180:183],v[116:119],v[84:87],a[180:183]
dt v[188:189],v27 offset:49152
mm a[176:179],v[112:115],v[84:87],a[176:179]
mm a[172:175],v[108:111],v[84:87],a[172:175]
dt v[190:191],v27 offset:51200
mm a[168:171],v[104:107],v[84:87],a[168:171]
mm a[164:167],v[100:103],v[84:87],a[164:167]
dr v[156:159],v19 offset:47104
mm a[160:163],v[96:99],v[84:87],a[160:163]
mm a[192:195],v[96:99],v[88:91],a[192:195]
mm a[196:199],v[100:103],v[88:91],a[196:199]
mm a[200:203],v[104:107],v[88:91],a[200:203]
mm a[204:207],v[108:111],v[88:91],a[204:207]
mm a[208:211],v[112:115],v[88:91],a[208:211]
mm a[212:215],v[116:119],v[88:91],a[212:215]
mm a[216:219],v[120:123],v[88:91],a[216:219]
mm a[220:223],v[124:127],v[88:91],a[220:223]
mm a[252:255],v[124:127],v[92:95],a[252:255]
mm a[248:251],v[120:123],v[92:95],a[248:251]
mm a[244:247],v[116:119],v[92:95],a[244:247]
mm a[240:243],v[112:115],v[92:95],a[240:243]
mm a[236:239],v[108:111],v[92:95],a[236:239]
mm a[232:235],v[104:107],v[92:95],a[232:235]
mm a[228:231],v[100:103],v[92:95],a[228:231]
mm a[224:227],v[96:99],v[92:95],a[224:227]
wt vmcnt(0) lgkmcnt(0)
s_barrier
mm a[0:3],v[160:163],v[128:131],a[0:3]
dt v[96:97],v20 offset:0
s_add_u32 m0,s43,32768
mm a[4:7],v[164:167],v[128:131],a[4:7]
l4 v2,s[28:31],s40 offen lds
mm a[8:11],v[168:171],v[128:131],a[8:11]
dt v[98:99],v20 offset:2048
mm a[12:15],v[172:175],v[128:131],a[12:15]
mm a[16:19],v[176:179],v[128:131],a[16:19]
dr v[64:67],v18 offset:0
mm a[20:23],v[180:183],v[128:131],a[20:23]
l4 v3,s[28:31],s40 offen offset:1024 lds
mm a[24:27],v[184:187],v[128:131],a[24:27]
dt v[100:101],v21 offset:0
mm a[28:31],v[188:191],v[128:131],a[28:31]
mm a[60:63],v[188:191],v[132:135],a[60:63]
dt v[102:103],v21 offset:2048
mm a[56:59],v[184:187],v[132:135],a[56:59]
l4 v4,s[28:31],s40 offen offset:2048 lds
mm a[52:55],v[180:183],v[132:135],a[52:55]
dr v[68:71],v18 offset:2048
mm a[48:51],v[176:179],v[132:135],a[48:51]
mm a[44:47],v[172:175],v[132:135],a[44:47]
dt v[104:105],v22 offset:0
mm a[40:43],v[168:171],v[132:135],a[40:43]
l4 v5,s[28:31],s40 offen offset:3072 lds
mm a[36:39],v[164:167],v[132:135],a[36:39]
dt v[106:107],v22 offset:2048
mm a[32:35],v[160:163],v[132:135],a[32:35]
s_add_u32 m0,s43,36864
mm a[64:67],v[160:163],v[136:139],a[64:67]
dr v[72:75],v18 offset:4096
mm a[68:71],v[164:167],v[136:139],a[68:71]
l4 v6,s[28:31],s40 offen lds
mm a[72:75],v[168:171],v[136:139],a[72:75]
dt v[108:109],v23 offset:0
mm a[76:79],v[172:175],v[136:139],a[76:79]
mm a[80:83],v[176:179],v[136:139],a[80:83]
dt v[110:111],v23 offset:2048
mm a[84:87],v[180:183],v[136:139],a[84:87]
l4 v7,s[28:31],s40 offen offset:1024 lds
mm a[88:91],v[184:187],v[136:139],a[88:91]
dr v[76:79],v18 offset:6144
mm a[92:95],v[188:191],v[136:139],a[92:95]
mm a[124:127],v[188:191],v[140:143],a[124:127]
dt v[112:113],v24 offset:0
mm a[120:123],v[184:187],v[140:143],a[120:123]
l4 v8,s[28:31],s40 offen offset:2048 lds
mm a[116:119],v[180:183],v[140:143],a[116:119]
dt v[114:115],v24 offset:2048
mm a[112:115],v[176:179],v[140:143],a[112:115]
mm a[108:111],v[172:175],v[140:143],a[108:111]
dr v[80:83],v18 offset:8192
mm a[104:107],v[168:171],v[140:143],a[104:107]
l4 v9,s[28:31],s40 offen offset:3072 lds
mm a[100:103],v[164:167],v[140:143],a[100:103]
dt v[116:117],v25 offset:0
mm a[96:99],v[160:163],v[140:143],a[96:99]
s_add_u32 s40,s40,128
s_add_u32 m0,s44,32768
mm a[128:131],v[160:163],v[144:147],a[128:131]
dt v[118:119],v25 offset:2048
mm a[132:135],v[164:167],v[144:147],a[132:135]
l4 v10,s[32:35],s41 offen lds
mm a[136:139],v[168:171],v[144:147],a[136:139]
dr v[84:87],v18 offset:10240
mm a[140:143],v[172:175],v[144:147],a[140:143]
mm a[144:147],v[176:179],v[144:147],a[144:147]
dt v[120:121],v26 offset:0
mm a[148:151],v[180:183],v[144:147],a[148:151]
l4 v11,s[32:35],s41 offen offset:1024 lds
mm a[152:155],v[184:187],v[144:147],a[152:155]
dt v[122:123],v26 offset:2048
mm a[156:159],v[188:191],v[144:147],a[156:159]
mm a[188:191],v[188:191],v[148:151],a[188:191]
dr v[88:91],v18 offset:12288
mm a[184:187],v[184:187],v[148:151],a[184:187]
l4 v12,s[32:35],s41 offen offset:2048 lds
mm a[180:183],v[180:183],v[148:151],a[180:183]
dt v[124:125],v27 offset:0
mm a[176:179],v[176:179],v[148:151],a[176:179]
mm a[172:175],v[172:175],v[148:151],a[172:175]
dt v[126:127],v27 offset:2048
mm a[168:171],v[168:171],v[148:151],a[168:171]
l4 v13,s[32:35],s41 offen offset:3072 lds
mm a[164:167],v[164:167],v[148:151],a[164:167]
dr v[92:95],v18 offset:14336
mm a[160:163],v[160:163],v[148:151],a[160:163]
s_add_u32 m0,s44,36864
mm a[192:195],v[160:163],v[152:155],a[192:195]
l4 v14,s[32:35],s41 offen lds
mm a[196:199],v[164:167],v[152:155],a[196:199]
mm a[200:203],v[168:171],v[152:155],a[200:203]
mm a[204:207],v[172:175],v[152:155],a[204:207]
l4 v15,s[32:35],s41 offen offset:1024 lds
mm a[208:211],v[176:179],v[152:155],a[208:211]
mm a[212:215],v[180:183],v[152:155],a[212:215]
mm a[216:219],v[184:187],v[152:155],a[216:219]
l4 v16,s[32:35],s41 offen offset:2048 lds
mm a[220:223],v[188:191],v[152:155],a[220:223]
mm a[252:255],v[188:191],v[156:159],a[252:255]
mm a[248:251],v[184:187],v[156:159],a[248:251]
l4 v17,s[32:35],s41 offen offset:3072 lds
mm a[244:247],v[180:183],v[156:159],a[244:247]
s_add_u32 s41,s41,s46
mm a[240:243],v[176:179],v[156:159],a[240:243]
buffer_load_dword v39,v38,s[84:87],s88 offen offset:0
mm a[236:239],v[172:175],v[156:159],a[236:239]
s_add_u32 s88,s88,4096
s_cmp_lt_u32 s88,s89
mm a[232:235],v[168:171],v[156:159],a[232:235]
s_cselect_b32 s88,s88,0x40000000
wt lgkmcnt(0)
mm a[228:231],v[164:167],v[156:159],a[228:231]
mm a[224:227],v[160:163],v[156:159],a[224:227]
s_sub_u32 s42,s42,2
G1F_k:
mm a[0:3],v[96:99],v[64:67],a[0:3]
dt v[160:161],v20 offset:16384
mm a[4:7],v[100:103],v[64:67],a[4:7]
mm a[8:11],v[104:107],v[64:67],a[8:11]
dt v[162:163],v20 offset:18432
mm a[12:15],v[108:111],v[64:67],a[12:15]
mm a[16:19],v[112:115],v[64:67],a[16:19]
dr v[128:131],v19 offset:0
mm a[20:23],v[116:119],v[64:67],a[20:23]
mm a[24:27],v[120:123],v[64:67],a[24:27]
dt v[164:165],v21 offset:16384
mm a[28:31],v[124:127],v[64:67],a[28:31]
mm a[60:63],v[124:127],v[68:71],a[60:63]
dt v[166:167],v21 offset:18432
mm a[56:59],v[120:123],v[68:71],a[56:59]
mm a[52:55],v[116:119],v[68:71],a[52:55]
dr v[132:135],v19 offset:2048
mm a[48:51],v[112:115],v[68:71],a[48:51]
mm a[44:47],v[108:111],v[68:71],a[44:47]
dt v[168:169],v22 offset:16384
mm a[40:43],v[104:107],v[68:71],a[40:43]
mm a[36:39],v[100:103],v[68:71],a[36:39]
dt v[170:171],v22 offset:18432
mm a[32:35],v[96:99],v[68:71],a[32:35]
mm a[64:67],v[96:99],v[72:75],a[64:67]
dr v[136:139],v19 offset:4096
mm a[68:71],v[100:103],v[72:75],a[68:71]
mm a[72:75],v[104:107],v[72:75],a[72:75]
dt v[172:173],v23 offset:16384
mm a[76:79],v[108:111],v[72:75],a[76:79]
mm a[80:83],v[112:115],v[72:75],a[80:83]
dt v[174:175],v23 offset:18432
mm a[84:87],v[116:119],v[72:75],a[84:87]
mm a[88:91],v[120:123],v[72:75],a[88:91]
dr v[140:143],v19 offset:6144
mm a[92:95],v[124:127],v[72:75],a[92:95]
mm a[124:127],v[124:127],v[76:79],a[124:127]
dt v[176:177],v24 offset:16384
mm a[120:123],v[120:123],v[76:79],a[120:123]
mm a[116:119],v[116:119],v[76:79],a[116:119]
dt v[178:179],v24 offset:18432
mm a[112:115],v[112:115],v[76:79],a[112:115]
mm a[108:111],v[108:111],v[76:79],a[108:111]
dr v[144:147],v19 offset:8192
mm a[104:107],v[104:107],v[76:79],a[104:107]
mm a[100:103],v[100:103],v[76:79],a[100:103]
dt v[180:181],v25 offset:16384
mm a[96:99],v[96:99],v[76:79],a[96:99]
mm a[128:131],v[96:99],v[80:83],a[128:131]
dt v[182:183],v25 offset:18432
mm a[132:135],v[100:103],v[80:83],a[132:135]
mm a[136:139],v[104:107],v[80:83],a[136:139]
dr v[148:151],v19 offset:10240
mm a[140:143],v[108:111],v[80:83],a[140:143]
mm a[144:147],v[112:115],v[80:83],a[144:147]
dt v[184:185],v26 offset:16384
mm a[148:151],v[116:119],v[80:83],a[148:151]
mm a[152:155],v[120:123],v[80:83],a[152:155]
dt v[186:187],v26 offset:18432
mm a[156:159],v[124:127],v[80:83],a[156:159]
mm a[188:191],v[124:127],v[84:87],a[188:191]
dr v[152:155],v19 offset:12288
mm a[184:187],v[120:123],v[84:87],a[184:187]
mm a[180:183],v[116:119],v[84:87],a[180:183]
dt v[188:189],v27 offset:16384
mm a[176:179],v[112:115],v[84:87],a[176:179]
mm a[172:175],v[108:111],v[84:87],a[172:175]
dt v[190:191],v27 offset:18432
mm a[168:171],v[104:107],v[84:87],a[168:171]
mm a[164:167],v[100:103],v[84:87],a[164:167]
dr v[156:159],v19 offset:14336
mm a[160:163],v[96:99],v[84:87],a[160:163]
mm a[192:195],v[96:99],v[88:91],a[192:195]
mm a[196:199],v[100:103],v[88:91],a[196:199]
mm a[200:203],v[104:107],v[88:91],a[200:203]
mm a[204:207],v[108:111],v[88:91],a[204:207]
mm a[208:211],v[112:115],v[88:91],a[208:211]
mm a[212:215],v[116:119],v[88:91],a[212:215]
mm a[216:219],v[120:123],v[88:91],a[216:219]
mm a[220:223],v[124:127],v[88:91],a[220:223]
mm a[252:255],v[124:127],v[92:95],a[252:255]
mm a[248:251],v[120:123],v[92:95],a[248:251]
mm a[244:247],v[116:119],v[92:95],a[244:247]
mm a[240:243],v[112:115],v[92:95],a[240:243]
mm a[236:239],v[108:111],v[92:95],a[236:239]
mm a[232:235],v[104:107],v[92:95],a[232:235]
mm a[228:231],v[100:103],v[92:95],a[228:231]
mm a[224:227],v[96:99],v[92:95],a[224:227]
wt vmcnt(1) lgkmcnt(0)
s_barrier
mm a[0:3],v[160:163],v[128:131],a[0:3]
dt v[96:97],v20 offset:32768
s_add_u32 m0,s43,0
mm a[4:7],v[164:167],v[128:131],a[4:7]
l4 v2,s[28:31],s40 offen lds
mm a[8:11],v[168:171],v[128:131],a[8:11]
dt v[98:99],v20 offset:34816
mm a[12:15],v[172:175],v[128:131],a[12:15]
mm a[16:19],v[176:179],v[128:131],a[16:19]
dr v[64:67],v18 offset:32768
mm a[20:23],v[180:183],v[128:131],a[20:23]
l4 v3,s[28:31],s40 offen offset:1024 lds
mm a[24:27],v[184:187],v[128:131],a[24:27]
dt v[100:101],v21 offset:32768
mm a[28:31],v[188:191],v[128:131],a[28:31]
mm a[60:63],v[188:191],v[132:135],a[60:63]
dt v[102:103],v21 offset:34816
mm a[56:59],v[184:187],v[132:135],a[56:59]
l4 v4,s[28:31],s40 offen offset:2048 lds
mm a[52:55],v[180:183],v[132:135],a[52:55]
dr v[68:71],v18 offset:34816
mm a[48:51],v[176:179],v[132:135],a[48:51]
mm a[44:47],v[172:175],v[132:135],a[44:47]
dt v[104:105],v22 offset:32768
mm a[40:43],v[168:171],v[132:135],a[40:43]
l4 v5,s[28:31],s40 offen offset:3072 lds
mm a[36:39],v[164:167],v[132:135],a[36:39]
dt v[106:107],v22 offset:34816
mm a[32:35],v[160:163],v[132:135],a[32:35]
s_add_u32 m0,s43,4096
mm a[64:67],v[160:163],v[136:139],a[64:67]
dr v[72:75],v18 offset:36864
mm a[68:71],v[164:167],v[136:139],a[68:71]
l4 v6,s[28:31],s40 offen lds
mm a[72:75],v[168:171],v[136:139],a[72:75]
dt v[108:109],v23 offset:32768
mm a[76:79],v[172:175],v[136:139],a[76:79]
mm a[80:83],v[176:179],v[136:139],a[80:83]
dt v[110:111],v23 offset:34816
mm a[84:87],v[180:183],v[136:139],a[84:87]
l4 v7,s[28:31],s40 offen offset:1024 lds
mm a[88:91],v[184:187],v[136:139],a[88:91]
dr v[76:79],v18 offset:38912
mm a[92:95],v[188:191],v[136:139],a[92:95]
mm a[124:127],v[188:191],v[140:143],a[124:127]
dt v[112:113],v24 offset:32768
mm a[120:123],v[184:187],v[140:143],a[120:123]
l4 v8,s[28:31],s40 offen offset:2048 lds
mm a[116:119],v[180:183],v[140:143],a[116:119]
dt v[114:115],v24 offset:34816
mm a[112:115],v[176:179],v[140:143],a[112:115]
mm a[108:111],v[172:175],v[140:143],a[108:111]
dr v[80:83],v18 offset:40960
mm a[104:107],v[168:171],v[140:143],a[104:107]
l4 v9,s[28:31],s40 offen offset:3072 lds
mm a[100:103],v[164:167],v[140:143],a[100:103]
dt v[116:117],v25 offset:32768
mm a[96:99],v[160:163],v[140:143],a[96:99]
s_add_u32 s40,s40,128
s_add_u32 m0,s44,0
mm a[128:131],v[160:163],v[144:147],a[128:131]
dt v[118:119],v25 offset:34816
mm a[132:135],v[164:167],v[144:147],a[132:135]
l4 v10,s[32:35],s41 offen lds
mm a[136:139],v[168:171],v[144:147],a[136:139]
dr v[84:87],v18 offset:43008
mm a[140:143],v[172:175],v[144:147],a[140:143]
mm a[144:147],v[176:179],v[144:147],a[144:147]
dt v[120:121],v26 offset:32768
mm a[148:151],v[180:183],v[144:147],a[148:151]
l4 v11,s[32:35],s41 offen offset:1024 lds
mm a[152:155],v[184:187],v[144:147],a[152:155]
dt v[122:123],v26 offset:34816
mm a[156:159],v[188:191],v[144:147],a[156:159]
mm a[188:191],v[188:191],v[148:151],a[188:191]
dr v[88:91],v18 offset:45056
mm a[184:187],v[184:187],v[148:151],a[184:187]
l4 v12,s[32:35],s41 offen offset:2048 lds
mm a[180:183],v[180:183],v[148:151],a[180:183]
dt v[124:125],v27 offset:32768
mm a[176:179],v[176:179],v[148:151],a[176:179]
mm a[172:175],v[172:175],v[148:151],a[172:175]
dt v[126:127],v27 offset:34816
mm a[168:171],v[168:171],v[148:151],a[168:171]
l4 v13,s[32:35],s41 offen offset:3072 lds
mm a[164:167],v[164:167],v[148:151],a[164:167]
dr v[92:95],v18 offset:47104
mm a[160:163],v[160:163],v[148:151],a[160:163]
s_add_u32 m0,s44,4096
mm a[192:195],v[160:163],v[152:155],a[192:195]
l4 v14,s[32:35],s41 offen lds
mm a[196:199],v[164:167],v[152:155],a[196:199]
mm a[200:203],v[168:171],v[152:155],a[200:203]
mm a[204:207],v[172:175],v[152:155],a[204:207]
l4 v15,s[32:35],s41 offen offset:1024 lds
mm a[208:211],v[176:179],v[152:155],a[208:211]
mm a[212:215],v[180:183],v[152:155],a[212:215]
mm a[216:219],v[184:187],v[152:155],a[216:219]
l4 v16,s[32:35],s41 offen offset:2048 lds
mm a[220:223],v[188:191],v[152:155],a[220:223]
mm a[252:255],v[188:191],v[156:159],a[252:255]
mm a[248:251],v[184:187],v[156:159],a[248:251]
l4 v17,s[32:35],s41 offen offset:3072 lds
mm a[244:247],v[180:183],v[156:159],a[244:247]
s_add_u32 s41,s41,s46
mm a[240:243],v[176:179],v[156:159],a[240:243]
mm a[236:239],v[172:175],v[156:159],a[236:239]
wt lgkmcnt(0)
mm a[232:235],v[168:171],v[156:159],a[232:235]
mm a[228:231],v[164:167],v[156:159],a[228:231]
mm a[224:227],v[160:163],v[156:159],a[224:227]
mm a[0:3],v[96:99],v[64:67],a[0:3]
dt v[160:161],v20 offset:49152
mm a[4:7],v[100:103],v[64:67],a[4:7]
mm a[8:11],v[104:107],v[64:67],a[8:11]
dt v[162:163],v20 offset:51200
mm a[12:15],v[108:111],v[64:67],a[12:15]
mm a[16:19],v[112:115],v[64:67],a[16:19]
dr v[128:131],v19 offset:32768
mm a[20:23],v[116:119],v[64:67],a[20:23]
mm a[24:27],v[120:123],v[64:67],a[24:27]
dt v[164:165],v21 offset:49152
mm a[28:31],v[124:127],v[64:67],a[28:31]
mm a[60:63],v[124:127],v[68:71],a[60:63]
dt v[166:167],v21 offset:51200
mm a[56:59],v[120:123],v[68:71],a[56:59]
mm a[52:55],v[116:119],v[68:71],a[52:55]
dr v[132:135],v19 offset:34816
mm a[48:51],v[112:115],v[68:71],a[48:51]
mm a[44:47],v[108:111],v[68:71],a[44:47]
dt v[168:169],v22 offset:49152
mm a[40:43],v[104:107],v[68:71],a[40:43]
mm a[36:39],v[100:103],v[68:71],a[36:39]
dt v[170:171],v22 offset:51200
mm a[32:35],v[96:99],v[68:71],a[32:35]
mm a[64:67],v[96:99],v[72:75],a[64:67]
dr v[136:139],v19 offset:36864
mm a[68:71],v[100:103],v[72:75],a[68:71]
mm a[72:75],v[104:107],v[72:75],a[72:75]
dt v[172:173],v23 offset:49152
mm a[76:79],v[108:111],v[72:75],a[76:79]
mm a[80:83],v[112:115],v[72:75],a[80:83]
dt v[174:175],v23 offset:51200
mm a[84:87],v[116:119],v[72:75],a[84:87]
mm a[88:91],v[120:123],v[72:75],a[88:91]
dr v[140:143],v19 offset:38912
mm a[92:95],v[124:127],v[72:75],a[92:95]
mm a[124:127],v[124:127],v[76:79],a[124:127]
dt v[176:177],v24 offset:49152
mm a[120:123],v[120:123],v[76:79],a[120:123]
mm a[116:119],v[116:119],v[76:79],a[116:119]
dt v[178:179],v24 offset:51200
mm a[112:115],v[112:115],v[76:79],a[112:115]
mm a[108:111],v[108:111],v[76:79],a[108:111]
dr v[144:147],v19 offset:40960
mm a[104:107],v[104:107],v[76:79],a[104:107]
mm a[100:103],v[100:103],v[76:79],a[100:103]
dt v[180:181],v25 offset:49152
mm a[96:99],v[96:99],v[76:79],a[96:99]
mm a[128:131],v[96:99],v[80:83],a[128:131]
dt v[182:183],v25 offset:51200
mm a[132:135],v[100:103],v[80:83],a[132:135]
mm a[136:139],v[104:107],v[80:83],a[136:139]
dr v[148:151],v19 offset:43008
mm a[140:143],v[108:111],v[80:83],a[140:143]
mm a[144:147],v[112:115],v[80:83],a[144:147]
dt v[184:185],v26 offset:49152
mm a[148:151],v[116:119],v[80:83],a[148:151]
mm a[152:155],v[120:123],v[80:83],a[152:155]
dt v[186:187],v26 offset:51200
mm a[156:159],v[124:127],v[80:83],a[156:159]
mm a[188:191],v[124:127],v[84:87],a[188:191]
dr v[152:155],v19 offset:45056
mm a[184:187],v[120:123],v[84:87],a[184:187]
mm a[180:183],v[116:119],v[84:87],a[180:183]
dt v[188:189],v27 offset:49152
mm a[176:179],v[112:115],v[84:87],a[176:179]
mm a[172:175],v[108:111],v[84:87],a[172:175]
dt v[190:191],v27 offset:51200
mm a[168:171],v[104:107],v[84:87],a[168:171]
mm a[164:167],v[100:103],v[84:87],a[164:167]
dr v[156:159],v19 offset:47104
mm a[160:163],v[96:99],v[84:87],a[160:163]
mm a[192:195],v[96:99],v[88:91],a[192:195]
mm a[196:199],v[100:103],v[88:91],a[196:199]
mm a[200:203],v[104:107],v[88:91],a[200:203]
mm a[204:207],v[108:111],v[88:91],a[204:207]
mm a[208:211],v[112:115],v[88:91],a[208:211]
mm a[212:215],v[116:119],v[88:91],a[212:215]
mm a[216:219],v[120:123],v[88:91],a[216:219]
mm a[220:223],v[124:127],v[88:91],a[220:223]
mm a[252:255],v[124:127],v[92:95],a[252:255]
mm a[248:251],v[120:123],v[92:95],a[248:251]
mm a[244:247],v[116:119],v[92:95],a[244:247]
mm a[240:243],v[112:115],v[92:95],a[240:243]
mm a[236:239],v[108:111],v[92:95],a[236:239]
mm a[232:235],v[104:107],v[92:95],a[232:235]
mm a[228:231],v[100:103],v[92:95],a[228:231]
mm a[224:227],v[96:99],v[92:95],a[224:227]
wt vmcnt(0) lgkmcnt(0)
s_barrier
mm a[0:3],v[160:163],v[128:131],a[0:3]
dt v[96:97],v20 offset:0
s_add_u32 m0,s43,32768
mm a[4:7],v[164:167],v[128:131],a[4:7]
l4 v2,s[28:31],s40 offen lds
mm a[8:11],v[168:171],v[128:131],a[8:11]
dt v[98:99],v20 offset:2048
mm a[12:15],v[172:175],v[128:131],a[12:15]
mm a[16:19],v[176:179],v[128:131],a[16:19]
dr v[64:67],v18 offset:0
mm a[20:23],v[180:183],v[128:131],a[20:23]
l4 v3,s[28:31],s40 offen offset:1024 lds
mm a[24:27],v[184:187],v[128:131],a[24:27]
dt v[100:101],v21 offset:0
mm a[28:31],v[188:191],v[128:131],a[28:31]
mm a[60:63],v[188:191],v[132:135],a[60:63]
dt v[102:103],v21 offset:2048
mm a[56:59],v[184:187],v[132:135],a[56:59]
l4 v4,s[28:31],s40 offen offset:2048 lds
mm a[52:55],v[180:183],v[132:135],a[52:55]
dr v[68:71],v18 offset:2048
mm a[48:51],v[176:179],v[132:135],a[48:51]
mm a[44:47],v[172:175],v[132:135],a[44:47]
dt v[104:105],v22 offset:0
mm a[40:43],v[168:171],v[132:135],a[40:43]
l4 v5,s[28:31],s40 offen offset:3072 lds
mm a[36:39],v[164:167],v[132:135],a[36:39]
dt v[106:107],v22 offset:2048
mm a[32:35],v[160:163],v[132:135],a[32:35]
s_add_u32 m0,s43,36864
mm a[64:67],v[160:163],v[136:139],a[64:67]
dr v[72:75],v18 offset:4096
mm a[68:71],v[164:167],v[136:139],a[68:71]
l4 v6,s[28:31],s40 offen lds
mm a[72:75],v[168:171],v[136:139],a[72:75]
dt v[108:109],v23 offset:0
mm a[76:79],v[172:175],v[136:139],a[76:79]
mm a[80:83],v[176:179],v[136:139],a[80:83]
dt v[110:111],v23 offset:2048
mm a[84:87],v[180:183],v[136:139],a[84:87]
l4 v7,s[28:31],s40 offen offset:1024 lds
mm a[88:91],v[184:187],v[136:139],a[88:91]
dr v[76:79],v18 offset:6144
mm a[92:95],v[188:191],v[136:139],a[92:95]
mm a[124:127],v[188:191],v[140:143],a[124:127]
dt v[112:113],v24 offset:0
mm a[120:123],v[184:187],v[140:143],a[120:123]
l4 v8,s[28:31],s40 offen offset:2048 lds
mm a[116:119],v[180:183],v[140:143],a[116:119]
dt v[114:115],v24 offset:2048
mm a[112:115],v[176:179],v[140:143],a[112:115]
mm a[108:111],v[172:175],v[140:143],a[108:111]
dr v[80:83],v18 offset:8192
mm a[104:107],v[168:171],v[140:143],a[104:107]
l4 v9,s[28:31],s40 offen offset:3072 lds
mm a[100:103],v[164:167],v[140:143],a[100:103]
dt v[116:117],v25 offset:0
mm a[96:99],v[160:163],v[140:143],a[96:99]
s_add_u32 s40,s40,128
s_add_u32 m0,s44,32768
mm a[128:131],v[160:163],v[144:147],a[128:131]
dt v[118:119],v25 offset:2048
mm a[132:135],v[164:167],v[144:147],a[132:135]
l4 v10,s[32:35],s41 offen lds
mm a[136:139],v[168:171],v[144:147],a[136:139]
dr v[84:87],v18 offset:10240
mm a[140:143],v[172:175],v[144:147],a[140:143]
mm a[144:147],v[176:179],v[144:147],a[144:147]
dt v[120:121],v26 offset:0
mm a[148:151],v[180:183],v[144:147],a[148:151]
l4 v11,s[32:35],s41 offen offset:1024 lds
mm a[152:155],v[184:187],v[144:147],a[152:155]
dt v[122:123],v26 offset:2048
mm a[156:159],v[188:191],v[144:147],a[156:159]
mm a[188:191],v[188:191],v[148:151],a[188:191]
dr v[88:91],v18 offset:12288
mm a[184:187],v[184:187],v[148:151],a[184:187]
l4 v12,s[32:35],s41 offen offset:2048 lds
mm a[180:183],v[180:183],v[148:151],a[180:183]
dt v[124:125],v27 offset:0
mm a[176:179],v[176:179],v[148:151],a[176:179]
mm a[172:175],v[172:175],v[148:151],a[172:175]
dt v[126:127],v27 offset:2048
mm a[168:171],v[168:171],v[148:151],a[168:171]
l4 v13,s[32:35],s41 offen offset:3072 lds
mm a[164:167],v[164:167],v[148:151],a[164:167]
dr v[92:95],v18 offset:14336
mm a[160:163],v[160:163],v[148:151],a[160:163]
s_add_u32 m0,s44,36864
mm a[192:195],v[160:163],v[152:155],a[192:195]
l4 v14,s[32:35],s41 offen lds
mm a[196:199],v[164:167],v[152:155],a[196:199]
mm a[200:203],v[168:171],v[152:155],a[200:203]
mm a[204:207],v[172:175],v[152:155],a[204:207]
l4 v15,s[32:35],s41 offen offset:1024 lds
mm a[208:211],v[176:179],v[152:155],a[208:211]
mm a[212:215],v[180:183],v[152:155],a[212:215]
mm a[216:219],v[184:187],v[152:155],a[216:219]
l4 v16,s[32:35],s41 offen offset:2048 lds
mm a[220:223],v[188:191],v[152:155],a[220:223]
mm a[252:255],v[188:191],v[156:159],a[252:255]
mm a[248:251],v[184:187],v[156:159],a[248:251]
l4 v17,s[32:35],s41 offen offset:3072 lds
mm a[244:247],v[180:183],v[156:159],a[244:247]
s_add_u32 s41,s41,s46
mm a[240:243],v[176:179],v[156:159],a[240:243]
buffer_load_dword v39,v38,s[84:87],s88 offen offset:0
mm a[236:239],v[172:175],v[156:159],a[236:239]
s_add_u32 s88,s88,4096
s_cmp_lt_u32 s88,s89
mm a[232:235],v[168:171],v[156:159],a[232:235]
s_cselect_b32 s88,s88,0x40000000
wt lgkmcnt(0)
mm a[228:231],v[164:167],v[156:159],a[228:231]
s_sub_u32 s42,s42,1
s_cmp_lg_u32 s42,0
mm a[224:227],v[160:163],v[156:159],a[224:227]
s_cbranch_scc1 G1F_k
s_bitcmp1_b32 s20,10
s_cbranch_scc1 G1F_chain
mm a[0:3],v[96:99],v[64:67],a[0:3]
dt v[160:161],v20 offset:16384
mm a[4:7],v[100:103],v[64:67],a[4:7]
mm a[8:11],v[104:107],v[64:67],a[8:11]
dt v[162:163],v20 offset:18432
mm a[12:15],v[108:111],v[64:67],a[12:15]
mm a[16:19],v[112:115],v[64:67],a[16:19]
dr v[128:131],v19 offset:0
mm a[20:23],v[116:119],v[64:67],a[20:23]
mm a[24:27],v[120:123],v[64:67],a[24:27]
dt v[164:165],v21 offset:16384
mm a[28:31],v[124:127],v[64:67],a[28:31]
mm a[60:63],v[124:127],v[68:71],a[60:63]
dt v[166:167],v21 offset:18432
mm a[56:59],v[120:123],v[68:71],a[56:59]
mm a[52:55],v[116:119],v[68:71],a[52:55]
dr v[132:135],v19 offset:2048
mm a[48:51],v[112:115],v[68:71],a[48:51]
mm a[44:47],v[108:111],v[68:71],a[44:47]
dt v[168:169],v22 offset:16384
mm a[40:43],v[104:107],v[68:71],a[40:43]
mm a[36:39],v[100:103],v[68:71],a[36:39]
dt v[170:171],v22 offset:18432
mm a[32:35],v[96:99],v[68:71],a[32:35]
mm a[64:67],v[96:99],v[72:75],a[64:67]
dr v[136:139],v19 offset:4096
mm a[68:71],v[100:103],v[72:75],a[68:71]
mm a[72:75],v[104:107],v[72:75],a[72:75]
dt v[172:173],v23 offset:16384
mm a[76:79],v[108:111],v[72:75],a[76:79]
mm a[80:83],v[112:115],v[72:75],a[80:83]
dt v[174:175],v23 offset:18432
mm a[84:87],v[116:119],v[72:75],a[84:87]
mm a[88:91],v[120:123],v[72:75],a[88:91]
dr v[140:143],v19 offset:6144
mm a[92:95],v[124:127],v[72:75],a[92:95]
mm a[124:127],v[124:127],v[76:79],a[124:127]
dt v[176:177],v24 offset:16384
mm a[120:123],v[120:123],v[76:79],a[120:123]
mm a[116:119],v[116:119],v[76:79],a[116:119]
dt v[178:179],v24 offset:18432
mm a[112:115],v[112:115],v[76:79],a[112:115]
mm a[108:111],v[108:111],v[76:79],a[108:111]
dr v[144:147],v19 offset:8192
mm a[104:107],v[104:107],v[76:79],a[104:107]
mm a[100:103],v[100:103],v[76:79],a[100:103]
dt v[180:181],v25 offset:16384
mm a[96:99],v[96:99],v[76:79],a[96:99]
mm a[128:131],v[96:99],v[80:83],a[128:131]
dt v[182:183],v25 offset:18432
mm a[132:135],v[100:103],v[80:83],a[132:135]
mm a[136:139],v[104:107],v[80:83],a[136:139]
dr v[148:151],v19 offset:10240
mm a[140:143],v[108:111],v[80:83],a[140:143]
mm a[144:147],v[112:115],v[80:83],a[144:147]
dt v[184:185],v26 offset:16384
mm a[148:151],v[116:119],v[80:83],a[148:151]
mm a[152:155],v[120:123],v[80:83],a[152:155]
dt v[186:187],v26 offset:18432
mm a[156:159],v[124:127],v[80:83],a[156:159]
mm a[188:191],v[124:127],v[84:87],a[188:191]
dr v[152:155],v19 offset:12288
mm a[184:187],v[120:123],v[84:87],a[184:187]
mm a[180:183],v[116:119],v[84:87],a[180:183]
dt v[188:189],v27 offset:16384
mm a[176:179],v[112:115],v[84:87],a[176:179]
mm a[172:175],v[108:111],v[84:87],a[172:175]
dt v[190:191],v27 offset:18432
mm a[168:171],v[104:107],v[84:87],a[168:171]
mm a[164:167],v[100:103],v[84:87],a[164:167]
dr v[156:159],v19 offset:14336
mm a[160:163],v[96:99],v[84:87],a[160:163]
mm a[192:195],v[96:99],v[88:91],a[192:195]
mm a[196:199],v[100:103],v[88:91],a[196:199]
mm a[200:203],v[104:107],v[88:91],a[200:203]
mm a[204:207],v[108:111],v[88:91],a[204:207]
mm a[208:211],v[112:115],v[88:91],a[208:211]
mm a[212:215],v[116:119],v[88:91],a[212:215]
mm a[216:219],v[120:123],v[88:91],a[216:219]
mm a[220:223],v[124:127],v[88:91],a[220:223]
mm a[252:255],v[124:127],v[92:95],a[252:255]
mm a[248:251],v[120:123],v[92:95],a[248:251]
mm a[244:247],v[116:119],v[92:95],a[244:247]
mm a[240:243],v[112:115],v[92:95],a[240:243]
mm a[236:239],v[108:111],v[92:95],a[236:239]
mm a[232:235],v[104:107],v[92:95],a[232:235]
mm a[228:231],v[100:103],v[92:95],a[228:231]
mm a[224:227],v[96:99],v[92:95],a[224:227]
wt vmcnt(0) lgkmcnt(0)
s_barrier
mm a[0:3],v[160:163],v[128:131],a[0:3]
dt v[96:97],v20 offset:32768
mm a[4:7],v[164:167],v[128:131],a[4:7]
mm a[8:11],v[168:171],v[128:131],a[8:11]
dt v[98:99],v20 offset:34816
mm a[12:15],v[172:175],v[128:131],a[12:15]
mm a[16:19],v[176:179],v[128:131],a[16:19]
dr v[64:67],v18 offset:32768
mm a[20:23],v[180:183],v[128:131],a[20:23]
mm a[24:27],v[184:187],v[128:131],a[24:27]
dt v[100:101],v21 offset:32768
mm a[28:31],v[188:191],v[128:131],a[28:31]
mm a[60:63],v[188:191],v[132:135],a[60:63]
dt v[102:103],v21 offset:34816
mm a[56:59],v[184:187],v[132:135],a[56:59]
mm a[52:55],v[180:183],v[132:135],a[52:55]
dr v[68:71],v18 offset:34816
mm a[48:51],v[176:179],v[132:135],a[48:51]
mm a[44:47],v[172:175],v[132:135],a[44:47]
dt v[104:105],v22 offset:32768
mm a[40:43],v[168:171],v[132:135],a[40:43]
mm a[36:39],v[164:167],v[132:135],a[36:39]
dt v[106:107],v22 offset:34816
mm a[32:35],v[160:163],v[132:135],a[32:35]
mm a[64:67],v[160:163],v[136:139],a[64:67]
dr v[72:75],v18 offset:36864
mm a[68:71],v[164:167],v[136:139],a[68:71]
mm a[72:75],v[168:171],v[136:139],a[72:75]
dt v[108:109],v23 offset:32768
mm a[76:79],v[172:175],v[136:139],a[76:79]
mm a[80:83],v[176:179],v[136:139],a[80:83]
dt v[110:111],v23 offset:34816
mm a[84:87],v[180:183],v[136:139],a[84:87]
mm a[88:91],v[184:187],v[136:139],a[88:91]
dr v[76:79],v18 offset:38912
mm a[92:95],v[188:191],v[136:139],a[92:95]
mm a[124:127],v[188:191],v[140:143],a[124:127]
dt v[112:113],v24 offset:32768
mm a[120:123],v[184:187],v[140:143],a[120:123]
mm a[116:119],v[180:183],v[140:143],a[116:119]
dt v[114:115],v24 offset:34816
mm a[112:115],v[176:179],v[140:143],a[112:115]
mm a[108:111],v[172:175],v[140:143],a[108:111]
dr v[80:83],v18 offset:40960
mm a[104:107],v[168:171],v[140:143],a[104:107]
mm a[100:103],v[164:167],v[140:143],a[100:103]
dt v[116:117],v25 offset:32768
mm a[96:99],v[160:163],v[140:143],a[96:99]
mm a[128:131],v[160:163],v[144:147],a[128:131]
dt v[118:119],v25 offset:34816
mm a[132:135],v[164:167],v[144:147],a[132:135]
mm a[136:139],v[168:171],v[144:147],a[136:139]
dr v[84:87],v18 offset:43008
mm a[140:143],v[172:175],v[144:147],a[140:143]
mm a[144:147],v[176:179],v[144:147],a[144:147]
dt v[120:121],v26 offset:32768
mm a[148:151],v[180:183],v[144:147],a[148:151]
mm a[152:155],v[184:187],v[144:147],a[152:155]
dt v[122:123],v26 offset:34816
mm a[156:159],v[188:191],v[144:147],a[156:159]
mm a[188:191],v[188:191],v[148:151],a[188:191]
dr v[88:91],v18 offset:45056
mm a[184:187],v[184:187],v[148:151],a[184:187]
mm a[180:183],v[180:183],v[148:151],a[180:183]
dt v[124:125],v27 offset:32768
mm a[176:179],v[176:179],v[148:151],a[176:179]
mm a[172:175],v[172:175],v[148:151],a[172:175]
dt v[126:127],v27 offset:34816
mm a[168:171],v[168:171],v[148:151],a[168:171]
mm a[164:167],v[164:167],v[148:151],a[164:167]
dr v[92:95],v18 offset:47104
mm a[160:163],v[160:163],v[148:151],a[160:163]
mm a[192:195],v[160:163],v[152:155],a[192:195]
mm a[196:199],v[164:167],v[152:155],a[196:199]
mm a[200:203],v[168:171],v[152:155],a[200:203]
mm a[204:207],v[172:175],v[152:155],a[204:207]
mm a[208:211],v[176:179],v[152:155],a[208:211]
mm a[212:215],v[180:183],v[152:155],a[212:215]
mm a[216:219],v[184:187],v[152:155],a[216:219]
mm a[220:223],v[188:191],v[152:155],a[220:223]
mm a[252:255],v[188:191],v[156:159],a[252:255]
mm a[248:251],v[184:187],v[156:159],a[248:251]
mm a[244:247],v[180:183],v[156:159],a[244:247]
mm a[240:243],v[176:179],v[156:159],a[240:243]
mm a[236:239],v[172:175],v[156:159],a[236:239]
mm a[232:235],v[168:171],v[156:159],a[232:235]
mm a[228:231],v[164:167],v[156:159],a[228:231]
mm a[224:227],v[160:163],v[156:159],a[224:227]
wt lgkmcnt(0)
mm a[0:3],v[96:99],v[64:67],a[0:3]
dt v[160:161],v20 offset:49152
mm a[4:7],v[100:103],v[64:67],a[4:7]
mm a[8:11],v[104:107],v[64:67],a[8:11]
dt v[162:163],v20 offset:51200
mm a[12:15],v[108:111],v[64:67],a[12:15]
mm a[16:19],v[112:115],v[64:67],a[16:19]
dr v[128:131],v19 offset:32768
mm a[20:23],v[116:119],v[64:67],a[20:23]
mm a[24:27],v[120:123],v[64:67],a[24:27]
dt v[164:165],v21 offset:49152
mm a[28:31],v[124:127],v[64:67],a[28:31]
mm a[60:63],v[124:127],v[68:71],a[60:63]
dt v[166:167],v21 offset:51200
mm a[56:59],v[120:123],v[68:71],a[56:59]
mm a[52:55],v[116:119],v[68:71],a[52:55]
dr v[132:135],v19 offset:34816
mm a[48:51],v[112:115],v[68:71],a[48:51]
mm a[44:47],v[108:111],v[68:71],a[44:47]
dt v[168:169],v22 offset:49152
mm a[40:43],v[104:107],v[68:71],a[40:43]
mm a[36:39],v[100:103],v[68:71],a[36:39]
dt v[170:171],v22 offset:51200
mm a[32:35],v[96:99],v[68:71],a[32:35]
mm a[64:67],v[96:99],v[72:75],a[64:67]
dr v[136:139],v19 offset:36864
mm a[68:71],v[100:103],v[72:75],a[68:71]
mm a[72:75],v[104:107],v[72:75],a[72:75]
dt v[172:173],v23 offset:49152
mm a[76:79],v[108:111],v[72:75],a[76:79]
mm a[80:83],v[112:115],v[72:75],a[80:83]
dt v[174:175],v23 offset:51200
mm a[84:87],v[116:119],v[72:75],a[84:87]
mm a[88:91],v[120:123],v[72:75],a[88:91]
dr v[140:143],v19 offset:38912
mm a[92:95],v[124:127],v[72:75],a[92:95]
mm a[124:127],v[124:127],v[76:79],a[124:127]
dt v[176:177],v24 offset:49152
mm a[120:123],v[120:123],v[76:79],a[120:123]
mm a[116:119],v[116:119],v[76:79],a[116:119]
dt v[178:179],v24 offset:51200
mm a[112:115],v[112:115],v[76:79],a[112:115]
mm a[108:111],v[108:111],v[76:79],a[108:111]
dr v[144:147],v19 offset:40960
mm a[104:107],v[104:107],v[76:79],a[104:107]
mm a[100:103],v[100:103],v[76:79],a[100:103]
dt v[180:181],v25 offset:49152
mm a[96:99],v[96:99],v[76:79],a[96:99]
mm a[128:131],v[96:99],v[80:83],a[128:131]
dt v[182:183],v25 offset:51200
mm a[132:135],v[100:103],v[80:83],a[132:135]
mm a[136:139],v[104:107],v[80:83],a[136:139]
dr v[148:151],v19 offset:43008
mm a[140:143],v[108:111],v[80:83],a[140:143]
mm a[144:147],v[112:115],v[80:83],a[144:147]
dt v[184:185],v26 offset:49152
mm a[148:151],v[116:119],v[80:83],a[148:151]
mm a[152:155],v[120:123],v[80:83],a[152:155]
dt v[186:187],v26 offset:51200
mm a[156:159],v[124:127],v[80:83],a[156:159]
mm a[188:191],v[124:127],v[84:87],a[188:191]
dr v[152:155],v19 offset:45056
mm a[184:187],v[120:123],v[84:87],a[184:187]
mm a[180:183],v[116:119],v[84:87],a[180:183]
dt v[188:189],v27 offset:49152
mm a[176:179],v[112:115],v[84:87],a[176:179]
mm a[172:175],v[108:111],v[84:87],a[172:175]
dt v[190:191],v27 offset:51200
mm a[168:171],v[104:107],v[84:87],a[168:171]
mm a[164:167],v[100:103],v[84:87],a[164:167]
dr v[156:159],v19 offset:47104
mm a[160:163],v[96:99],v[84:87],a[160:163]
mm a[192:195],v[96:99],v[88:91],a[192:195]
mm a[196:199],v[100:103],v[88:91],a[196:199]
mm a[200:203],v[104:107],v[88:91],a[200:203]
mm a[204:207],v[108:111],v[88:91],a[204:207]
mm a[208:211],v[112:115],v[88:91],a[208:211]
mm a[212:215],v[116:119],v[88:91],a[212:215]
mm a[216:219],v[120:123],v[88:91],a[216:219]
mm a[220:223],v[124:127],v[88:91],a[220:223]
mm a[252:255],v[124:127],v[92:95],a[252:255]
mm a[248:251],v[120:123],v[92:95],a[248:251]
mm a[244:247],v[116:119],v[92:95],a[244:247]
mm a[240:243],v[112:115],v[92:95],a[240:243]
mm a[236:239],v[108:111],v[92:95],a[236:239]
mm a[232:235],v[104:107],v[92:95],a[232:235]
mm a[228:231],v[100:103],v[92:95],a[228:231]
mm a[224:227],v[96:99],v[92:95],a[224:227]
wt lgkmcnt(0)
mm a[0:3],v[160:163],v[128:131],a[0:3]
mm a[4:7],v[164:167],v[128:131],a[4:7]
mm a[8:11],v[168:171],v[128:131],a[8:11]
mm a[12:15],v[172:175],v[128:131],a[12:15]
mm a[16:19],v[176:179],v[128:131],a[16:19]
mm a[20:23],v[180:183],v[128:131],a[20:23]
mm a[24:27],v[184:187],v[128:131],a[24:27]
mm a[28:31],v[188:191],v[128:131],a[28:31]
mm a[60:63],v[188:191],v[132:135],a[60:63]
mm a[56:59],v[184:187],v[132:135],a[56:59]
mm a[52:55],v[180:183],v[132:135],a[52:55]
mm a[48:51],v[176:179],v[132:135],a[48:51]
mm a[44:47],v[172:175],v[132:135],a[44:47]
mm a[40:43],v[168:171],v[132:135],a[40:43]
mm a[36:39],v[164:167],v[132:135],a[36:39]
mm a[32:35],v[160:163],v[132:135],a[32:35]
mm a[64:67],v[160:163],v[136:139],a[64:67]
mm a[68:71],v[164:167],v[136:139],a[68:71]
mm a[72:75],v[168:171],v[136:139],a[72:75]
mm a[76:79],v[172:175],v[136:139],a[76:79]
mm a[80:83],v[176:179],v[136:139],a[80:83]
mm a[84:87],v[180:183],v[136:139],a[84:87]
mm a[88:91],v[184:187],v[136:139],a[88:91]
mm a[92:95],v[188:191],v[136:139],a[92:95]
mm a[124:127],v[188:191],v[140:143],a[124:127]
mm a[120:123],v[184:187],v[140:143],a[120:123]
mm a[116:119],v[180:183],v[140:143],a[116:119]
mm a[112:115],v[176:179],v[140:143],a[112:115]
mm a[108:111],v[172:175],v[140:143],a[108:111]
mm a[104:107],v[168:171],v[140:143],a[104:107]
mm a[100:103],v[164:167],v[140:143],a[100:103]
mm a[96:99],v[160:163],v[140:143],a[96:99]
mm a[128:131],v[160:163],v[144:147],a[128:131]
mm a[132:135],v[164:167],v[144:147],a[132:135]
mm a[136:139],v[168:171],v[144:147],a[136:139]
mm a[140:143],v[172:175],v[144:147],a[140:143]
mm a[144:147],v[176:179],v[144:147],a[144:147]
mm a[148:151],v[180:183],v[144:147],a[148:151]
mm a[152:155],v[184:187],v[144:147],a[152:155]
mm a[156:159],v[188:191],v[144:147],a[156:159]
mm a[188:191],v[188:191],v[148:151],a[188:191]
mm a[184:187],v[184:187],v[148:151],a[184:187]
mm a[180:183],v[180:183],v[148:151],a[180:183]
mm a[176:179],v[176:179],v[148:151],a[176:179]
mm a[172:175],v[172:175],v[148:151],a[172:175]
mm a[168:171],v[168:171],v[148:151],a[168:171]
mm a[164:167],v[164:167],v[148:151],a[164:167]
mm a[160:163],v[160:163],v[148:151],a[160:163]
mm a[192:195],v[160:163],v[152:155],a[192:195]
mm a[196:199],v[164:167],v[152:155],a[196:199]
mm a[200:203],v[168:171],v[152:155],a[200:203]
mm a[204:207],v[172:175],v[152:155],a[204:207]
mm a[208:211],v[176:179],v[152:155],a[208:211]
mm a[212:215],v[180:183],v[152:155],a[212:215]
mm a[216:219],v[184:187],v[152:155],a[216:219]
mm a[220:223],v[188:191],v[152:155],a[220:223]
mm a[252:255],v[188:191],v[156:159],a[252:255]
mm a[248:251],v[184:187],v[156:159],a[248:251]
mm a[244:247],v[180:183],v[156:159],a[244:247]
mm a[240:243],v[176:179],v[156:159],a[240:243]
mm a[236:239],v[172:175],v[156:159],a[236:239]
mm a[232:235],v[168:171],v[156:159],a[232:235]
mm a[228:231],v[164:167],v[156:159],a[228:231]
mm a[224:227],v[160:163],v[156:159],a[224:227]
s_cmp_eq_u32 s90,4
s_cbranch_scc1 G_ebq
v_mov_b32 v45,0
buffer_load_dword v44,v45,s[8:11],s24 offen sc1
s_lshl_b32 s48,s76,22
s_lshl_b32 s49,s77,14
s_add_u32 s48,s48,s49
s_lshl_b32 s49,s93,0
s_add_u32 s48,s48,s49
s_xor_b32 s48,s48,s7
ar v192,a0
ar v193,a1
ar v194,a2
ar v195,a3
ar v196,a4
ar v197,a5
ar v198,a6
ar v199,a7
cv v200,v192,v193
cv v201,v194,v195
cv v202,v196,v197
cv v203,v198,v199
w4 v[200:203],v28,s[8:11],s48 offen sc1
ar v204,a8
ar v205,a9
ar v206,a10
ar v207,a11
ar v208,a12
ar v209,a13
ar v210,a14
ar v211,a15
cv v212,v204,v205
cv v213,v206,v207
cv v214,v208,v209
cv v215,v210,v211
w4 v[212:215],v28,s[8:11],s48 offen offset:2048 sc1
ar v216,a16
ar v217,a17
ar v218,a18
ar v219,a19
ar v220,a20
ar v221,a21
ar v222,a22
ar v223,a23
cv v224,v216,v217
cv v225,v218,v219
cv v226,v220,v221
cv v227,v222,v223
s_add_u32 s48,s48,4096
w4 v[224:227],v28,s[8:11],s48 offen sc1
ar v228,a24
ar v229,a25
ar v230,a26
ar v231,a27
ar v232,a28
ar v233,a29
ar v234,a30
ar v235,a31
cv v236,v228,v229
cv v237,v230,v231
cv v238,v232,v233
cv v239,v234,v235
w4 v[236:239],v28,s[8:11],s48 offen offset:2048 sc1
s_add_u32 s48,s48,-4096
ar v192,a32
ar v193,a33
ar v194,a34
ar v195,a35
ar v196,a36
ar v197,a37
ar v198,a38
ar v199,a39
cv v200,v192,v193
cv v201,v194,v195
cv v202,v196,v197
cv v203,v198,v199
w4 v[200:203],v28,s[8:11],s48 offen offset:256 sc1
ar v204,a40
ar v205,a41
ar v206,a42
ar v207,a43
ar v208,a44
ar v209,a45
ar v210,a46
ar v211,a47
cv v212,v204,v205
cv v213,v206,v207
cv v214,v208,v209
cv v215,v210,v211
w4 v[212:215],v28,s[8:11],s48 offen offset:2304 sc1
ar v216,a48
ar v217,a49
ar v218,a50
ar v219,a51
ar v220,a52
ar v221,a53
ar v222,a54
ar v223,a55
cv v224,v216,v217
cv v225,v218,v219
cv v226,v220,v221
cv v227,v222,v223
s_add_u32 s48,s48,4096
w4 v[224:227],v28,s[8:11],s48 offen offset:256 sc1
ar v228,a56
ar v229,a57
ar v230,a58
ar v231,a59
ar v232,a60
ar v233,a61
ar v234,a62
ar v235,a63
cv v236,v228,v229
cv v237,v230,v231
cv v238,v232,v233
cv v239,v234,v235
w4 v[236:239],v28,s[8:11],s48 offen offset:2304 sc1
s_add_u32 s48,s48,520192
ar v192,a64
ar v193,a65
ar v194,a66
ar v195,a67
ar v196,a68
ar v197,a69
ar v198,a70
ar v199,a71
cv v200,v192,v193
cv v201,v194,v195
cv v202,v196,v197
cv v203,v198,v199
w4 v[200:203],v28,s[8:11],s48 offen sc1
ar v204,a72
ar v205,a73
ar v206,a74
ar v207,a75
ar v208,a76
ar v209,a77
ar v210,a78
ar v211,a79
cv v212,v204,v205
cv v213,v206,v207
cv v214,v208,v209
cv v215,v210,v211
w4 v[212:215],v28,s[8:11],s48 offen offset:2048 sc1
ar v216,a80
ar v217,a81
ar v218,a82
ar v219,a83
ar v220,a84
ar v221,a85
ar v222,a86
ar v223,a87
cv v224,v216,v217
cv v225,v218,v219
cv v226,v220,v221
cv v227,v222,v223
s_add_u32 s48,s48,4096
w4 v[224:227],v28,s[8:11],s48 offen sc1
ar v228,a88
ar v229,a89
ar v230,a90
ar v231,a91
ar v232,a92
ar v233,a93
ar v234,a94
ar v235,a95
cv v236,v228,v229
cv v237,v230,v231
cv v238,v232,v233
cv v239,v234,v235
w4 v[236:239],v28,s[8:11],s48 offen offset:2048 sc1
s_add_u32 s48,s48,-4096
ar v192,a96
ar v193,a97
ar v194,a98
ar v195,a99
ar v196,a100
ar v197,a101
ar v198,a102
ar v199,a103
cv v200,v192,v193
cv v201,v194,v195
cv v202,v196,v197
cv v203,v198,v199
w4 v[200:203],v28,s[8:11],s48 offen offset:256 sc1
ar v204,a104
ar v205,a105
ar v206,a106
ar v207,a107
ar v208,a108
ar v209,a109
ar v210,a110
ar v211,a111
cv v212,v204,v205
cv v213,v206,v207
cv v214,v208,v209
cv v215,v210,v211
w4 v[212:215],v28,s[8:11],s48 offen offset:2304 sc1
ar v216,a112
ar v217,a113
ar v218,a114
ar v219,a115
ar v220,a116
ar v221,a117
ar v222,a118
ar v223,a119
cv v224,v216,v217
cv v225,v218,v219
cv v226,v220,v221
cv v227,v222,v223
s_add_u32 s48,s48,4096
w4 v[224:227],v28,s[8:11],s48 offen offset:256 sc1
ar v228,a120
ar v229,a121
ar v230,a122
ar v231,a123
ar v232,a124
ar v233,a125
ar v234,a126
ar v235,a127
cv v236,v228,v229
cv v237,v230,v231
cv v238,v232,v233
cv v239,v234,v235
w4 v[236:239],v28,s[8:11],s48 offen offset:2304 sc1
s_add_u32 s48,s48,520192
ar v192,a128
ar v193,a129
ar v194,a130
ar v195,a131
ar v196,a132
ar v197,a133
ar v198,a134
ar v199,a135
cv v200,v192,v193
cv v201,v194,v195
cv v202,v196,v197
cv v203,v198,v199
w4 v[200:203],v28,s[8:11],s48 offen sc1
ar v204,a136
ar v205,a137
ar v206,a138
ar v207,a139
ar v208,a140
ar v209,a141
ar v210,a142
ar v211,a143
cv v212,v204,v205
cv v213,v206,v207
cv v214,v208,v209
cv v215,v210,v211
w4 v[212:215],v28,s[8:11],s48 offen offset:2048 sc1
ar v216,a144
ar v217,a145
ar v218,a146
ar v219,a147
ar v220,a148
ar v221,a149
ar v222,a150
ar v223,a151
cv v224,v216,v217
cv v225,v218,v219
cv v226,v220,v221
cv v227,v222,v223
s_add_u32 s48,s48,4096
w4 v[224:227],v28,s[8:11],s48 offen sc1
ar v228,a152
ar v229,a153
ar v230,a154
ar v231,a155
ar v232,a156
ar v233,a157
ar v234,a158
ar v235,a159
cv v236,v228,v229
cv v237,v230,v231
cv v238,v232,v233
cv v239,v234,v235
w4 v[236:239],v28,s[8:11],s48 offen offset:2048 sc1
s_add_u32 s48,s48,-4096
ar v192,a160
ar v193,a161
ar v194,a162
ar v195,a163
ar v196,a164
ar v197,a165
ar v198,a166
ar v199,a167
cv v200,v192,v193
cv v201,v194,v195
cv v202,v196,v197
cv v203,v198,v199
w4 v[200:203],v28,s[8:11],s48 offen offset:256 sc1
ar v204,a168
ar v205,a169
ar v206,a170
ar v207,a171
ar v208,a172
ar v209,a173
ar v210,a174
ar v211,a175
cv v212,v204,v205
cv v213,v206,v207
cv v214,v208,v209
cv v215,v210,v211
w4 v[212:215],v28,s[8:11],s48 offen offset:2304 sc1
ar v216,a176
ar v217,a177
ar v218,a178
ar v219,a179
ar v220,a180
ar v221,a181
ar v222,a182
ar v223,a183
cv v224,v216,v217
cv v225,v218,v219
cv v226,v220,v221
cv v227,v222,v223
s_add_u32 s48,s48,4096
w4 v[224:227],v28,s[8:11],s48 offen offset:256 sc1
ar v228,a184
ar v229,a185
ar v230,a186
ar v231,a187
ar v232,a188
ar v233,a189
ar v234,a190
ar v235,a191
cv v236,v228,v229
cv v237,v230,v231
cv v238,v232,v233
cv v239,v234,v235
w4 v[236:239],v28,s[8:11],s48 offen offset:2304 sc1
s_add_u32 s48,s48,520192
ar v192,a192
ar v193,a193
ar v194,a194
ar v195,a195
ar v196,a196
ar v197,a197
ar v198,a198
ar v199,a199
cv v200,v192,v193
cv v201,v194,v195
cv v202,v196,v197
cv v203,v198,v199
w4 v[200:203],v28,s[8:11],s48 offen sc1
ar v204,a200
ar v205,a201
ar v206,a202
ar v207,a203
ar v208,a204
ar v209,a205
ar v210,a206
ar v211,a207
cv v212,v204,v205
cv v213,v206,v207
cv v214,v208,v209
cv v215,v210,v211
w4 v[212:215],v28,s[8:11],s48 offen offset:2048 sc1
ar v216,a208
ar v217,a209
ar v218,a210
ar v219,a211
ar v220,a212
ar v221,a213
ar v222,a214
ar v223,a215
cv v224,v216,v217
cv v225,v218,v219
cv v226,v220,v221
cv v227,v222,v223
s_add_u32 s48,s48,4096
w4 v[224:227],v28,s[8:11],s48 offen sc1
ar v228,a216
ar v229,a217
ar v230,a218
ar v231,a219
ar v232,a220
ar v233,a221
ar v234,a222
ar v235,a223
cv v236,v228,v229
cv v237,v230,v231
cv v238,v232,v233
cv v239,v234,v235
w4 v[236:239],v28,s[8:11],s48 offen offset:2048 sc1
s_add_u32 s48,s48,-4096
ar v192,a224
ar v193,a225
ar v194,a226
ar v195,a227
ar v196,a228
ar v197,a229
ar v198,a230
ar v199,a231
cv v200,v192,v193
cv v201,v194,v195
cv v202,v196,v197
cv v203,v198,v199
w4 v[200:203],v28,s[8:11],s48 offen offset:256 sc1
ar v204,a232
ar v205,a233
ar v206,a234
ar v207,a235
ar v208,a236
ar v209,a237
ar v210,a238
ar v211,a239
cv v212,v204,v205
cv v213,v206,v207
cv v214,v208,v209
cv v215,v210,v211
w4 v[212:215],v28,s[8:11],s48 offen offset:2304 sc1
ar v216,a240
ar v217,a241
ar v218,a242
ar v219,a243
ar v220,a244
ar v221,a245
ar v222,a246
ar v223,a247
cv v224,v216,v217
cv v225,v218,v219
cv v226,v220,v221
cv v227,v222,v223
s_add_u32 s48,s48,4096
w4 v[224:227],v28,s[8:11],s48 offen offset:256 sc1
ar v228,a248
ar v229,a249
ar v230,a250
ar v231,a251
ar v232,a252
ar v233,a253
ar v234,a254
ar v235,a255
cv v236,v228,v229
cv v237,v230,v231
cv v238,v232,v233
cv v239,v234,v235
w4 v[236:239],v28,s[8:11],s48 offen offset:2304 sc1
s_add_u32 s48,s48,520192
s_and_b32 s50,s97,3
s_cselect_b32 s50,2,512
s_bitcmp1_b32 s97,5
s_cbranch_scc0 G1F_sn
s_mov_b32 s100,s96
s_mov_b32 s101,s50
wt vmcnt(32)
s_branch G_have
G1F_sn:
wt vmcnt(0)
s_barrier
s_cmp_eq_u32 s14,0
s_cbranch_scc0 G1F_s
v_mul_u32_u24 v30,2048,v1
v_mov_b32 v31,s50
s_mov_b64 exec,3
buffer_atomic_add v31,v30,s[8:11],s96 offen sc1
s_mov_b64 exec,-1
G1F_s:
s_branch G_have
G1F_chain:
mm a[0:3],v[96:99],v[64:67],a[0:3]
dt v[160:161],v20 offset:16384
s_mov_b32 s78,s20
mm a[4:7],v[100:103],v[64:67],a[4:7]
s_and_b32 s20,s20,0xff
s_mov_b32 s40,s21
mm a[8:11],v[104:107],v[64:67],a[8:11]
dt v[162:163],v20 offset:18432
s_mov_b32 s41,s22
mm a[12:15],v[108:111],v[64:67],a[12:15]
s_mov_b32 s47,8192
s_mov_b32 s34,0x800000
mm a[16:19],v[112:115],v[64:67],a[16:19]
dr v[128:131],v19 offset:0
s_cmp_ge_u32 s20,3
mm a[20:23],v[116:119],v[64:67],a[20:23]
s_cselect_b64 s[28:29],s[70:71],s[60:61]
s_cselect_b32 s47,6144,s47
mm a[24:27],v[120:123],v[64:67],a[24:27]
dt v[164:165],v21 offset:16384
s_cselect_b32 s34,0x600000,s34
mm a[28:31],v[124:127],v[64:67],a[28:31]
s_cselect_b64 s[32:33],s[72:73],s[62:63]
s_cselect_b32 s48,0,s27
mm a[60:63],v[124:127],v[68:71],a[60:63]
dt v[166:167],v21 offset:18432
s_and_b32 s48,s48,3
mm a[56:59],v[120:123],v[68:71],a[56:59]
s_cmp_eq_u32 s48,1
s_cselect_b64 s[32:33],s[64:65],s[32:33]
mm a[52:55],v[116:119],v[68:71],a[52:55]
dr v[132:135],v19 offset:2048
s_cmp_eq_u32 s48,2
mm a[48:51],v[112:115],v[68:71],a[48:51]
s_cselect_b64 s[32:33],s[66:67],s[32:33]
s_movk_i32 s50,128
mm a[44:47],v[108:111],v[68:71],a[44:47]
dt v[168:169],v22 offset:16384
s_cmp_eq_u32 s20,3
mm a[40:43],v[104:107],v[68:71],a[40:43]
s_cselect_b32 s50,64,s50
s_cselect_b32 s51,2048,64
mm a[36:39],v[100:103],v[68:71],a[36:39]
dt v[170:171],v22 offset:18432
s_lshl_b32 s46,s47,6
mm a[32:35],v[96:99],v[68:71],a[32:35]
s_lshl_b32 s48,s14,4
v_bfe_u32 v30,v1,5,1
mm a[64:67],v[96:99],v[72:75],a[64:67]
dr v[136:139],v19 offset:4096
v_add_u32 v30,s48,v30
mm a[68:71],v[100:103],v[72:75],a[68:71]
v_mul_lo_u32 v30,v30,s47
v_bfe_u32 v31,v1,0,1
mm a[72:75],v[104:107],v[72:75],a[72:75]
dt v[172:173],v23 offset:16384
v_lshlrev_b32 v31,4,v31
mm a[76:79],v[108:111],v[72:75],a[76:79]
v_add_u32 v30,v30,v31
v_bfe_u32 v31,v1,1,4
mm a[80:83],v[112:115],v[72:75],a[80:83]
dt v[174:175],v23 offset:18432
v_bfe_u32 v32,v1,5,1
mm a[84:87],v[116:119],v[72:75],a[84:87]
v_xor_b32 v31,v31,v32
v_and_b32 v32,1,v31
mm a[88:91],v[120:123],v[72:75],a[88:91]
dr v[140:143],v19 offset:6144
v_lshl_add_u32 v30,v32,5,v30
mm a[92:95],v[124:127],v[72:75],a[92:95]
v_xor_b32 v32,0,v31
v_lshrrev_b32 v33,2,v32
mm a[124:127],v[124:127],v[76:79],a[124:127]
dt v[176:177],v24 offset:16384
v_mad_u32_u24 v33,v33,s50,v30
mm a[120:123],v[120:123],v[76:79],a[120:123]
v_bfe_u32 v32,v32,1,1
v_mad_u32_u24 v33,v32,s51,v33
mm a[116:119],v[116:119],v[76:79],a[116:119]
dt v[178:179],v24 offset:18432
s_mul_i32 s48,s47,0
mm a[112:115],v[112:115],v[76:79],a[112:115]
s_sub_u32 s48,s48,0
v_add_u32 v10,s48,v33
mm a[108:111],v[108:111],v[76:79],a[108:111]
dr v[144:147],v19 offset:8192
s_mul_i32 s48,s47,4
mm a[104:107],v[104:107],v[76:79],a[104:107]
s_sub_u32 s48,s48,2048
v_add_u32 v12,s48,v33
mm a[100:103],v[100:103],v[76:79],a[100:103]
dt v[180:181],v25 offset:16384
v_xor_b32 v32,2,v31
mm a[96:99],v[96:99],v[76:79],a[96:99]
v_lshrrev_b32 v33,2,v32
v_mad_u32_u24 v33,v33,s50,v30
mm a[128:131],v[96:99],v[80:83],a[128:131]
dt v[182:183],v25 offset:18432
v_bfe_u32 v32,v32,1,1
mm a[132:135],v[100:103],v[80:83],a[132:135]
v_mad_u32_u24 v33,v32,s51,v33
s_mul_i32 s48,s47,2
mm a[136:139],v[104:107],v[80:83],a[136:139]
dr v[148:151],v19 offset:10240
s_sub_u32 s48,s48,1024
mm a[140:143],v[108:111],v[80:83],a[140:143]
v_add_u32 v11,s48,v33
s_mul_i32 s48,s47,6
mm a[144:147],v[112:115],v[80:83],a[144:147]
dt v[184:185],v26 offset:16384
s_sub_u32 s48,s48,3072
mm a[148:151],v[116:119],v[80:83],a[148:151]
v_add_u32 v13,s48,v33
v_xor_b32 v32,4,v31
mm a[152:155],v[120:123],v[80:83],a[152:155]
dt v[186:187],v26 offset:18432
v_lshrrev_b32 v33,2,v32
mm a[156:159],v[124:127],v[80:83],a[156:159]
v_mad_u32_u24 v33,v33,s50,v30
v_bfe_u32 v32,v32,1,1
mm a[188:191],v[124:127],v[84:87],a[188:191]
dr v[152:155],v19 offset:12288
v_mad_u32_u24 v33,v32,s51,v33
mm a[184:187],v[120:123],v[84:87],a[184:187]
s_mul_i32 s48,s47,8
s_sub_u32 s48,s48,0
mm a[180:183],v[116:119],v[84:87],a[180:183]
dt v[188:189],v27 offset:16384
v_add_u32 v14,s48,v33
mm a[176:179],v[112:115],v[84:87],a[176:179]
s_mul_i32 s48,s47,12
s_sub_u32 s48,s48,2048
mm a[172:175],v[108:111],v[84:87],a[172:175]
dt v[190:191],v27 offset:18432
v_add_u32 v16,s48,v33
mm a[168:171],v[104:107],v[84:87],a[168:171]
v_xor_b32 v32,6,v31
v_lshrrev_b32 v33,2,v32
mm a[164:167],v[100:103],v[84:87],a[164:167]
dr v[156:159],v19 offset:14336
v_mad_u32_u24 v33,v33,s50,v30
mm a[160:163],v[96:99],v[84:87],a[160:163]
v_bfe_u32 v32,v32,1,1
v_mad_u32_u24 v33,v32,s51,v33
mm a[192:195],v[96:99],v[88:91],a[192:195]
s_mul_i32 s48,s47,10
s_sub_u32 s48,s48,1024
mm a[196:199],v[100:103],v[88:91],a[196:199]
v_add_u32 v15,s48,v33
s_mul_i32 s48,s47,14
mm a[200:203],v[104:107],v[88:91],a[200:203]
s_sub_u32 s48,s48,3072
v_add_u32 v17,s48,v33
mm a[204:207],v[108:111],v[88:91],a[204:207]
mm a[208:211],v[112:115],v[88:91],a[208:211]
mm a[212:215],v[116:119],v[88:91],a[212:215]
mm a[216:219],v[120:123],v[88:91],a[216:219]
mm a[220:223],v[124:127],v[88:91],a[220:223]
mm a[252:255],v[124:127],v[92:95],a[252:255]
mm a[248:251],v[120:123],v[92:95],a[248:251]
mm a[244:247],v[116:119],v[92:95],a[244:247]
mm a[240:243],v[112:115],v[92:95],a[240:243]
mm a[236:239],v[108:111],v[92:95],a[236:239]
mm a[232:235],v[104:107],v[92:95],a[232:235]
mm a[228:231],v[100:103],v[92:95],a[228:231]
mm a[224:227],v[96:99],v[92:95],a[224:227]
wt vmcnt(0) lgkmcnt(0)
s_barrier
mm a[0:3],v[160:163],v[128:131],a[0:3]
dt v[96:97],v20 offset:32768
s_add_u32 m0,s43,0
mm a[4:7],v[164:167],v[128:131],a[4:7]
l4 v2,s[28:31],s40 offen lds
mm a[8:11],v[168:171],v[128:131],a[8:11]
dt v[98:99],v20 offset:34816
mm a[12:15],v[172:175],v[128:131],a[12:15]
mm a[16:19],v[176:179],v[128:131],a[16:19]
dr v[64:67],v18 offset:32768
mm a[20:23],v[180:183],v[128:131],a[20:23]
l4 v3,s[28:31],s40 offen offset:1024 lds
mm a[24:27],v[184:187],v[128:131],a[24:27]
dt v[100:101],v21 offset:32768
mm a[28:31],v[188:191],v[128:131],a[28:31]
mm a[60:63],v[188:191],v[132:135],a[60:63]
dt v[102:103],v21 offset:34816
mm a[56:59],v[184:187],v[132:135],a[56:59]
l4 v4,s[28:31],s40 offen offset:2048 lds
mm a[52:55],v[180:183],v[132:135],a[52:55]
dr v[68:71],v18 offset:34816
mm a[48:51],v[176:179],v[132:135],a[48:51]
mm a[44:47],v[172:175],v[132:135],a[44:47]
dt v[104:105],v22 offset:32768
mm a[40:43],v[168:171],v[132:135],a[40:43]
l4 v5,s[28:31],s40 offen offset:3072 lds
mm a[36:39],v[164:167],v[132:135],a[36:39]
dt v[106:107],v22 offset:34816
mm a[32:35],v[160:163],v[132:135],a[32:35]
s_add_u32 m0,s43,4096
mm a[64:67],v[160:163],v[136:139],a[64:67]
dr v[72:75],v18 offset:36864
mm a[68:71],v[164:167],v[136:139],a[68:71]
l4 v6,s[28:31],s40 offen lds
mm a[72:75],v[168:171],v[136:139],a[72:75]
dt v[108:109],v23 offset:32768
mm a[76:79],v[172:175],v[136:139],a[76:79]
mm a[80:83],v[176:179],v[136:139],a[80:83]
dt v[110:111],v23 offset:34816
mm a[84:87],v[180:183],v[136:139],a[84:87]
l4 v7,s[28:31],s40 offen offset:1024 lds
mm a[88:91],v[184:187],v[136:139],a[88:91]
dr v[76:79],v18 offset:38912
mm a[92:95],v[188:191],v[136:139],a[92:95]
mm a[124:127],v[188:191],v[140:143],a[124:127]
dt v[112:113],v24 offset:32768
mm a[120:123],v[184:187],v[140:143],a[120:123]
l4 v8,s[28:31],s40 offen offset:2048 lds
mm a[116:119],v[180:183],v[140:143],a[116:119]
dt v[114:115],v24 offset:34816
mm a[112:115],v[176:179],v[140:143],a[112:115]
mm a[108:111],v[172:175],v[140:143],a[108:111]
dr v[80:83],v18 offset:40960
mm a[104:107],v[168:171],v[140:143],a[104:107]
l4 v9,s[28:31],s40 offen offset:3072 lds
mm a[100:103],v[164:167],v[140:143],a[100:103]
dt v[116:117],v25 offset:32768
mm a[96:99],v[160:163],v[140:143],a[96:99]
s_add_u32 s40,s40,128
s_add_u32 m0,s44,0
mm a[128:131],v[160:163],v[144:147],a[128:131]
dt v[118:119],v25 offset:34816
mm a[132:135],v[164:167],v[144:147],a[132:135]
l4 v10,s[32:35],s41 offen lds
mm a[136:139],v[168:171],v[144:147],a[136:139]
dr v[84:87],v18 offset:43008
mm a[140:143],v[172:175],v[144:147],a[140:143]
mm a[144:147],v[176:179],v[144:147],a[144:147]
dt v[120:121],v26 offset:32768
mm a[148:151],v[180:183],v[144:147],a[148:151]
l4 v11,s[32:35],s41 offen offset:1024 lds
mm a[152:155],v[184:187],v[144:147],a[152:155]
dt v[122:123],v26 offset:34816
mm a[156:159],v[188:191],v[144:147],a[156:159]
mm a[188:191],v[188:191],v[148:151],a[188:191]
dr v[88:91],v18 offset:45056
mm a[184:187],v[184:187],v[148:151],a[184:187]
l4 v12,s[32:35],s41 offen offset:2048 lds
mm a[180:183],v[180:183],v[148:151],a[180:183]
dt v[124:125],v27 offset:32768
mm a[176:179],v[176:179],v[148:151],a[176:179]
mm a[172:175],v[172:175],v[148:151],a[172:175]
dt v[126:127],v27 offset:34816
mm a[168:171],v[168:171],v[148:151],a[168:171]
l4 v13,s[32:35],s41 offen offset:3072 lds
mm a[164:167],v[164:167],v[148:151],a[164:167]
dr v[92:95],v18 offset:47104
mm a[160:163],v[160:163],v[148:151],a[160:163]
s_add_u32 m0,s44,4096
mm a[192:195],v[160:163],v[152:155],a[192:195]
l4 v14,s[32:35],s41 offen lds
mm a[196:199],v[164:167],v[152:155],a[196:199]
mm a[200:203],v[168:171],v[152:155],a[200:203]
mm a[204:207],v[172:175],v[152:155],a[204:207]
l4 v15,s[32:35],s41 offen offset:1024 lds
mm a[208:211],v[176:179],v[152:155],a[208:211]
mm a[212:215],v[180:183],v[152:155],a[212:215]
mm a[216:219],v[184:187],v[152:155],a[216:219]
l4 v16,s[32:35],s41 offen offset:2048 lds
mm a[220:223],v[188:191],v[152:155],a[220:223]
mm a[252:255],v[188:191],v[156:159],a[252:255]
mm a[248:251],v[184:187],v[156:159],a[248:251]
l4 v17,s[32:35],s41 offen offset:3072 lds
mm a[244:247],v[180:183],v[156:159],a[244:247]
s_add_u32 s41,s41,s46
mm a[240:243],v[176:179],v[156:159],a[240:243]
mm a[236:239],v[172:175],v[156:159],a[236:239]
wt lgkmcnt(0)
mm a[232:235],v[168:171],v[156:159],a[232:235]
mm a[228:231],v[164:167],v[156:159],a[228:231]
mm a[224:227],v[160:163],v[156:159],a[224:227]
mm a[0:3],v[96:99],v[64:67],a[0:3]
dt v[160:161],v20 offset:49152
mm a[4:7],v[100:103],v[64:67],a[4:7]
mm a[8:11],v[104:107],v[64:67],a[8:11]
dt v[162:163],v20 offset:51200
mm a[12:15],v[108:111],v[64:67],a[12:15]
mm a[16:19],v[112:115],v[64:67],a[16:19]
dr v[128:131],v19 offset:32768
mm a[20:23],v[116:119],v[64:67],a[20:23]
mm a[24:27],v[120:123],v[64:67],a[24:27]
dt v[164:165],v21 offset:49152
mm a[28:31],v[124:127],v[64:67],a[28:31]
mm a[60:63],v[124:127],v[68:71],a[60:63]
dt v[166:167],v21 offset:51200
mm a[56:59],v[120:123],v[68:71],a[56:59]
mm a[52:55],v[116:119],v[68:71],a[52:55]
dr v[132:135],v19 offset:34816
mm a[48:51],v[112:115],v[68:71],a[48:51]
mm a[44:47],v[108:111],v[68:71],a[44:47]
dt v[168:169],v22 offset:49152
mm a[40:43],v[104:107],v[68:71],a[40:43]
mm a[36:39],v[100:103],v[68:71],a[36:39]
dt v[170:171],v22 offset:51200
mm a[32:35],v[96:99],v[68:71],a[32:35]
mm a[64:67],v[96:99],v[72:75],a[64:67]
dr v[136:139],v19 offset:36864
mm a[68:71],v[100:103],v[72:75],a[68:71]
mm a[72:75],v[104:107],v[72:75],a[72:75]
dt v[172:173],v23 offset:49152
mm a[76:79],v[108:111],v[72:75],a[76:79]
mm a[80:83],v[112:115],v[72:75],a[80:83]
dt v[174:175],v23 offset:51200
mm a[84:87],v[116:119],v[72:75],a[84:87]
mm a[88:91],v[120:123],v[72:75],a[88:91]
dr v[140:143],v19 offset:38912
mm a[92:95],v[124:127],v[72:75],a[92:95]
mm a[124:127],v[124:127],v[76:79],a[124:127]
dt v[176:177],v24 offset:49152
mm a[120:123],v[120:123],v[76:79],a[120:123]
mm a[116:119],v[116:119],v[76:79],a[116:119]
dt v[178:179],v24 offset:51200
mm a[112:115],v[112:115],v[76:79],a[112:115]
mm a[108:111],v[108:111],v[76:79],a[108:111]
dr v[144:147],v19 offset:40960
mm a[104:107],v[104:107],v[76:79],a[104:107]
mm a[100:103],v[100:103],v[76:79],a[100:103]
dt v[180:181],v25 offset:49152
mm a[96:99],v[96:99],v[76:79],a[96:99]
mm a[128:131],v[96:99],v[80:83],a[128:131]
dt v[182:183],v25 offset:51200
mm a[132:135],v[100:103],v[80:83],a[132:135]
mm a[136:139],v[104:107],v[80:83],a[136:139]
dr v[148:151],v19 offset:43008
mm a[140:143],v[108:111],v[80:83],a[140:143]
mm a[144:147],v[112:115],v[80:83],a[144:147]
dt v[184:185],v26 offset:49152
mm a[148:151],v[116:119],v[80:83],a[148:151]
mm a[152:155],v[120:123],v[80:83],a[152:155]
dt v[186:187],v26 offset:51200
mm a[156:159],v[124:127],v[80:83],a[156:159]
mm a[188:191],v[124:127],v[84:87],a[188:191]
dr v[152:155],v19 offset:45056
mm a[184:187],v[120:123],v[84:87],a[184:187]
mm a[180:183],v[116:119],v[84:87],a[180:183]
dt v[188:189],v27 offset:49152
mm a[176:179],v[112:115],v[84:87],a[176:179]
mm a[172:175],v[108:111],v[84:87],a[172:175]
dt v[190:191],v27 offset:51200
mm a[168:171],v[104:107],v[84:87],a[168:171]
mm a[164:167],v[100:103],v[84:87],a[164:167]
dr v[156:159],v19 offset:47104
mm a[160:163],v[96:99],v[84:87],a[160:163]
mm a[192:195],v[96:99],v[88:91],a[192:195]
mm a[196:199],v[100:103],v[88:91],a[196:199]
mm a[200:203],v[104:107],v[88:91],a[200:203]
mm a[204:207],v[108:111],v[88:91],a[204:207]
mm a[208:211],v[112:115],v[88:91],a[208:211]
mm a[212:215],v[116:119],v[88:91],a[212:215]
mm a[216:219],v[120:123],v[88:91],a[216:219]
mm a[220:223],v[124:127],v[88:91],a[220:223]
mm a[252:255],v[124:127],v[92:95],a[252:255]
mm a[248:251],v[120:123],v[92:95],a[248:251]
mm a[244:247],v[116:119],v[92:95],a[244:247]
mm a[240:243],v[112:115],v[92:95],a[240:243]
mm a[236:239],v[108:111],v[92:95],a[236:239]
mm a[232:235],v[104:107],v[92:95],a[232:235]
mm a[228:231],v[100:103],v[92:95],a[228:231]
mm a[224:227],v[96:99],v[92:95],a[224:227]
wt vmcnt(0) lgkmcnt(0)
s_barrier
mm a[0:3],v[160:163],v[128:131],a[0:3]
dt v[96:97],v20 offset:0
s_add_u32 m0,s43,32768
mm a[4:7],v[164:167],v[128:131],a[4:7]
l4 v2,s[28:31],s40 offen lds
mm a[8:11],v[168:171],v[128:131],a[8:11]
dt v[98:99],v20 offset:2048
mm a[12:15],v[172:175],v[128:131],a[12:15]
mm a[16:19],v[176:179],v[128:131],a[16:19]
dr v[64:67],v18 offset:0
mm a[20:23],v[180:183],v[128:131],a[20:23]
l4 v3,s[28:31],s40 offen offset:1024 lds
mm a[24:27],v[184:187],v[128:131],a[24:27]
dt v[100:101],v21 offset:0
mm a[28:31],v[188:191],v[128:131],a[28:31]
mm a[60:63],v[188:191],v[132:135],a[60:63]
dt v[102:103],v21 offset:2048
mm a[56:59],v[184:187],v[132:135],a[56:59]
l4 v4,s[28:31],s40 offen offset:2048 lds
mm a[52:55],v[180:183],v[132:135],a[52:55]
dr v[68:71],v18 offset:2048
mm a[48:51],v[176:179],v[132:135],a[48:51]
mm a[44:47],v[172:175],v[132:135],a[44:47]
dt v[104:105],v22 offset:0
mm a[40:43],v[168:171],v[132:135],a[40:43]
l4 v5,s[28:31],s40 offen offset:3072 lds
mm a[36:39],v[164:167],v[132:135],a[36:39]
dt v[106:107],v22 offset:2048
mm a[32:35],v[160:163],v[132:135],a[32:35]
s_add_u32 m0,s43,36864
mm a[64:67],v[160:163],v[136:139],a[64:67]
dr v[72:75],v18 offset:4096
mm a[68:71],v[164:167],v[136:139],a[68:71]
l4 v6,s[28:31],s40 offen lds
mm a[72:75],v[168:171],v[136:139],a[72:75]
dt v[108:109],v23 offset:0
mm a[76:79],v[172:175],v[136:139],a[76:79]
mm a[80:83],v[176:179],v[136:139],a[80:83]
dt v[110:111],v23 offset:2048
mm a[84:87],v[180:183],v[136:139],a[84:87]
l4 v7,s[28:31],s40 offen offset:1024 lds
mm a[88:91],v[184:187],v[136:139],a[88:91]
dr v[76:79],v18 offset:6144
mm a[92:95],v[188:191],v[136:139],a[92:95]
mm a[124:127],v[188:191],v[140:143],a[124:127]
dt v[112:113],v24 offset:0
mm a[120:123],v[184:187],v[140:143],a[120:123]
l4 v8,s[28:31],s40 offen offset:2048 lds
mm a[116:119],v[180:183],v[140:143],a[116:119]
dt v[114:115],v24 offset:2048
mm a[112:115],v[176:179],v[140:143],a[112:115]
mm a[108:111],v[172:175],v[140:143],a[108:111]
dr v[80:83],v18 offset:8192
mm a[104:107],v[168:171],v[140:143],a[104:107]
l4 v9,s[28:31],s40 offen offset:3072 lds
mm a[100:103],v[164:167],v[140:143],a[100:103]
dt v[116:117],v25 offset:0
mm a[96:99],v[160:163],v[140:143],a[96:99]
s_add_u32 s40,s40,128
s_add_u32 m0,s44,32768
mm a[128:131],v[160:163],v[144:147],a[128:131]
dt v[118:119],v25 offset:2048
mm a[132:135],v[164:167],v[144:147],a[132:135]
l4 v10,s[32:35],s41 offen lds
mm a[136:139],v[168:171],v[144:147],a[136:139]
dr v[84:87],v18 offset:10240
mm a[140:143],v[172:175],v[144:147],a[140:143]
mm a[144:147],v[176:179],v[144:147],a[144:147]
dt v[120:121],v26 offset:0
mm a[148:151],v[180:183],v[144:147],a[148:151]
l4 v11,s[32:35],s41 offen offset:1024 lds
mm a[152:155],v[184:187],v[144:147],a[152:155]
dt v[122:123],v26 offset:2048
mm a[156:159],v[188:191],v[144:147],a[156:159]
mm a[188:191],v[188:191],v[148:151],a[188:191]
dr v[88:91],v18 offset:12288
mm a[184:187],v[184:187],v[148:151],a[184:187]
l4 v12,s[32:35],s41 offen offset:2048 lds
mm a[180:183],v[180:183],v[148:151],a[180:183]
dt v[124:125],v27 offset:0
mm a[176:179],v[176:179],v[148:151],a[176:179]
mm a[172:175],v[172:175],v[148:151],a[172:175]
dt v[126:127],v27 offset:2048
mm a[168:171],v[168:171],v[148:151],a[168:171]
l4 v13,s[32:35],s41 offen offset:3072 lds
mm a[164:167],v[164:167],v[148:151],a[164:167]
dr v[92:95],v18 offset:14336
mm a[160:163],v[160:163],v[148:151],a[160:163]
s_add_u32 m0,s44,36864
mm a[192:195],v[160:163],v[152:155],a[192:195]
l4 v14,s[32:35],s41 offen lds
mm a[196:199],v[164:167],v[152:155],a[196:199]
mm a[200:203],v[168:171],v[152:155],a[200:203]
mm a[204:207],v[172:175],v[152:155],a[204:207]
l4 v15,s[32:35],s41 offen offset:1024 lds
mm a[208:211],v[176:179],v[152:155],a[208:211]
mm a[212:215],v[180:183],v[152:155],a[212:215]
mm a[216:219],v[184:187],v[152:155],a[216:219]
l4 v16,s[32:35],s41 offen offset:2048 lds
mm a[220:223],v[188:191],v[152:155],a[220:223]
mm a[252:255],v[188:191],v[156:159],a[252:255]
mm a[248:251],v[184:187],v[156:159],a[248:251]
l4 v17,s[32:35],s41 offen offset:3072 lds
mm a[244:247],v[180:183],v[156:159],a[244:247]
s_add_u32 s41,s41,s46
mm a[240:243],v[176:179],v[156:159],a[240:243]
mm a[236:239],v[172:175],v[156:159],a[236:239]
wt lgkmcnt(0)
mm a[232:235],v[168:171],v[156:159],a[232:235]
mm a[228:231],v[164:167],v[156:159],a[228:231]
mm a[224:227],v[160:163],v[156:159],a[224:227]
s_lshl_b32 s79,s76,22
s_lshl_b32 s49,s77,14
s_add_u32 s79,s79,s49
s_lshl_b32 s49,s93,0
s_add_u32 s79,s79,s49
s_xor_b32 s79,s79,s7
s_mov_b32 s100,s96
s_and_b32 s101,s97,3
s_cselect_b32 s101,2,0x200
s_mov_b64 s[90:91],s[20:21]
s_mov_b64 s[92:93],s[22:23]
s_mov_b64 s[94:95],s[24:25]
s_mov_b64 s[96:97],s[26:27]
s_load_dwordx8 s[20:27],s[18:19],0
s_add_u32 s18,s18,32
s_addc_u32 s19,s19,0
s_bfe_u32 s48,s78,0x20008
s_mov_b64 s[84:85],s[60:61]
s_mov_b32 s86,0x400000
s_mov_b32 s87,0x20000
s_mov_b32 s89,8192
s_cmp_eq_u32 s48,1
s_cselect_b64 s[84:85],s[70:71],s[84:85]
s_cselect_b32 s89,16384,s89
s_cmp_eq_u32 s48,2
s_cselect_b64 s[84:85],s[72:73],s[84:85]
s_cselect_b32 s86,0x600000,s86
s_cselect_b32 s89,24576,s89
s_cmp_eq_u32 s48,3
s_cselect_b64 s[84:85],s[74:75],s[84:85]
s_cselect_b32 s86,0x200000,s86
s_bfe_u32 s48,s78,0x80010
s_xor_b32 s48,s48,0xff
s_lshl2_add_u32 s48,s48,s14
s_mul_i32 s48,s48,s89
s_mov_b32 s88,0
v_lshrrev_b32 v38,5,v1
v_lshlrev_b32 v38,29,v38
v_lshl_add_u32 v38,v1,7,v38
v_add_u32 v38,s48,v38
s_cmp_eq_u32 s90,3
s_cbranch_scc1 GKV_fused
G1F_fused:
ar v192,a0
ar v193,a1
ar v194,a2
ar v195,a3
ar v196,a4
ar v197,a5
ar v198,a6
ar v199,a7
mm a[0:3],v[96:99],v[64:67],0
cv v200,v192,v193
cv v201,v194,v195
mm a[4:7],v[100:103],v[64:67],0
cv v202,v196,v197
cv v203,v198,v199
w4 v[200:203],v28,s[8:11],s79 offen sc1
dt v[160:161],v20 offset:16384
ar v204,a8
ar v205,a9
ar v206,a10
ar v207,a11
ar v208,a12
ar v209,a13
ar v210,a14
ar v211,a15
mm a[8:11],v[104:107],v[64:67],0
cv v212,v204,v205
cv v213,v206,v207
mm a[12:15],v[108:111],v[64:67],0
cv v214,v208,v209
cv v215,v210,v211
w4 v[212:215],v28,s[8:11],s79 offen offset:2048 sc1
dt v[162:163],v20 offset:18432
ar v216,a16
ar v217,a17
ar v218,a18
ar v219,a19
ar v220,a20
ar v221,a21
ar v222,a22
ar v223,a23
mm a[16:19],v[112:115],v[64:67],0
cv v224,v216,v217
cv v225,v218,v219
mm a[20:23],v[116:119],v[64:67],0
cv v226,v220,v221
cv v227,v222,v223
s_add_u32 s79,s79,4096
w4 v[224:227],v28,s[8:11],s79 offen sc1
dr v[128:131],v19 offset:0
ar v228,a24
ar v229,a25
ar v230,a26
ar v231,a27
ar v232,a28
ar v233,a29
ar v234,a30
ar v235,a31
mm a[24:27],v[120:123],v[64:67],0
cv v236,v228,v229
cv v237,v230,v231
mm a[28:31],v[124:127],v[64:67],0
cv v238,v232,v233
cv v239,v234,v235
w4 v[236:239],v28,s[8:11],s79 offen offset:2048 sc1
dt v[164:165],v21 offset:16384
s_add_u32 s79,s79,-4096
ar v192,a32
ar v193,a33
ar v194,a34
ar v195,a35
ar v196,a36
ar v197,a37
ar v198,a38
ar v199,a39
mm a[32:35],v[96:99],v[68:71],0
cv v200,v192,v193
cv v201,v194,v195
mm a[36:39],v[100:103],v[68:71],0
cv v202,v196,v197
cv v203,v198,v199
w4 v[200:203],v28,s[8:11],s79 offen offset:256 sc1
dt v[166:167],v21 offset:18432
ar v204,a40
ar v205,a41
ar v206,a42
ar v207,a43
ar v208,a44
ar v209,a45
ar v210,a46
ar v211,a47
mm a[40:43],v[104:107],v[68:71],0
cv v212,v204,v205
cv v213,v206,v207
mm a[44:47],v[108:111],v[68:71],0
cv v214,v208,v209
cv v215,v210,v211
w4 v[212:215],v28,s[8:11],s79 offen offset:2304 sc1
dr v[132:135],v19 offset:2048
ar v216,a48
ar v217,a49
ar v218,a50
ar v219,a51
ar v220,a52
ar v221,a53
ar v222,a54
ar v223,a55
mm a[48:51],v[112:115],v[68:71],0
cv v224,v216,v217
cv v225,v218,v219
mm a[52:55],v[116:119],v[68:71],0
cv v226,v220,v221
cv v227,v222,v223
s_add_u32 s79,s79,4096
w4 v[224:227],v28,s[8:11],s79 offen offset:256 sc1
dt v[168:169],v22 offset:16384
ar v228,a56
ar v229,a57
ar v230,a58
ar v231,a59
ar v232,a60
ar v233,a61
ar v234,a62
ar v235,a63
mm a[56:59],v[120:123],v[68:71],0
cv v236,v228,v229
cv v237,v230,v231
mm a[60:63],v[124:127],v[68:71],0
cv v238,v232,v233
cv v239,v234,v235
w4 v[236:239],v28,s[8:11],s79 offen offset:2304 sc1
dt v[170:171],v22 offset:18432
s_add_u32 s79,s79,520192
ar v192,a64
ar v193,a65
ar v194,a66
ar v195,a67
ar v196,a68
ar v197,a69
ar v198,a70
ar v199,a71
mm a[64:67],v[96:99],v[72:75],0
cv v200,v192,v193
cv v201,v194,v195
mm a[68:71],v[100:103],v[72:75],0
cv v202,v196,v197
cv v203,v198,v199
w4 v[200:203],v28,s[8:11],s79 offen sc1
dr v[136:139],v19 offset:4096
ar v204,a72
ar v205,a73
ar v206,a74
ar v207,a75
ar v208,a76
ar v209,a77
ar v210,a78
ar v211,a79
mm a[72:75],v[104:107],v[72:75],0
cv v212,v204,v205
cv v213,v206,v207
mm a[76:79],v[108:111],v[72:75],0
cv v214,v208,v209
cv v215,v210,v211
w4 v[212:215],v28,s[8:11],s79 offen offset:2048 sc1
dt v[172:173],v23 offset:16384
ar v216,a80
ar v217,a81
ar v218,a82
ar v219,a83
ar v220,a84
ar v221,a85
ar v222,a86
ar v223,a87
mm a[80:83],v[112:115],v[72:75],0
cv v224,v216,v217
cv v225,v218,v219
mm a[84:87],v[116:119],v[72:75],0
cv v226,v220,v221
cv v227,v222,v223
s_add_u32 s79,s79,4096
w4 v[224:227],v28,s[8:11],s79 offen sc1
dt v[174:175],v23 offset:18432
ar v228,a88
ar v229,a89
ar v230,a90
ar v231,a91
ar v232,a92
ar v233,a93
ar v234,a94
ar v235,a95
mm a[88:91],v[120:123],v[72:75],0
cv v236,v228,v229
cv v237,v230,v231
mm a[92:95],v[124:127],v[72:75],0
cv v238,v232,v233
cv v239,v234,v235
w4 v[236:239],v28,s[8:11],s79 offen offset:2048 sc1
dr v[140:143],v19 offset:6144
s_add_u32 s79,s79,-4096
ar v192,a96
ar v193,a97
ar v194,a98
ar v195,a99
ar v196,a100
ar v197,a101
ar v198,a102
ar v199,a103
mm a[96:99],v[96:99],v[76:79],0
cv v200,v192,v193
cv v201,v194,v195
mm a[100:103],v[100:103],v[76:79],0
cv v202,v196,v197
cv v203,v198,v199
w4 v[200:203],v28,s[8:11],s79 offen offset:256 sc1
dt v[176:177],v24 offset:16384
ar v204,a104
ar v205,a105
ar v206,a106
ar v207,a107
ar v208,a108
ar v209,a109
ar v210,a110
ar v211,a111
mm a[104:107],v[104:107],v[76:79],0
cv v212,v204,v205
cv v213,v206,v207
mm a[108:111],v[108:111],v[76:79],0
cv v214,v208,v209
cv v215,v210,v211
w4 v[212:215],v28,s[8:11],s79 offen offset:2304 sc1
dt v[178:179],v24 offset:18432
ar v216,a112
ar v217,a113
ar v218,a114
ar v219,a115
ar v220,a116
ar v221,a117
ar v222,a118
ar v223,a119
mm a[112:115],v[112:115],v[76:79],0
cv v224,v216,v217
cv v225,v218,v219
mm a[116:119],v[116:119],v[76:79],0
cv v226,v220,v221
cv v227,v222,v223
s_add_u32 s79,s79,4096
w4 v[224:227],v28,s[8:11],s79 offen offset:256 sc1
dr v[144:147],v19 offset:8192
ar v228,a120
ar v229,a121
ar v230,a122
ar v231,a123
ar v232,a124
ar v233,a125
ar v234,a126
ar v235,a127
mm a[120:123],v[120:123],v[76:79],0
cv v236,v228,v229
cv v237,v230,v231
mm a[124:127],v[124:127],v[76:79],0
cv v238,v232,v233
cv v239,v234,v235
w4 v[236:239],v28,s[8:11],s79 offen offset:2304 sc1
dt v[180:181],v25 offset:16384
s_add_u32 s79,s79,520192
ar v192,a128
ar v193,a129
ar v194,a130
ar v195,a131
ar v196,a132
ar v197,a133
ar v198,a134
ar v199,a135
mm a[128:131],v[96:99],v[80:83],0
cv v200,v192,v193
cv v201,v194,v195
mm a[132:135],v[100:103],v[80:83],0
cv v202,v196,v197
cv v203,v198,v199
w4 v[200:203],v28,s[8:11],s79 offen sc1
dt v[182:183],v25 offset:18432
ar v204,a136
ar v205,a137
ar v206,a138
ar v207,a139
ar v208,a140
ar v209,a141
ar v210,a142
ar v211,a143
mm a[136:139],v[104:107],v[80:83],0
cv v212,v204,v205
cv v213,v206,v207
mm a[140:143],v[108:111],v[80:83],0
cv v214,v208,v209
cv v215,v210,v211
w4 v[212:215],v28,s[8:11],s79 offen offset:2048 sc1
dr v[148:151],v19 offset:10240
ar v216,a144
ar v217,a145
ar v218,a146
ar v219,a147
ar v220,a148
ar v221,a149
ar v222,a150
ar v223,a151
mm a[144:147],v[112:115],v[80:83],0
cv v224,v216,v217
cv v225,v218,v219
mm a[148:151],v[116:119],v[80:83],0
cv v226,v220,v221
cv v227,v222,v223
s_add_u32 s79,s79,4096
w4 v[224:227],v28,s[8:11],s79 offen sc1
dt v[184:185],v26 offset:16384
ar v228,a152
ar v229,a153
ar v230,a154
ar v231,a155
ar v232,a156
ar v233,a157
ar v234,a158
ar v235,a159
mm a[152:155],v[120:123],v[80:83],0
cv v236,v228,v229
cv v237,v230,v231
mm a[156:159],v[124:127],v[80:83],0
cv v238,v232,v233
cv v239,v234,v235
w4 v[236:239],v28,s[8:11],s79 offen offset:2048 sc1
dt v[186:187],v26 offset:18432
s_add_u32 s79,s79,-4096
ar v192,a160
ar v193,a161
ar v194,a162
ar v195,a163
ar v196,a164
ar v197,a165
ar v198,a166
ar v199,a167
mm a[160:163],v[96:99],v[84:87],0
cv v200,v192,v193
cv v201,v194,v195
mm a[164:167],v[100:103],v[84:87],0
cv v202,v196,v197
cv v203,v198,v199
w4 v[200:203],v28,s[8:11],s79 offen offset:256 sc1
dr v[152:155],v19 offset:12288
ar v204,a168
ar v205,a169
ar v206,a170
ar v207,a171
ar v208,a172
ar v209,a173
ar v210,a174
ar v211,a175
mm a[168:171],v[104:107],v[84:87],0
cv v212,v204,v205
cv v213,v206,v207
mm a[172:175],v[108:111],v[84:87],0
cv v214,v208,v209
cv v215,v210,v211
w4 v[212:215],v28,s[8:11],s79 offen offset:2304 sc1
dt v[188:189],v27 offset:16384
ar v216,a176
ar v217,a177
ar v218,a178
ar v219,a179
ar v220,a180
ar v221,a181
ar v222,a182
ar v223,a183
mm a[176:179],v[112:115],v[84:87],0
cv v224,v216,v217
cv v225,v218,v219
mm a[180:183],v[116:119],v[84:87],0
cv v226,v220,v221
cv v227,v222,v223
s_add_u32 s79,s79,4096
w4 v[224:227],v28,s[8:11],s79 offen offset:256 sc1
dt v[190:191],v27 offset:18432
ar v228,a184
ar v229,a185
ar v230,a186
ar v231,a187
ar v232,a188
ar v233,a189
ar v234,a190
ar v235,a191
mm a[184:187],v[120:123],v[84:87],0
cv v236,v228,v229
cv v237,v230,v231
mm a[188:191],v[124:127],v[84:87],0
cv v238,v232,v233
cv v239,v234,v235
w4 v[236:239],v28,s[8:11],s79 offen offset:2304 sc1
dr v[156:159],v19 offset:14336
s_add_u32 s79,s79,520192
ar v192,a192
ar v193,a193
ar v194,a194
ar v195,a195
ar v196,a196
ar v197,a197
ar v198,a198
ar v199,a199
mm a[192:195],v[96:99],v[88:91],0
cv v200,v192,v193
cv v201,v194,v195
mm a[196:199],v[100:103],v[88:91],0
cv v202,v196,v197
cv v203,v198,v199
w4 v[200:203],v28,s[8:11],s79 offen sc1
ar v204,a200
ar v205,a201
ar v206,a202
ar v207,a203
ar v208,a204
ar v209,a205
ar v210,a206
ar v211,a207
mm a[200:203],v[104:107],v[88:91],0
cv v212,v204,v205
cv v213,v206,v207
mm a[204:207],v[108:111],v[88:91],0
cv v214,v208,v209
cv v215,v210,v211
w4 v[212:215],v28,s[8:11],s79 offen offset:2048 sc1
ar v216,a208
ar v217,a209
ar v218,a210
ar v219,a211
ar v220,a212
ar v221,a213
ar v222,a214
ar v223,a215
mm a[208:211],v[112:115],v[88:91],0
cv v224,v216,v217
cv v225,v218,v219
mm a[212:215],v[116:119],v[88:91],0
cv v226,v220,v221
cv v227,v222,v223
s_add_u32 s79,s79,4096
w4 v[224:227],v28,s[8:11],s79 offen sc1
ar v228,a216
ar v229,a217
ar v230,a218
ar v231,a219
ar v232,a220
ar v233,a221
ar v234,a222
ar v235,a223
mm a[216:219],v[120:123],v[88:91],0
cv v236,v228,v229
cv v237,v230,v231
mm a[220:223],v[124:127],v[88:91],0
cv v238,v232,v233
cv v239,v234,v235
w4 v[236:239],v28,s[8:11],s79 offen offset:2048 sc1
s_add_u32 s79,s79,-4096
ar v192,a224
ar v193,a225
ar v194,a226
ar v195,a227
ar v196,a228
ar v197,a229
ar v198,a230
ar v199,a231
mm a[224:227],v[96:99],v[92:95],0
cv v200,v192,v193
cv v201,v194,v195
mm a[228:231],v[100:103],v[92:95],0
cv v202,v196,v197
cv v203,v198,v199
w4 v[200:203],v28,s[8:11],s79 offen offset:256 sc1
ar v204,a232
ar v205,a233
ar v206,a234
ar v207,a235
ar v208,a236
ar v209,a237
ar v210,a238
ar v211,a239
mm a[232:235],v[104:107],v[92:95],0
cv v212,v204,v205
cv v213,v206,v207
mm a[236:239],v[108:111],v[92:95],0
cv v214,v208,v209
cv v215,v210,v211
w4 v[212:215],v28,s[8:11],s79 offen offset:2304 sc1
ar v216,a240
ar v217,a241
ar v218,a242
ar v219,a243
ar v220,a244
ar v221,a245
ar v222,a246
ar v223,a247
mm a[240:243],v[112:115],v[92:95],0
cv v224,v216,v217
cv v225,v218,v219
mm a[244:247],v[116:119],v[92:95],0
cv v226,v220,v221
cv v227,v222,v223
s_add_u32 s79,s79,4096
w4 v[224:227],v28,s[8:11],s79 offen offset:256 sc1
ar v228,a248
ar v229,a249
ar v230,a250
ar v231,a251
ar v232,a252
ar v233,a253
ar v234,a254
ar v235,a255
mm a[248:251],v[120:123],v[92:95],0
cv v236,v228,v229
cv v237,v230,v231
mm a[252:255],v[124:127],v[92:95],0
cv v238,v232,v233
cv v239,v234,v235
w4 v[236:239],v28,s[8:11],s79 offen offset:2304 sc1
s_add_u32 s79,s79,520192
wt vmcnt(32) lgkmcnt(0)
s_barrier
mm a[0:3],v[160:163],v[128:131],a[0:3]
dt v[96:97],v20 offset:32768
s_add_u32 m0,s43,0
mm a[4:7],v[164:167],v[128:131],a[4:7]
l4 v2,s[28:31],s40 offen lds
mm a[8:11],v[168:171],v[128:131],a[8:11]
dt v[98:99],v20 offset:34816
mm a[12:15],v[172:175],v[128:131],a[12:15]
mm a[16:19],v[176:179],v[128:131],a[16:19]
dr v[64:67],v18 offset:32768
mm a[20:23],v[180:183],v[128:131],a[20:23]
l4 v3,s[28:31],s40 offen offset:1024 lds
mm a[24:27],v[184:187],v[128:131],a[24:27]
dt v[100:101],v21 offset:32768
mm a[28:31],v[188:191],v[128:131],a[28:31]
mm a[60:63],v[188:191],v[132:135],a[60:63]
dt v[102:103],v21 offset:34816
mm a[56:59],v[184:187],v[132:135],a[56:59]
l4 v4,s[28:31],s40 offen offset:2048 lds
mm a[52:55],v[180:183],v[132:135],a[52:55]
dr v[68:71],v18 offset:34816
mm a[48:51],v[176:179],v[132:135],a[48:51]
mm a[44:47],v[172:175],v[132:135],a[44:47]
dt v[104:105],v22 offset:32768
mm a[40:43],v[168:171],v[132:135],a[40:43]
l4 v5,s[28:31],s40 offen offset:3072 lds
mm a[36:39],v[164:167],v[132:135],a[36:39]
dt v[106:107],v22 offset:34816
mm a[32:35],v[160:163],v[132:135],a[32:35]
s_add_u32 m0,s43,4096
mm a[64:67],v[160:163],v[136:139],a[64:67]
dr v[72:75],v18 offset:36864
mm a[68:71],v[164:167],v[136:139],a[68:71]
l4 v6,s[28:31],s40 offen lds
mm a[72:75],v[168:171],v[136:139],a[72:75]
dt v[108:109],v23 offset:32768
mm a[76:79],v[172:175],v[136:139],a[76:79]
mm a[80:83],v[176:179],v[136:139],a[80:83]
dt v[110:111],v23 offset:34816
mm a[84:87],v[180:183],v[136:139],a[84:87]
l4 v7,s[28:31],s40 offen offset:1024 lds
mm a[88:91],v[184:187],v[136:139],a[88:91]
dr v[76:79],v18 offset:38912
mm a[92:95],v[188:191],v[136:139],a[92:95]
mm a[124:127],v[188:191],v[140:143],a[124:127]
dt v[112:113],v24 offset:32768
mm a[120:123],v[184:187],v[140:143],a[120:123]
l4 v8,s[28:31],s40 offen offset:2048 lds
mm a[116:119],v[180:183],v[140:143],a[116:119]
dt v[114:115],v24 offset:34816
mm a[112:115],v[176:179],v[140:143],a[112:115]
mm a[108:111],v[172:175],v[140:143],a[108:111]
dr v[80:83],v18 offset:40960
mm a[104:107],v[168:171],v[140:143],a[104:107]
l4 v9,s[28:31],s40 offen offset:3072 lds
mm a[100:103],v[164:167],v[140:143],a[100:103]
dt v[116:117],v25 offset:32768
mm a[96:99],v[160:163],v[140:143],a[96:99]
s_add_u32 s40,s40,128
s_add_u32 m0,s44,0
mm a[128:131],v[160:163],v[144:147],a[128:131]
dt v[118:119],v25 offset:34816
mm a[132:135],v[164:167],v[144:147],a[132:135]
l4 v10,s[32:35],s41 offen lds
mm a[136:139],v[168:171],v[144:147],a[136:139]
dr v[84:87],v18 offset:43008
mm a[140:143],v[172:175],v[144:147],a[140:143]
mm a[144:147],v[176:179],v[144:147],a[144:147]
dt v[120:121],v26 offset:32768
mm a[148:151],v[180:183],v[144:147],a[148:151]
l4 v11,s[32:35],s41 offen offset:1024 lds
mm a[152:155],v[184:187],v[144:147],a[152:155]
dt v[122:123],v26 offset:34816
mm a[156:159],v[188:191],v[144:147],a[156:159]
mm a[188:191],v[188:191],v[148:151],a[188:191]
dr v[88:91],v18 offset:45056
mm a[184:187],v[184:187],v[148:151],a[184:187]
l4 v12,s[32:35],s41 offen offset:2048 lds
mm a[180:183],v[180:183],v[148:151],a[180:183]
dt v[124:125],v27 offset:32768
mm a[176:179],v[176:179],v[148:151],a[176:179]
mm a[172:175],v[172:175],v[148:151],a[172:175]
dt v[126:127],v27 offset:34816
mm a[168:171],v[168:171],v[148:151],a[168:171]
l4 v13,s[32:35],s41 offen offset:3072 lds
mm a[164:167],v[164:167],v[148:151],a[164:167]
dr v[92:95],v18 offset:47104
mm a[160:163],v[160:163],v[148:151],a[160:163]
s_add_u32 m0,s44,4096
mm a[192:195],v[160:163],v[152:155],a[192:195]
l4 v14,s[32:35],s41 offen lds
mm a[196:199],v[164:167],v[152:155],a[196:199]
mm a[200:203],v[168:171],v[152:155],a[200:203]
mm a[204:207],v[172:175],v[152:155],a[204:207]
l4 v15,s[32:35],s41 offen offset:1024 lds
mm a[208:211],v[176:179],v[152:155],a[208:211]
mm a[212:215],v[180:183],v[152:155],a[212:215]
mm a[216:219],v[184:187],v[152:155],a[216:219]
l4 v16,s[32:35],s41 offen offset:2048 lds
mm a[220:223],v[188:191],v[152:155],a[220:223]
mm a[252:255],v[188:191],v[156:159],a[252:255]
mm a[248:251],v[184:187],v[156:159],a[248:251]
l4 v17,s[32:35],s41 offen offset:3072 lds
mm a[244:247],v[180:183],v[156:159],a[244:247]
s_add_u32 s41,s41,s46
mm a[240:243],v[176:179],v[156:159],a[240:243]
mm a[236:239],v[172:175],v[156:159],a[236:239]
mm a[232:235],v[168:171],v[156:159],a[232:235]
mm a[228:231],v[164:167],v[156:159],a[228:231]
mm a[224:227],v[160:163],v[156:159],a[224:227]
wt lgkmcnt(0)
mm a[0:3],v[96:99],v[64:67],a[0:3]
dt v[160:161],v20 offset:49152
mm a[4:7],v[100:103],v[64:67],a[4:7]
mm a[8:11],v[104:107],v[64:67],a[8:11]
dt v[162:163],v20 offset:51200
mm a[12:15],v[108:111],v[64:67],a[12:15]
mm a[16:19],v[112:115],v[64:67],a[16:19]
dr v[128:131],v19 offset:32768
mm a[20:23],v[116:119],v[64:67],a[20:23]
mm a[24:27],v[120:123],v[64:67],a[24:27]
dt v[164:165],v21 offset:49152
mm a[28:31],v[124:127],v[64:67],a[28:31]
mm a[60:63],v[124:127],v[68:71],a[60:63]
dt v[166:167],v21 offset:51200
mm a[56:59],v[120:123],v[68:71],a[56:59]
mm a[52:55],v[116:119],v[68:71],a[52:55]
dr v[132:135],v19 offset:34816
mm a[48:51],v[112:115],v[68:71],a[48:51]
mm a[44:47],v[108:111],v[68:71],a[44:47]
dt v[168:169],v22 offset:49152
mm a[40:43],v[104:107],v[68:71],a[40:43]
mm a[36:39],v[100:103],v[68:71],a[36:39]
dt v[170:171],v22 offset:51200
mm a[32:35],v[96:99],v[68:71],a[32:35]
mm a[64:67],v[96:99],v[72:75],a[64:67]
dr v[136:139],v19 offset:36864
mm a[68:71],v[100:103],v[72:75],a[68:71]
mm a[72:75],v[104:107],v[72:75],a[72:75]
dt v[172:173],v23 offset:49152
mm a[76:79],v[108:111],v[72:75],a[76:79]
mm a[80:83],v[112:115],v[72:75],a[80:83]
dt v[174:175],v23 offset:51200
mm a[84:87],v[116:119],v[72:75],a[84:87]
mm a[88:91],v[120:123],v[72:75],a[88:91]
dr v[140:143],v19 offset:38912
mm a[92:95],v[124:127],v[72:75],a[92:95]
mm a[124:127],v[124:127],v[76:79],a[124:127]
dt v[176:177],v24 offset:49152
mm a[120:123],v[120:123],v[76:79],a[120:123]
mm a[116:119],v[116:119],v[76:79],a[116:119]
dt v[178:179],v24 offset:51200
mm a[112:115],v[112:115],v[76:79],a[112:115]
mm a[108:111],v[108:111],v[76:79],a[108:111]
dr v[144:147],v19 offset:40960
mm a[104:107],v[104:107],v[76:79],a[104:107]
mm a[100:103],v[100:103],v[76:79],a[100:103]
dt v[180:181],v25 offset:49152
mm a[96:99],v[96:99],v[76:79],a[96:99]
mm a[128:131],v[96:99],v[80:83],a[128:131]
dt v[182:183],v25 offset:51200
mm a[132:135],v[100:103],v[80:83],a[132:135]
mm a[136:139],v[104:107],v[80:83],a[136:139]
dr v[148:151],v19 offset:43008
mm a[140:143],v[108:111],v[80:83],a[140:143]
mm a[144:147],v[112:115],v[80:83],a[144:147]
dt v[184:185],v26 offset:49152
mm a[148:151],v[116:119],v[80:83],a[148:151]
mm a[152:155],v[120:123],v[80:83],a[152:155]
dt v[186:187],v26 offset:51200
mm a[156:159],v[124:127],v[80:83],a[156:159]
mm a[188:191],v[124:127],v[84:87],a[188:191]
dr v[152:155],v19 offset:45056
mm a[184:187],v[120:123],v[84:87],a[184:187]
mm a[180:183],v[116:119],v[84:87],a[180:183]
dt v[188:189],v27 offset:49152
mm a[176:179],v[112:115],v[84:87],a[176:179]
mm a[172:175],v[108:111],v[84:87],a[172:175]
dt v[190:191],v27 offset:51200
mm a[168:171],v[104:107],v[84:87],a[168:171]
mm a[164:167],v[100:103],v[84:87],a[164:167]
dr v[156:159],v19 offset:47104
mm a[160:163],v[96:99],v[84:87],a[160:163]
mm a[192:195],v[96:99],v[88:91],a[192:195]
mm a[196:199],v[100:103],v[88:91],a[196:199]
mm a[200:203],v[104:107],v[88:91],a[200:203]
mm a[204:207],v[108:111],v[88:91],a[204:207]
mm a[208:211],v[112:115],v[88:91],a[208:211]
mm a[212:215],v[116:119],v[88:91],a[212:215]
mm a[216:219],v[120:123],v[88:91],a[216:219]
mm a[220:223],v[124:127],v[88:91],a[220:223]
mm a[252:255],v[124:127],v[92:95],a[252:255]
mm a[248:251],v[120:123],v[92:95],a[248:251]
mm a[244:247],v[116:119],v[92:95],a[244:247]
mm a[240:243],v[112:115],v[92:95],a[240:243]
mm a[236:239],v[108:111],v[92:95],a[236:239]
mm a[232:235],v[104:107],v[92:95],a[232:235]
mm a[228:231],v[100:103],v[92:95],a[228:231]
mm a[224:227],v[96:99],v[92:95],a[224:227]
wt vmcnt(0) lgkmcnt(0)
s_barrier
s_cmp_eq_u32 s14,0
s_cbranch_scc0 G1F_fs
v_mul_u32_u24 v30,2048,v1
v_mov_b32 v31,s101
s_mov_b64 exec,3
buffer_atomic_add v31,v30,s[8:11],s100 offen sc1
s_mov_b64 exec,-1
G1F_fs:
s_mov_b32 s101,0
mm a[0:3],v[160:163],v[128:131],a[0:3]
dt v[96:97],v20 offset:0
s_add_u32 m0,s43,32768
mm a[4:7],v[164:167],v[128:131],a[4:7]
l4 v2,s[28:31],s40 offen lds
mm a[8:11],v[168:171],v[128:131],a[8:11]
dt v[98:99],v20 offset:2048
mm a[12:15],v[172:175],v[128:131],a[12:15]
mm a[16:19],v[176:179],v[128:131],a[16:19]
dr v[64:67],v18 offset:0
mm a[20:23],v[180:183],v[128:131],a[20:23]
l4 v3,s[28:31],s40 offen offset:1024 lds
mm a[24:27],v[184:187],v[128:131],a[24:27]
dt v[100:101],v21 offset:0
mm a[28:31],v[188:191],v[128:131],a[28:31]
mm a[60:63],v[188:191],v[132:135],a[60:63]
dt v[102:103],v21 offset:2048
mm a[56:59],v[184:187],v[132:135],a[56:59]
l4 v4,s[28:31],s40 offen offset:2048 lds
mm a[52:55],v[180:183],v[132:135],a[52:55]
dr v[68:71],v18 offset:2048
mm a[48:51],v[176:179],v[132:135],a[48:51]
mm a[44:47],v[172:175],v[132:135],a[44:47]
dt v[104:105],v22 offset:0
mm a[40:43],v[168:171],v[132:135],a[40:43]
l4 v5,s[28:31],s40 offen offset:3072 lds
mm a[36:39],v[164:167],v[132:135],a[36:39]
dt v[106:107],v22 offset:2048
mm a[32:35],v[160:163],v[132:135],a[32:35]
s_add_u32 m0,s43,36864
mm a[64:67],v[160:163],v[136:139],a[64:67]
dr v[72:75],v18 offset:4096
mm a[68:71],v[164:167],v[136:139],a[68:71]
l4 v6,s[28:31],s40 offen lds
mm a[72:75],v[168:171],v[136:139],a[72:75]
dt v[108:109],v23 offset:0
mm a[76:79],v[172:175],v[136:139],a[76:79]
mm a[80:83],v[176:179],v[136:139],a[80:83]
dt v[110:111],v23 offset:2048
mm a[84:87],v[180:183],v[136:139],a[84:87]
l4 v7,s[28:31],s40 offen offset:1024 lds
mm a[88:91],v[184:187],v[136:139],a[88:91]
dr v[76:79],v18 offset:6144
mm a[92:95],v[188:191],v[136:139],a[92:95]
mm a[124:127],v[188:191],v[140:143],a[124:127]
dt v[112:113],v24 offset:0
mm a[120:123],v[184:187],v[140:143],a[120:123]
l4 v8,s[28:31],s40 offen offset:2048 lds
mm a[116:119],v[180:183],v[140:143],a[116:119]
dt v[114:115],v24 offset:2048
mm a[112:115],v[176:179],v[140:143],a[112:115]
mm a[108:111],v[172:175],v[140:143],a[108:111]
dr v[80:83],v18 offset:8192
mm a[104:107],v[168:171],v[140:143],a[104:107]
l4 v9,s[28:31],s40 offen offset:3072 lds
mm a[100:103],v[164:167],v[140:143],a[100:103]
dt v[116:117],v25 offset:0
mm a[96:99],v[160:163],v[140:143],a[96:99]
s_add_u32 s40,s40,128
s_add_u32 m0,s44,32768
mm a[128:131],v[160:163],v[144:147],a[128:131]
dt v[118:119],v25 offset:2048
mm a[132:135],v[164:167],v[144:147],a[132:135]
l4 v10,s[32:35],s41 offen lds
mm a[136:139],v[168:171],v[144:147],a[136:139]
dr v[84:87],v18 offset:10240
mm a[140:143],v[172:175],v[144:147],a[140:143]
mm a[144:147],v[176:179],v[144:147],a[144:147]
dt v[120:121],v26 offset:0
mm a[148:151],v[180:183],v[144:147],a[148:151]
l4 v11,s[32:35],s41 offen offset:1024 lds
mm a[152:155],v[184:187],v[144:147],a[152:155]
dt v[122:123],v26 offset:2048
mm a[156:159],v[188:191],v[144:147],a[156:159]
mm a[188:191],v[188:191],v[148:151],a[188:191]
dr v[88:91],v18 offset:12288
mm a[184:187],v[184:187],v[148:151],a[184:187]
l4 v12,s[32:35],s41 offen offset:2048 lds
mm a[180:183],v[180:183],v[148:151],a[180:183]
dt v[124:125],v27 offset:0
mm a[176:179],v[176:179],v[148:151],a[176:179]
mm a[172:175],v[172:175],v[148:151],a[172:175]
dt v[126:127],v27 offset:2048
mm a[168:171],v[168:171],v[148:151],a[168:171]
l4 v13,s[32:35],s41 offen offset:3072 lds
mm a[164:167],v[164:167],v[148:151],a[164:167]
dr v[92:95],v18 offset:14336
mm a[160:163],v[160:163],v[148:151],a[160:163]
s_add_u32 m0,s44,36864
mm a[192:195],v[160:163],v[152:155],a[192:195]
l4 v14,s[32:35],s41 offen lds
mm a[196:199],v[164:167],v[152:155],a[196:199]
mm a[200:203],v[168:171],v[152:155],a[200:203]
mm a[204:207],v[172:175],v[152:155],a[204:207]
l4 v15,s[32:35],s41 offen offset:1024 lds
mm a[208:211],v[176:179],v[152:155],a[208:211]
mm a[212:215],v[180:183],v[152:155],a[212:215]
mm a[216:219],v[184:187],v[152:155],a[216:219]
l4 v16,s[32:35],s41 offen offset:2048 lds
mm a[220:223],v[188:191],v[152:155],a[220:223]
mm a[252:255],v[188:191],v[156:159],a[252:255]
mm a[248:251],v[184:187],v[156:159],a[248:251]
l4 v17,s[32:35],s41 offen offset:3072 lds
mm a[244:247],v[180:183],v[156:159],a[244:247]
s_add_u32 s41,s41,s46
mm a[240:243],v[176:179],v[156:159],a[240:243]
buffer_load_dword v39,v38,s[84:87],s88 offen offset:0
mm a[236:239],v[172:175],v[156:159],a[236:239]
s_add_u32 s88,s88,4096
s_cmp_lt_u32 s88,s89
mm a[232:235],v[168:171],v[156:159],a[232:235]
s_cselect_b32 s88,s88,0x40000000
wt lgkmcnt(0)
mm a[228:231],v[164:167],v[156:159],a[228:231]
mm a[224:227],v[160:163],v[156:159],a[224:227]
s_mov_b32 s42,6
s_branch G1F_k
G_ebq:
v_mov_b32 v30,0
G_bqw:
buffer_load_dword v31,v30,s[8:11],s94 offen sc1
s_sub_u32 s15,s15,1
s_max_i32 s15,s15,0
wt vmcnt(0)
G_bqw_1:
v_readfirstlane_b32 s58,v31
s_nop 0
s_cmp_ge_u32 s58,s95
s_cbranch_scc1 G_bqw_ok
s_cmp_eq_u32 s15,0
s_cbranch_scc1 G_bqw_ok
s_sleep 2
s_branch G_bqw
G_bqw_ok:
s_mul_i32 s48,s77,12288
s_add_u32 s48,s48,s97
v_bfe_u32 v30,v1,0,6
v_lshlrev_b32 v30,4,v30
l4 v[64:67],v30,s[8:11],s48 offen sc1
l4 v[68:71],v30,s[8:11],s48 offen offset:1024 sc1
l4 v[72:75],v30,s[8:11],s48 offen offset:2048 sc1
s_add_u32 s48,s48,3072
l4 v[76:79],v30,s[8:11],s48 offen sc1
l4 v[80:83],v30,s[8:11],s48 offen offset:1024 sc1
l4 v[84:87],v30,s[8:11],s48 offen offset:2048 sc1
s_add_u32 s48,s48,3072
l4 v[88:91],v30,s[8:11],s48 offen sc1
l4 v[92:95],v30,s[8:11],s48 offen offset:1024 sc1
l4 v[96:99],v30,s[8:11],s48 offen offset:2048 sc1
s_add_u32 s48,s48,3072
l4 v[100:103],v30,s[8:11],s48 offen sc1
l4 v[104:107],v30,s[8:11],s48 offen offset:1024 sc1
l4 v[108:111],v30,s[8:11],s48 offen offset:2048 sc1
s_add_u32 s48,s48,3072
s_lshl_b32 s48,s76,19
s_lshl_b32 s49,s77,14
s_add_u32 s48,s48,s49
s_lshl_b32 s49,s93,0
s_add_u32 s48,s48,s49
s_xor_b32 s48,s48,s7
ar v144,a0
ar v145,a1
ar v146,a2
ar v147,a3
ar v148,a4
ar v149,a5
ar v150,a6
ar v151,a7
pm v[152:153],v[144:145],s[80:81] op_sel_hi:[1,0]
pm v[154:155],v[146:147],s[80:81] op_sel_hi:[1,0]
pm v[156:157],v[148:149],s[80:81] op_sel_hi:[1,0]
pm v[158:159],v[150:151],s[80:81] op_sel_hi:[1,0]
v_exp_f32 v152,v152 clamp
v_max_f32 v144,0,v144
v_exp_f32 v153,v153 clamp
v_max_f32 v145,0,v145
v_exp_f32 v154,v154 clamp
v_max_f32 v146,0,v146
v_exp_f32 v155,v155 clamp
v_max_f32 v147,0,v147
v_exp_f32 v156,v156 clamp
v_max_f32 v148,0,v148
v_exp_f32 v157,v157 clamp
v_max_f32 v149,0,v149
v_exp_f32 v158,v158 clamp
v_max_f32 v150,0,v150
v_exp_f32 v159,v159 clamp
v_max_f32 v151,0,v151
pa v[152:153],v[152:153],v[144:145]
pa v[154:155],v[154:155],v[146:147]
pa v[156:157],v[156:157],v[148:149]
pa v[158:159],v[158:159],v[150:151]
pa v[152:153],v[152:153],s[80:81] op_sel:[0,1]
pa v[154:155],v[154:155],s[80:81] op_sel:[0,1]
pa v[156:157],v[156:157],s[80:81] op_sel:[0,1]
pa v[158:159],v[158:159],s[80:81] op_sel:[0,1]
cv v112,v152,v153
cv v113,v154,v155
cv v114,v156,v157
cv v115,v158,v159
wt vmcnt(0)
s_nop 0
mm v[128:131],v[72:75],v[112:115],0
mm v[120:123],v[64:67],v[112:115],0
mm v[124:127],v[68:71],v[112:115],0
ar v144,a8
ar v145,a9
ar v146,a10
ar v147,a11
ar v148,a12
ar v149,a13
ar v150,a14
ar v151,a15
pm v[152:153],v[144:145],s[80:81] op_sel_hi:[1,0]
pm v[154:155],v[146:147],s[80:81] op_sel_hi:[1,0]
pm v[156:157],v[148:149],s[80:81] op_sel_hi:[1,0]
pm v[158:159],v[150:151],s[80:81] op_sel_hi:[1,0]
v_exp_f32 v152,v152 clamp
v_max_f32 v144,0,v144
v_exp_f32 v153,v153 clamp
v_max_f32 v145,0,v145
v_exp_f32 v154,v154 clamp
v_max_f32 v146,0,v146
v_exp_f32 v155,v155 clamp
v_max_f32 v147,0,v147
v_exp_f32 v156,v156 clamp
v_max_f32 v148,0,v148
v_exp_f32 v157,v157 clamp
v_max_f32 v149,0,v149
v_exp_f32 v158,v158 clamp
v_max_f32 v150,0,v150
v_exp_f32 v159,v159 clamp
v_max_f32 v151,0,v151
pa v[152:153],v[152:153],v[144:145]
pa v[154:155],v[154:155],v[146:147]
pa v[156:157],v[156:157],v[148:149]
pa v[158:159],v[158:159],v[150:151]
pa v[152:153],v[152:153],s[80:81] op_sel:[0,1]
pa v[154:155],v[154:155],s[80:81] op_sel:[0,1]
pa v[156:157],v[156:157],s[80:81] op_sel:[0,1]
pa v[158:159],v[158:159],s[80:81] op_sel:[0,1]
cv v116,v152,v153
cv v117,v154,v155
cv v118,v156,v157
cv v119,v158,v159
s_nop 1
mm v[140:143],v[84:87],v[116:119],0
mm v[132:135],v[76:79],v[116:119],0
mm v[136:139],v[80:83],v[116:119],0
v_add_f32 v128,s81,v128
v_rcp_f32 v128,v128
s_nop 0
pm v[120:121],v[120:121],v[128:129] op_sel_hi:[1,0]
pm v[122:123],v[122:123],v[128:129] op_sel_hi:[1,0]
pm v[124:125],v[124:125],v[128:129] op_sel_hi:[1,0]
pm v[126:127],v[126:127],v[128:129] op_sel_hi:[1,0]
cv v168,v120,v121
cv v169,v122,v123
cv v170,v124,v125
cv v171,v126,v127
s_xor_b32 s49,s48,0
w4 v[168:171],v28,s[8:11],s49 offen sc1
ar v144,a16
ar v145,a17
ar v146,a18
ar v147,a19
ar v148,a20
ar v149,a21
ar v150,a22
ar v151,a23
pm v[152:153],v[144:145],s[80:81] op_sel_hi:[1,0]
pm v[154:155],v[146:147],s[80:81] op_sel_hi:[1,0]
pm v[156:157],v[148:149],s[80:81] op_sel_hi:[1,0]
pm v[158:159],v[150:151],s[80:81] op_sel_hi:[1,0]
v_exp_f32 v152,v152 clamp
v_max_f32 v144,0,v144
v_exp_f32 v153,v153 clamp
v_max_f32 v145,0,v145
v_exp_f32 v154,v154 clamp
v_max_f32 v146,0,v146
v_exp_f32 v155,v155 clamp
v_max_f32 v147,0,v147
v_exp_f32 v156,v156 clamp
v_max_f32 v148,0,v148
v_exp_f32 v157,v157 clamp
v_max_f32 v149,0,v149
v_exp_f32 v158,v158 clamp
v_max_f32 v150,0,v150
v_exp_f32 v159,v159 clamp
v_max_f32 v151,0,v151
pa v[152:153],v[152:153],v[144:145]
pa v[154:155],v[154:155],v[146:147]
pa v[156:157],v[156:157],v[148:149]
pa v[158:159],v[158:159],v[150:151]
pa v[152:153],v[152:153],s[80:81] op_sel:[0,1]
pa v[154:155],v[154:155],s[80:81] op_sel:[0,1]
pa v[156:157],v[156:157],s[80:81] op_sel:[0,1]
pa v[158:159],v[158:159],s[80:81] op_sel:[0,1]
cv v112,v152,v153
cv v113,v154,v155
cv v114,v156,v157
cv v115,v158,v159
s_nop 1
mm v[128:131],v[96:99],v[112:115],0
mm v[120:123],v[88:91],v[112:115],0
mm v[124:127],v[92:95],v[112:115],0
v_add_f32 v140,s81,v140
v_rcp_f32 v140,v140
s_nop 0
pm v[132:133],v[132:133],v[140:141] op_sel_hi:[1,0]
pm v[134:135],v[134:135],v[140:141] op_sel_hi:[1,0]
pm v[136:137],v[136:137],v[140:141] op_sel_hi:[1,0]
pm v[138:139],v[138:139],v[140:141] op_sel_hi:[1,0]
cv v172,v132,v133
cv v173,v134,v135
cv v174,v136,v137
cv v175,v138,v139
s_xor_b32 s49,s48,0
w4 v[172:175],v28,s[8:11],s49 offen offset:2048 sc1
ar v144,a24
ar v145,a25
ar v146,a26
ar v147,a27
ar v148,a28
ar v149,a29
ar v150,a30
ar v151,a31
pm v[152:153],v[144:145],s[80:81] op_sel_hi:[1,0]
pm v[154:155],v[146:147],s[80:81] op_sel_hi:[1,0]
pm v[156:157],v[148:149],s[80:81] op_sel_hi:[1,0]
pm v[158:159],v[150:151],s[80:81] op_sel_hi:[1,0]
v_exp_f32 v152,v152 clamp
v_max_f32 v144,0,v144
v_exp_f32 v153,v153 clamp
v_max_f32 v145,0,v145
v_exp_f32 v154,v154 clamp
v_max_f32 v146,0,v146
v_exp_f32 v155,v155 clamp
v_max_f32 v147,0,v147
v_exp_f32 v156,v156 clamp
v_max_f32 v148,0,v148
v_exp_f32 v157,v157 clamp
v_max_f32 v149,0,v149
v_exp_f32 v158,v158 clamp
v_max_f32 v150,0,v150
v_exp_f32 v159,v159 clamp
v_max_f32 v151,0,v151
pa v[152:153],v[152:153],v[144:145]
pa v[154:155],v[154:155],v[146:147]
pa v[156:157],v[156:157],v[148:149]
pa v[158:159],v[158:159],v[150:151]
pa v[152:153],v[152:153],s[80:81] op_sel:[0,1]
pa v[154:155],v[154:155],s[80:81] op_sel:[0,1]
pa v[156:157],v[156:157],s[80:81] op_sel:[0,1]
pa v[158:159],v[158:159],s[80:81] op_sel:[0,1]
cv v116,v152,v153
cv v117,v154,v155
cv v118,v156,v157
cv v119,v158,v159
s_nop 1
mm v[140:143],v[108:111],v[116:119],0
mm v[132:135],v[100:103],v[116:119],0
mm v[136:139],v[104:107],v[116:119],0
v_add_f32 v128,s81,v128
v_rcp_f32 v128,v128
s_nop 0
pm v[120:121],v[120:121],v[128:129] op_sel_hi:[1,0]
pm v[122:123],v[122:123],v[128:129] op_sel_hi:[1,0]
pm v[124:125],v[124:125],v[128:129] op_sel_hi:[1,0]
pm v[126:127],v[126:127],v[128:129] op_sel_hi:[1,0]
cv v168,v120,v121
cv v169,v122,v123
cv v170,v124,v125
cv v171,v126,v127
s_xor_b32 s49,s48,4096
w4 v[168:171],v28,s[8:11],s49 offen sc1
ar v144,a32
ar v145,a33
ar v146,a34
ar v147,a35
ar v148,a36
ar v149,a37
ar v150,a38
ar v151,a39
pm v[152:153],v[144:145],s[80:81] op_sel_hi:[1,0]
pm v[154:155],v[146:147],s[80:81] op_sel_hi:[1,0]
pm v[156:157],v[148:149],s[80:81] op_sel_hi:[1,0]
pm v[158:159],v[150:151],s[80:81] op_sel_hi:[1,0]
v_exp_f32 v152,v152 clamp
v_max_f32 v144,0,v144
v_exp_f32 v153,v153 clamp
v_max_f32 v145,0,v145
v_exp_f32 v154,v154 clamp
v_max_f32 v146,0,v146
v_exp_f32 v155,v155 clamp
v_max_f32 v147,0,v147
v_exp_f32 v156,v156 clamp
v_max_f32 v148,0,v148
v_exp_f32 v157,v157 clamp
v_max_f32 v149,0,v149
v_exp_f32 v158,v158 clamp
v_max_f32 v150,0,v150
v_exp_f32 v159,v159 clamp
v_max_f32 v151,0,v151
pa v[152:153],v[152:153],v[144:145]
pa v[154:155],v[154:155],v[146:147]
pa v[156:157],v[156:157],v[148:149]
pa v[158:159],v[158:159],v[150:151]
pa v[152:153],v[152:153],s[80:81] op_sel:[0,1]
pa v[154:155],v[154:155],s[80:81] op_sel:[0,1]
pa v[156:157],v[156:157],s[80:81] op_sel:[0,1]
pa v[158:159],v[158:159],s[80:81] op_sel:[0,1]
cv v112,v152,v153
cv v113,v154,v155
cv v114,v156,v157
cv v115,v158,v159
s_nop 1
mm v[128:131],v[72:75],v[112:115],0
mm v[120:123],v[64:67],v[112:115],0
mm v[124:127],v[68:71],v[112:115],0
v_add_f32 v140,s81,v140
v_rcp_f32 v140,v140
s_nop 0
pm v[132:133],v[132:133],v[140:141] op_sel_hi:[1,0]
pm v[134:135],v[134:135],v[140:141] op_sel_hi:[1,0]
pm v[136:137],v[136:137],v[140:141] op_sel_hi:[1,0]
pm v[138:139],v[138:139],v[140:141] op_sel_hi:[1,0]
cv v172,v132,v133
cv v173,v134,v135
cv v174,v136,v137
cv v175,v138,v139
s_xor_b32 s49,s48,4096
w4 v[172:175],v28,s[8:11],s49 offen offset:2048 sc1
ar v144,a40
ar v145,a41
ar v146,a42
ar v147,a43
ar v148,a44
ar v149,a45
ar v150,a46
ar v151,a47
pm v[152:153],v[144:145],s[80:81] op_sel_hi:[1,0]
pm v[154:155],v[146:147],s[80:81] op_sel_hi:[1,0]
pm v[156:157],v[148:149],s[80:81] op_sel_hi:[1,0]
pm v[158:159],v[150:151],s[80:81] op_sel_hi:[1,0]
v_exp_f32 v152,v152 clamp
v_max_f32 v144,0,v144
v_exp_f32 v153,v153 clamp
v_max_f32 v145,0,v145
v_exp_f32 v154,v154 clamp
v_max_f32 v146,0,v146
v_exp_f32 v155,v155 clamp
v_max_f32 v147,0,v147
v_exp_f32 v156,v156 clamp
v_max_f32 v148,0,v148
v_exp_f32 v157,v157 clamp
v_max_f32 v149,0,v149
v_exp_f32 v158,v158 clamp
v_max_f32 v150,0,v150
v_exp_f32 v159,v159 clamp
v_max_f32 v151,0,v151
pa v[152:153],v[152:153],v[144:145]
pa v[154:155],v[154:155],v[146:147]
pa v[156:157],v[156:157],v[148:149]
pa v[158:159],v[158:159],v[150:151]
pa v[152:153],v[152:153],s[80:81] op_sel:[0,1]
pa v[154:155],v[154:155],s[80:81] op_sel:[0,1]
pa v[156:157],v[156:157],s[80:81] op_sel:[0,1]
pa v[158:159],v[158:159],s[80:81] op_sel:[0,1]
cv v116,v152,v153
cv v117,v154,v155
cv v118,v156,v157
cv v119,v158,v159
s_nop 1
mm v[140:143],v[84:87],v[116:119],0
mm v[132:135],v[76:79],v[116:119],0
mm v[136:139],v[80:83],v[116:119],0
v_add_f32 v128,s81,v128
v_rcp_f32 v128,v128
s_nop 0
pm v[120:121],v[120:121],v[128:129] op_sel_hi:[1,0]
pm v[122:123],v[122:123],v[128:129] op_sel_hi:[1,0]
pm v[124:125],v[124:125],v[128:129] op_sel_hi:[1,0]
pm v[126:127],v[126:127],v[128:129] op_sel_hi:[1,0]
cv v168,v120,v121
cv v169,v122,v123
cv v170,v124,v125
cv v171,v126,v127
s_xor_b32 s49,s48,0
w4 v[168:171],v28,s[8:11],s49 offen offset:256 sc1
ar v144,a48
ar v145,a49
ar v146,a50
ar v147,a51
ar v148,a52
ar v149,a53
ar v150,a54
ar v151,a55
pm v[152:153],v[144:145],s[80:81] op_sel_hi:[1,0]
pm v[154:155],v[146:147],s[80:81] op_sel_hi:[1,0]
pm v[156:157],v[148:149],s[80:81] op_sel_hi:[1,0]
pm v[158:159],v[150:151],s[80:81] op_sel_hi:[1,0]
v_exp_f32 v152,v152 clamp
v_max_f32 v144,0,v144
v_exp_f32 v153,v153 clamp
v_max_f32 v145,0,v145
v_exp_f32 v154,v154 clamp
v_max_f32 v146,0,v146
v_exp_f32 v155,v155 clamp
v_max_f32 v147,0,v147
v_exp_f32 v156,v156 clamp
v_max_f32 v148,0,v148
v_exp_f32 v157,v157 clamp
v_max_f32 v149,0,v149
v_exp_f32 v158,v158 clamp
v_max_f32 v150,0,v150
v_exp_f32 v159,v159 clamp
v_max_f32 v151,0,v151
pa v[152:153],v[152:153],v[144:145]
pa v[154:155],v[154:155],v[146:147]
pa v[156:157],v[156:157],v[148:149]
pa v[158:159],v[158:159],v[150:151]
pa v[152:153],v[152:153],s[80:81] op_sel:[0,1]
pa v[154:155],v[154:155],s[80:81] op_sel:[0,1]
pa v[156:157],v[156:157],s[80:81] op_sel:[0,1]
pa v[158:159],v[158:159],s[80:81] op_sel:[0,1]
cv v112,v152,v153
cv v113,v154,v155
cv v114,v156,v157
cv v115,v158,v159
s_nop 1
mm v[128:131],v[96:99],v[112:115],0
mm v[120:123],v[88:91],v[112:115],0
mm v[124:127],v[92:95],v[112:115],0
v_add_f32 v140,s81,v140
v_rcp_f32 v140,v140
s_nop 0
pm v[132:133],v[132:133],v[140:141] op_sel_hi:[1,0]
pm v[134:135],v[134:135],v[140:141] op_sel_hi:[1,0]
pm v[136:137],v[136:137],v[140:141] op_sel_hi:[1,0]
pm v[138:139],v[138:139],v[140:141] op_sel_hi:[1,0]
cv v172,v132,v133
cv v173,v134,v135
cv v174,v136,v137
cv v175,v138,v139
s_xor_b32 s49,s48,0
w4 v[172:175],v28,s[8:11],s49 offen offset:2304 sc1
ar v144,a56
ar v145,a57
ar v146,a58
ar v147,a59
ar v148,a60
ar v149,a61
ar v150,a62
ar v151,a63
pm v[152:153],v[144:145],s[80:81] op_sel_hi:[1,0]
pm v[154:155],v[146:147],s[80:81] op_sel_hi:[1,0]
pm v[156:157],v[148:149],s[80:81] op_sel_hi:[1,0]
pm v[158:159],v[150:151],s[80:81] op_sel_hi:[1,0]
v_exp_f32 v152,v152 clamp
v_max_f32 v144,0,v144
v_exp_f32 v153,v153 clamp
v_max_f32 v145,0,v145
v_exp_f32 v154,v154 clamp
v_max_f32 v146,0,v146
v_exp_f32 v155,v155 clamp
v_max_f32 v147,0,v147
v_exp_f32 v156,v156 clamp
v_max_f32 v148,0,v148
v_exp_f32 v157,v157 clamp
v_max_f32 v149,0,v149
v_exp_f32 v158,v158 clamp
v_max_f32 v150,0,v150
v_exp_f32 v159,v159 clamp
v_max_f32 v151,0,v151
pa v[152:153],v[152:153],v[144:145]
pa v[154:155],v[154:155],v[146:147]
pa v[156:157],v[156:157],v[148:149]
pa v[158:159],v[158:159],v[150:151]
pa v[152:153],v[152:153],s[80:81] op_sel:[0,1]
pa v[154:155],v[154:155],s[80:81] op_sel:[0,1]
pa v[156:157],v[156:157],s[80:81] op_sel:[0,1]
pa v[158:159],v[158:159],s[80:81] op_sel:[0,1]
cv v116,v152,v153
cv v117,v154,v155
cv v118,v156,v157
cv v119,v158,v159
s_nop 1
mm v[140:143],v[108:111],v[116:119],0
mm v[132:135],v[100:103],v[116:119],0
mm v[136:139],v[104:107],v[116:119],0
v_add_f32 v128,s81,v128
v_rcp_f32 v128,v128
s_nop 0
pm v[120:121],v[120:121],v[128:129] op_sel_hi:[1,0]
pm v[122:123],v[122:123],v[128:129] op_sel_hi:[1,0]
pm v[124:125],v[124:125],v[128:129] op_sel_hi:[1,0]
pm v[126:127],v[126:127],v[128:129] op_sel_hi:[1,0]
cv v168,v120,v121
cv v169,v122,v123
cv v170,v124,v125
cv v171,v126,v127
s_xor_b32 s49,s48,4096
w4 v[168:171],v28,s[8:11],s49 offen offset:256 sc1
ar v144,a64
ar v145,a65
ar v146,a66
ar v147,a67
ar v148,a68
ar v149,a69
ar v150,a70
ar v151,a71
pm v[152:153],v[144:145],s[80:81] op_sel_hi:[1,0]
pm v[154:155],v[146:147],s[80:81] op_sel_hi:[1,0]
pm v[156:157],v[148:149],s[80:81] op_sel_hi:[1,0]
pm v[158:159],v[150:151],s[80:81] op_sel_hi:[1,0]
v_exp_f32 v152,v152 clamp
v_max_f32 v144,0,v144
v_exp_f32 v153,v153 clamp
v_max_f32 v145,0,v145
v_exp_f32 v154,v154 clamp
v_max_f32 v146,0,v146
v_exp_f32 v155,v155 clamp
v_max_f32 v147,0,v147
v_exp_f32 v156,v156 clamp
v_max_f32 v148,0,v148
v_exp_f32 v157,v157 clamp
v_max_f32 v149,0,v149
v_exp_f32 v158,v158 clamp
v_max_f32 v150,0,v150
v_exp_f32 v159,v159 clamp
v_max_f32 v151,0,v151
pa v[152:153],v[152:153],v[144:145]
pa v[154:155],v[154:155],v[146:147]
pa v[156:157],v[156:157],v[148:149]
pa v[158:159],v[158:159],v[150:151]
pa v[152:153],v[152:153],s[80:81] op_sel:[0,1]
pa v[154:155],v[154:155],s[80:81] op_sel:[0,1]
pa v[156:157],v[156:157],s[80:81] op_sel:[0,1]
pa v[158:159],v[158:159],s[80:81] op_sel:[0,1]
cv v112,v152,v153
cv v113,v154,v155
cv v114,v156,v157
cv v115,v158,v159
s_nop 1
mm v[128:131],v[72:75],v[112:115],0
mm v[120:123],v[64:67],v[112:115],0
mm v[124:127],v[68:71],v[112:115],0
v_add_f32 v140,s81,v140
v_rcp_f32 v140,v140
s_nop 0
pm v[132:133],v[132:133],v[140:141] op_sel_hi:[1,0]
pm v[134:135],v[134:135],v[140:141] op_sel_hi:[1,0]
pm v[136:137],v[136:137],v[140:141] op_sel_hi:[1,0]
pm v[138:139],v[138:139],v[140:141] op_sel_hi:[1,0]
cv v172,v132,v133
cv v173,v134,v135
cv v174,v136,v137
cv v175,v138,v139
s_xor_b32 s49,s48,4096
w4 v[172:175],v28,s[8:11],s49 offen offset:2304 sc1
ar v144,a72
ar v145,a73
ar v146,a74
ar v147,a75
ar v148,a76
ar v149,a77
ar v150,a78
ar v151,a79
pm v[152:153],v[144:145],s[80:81] op_sel_hi:[1,0]
pm v[154:155],v[146:147],s[80:81] op_sel_hi:[1,0]
pm v[156:157],v[148:149],s[80:81] op_sel_hi:[1,0]
pm v[158:159],v[150:151],s[80:81] op_sel_hi:[1,0]
v_exp_f32 v152,v152 clamp
v_max_f32 v144,0,v144
v_exp_f32 v153,v153 clamp
v_max_f32 v145,0,v145
v_exp_f32 v154,v154 clamp
v_max_f32 v146,0,v146
v_exp_f32 v155,v155 clamp
v_max_f32 v147,0,v147
v_exp_f32 v156,v156 clamp
v_max_f32 v148,0,v148
v_exp_f32 v157,v157 clamp
v_max_f32 v149,0,v149
v_exp_f32 v158,v158 clamp
v_max_f32 v150,0,v150
v_exp_f32 v159,v159 clamp
v_max_f32 v151,0,v151
pa v[152:153],v[152:153],v[144:145]
pa v[154:155],v[154:155],v[146:147]
pa v[156:157],v[156:157],v[148:149]
pa v[158:159],v[158:159],v[150:151]
pa v[152:153],v[152:153],s[80:81] op_sel:[0,1]
pa v[154:155],v[154:155],s[80:81] op_sel:[0,1]
pa v[156:157],v[156:157],s[80:81] op_sel:[0,1]
pa v[158:159],v[158:159],s[80:81] op_sel:[0,1]
cv v116,v152,v153
cv v117,v154,v155
cv v118,v156,v157
cv v119,v158,v159
s_nop 1
mm v[140:143],v[84:87],v[116:119],0
mm v[132:135],v[76:79],v[116:119],0
mm v[136:139],v[80:83],v[116:119],0
v_add_f32 v128,s81,v128
v_rcp_f32 v128,v128
s_nop 0
pm v[120:121],v[120:121],v[128:129] op_sel_hi:[1,0]
pm v[122:123],v[122:123],v[128:129] op_sel_hi:[1,0]
pm v[124:125],v[124:125],v[128:129] op_sel_hi:[1,0]
pm v[126:127],v[126:127],v[128:129] op_sel_hi:[1,0]
cv v168,v120,v121
cv v169,v122,v123
cv v170,v124,v125
cv v171,v126,v127
s_xor_b32 s49,s48,135168
w4 v[168:171],v28,s[8:11],s49 offen sc1
ar v144,a80
ar v145,a81
ar v146,a82
ar v147,a83
ar v148,a84
ar v149,a85
ar v150,a86
ar v151,a87
pm v[152:153],v[144:145],s[80:81] op_sel_hi:[1,0]
pm v[154:155],v[146:147],s[80:81] op_sel_hi:[1,0]
pm v[156:157],v[148:149],s[80:81] op_sel_hi:[1,0]
pm v[158:159],v[150:151],s[80:81] op_sel_hi:[1,0]
v_exp_f32 v152,v152 clamp
v_max_f32 v144,0,v144
v_exp_f32 v153,v153 clamp
v_max_f32 v145,0,v145
v_exp_f32 v154,v154 clamp
v_max_f32 v146,0,v146
v_exp_f32 v155,v155 clamp
v_max_f32 v147,0,v147
v_exp_f32 v156,v156 clamp
v_max_f32 v148,0,v148
v_exp_f32 v157,v157 clamp
v_max_f32 v149,0,v149
v_exp_f32 v158,v158 clamp
v_max_f32 v150,0,v150
v_exp_f32 v159,v159 clamp
v_max_f32 v151,0,v151
pa v[152:153],v[152:153],v[144:145]
pa v[154:155],v[154:155],v[146:147]
pa v[156:157],v[156:157],v[148:149]
pa v[158:159],v[158:159],v[150:151]
pa v[152:153],v[152:153],s[80:81] op_sel:[0,1]
pa v[154:155],v[154:155],s[80:81] op_sel:[0,1]
pa v[156:157],v[156:157],s[80:81] op_sel:[0,1]
pa v[158:159],v[158:159],s[80:81] op_sel:[0,1]
cv v112,v152,v153
cv v113,v154,v155
cv v114,v156,v157
cv v115,v158,v159
s_nop 1
mm v[128:131],v[96:99],v[112:115],0
mm v[120:123],v[88:91],v[112:115],0
mm v[124:127],v[92:95],v[112:115],0
v_add_f32 v140,s81,v140
v_rcp_f32 v140,v140
s_nop 0
pm v[132:133],v[132:133],v[140:141] op_sel_hi:[1,0]
pm v[134:135],v[134:135],v[140:141] op_sel_hi:[1,0]
pm v[136:137],v[136:137],v[140:141] op_sel_hi:[1,0]
pm v[138:139],v[138:139],v[140:141] op_sel_hi:[1,0]
cv v172,v132,v133
cv v173,v134,v135
cv v174,v136,v137
cv v175,v138,v139
s_xor_b32 s49,s48,135168
w4 v[172:175],v28,s[8:11],s49 offen offset:2048 sc1
ar v144,a88
ar v145,a89
ar v146,a90
ar v147,a91
ar v148,a92
ar v149,a93
ar v150,a94
ar v151,a95
pm v[152:153],v[144:145],s[80:81] op_sel_hi:[1,0]
pm v[154:155],v[146:147],s[80:81] op_sel_hi:[1,0]
pm v[156:157],v[148:149],s[80:81] op_sel_hi:[1,0]
pm v[158:159],v[150:151],s[80:81] op_sel_hi:[1,0]
v_exp_f32 v152,v152 clamp
v_max_f32 v144,0,v144
v_exp_f32 v153,v153 clamp
v_max_f32 v145,0,v145
v_exp_f32 v154,v154 clamp
v_max_f32 v146,0,v146
v_exp_f32 v155,v155 clamp
v_max_f32 v147,0,v147
v_exp_f32 v156,v156 clamp
v_max_f32 v148,0,v148
v_exp_f32 v157,v157 clamp
v_max_f32 v149,0,v149
v_exp_f32 v158,v158 clamp
v_max_f32 v150,0,v150
v_exp_f32 v159,v159 clamp
v_max_f32 v151,0,v151
pa v[152:153],v[152:153],v[144:145]
pa v[154:155],v[154:155],v[146:147]
pa v[156:157],v[156:157],v[148:149]
pa v[158:159],v[158:159],v[150:151]
pa v[152:153],v[152:153],s[80:81] op_sel:[0,1]
pa v[154:155],v[154:155],s[80:81] op_sel:[0,1]
pa v[156:157],v[156:157],s[80:81] op_sel:[0,1]
pa v[158:159],v[158:159],s[80:81] op_sel:[0,1]
cv v116,v152,v153
cv v117,v154,v155
cv v118,v156,v157
cv v119,v158,v159
s_nop 1
mm v[140:143],v[108:111],v[116:119],0
mm v[132:135],v[100:103],v[116:119],0
mm v[136:139],v[104:107],v[116:119],0
v_add_f32 v128,s81,v128
v_rcp_f32 v128,v128
s_nop 0
pm v[120:121],v[120:121],v[128:129] op_sel_hi:[1,0]
pm v[122:123],v[122:123],v[128:129] op_sel_hi:[1,0]
pm v[124:125],v[124:125],v[128:129] op_sel_hi:[1,0]
pm v[126:127],v[126:127],v[128:129] op_sel_hi:[1,0]
cv v168,v120,v121
cv v169,v122,v123
cv v170,v124,v125
cv v171,v126,v127
s_xor_b32 s49,s48,131072
w4 v[168:171],v28,s[8:11],s49 offen sc1
ar v144,a96
ar v145,a97
ar v146,a98
ar v147,a99
ar v148,a100
ar v149,a101
ar v150,a102
ar v151,a103
pm v[152:153],v[144:145],s[80:81] op_sel_hi:[1,0]
pm v[154:155],v[146:147],s[80:81] op_sel_hi:[1,0]
pm v[156:157],v[148:149],s[80:81] op_sel_hi:[1,0]
pm v[158:159],v[150:151],s[80:81] op_sel_hi:[1,0]
v_exp_f32 v152,v152 clamp
v_max_f32 v144,0,v144
v_exp_f32 v153,v153 clamp
v_max_f32 v145,0,v145
v_exp_f32 v154,v154 clamp
v_max_f32 v146,0,v146
v_exp_f32 v155,v155 clamp
v_max_f32 v147,0,v147
v_exp_f32 v156,v156 clamp
v_max_f32 v148,0,v148
v_exp_f32 v157,v157 clamp
v_max_f32 v149,0,v149
v_exp_f32 v158,v158 clamp
v_max_f32 v150,0,v150
v_exp_f32 v159,v159 clamp
v_max_f32 v151,0,v151
pa v[152:153],v[152:153],v[144:145]
pa v[154:155],v[154:155],v[146:147]
pa v[156:157],v[156:157],v[148:149]
pa v[158:159],v[158:159],v[150:151]
pa v[152:153],v[152:153],s[80:81] op_sel:[0,1]
pa v[154:155],v[154:155],s[80:81] op_sel:[0,1]
pa v[156:157],v[156:157],s[80:81] op_sel:[0,1]
pa v[158:159],v[158:159],s[80:81] op_sel:[0,1]
cv v112,v152,v153
cv v113,v154,v155
cv v114,v156,v157
cv v115,v158,v159
s_nop 1
mm v[128:131],v[72:75],v[112:115],0
mm v[120:123],v[64:67],v[112:115],0
mm v[124:127],v[68:71],v[112:115],0
v_add_f32 v140,s81,v140
v_rcp_f32 v140,v140
s_nop 0
pm v[132:133],v[132:133],v[140:141] op_sel_hi:[1,0]
pm v[134:135],v[134:135],v[140:141] op_sel_hi:[1,0]
pm v[136:137],v[136:137],v[140:141] op_sel_hi:[1,0]
pm v[138:139],v[138:139],v[140:141] op_sel_hi:[1,0]
cv v172,v132,v133
cv v173,v134,v135
cv v174,v136,v137
cv v175,v138,v139
s_xor_b32 s49,s48,131072
w4 v[172:175],v28,s[8:11],s49 offen offset:2048 sc1
ar v144,a104
ar v145,a105
ar v146,a106
ar v147,a107
ar v148,a108
ar v149,a109
ar v150,a110
ar v151,a111
pm v[152:153],v[144:145],s[80:81] op_sel_hi:[1,0]
pm v[154:155],v[146:147],s[80:81] op_sel_hi:[1,0]
pm v[156:157],v[148:149],s[80:81] op_sel_hi:[1,0]
pm v[158:159],v[150:151],s[80:81] op_sel_hi:[1,0]
v_exp_f32 v152,v152 clamp
v_max_f32 v144,0,v144
v_exp_f32 v153,v153 clamp
v_max_f32 v145,0,v145
v_exp_f32 v154,v154 clamp
v_max_f32 v146,0,v146
v_exp_f32 v155,v155 clamp
v_max_f32 v147,0,v147
v_exp_f32 v156,v156 clamp
v_max_f32 v148,0,v148
v_exp_f32 v157,v157 clamp
v_max_f32 v149,0,v149
v_exp_f32 v158,v158 clamp
v_max_f32 v150,0,v150
v_exp_f32 v159,v159 clamp
v_max_f32 v151,0,v151
pa v[152:153],v[152:153],v[144:145]
pa v[154:155],v[154:155],v[146:147]
pa v[156:157],v[156:157],v[148:149]
pa v[158:159],v[158:159],v[150:151]
pa v[152:153],v[152:153],s[80:81] op_sel:[0,1]
pa v[154:155],v[154:155],s[80:81] op_sel:[0,1]
pa v[156:157],v[156:157],s[80:81] op_sel:[0,1]
pa v[158:159],v[158:159],s[80:81] op_sel:[0,1]
cv v116,v152,v153
cv v117,v154,v155
cv v118,v156,v157
cv v119,v158,v159
s_nop 1
mm v[140:143],v[84:87],v[116:119],0
mm v[132:135],v[76:79],v[116:119],0
mm v[136:139],v[80:83],v[116:119],0
v_add_f32 v128,s81,v128
v_rcp_f32 v128,v128
s_nop 0
pm v[120:121],v[120:121],v[128:129] op_sel_hi:[1,0]
pm v[122:123],v[122:123],v[128:129] op_sel_hi:[1,0]
pm v[124:125],v[124:125],v[128:129] op_sel_hi:[1,0]
pm v[126:127],v[126:127],v[128:129] op_sel_hi:[1,0]
cv v168,v120,v121
cv v169,v122,v123
cv v170,v124,v125
cv v171,v126,v127
s_xor_b32 s49,s48,135168
w4 v[168:171],v28,s[8:11],s49 offen offset:256 sc1
ar v144,a112
ar v145,a113
ar v146,a114
ar v147,a115
ar v148,a116
ar v149,a117
ar v150,a118
ar v151,a119
pm v[152:153],v[144:145],s[80:81] op_sel_hi:[1,0]
pm v[154:155],v[146:147],s[80:81] op_sel_hi:[1,0]
pm v[156:157],v[148:149],s[80:81] op_sel_hi:[1,0]
pm v[158:159],v[150:151],s[80:81] op_sel_hi:[1,0]
v_exp_f32 v152,v152 clamp
v_max_f32 v144,0,v144
v_exp_f32 v153,v153 clamp
v_max_f32 v145,0,v145
v_exp_f32 v154,v154 clamp
v_max_f32 v146,0,v146
v_exp_f32 v155,v155 clamp
v_max_f32 v147,0,v147
v_exp_f32 v156,v156 clamp
v_max_f32 v148,0,v148
v_exp_f32 v157,v157 clamp
v_max_f32 v149,0,v149
v_exp_f32 v158,v158 clamp
v_max_f32 v150,0,v150
v_exp_f32 v159,v159 clamp
v_max_f32 v151,0,v151
pa v[152:153],v[152:153],v[144:145]
pa v[154:155],v[154:155],v[146:147]
pa v[156:157],v[156:157],v[148:149]
pa v[158:159],v[158:159],v[150:151]
pa v[152:153],v[152:153],s[80:81] op_sel:[0,1]
pa v[154:155],v[154:155],s[80:81] op_sel:[0,1]
pa v[156:157],v[156:157],s[80:81] op_sel:[0,1]
pa v[158:159],v[158:159],s[80:81] op_sel:[0,1]
cv v112,v152,v153
cv v113,v154,v155
cv v114,v156,v157
cv v115,v158,v159
s_nop 1
mm v[128:131],v[96:99],v[112:115],0
mm v[120:123],v[88:91],v[112:115],0
mm v[124:127],v[92:95],v[112:115],0
v_add_f32 v140,s81,v140
v_rcp_f32 v140,v140
s_nop 0
pm v[132:133],v[132:133],v[140:141] op_sel_hi:[1,0]
pm v[134:135],v[134:135],v[140:141] op_sel_hi:[1,0]
pm v[136:137],v[136:137],v[140:141] op_sel_hi:[1,0]
pm v[138:139],v[138:139],v[140:141] op_sel_hi:[1,0]
cv v172,v132,v133
cv v173,v134,v135
cv v174,v136,v137
cv v175,v138,v139
s_xor_b32 s49,s48,135168
w4 v[172:175],v28,s[8:11],s49 offen offset:2304 sc1
ar v144,a120
ar v145,a121
ar v146,a122
ar v147,a123
ar v148,a124
ar v149,a125
ar v150,a126
ar v151,a127
pm v[152:153],v[144:145],s[80:81] op_sel_hi:[1,0]
pm v[154:155],v[146:147],s[80:81] op_sel_hi:[1,0]
pm v[156:157],v[148:149],s[80:81] op_sel_hi:[1,0]
pm v[158:159],v[150:151],s[80:81] op_sel_hi:[1,0]
v_exp_f32 v152,v152 clamp
v_max_f32 v144,0,v144
v_exp_f32 v153,v153 clamp
v_max_f32 v145,0,v145
v_exp_f32 v154,v154 clamp
v_max_f32 v146,0,v146
v_exp_f32 v155,v155 clamp
v_max_f32 v147,0,v147
v_exp_f32 v156,v156 clamp
v_max_f32 v148,0,v148
v_exp_f32 v157,v157 clamp
v_max_f32 v149,0,v149
v_exp_f32 v158,v158 clamp
v_max_f32 v150,0,v150
v_exp_f32 v159,v159 clamp
v_max_f32 v151,0,v151
pa v[152:153],v[152:153],v[144:145]
pa v[154:155],v[154:155],v[146:147]
pa v[156:157],v[156:157],v[148:149]
pa v[158:159],v[158:159],v[150:151]
pa v[152:153],v[152:153],s[80:81] op_sel:[0,1]
pa v[154:155],v[154:155],s[80:81] op_sel:[0,1]
pa v[156:157],v[156:157],s[80:81] op_sel:[0,1]
pa v[158:159],v[158:159],s[80:81] op_sel:[0,1]
cv v116,v152,v153
cv v117,v154,v155
cv v118,v156,v157
cv v119,v158,v159
s_nop 1
mm v[140:143],v[108:111],v[116:119],0
mm v[132:135],v[100:103],v[116:119],0
mm v[136:139],v[104:107],v[116:119],0
v_add_f32 v128,s81,v128
v_rcp_f32 v128,v128
s_nop 0
pm v[120:121],v[120:121],v[128:129] op_sel_hi:[1,0]
pm v[122:123],v[122:123],v[128:129] op_sel_hi:[1,0]
pm v[124:125],v[124:125],v[128:129] op_sel_hi:[1,0]
pm v[126:127],v[126:127],v[128:129] op_sel_hi:[1,0]
cv v168,v120,v121
cv v169,v122,v123
cv v170,v124,v125
cv v171,v126,v127
s_xor_b32 s49,s48,131072
w4 v[168:171],v28,s[8:11],s49 offen offset:256 sc1
ar v144,a128
ar v145,a129
ar v146,a130
ar v147,a131
ar v148,a132
ar v149,a133
ar v150,a134
ar v151,a135
pm v[152:153],v[144:145],s[80:81] op_sel_hi:[1,0]
pm v[154:155],v[146:147],s[80:81] op_sel_hi:[1,0]
pm v[156:157],v[148:149],s[80:81] op_sel_hi:[1,0]
pm v[158:159],v[150:151],s[80:81] op_sel_hi:[1,0]
v_exp_f32 v152,v152 clamp
v_max_f32 v144,0,v144
v_exp_f32 v153,v153 clamp
v_max_f32 v145,0,v145
v_exp_f32 v154,v154 clamp
v_max_f32 v146,0,v146
v_exp_f32 v155,v155 clamp
v_max_f32 v147,0,v147
v_exp_f32 v156,v156 clamp
v_max_f32 v148,0,v148
v_exp_f32 v157,v157 clamp
v_max_f32 v149,0,v149
v_exp_f32 v158,v158 clamp
v_max_f32 v150,0,v150
v_exp_f32 v159,v159 clamp
v_max_f32 v151,0,v151
pa v[152:153],v[152:153],v[144:145]
pa v[154:155],v[154:155],v[146:147]
pa v[156:157],v[156:157],v[148:149]
pa v[158:159],v[158:159],v[150:151]
pa v[152:153],v[152:153],s[80:81] op_sel:[0,1]
pa v[154:155],v[154:155],s[80:81] op_sel:[0,1]
pa v[156:157],v[156:157],s[80:81] op_sel:[0,1]
pa v[158:159],v[158:159],s[80:81] op_sel:[0,1]
cv v112,v152,v153
cv v113,v154,v155
cv v114,v156,v157
cv v115,v158,v159
s_nop 1
mm v[128:131],v[72:75],v[112:115],0
mm v[120:123],v[64:67],v[112:115],0
mm v[124:127],v[68:71],v[112:115],0
v_add_f32 v140,s81,v140
v_rcp_f32 v140,v140
s_nop 0
pm v[132:133],v[132:133],v[140:141] op_sel_hi:[1,0]
pm v[134:135],v[134:135],v[140:141] op_sel_hi:[1,0]
pm v[136:137],v[136:137],v[140:141] op_sel_hi:[1,0]
pm v[138:139],v[138:139],v[140:141] op_sel_hi:[1,0]
cv v172,v132,v133
cv v173,v134,v135
cv v174,v136,v137
cv v175,v138,v139
s_xor_b32 s49,s48,131072
w4 v[172:175],v28,s[8:11],s49 offen offset:2304 sc1
ar v144,a136
ar v145,a137
ar v146,a138
ar v147,a139
ar v148,a140
ar v149,a141
ar v150,a142
ar v151,a143
pm v[152:153],v[144:145],s[80:81] op_sel_hi:[1,0]
pm v[154:155],v[146:147],s[80:81] op_sel_hi:[1,0]
pm v[156:157],v[148:149],s[80:81] op_sel_hi:[1,0]
pm v[158:159],v[150:151],s[80:81] op_sel_hi:[1,0]
v_exp_f32 v152,v152 clamp
v_max_f32 v144,0,v144
v_exp_f32 v153,v153 clamp
v_max_f32 v145,0,v145
v_exp_f32 v154,v154 clamp
v_max_f32 v146,0,v146
v_exp_f32 v155,v155 clamp
v_max_f32 v147,0,v147
v_exp_f32 v156,v156 clamp
v_max_f32 v148,0,v148
v_exp_f32 v157,v157 clamp
v_max_f32 v149,0,v149
v_exp_f32 v158,v158 clamp
v_max_f32 v150,0,v150
v_exp_f32 v159,v159 clamp
v_max_f32 v151,0,v151
pa v[152:153],v[152:153],v[144:145]
pa v[154:155],v[154:155],v[146:147]
pa v[156:157],v[156:157],v[148:149]
pa v[158:159],v[158:159],v[150:151]
pa v[152:153],v[152:153],s[80:81] op_sel:[0,1]
pa v[154:155],v[154:155],s[80:81] op_sel:[0,1]
pa v[156:157],v[156:157],s[80:81] op_sel:[0,1]
pa v[158:159],v[158:159],s[80:81] op_sel:[0,1]
cv v116,v152,v153
cv v117,v154,v155
cv v118,v156,v157
cv v119,v158,v159
s_nop 1
mm v[140:143],v[84:87],v[116:119],0
mm v[132:135],v[76:79],v[116:119],0
mm v[136:139],v[80:83],v[116:119],0
v_add_f32 v128,s81,v128
v_rcp_f32 v128,v128
s_nop 0
pm v[120:121],v[120:121],v[128:129] op_sel_hi:[1,0]
pm v[122:123],v[122:123],v[128:129] op_sel_hi:[1,0]
pm v[124:125],v[124:125],v[128:129] op_sel_hi:[1,0]
pm v[126:127],v[126:127],v[128:129] op_sel_hi:[1,0]
cv v168,v120,v121
cv v169,v122,v123
cv v170,v124,v125
cv v171,v126,v127
s_xor_b32 s49,s48,278528
w4 v[168:171],v28,s[8:11],s49 offen sc1
ar v144,a144
ar v145,a145
ar v146,a146
ar v147,a147
ar v148,a148
ar v149,a149
ar v150,a150
ar v151,a151
pm v[152:153],v[144:145],s[80:81] op_sel_hi:[1,0]
pm v[154:155],v[146:147],s[80:81] op_sel_hi:[1,0]
pm v[156:157],v[148:149],s[80:81] op_sel_hi:[1,0]
pm v[158:159],v[150:151],s[80:81] op_sel_hi:[1,0]
v_exp_f32 v152,v152 clamp
v_max_f32 v144,0,v144
v_exp_f32 v153,v153 clamp
v_max_f32 v145,0,v145
v_exp_f32 v154,v154 clamp
v_max_f32 v146,0,v146
v_exp_f32 v155,v155 clamp
v_max_f32 v147,0,v147
v_exp_f32 v156,v156 clamp
v_max_f32 v148,0,v148
v_exp_f32 v157,v157 clamp
v_max_f32 v149,0,v149
v_exp_f32 v158,v158 clamp
v_max_f32 v150,0,v150
v_exp_f32 v159,v159 clamp
v_max_f32 v151,0,v151
pa v[152:153],v[152:153],v[144:145]
pa v[154:155],v[154:155],v[146:147]
pa v[156:157],v[156:157],v[148:149]
pa v[158:159],v[158:159],v[150:151]
pa v[152:153],v[152:153],s[80:81] op_sel:[0,1]
pa v[154:155],v[154:155],s[80:81] op_sel:[0,1]
pa v[156:157],v[156:157],s[80:81] op_sel:[0,1]
pa v[158:159],v[158:159],s[80:81] op_sel:[0,1]
cv v112,v152,v153
cv v113,v154,v155
cv v114,v156,v157
cv v115,v158,v159
s_nop 1
mm v[128:131],v[96:99],v[112:115],0
mm v[120:123],v[88:91],v[112:115],0
mm v[124:127],v[92:95],v[112:115],0
v_add_f32 v140,s81,v140
v_rcp_f32 v140,v140
s_nop 0
pm v[132:133],v[132:133],v[140:141] op_sel_hi:[1,0]
pm v[134:135],v[134:135],v[140:141] op_sel_hi:[1,0]
pm v[136:137],v[136:137],v[140:141] op_sel_hi:[1,0]
pm v[138:139],v[138:139],v[140:141] op_sel_hi:[1,0]
cv v172,v132,v133
cv v173,v134,v135
cv v174,v136,v137
cv v175,v138,v139
s_xor_b32 s49,s48,278528
w4 v[172:175],v28,s[8:11],s49 offen offset:2048 sc1
ar v144,a152
ar v145,a153
ar v146,a154
ar v147,a155
ar v148,a156
ar v149,a157
ar v150,a158
ar v151,a159
pm v[152:153],v[144:145],s[80:81] op_sel_hi:[1,0]
pm v[154:155],v[146:147],s[80:81] op_sel_hi:[1,0]
pm v[156:157],v[148:149],s[80:81] op_sel_hi:[1,0]
pm v[158:159],v[150:151],s[80:81] op_sel_hi:[1,0]
v_exp_f32 v152,v152 clamp
v_max_f32 v144,0,v144
v_exp_f32 v153,v153 clamp
v_max_f32 v145,0,v145
v_exp_f32 v154,v154 clamp
v_max_f32 v146,0,v146
v_exp_f32 v155,v155 clamp
v_max_f32 v147,0,v147
v_exp_f32 v156,v156 clamp
v_max_f32 v148,0,v148
v_exp_f32 v157,v157 clamp
v_max_f32 v149,0,v149
v_exp_f32 v158,v158 clamp
v_max_f32 v150,0,v150
v_exp_f32 v159,v159 clamp
v_max_f32 v151,0,v151
pa v[152:153],v[152:153],v[144:145]
pa v[154:155],v[154:155],v[146:147]
pa v[156:157],v[156:157],v[148:149]
pa v[158:159],v[158:159],v[150:151]
pa v[152:153],v[152:153],s[80:81] op_sel:[0,1]
pa v[154:155],v[154:155],s[80:81] op_sel:[0,1]
pa v[156:157],v[156:157],s[80:81] op_sel:[0,1]
pa v[158:159],v[158:159],s[80:81] op_sel:[0,1]
cv v116,v152,v153
cv v117,v154,v155
cv v118,v156,v157
cv v119,v158,v159
s_nop 1
mm v[140:143],v[108:111],v[116:119],0
mm v[132:135],v[100:103],v[116:119],0
mm v[136:139],v[104:107],v[116:119],0
v_add_f32 v128,s81,v128
v_rcp_f32 v128,v128
s_nop 0
pm v[120:121],v[120:121],v[128:129] op_sel_hi:[1,0]
pm v[122:123],v[122:123],v[128:129] op_sel_hi:[1,0]
pm v[124:125],v[124:125],v[128:129] op_sel_hi:[1,0]
pm v[126:127],v[126:127],v[128:129] op_sel_hi:[1,0]
cv v168,v120,v121
cv v169,v122,v123
cv v170,v124,v125
cv v171,v126,v127
s_xor_b32 s49,s48,282624
w4 v[168:171],v28,s[8:11],s49 offen sc1
ar v144,a160
ar v145,a161
ar v146,a162
ar v147,a163
ar v148,a164
ar v149,a165
ar v150,a166
ar v151,a167
pm v[152:153],v[144:145],s[80:81] op_sel_hi:[1,0]
pm v[154:155],v[146:147],s[80:81] op_sel_hi:[1,0]
pm v[156:157],v[148:149],s[80:81] op_sel_hi:[1,0]
pm v[158:159],v[150:151],s[80:81] op_sel_hi:[1,0]
v_exp_f32 v152,v152 clamp
v_max_f32 v144,0,v144
v_exp_f32 v153,v153 clamp
v_max_f32 v145,0,v145
v_exp_f32 v154,v154 clamp
v_max_f32 v146,0,v146
v_exp_f32 v155,v155 clamp
v_max_f32 v147,0,v147
v_exp_f32 v156,v156 clamp
v_max_f32 v148,0,v148
v_exp_f32 v157,v157 clamp
v_max_f32 v149,0,v149
v_exp_f32 v158,v158 clamp
v_max_f32 v150,0,v150
v_exp_f32 v159,v159 clamp
v_max_f32 v151,0,v151
pa v[152:153],v[152:153],v[144:145]
pa v[154:155],v[154:155],v[146:147]
pa v[156:157],v[156:157],v[148:149]
pa v[158:159],v[158:159],v[150:151]
pa v[152:153],v[152:153],s[80:81] op_sel:[0,1]
pa v[154:155],v[154:155],s[80:81] op_sel:[0,1]
pa v[156:157],v[156:157],s[80:81] op_sel:[0,1]
pa v[158:159],v[158:159],s[80:81] op_sel:[0,1]
cv v112,v152,v153
cv v113,v154,v155
cv v114,v156,v157
cv v115,v158,v159
s_nop 1
mm v[128:131],v[72:75],v[112:115],0
mm v[120:123],v[64:67],v[112:115],0
mm v[124:127],v[68:71],v[112:115],0
v_add_f32 v140,s81,v140
v_rcp_f32 v140,v140
s_nop 0
pm v[132:133],v[132:133],v[140:141] op_sel_hi:[1,0]
pm v[134:135],v[134:135],v[140:141] op_sel_hi:[1,0]
pm v[136:137],v[136:137],v[140:141] op_sel_hi:[1,0]
pm v[138:139],v[138:139],v[140:141] op_sel_hi:[1,0]
cv v172,v132,v133
cv v173,v134,v135
cv v174,v136,v137
cv v175,v138,v139
s_xor_b32 s49,s48,282624
w4 v[172:175],v28,s[8:11],s49 offen offset:2048 sc1
ar v144,a168
ar v145,a169
ar v146,a170
ar v147,a171
ar v148,a172
ar v149,a173
ar v150,a174
ar v151,a175
pm v[152:153],v[144:145],s[80:81] op_sel_hi:[1,0]
pm v[154:155],v[146:147],s[80:81] op_sel_hi:[1,0]
pm v[156:157],v[148:149],s[80:81] op_sel_hi:[1,0]
pm v[158:159],v[150:151],s[80:81] op_sel_hi:[1,0]
v_exp_f32 v152,v152 clamp
v_max_f32 v144,0,v144
v_exp_f32 v153,v153 clamp
v_max_f32 v145,0,v145
v_exp_f32 v154,v154 clamp
v_max_f32 v146,0,v146
v_exp_f32 v155,v155 clamp
v_max_f32 v147,0,v147
v_exp_f32 v156,v156 clamp
v_max_f32 v148,0,v148
v_exp_f32 v157,v157 clamp
v_max_f32 v149,0,v149
v_exp_f32 v158,v158 clamp
v_max_f32 v150,0,v150
v_exp_f32 v159,v159 clamp
v_max_f32 v151,0,v151
pa v[152:153],v[152:153],v[144:145]
pa v[154:155],v[154:155],v[146:147]
pa v[156:157],v[156:157],v[148:149]
pa v[158:159],v[158:159],v[150:151]
pa v[152:153],v[152:153],s[80:81] op_sel:[0,1]
pa v[154:155],v[154:155],s[80:81] op_sel:[0,1]
pa v[156:157],v[156:157],s[80:81] op_sel:[0,1]
pa v[158:159],v[158:159],s[80:81] op_sel:[0,1]
cv v116,v152,v153
cv v117,v154,v155
cv v118,v156,v157
cv v119,v158,v159
s_nop 1
mm v[140:143],v[84:87],v[116:119],0
mm v[132:135],v[76:79],v[116:119],0
mm v[136:139],v[80:83],v[116:119],0
v_add_f32 v128,s81,v128
v_rcp_f32 v128,v128
s_nop 0
pm v[120:121],v[120:121],v[128:129] op_sel_hi:[1,0]
pm v[122:123],v[122:123],v[128:129] op_sel_hi:[1,0]
pm v[124:125],v[124:125],v[128:129] op_sel_hi:[1,0]
pm v[126:127],v[126:127],v[128:129] op_sel_hi:[1,0]
cv v168,v120,v121
cv v169,v122,v123
cv v170,v124,v125
cv v171,v126,v127
s_xor_b32 s49,s48,278528
w4 v[168:171],v28,s[8:11],s49 offen offset:256 sc1
ar v144,a176
ar v145,a177
ar v146,a178
ar v147,a179
ar v148,a180
ar v149,a181
ar v150,a182
ar v151,a183
pm v[152:153],v[144:145],s[80:81] op_sel_hi:[1,0]
pm v[154:155],v[146:147],s[80:81] op_sel_hi:[1,0]
pm v[156:157],v[148:149],s[80:81] op_sel_hi:[1,0]
pm v[158:159],v[150:151],s[80:81] op_sel_hi:[1,0]
v_exp_f32 v152,v152 clamp
v_max_f32 v144,0,v144
v_exp_f32 v153,v153 clamp
v_max_f32 v145,0,v145
v_exp_f32 v154,v154 clamp
v_max_f32 v146,0,v146
v_exp_f32 v155,v155 clamp
v_max_f32 v147,0,v147
v_exp_f32 v156,v156 clamp
v_max_f32 v148,0,v148
v_exp_f32 v157,v157 clamp
v_max_f32 v149,0,v149
v_exp_f32 v158,v158 clamp
v_max_f32 v150,0,v150
v_exp_f32 v159,v159 clamp
v_max_f32 v151,0,v151
pa v[152:153],v[152:153],v[144:145]
pa v[154:155],v[154:155],v[146:147]
pa v[156:157],v[156:157],v[148:149]
pa v[158:159],v[158:159],v[150:151]
pa v[152:153],v[152:153],s[80:81] op_sel:[0,1]
pa v[154:155],v[154:155],s[80:81] op_sel:[0,1]
pa v[156:157],v[156:157],s[80:81] op_sel:[0,1]
pa v[158:159],v[158:159],s[80:81] op_sel:[0,1]
cv v112,v152,v153
cv v113,v154,v155
cv v114,v156,v157
cv v115,v158,v159
s_nop 1
mm v[128:131],v[96:99],v[112:115],0
mm v[120:123],v[88:91],v[112:115],0
mm v[124:127],v[92:95],v[112:115],0
v_add_f32 v140,s81,v140
v_rcp_f32 v140,v140
s_nop 0
pm v[132:133],v[132:133],v[140:141] op_sel_hi:[1,0]
pm v[134:135],v[134:135],v[140:141] op_sel_hi:[1,0]
pm v[136:137],v[136:137],v[140:141] op_sel_hi:[1,0]
pm v[138:139],v[138:139],v[140:141] op_sel_hi:[1,0]
cv v172,v132,v133
cv v173,v134,v135
cv v174,v136,v137
cv v175,v138,v139
s_xor_b32 s49,s48,278528
w4 v[172:175],v28,s[8:11],s49 offen offset:2304 sc1
ar v144,a184
ar v145,a185
ar v146,a186
ar v147,a187
ar v148,a188
ar v149,a189
ar v150,a190
ar v151,a191
pm v[152:153],v[144:145],s[80:81] op_sel_hi:[1,0]
pm v[154:155],v[146:147],s[80:81] op_sel_hi:[1,0]
pm v[156:157],v[148:149],s[80:81] op_sel_hi:[1,0]
pm v[158:159],v[150:151],s[80:81] op_sel_hi:[1,0]
v_exp_f32 v152,v152 clamp
v_max_f32 v144,0,v144
v_exp_f32 v153,v153 clamp
v_max_f32 v145,0,v145
v_exp_f32 v154,v154 clamp
v_max_f32 v146,0,v146
v_exp_f32 v155,v155 clamp
v_max_f32 v147,0,v147
v_exp_f32 v156,v156 clamp
v_max_f32 v148,0,v148
v_exp_f32 v157,v157 clamp
v_max_f32 v149,0,v149
v_exp_f32 v158,v158 clamp
v_max_f32 v150,0,v150
v_exp_f32 v159,v159 clamp
v_max_f32 v151,0,v151
pa v[152:153],v[152:153],v[144:145]
pa v[154:155],v[154:155],v[146:147]
pa v[156:157],v[156:157],v[148:149]
pa v[158:159],v[158:159],v[150:151]
pa v[152:153],v[152:153],s[80:81] op_sel:[0,1]
pa v[154:155],v[154:155],s[80:81] op_sel:[0,1]
pa v[156:157],v[156:157],s[80:81] op_sel:[0,1]
pa v[158:159],v[158:159],s[80:81] op_sel:[0,1]
cv v116,v152,v153
cv v117,v154,v155
cv v118,v156,v157
cv v119,v158,v159
s_nop 1
mm v[140:143],v[108:111],v[116:119],0
mm v[132:135],v[100:103],v[116:119],0
mm v[136:139],v[104:107],v[116:119],0
v_add_f32 v128,s81,v128
v_rcp_f32 v128,v128
s_nop 0
pm v[120:121],v[120:121],v[128:129] op_sel_hi:[1,0]
pm v[122:123],v[122:123],v[128:129] op_sel_hi:[1,0]
pm v[124:125],v[124:125],v[128:129] op_sel_hi:[1,0]
pm v[126:127],v[126:127],v[128:129] op_sel_hi:[1,0]
cv v168,v120,v121
cv v169,v122,v123
cv v170,v124,v125
cv v171,v126,v127
s_xor_b32 s49,s48,282624
w4 v[168:171],v28,s[8:11],s49 offen offset:256 sc1
ar v144,a192
ar v145,a193
ar v146,a194
ar v147,a195
ar v148,a196
ar v149,a197
ar v150,a198
ar v151,a199
pm v[152:153],v[144:145],s[80:81] op_sel_hi:[1,0]
pm v[154:155],v[146:147],s[80:81] op_sel_hi:[1,0]
pm v[156:157],v[148:149],s[80:81] op_sel_hi:[1,0]
pm v[158:159],v[150:151],s[80:81] op_sel_hi:[1,0]
v_exp_f32 v152,v152 clamp
v_max_f32 v144,0,v144
v_exp_f32 v153,v153 clamp
v_max_f32 v145,0,v145
v_exp_f32 v154,v154 clamp
v_max_f32 v146,0,v146
v_exp_f32 v155,v155 clamp
v_max_f32 v147,0,v147
v_exp_f32 v156,v156 clamp
v_max_f32 v148,0,v148
v_exp_f32 v157,v157 clamp
v_max_f32 v149,0,v149
v_exp_f32 v158,v158 clamp
v_max_f32 v150,0,v150
v_exp_f32 v159,v159 clamp
v_max_f32 v151,0,v151
pa v[152:153],v[152:153],v[144:145]
pa v[154:155],v[154:155],v[146:147]
pa v[156:157],v[156:157],v[148:149]
pa v[158:159],v[158:159],v[150:151]
pa v[152:153],v[152:153],s[80:81] op_sel:[0,1]
pa v[154:155],v[154:155],s[80:81] op_sel:[0,1]
pa v[156:157],v[156:157],s[80:81] op_sel:[0,1]
pa v[158:159],v[158:159],s[80:81] op_sel:[0,1]
cv v112,v152,v153
cv v113,v154,v155
cv v114,v156,v157
cv v115,v158,v159
s_nop 1
mm v[128:131],v[72:75],v[112:115],0
mm v[120:123],v[64:67],v[112:115],0
mm v[124:127],v[68:71],v[112:115],0
v_add_f32 v140,s81,v140
v_rcp_f32 v140,v140
s_nop 0
pm v[132:133],v[132:133],v[140:141] op_sel_hi:[1,0]
pm v[134:135],v[134:135],v[140:141] op_sel_hi:[1,0]
pm v[136:137],v[136:137],v[140:141] op_sel_hi:[1,0]
pm v[138:139],v[138:139],v[140:141] op_sel_hi:[1,0]
cv v172,v132,v133
cv v173,v134,v135
cv v174,v136,v137
cv v175,v138,v139
s_xor_b32 s49,s48,282624
w4 v[172:175],v28,s[8:11],s49 offen offset:2304 sc1
ar v144,a200
ar v145,a201
ar v146,a202
ar v147,a203
ar v148,a204
ar v149,a205
ar v150,a206
ar v151,a207
pm v[152:153],v[144:145],s[80:81] op_sel_hi:[1,0]
pm v[154:155],v[146:147],s[80:81] op_sel_hi:[1,0]
pm v[156:157],v[148:149],s[80:81] op_sel_hi:[1,0]
pm v[158:159],v[150:151],s[80:81] op_sel_hi:[1,0]
v_exp_f32 v152,v152 clamp
v_max_f32 v144,0,v144
v_exp_f32 v153,v153 clamp
v_max_f32 v145,0,v145
v_exp_f32 v154,v154 clamp
v_max_f32 v146,0,v146
v_exp_f32 v155,v155 clamp
v_max_f32 v147,0,v147
v_exp_f32 v156,v156 clamp
v_max_f32 v148,0,v148
v_exp_f32 v157,v157 clamp
v_max_f32 v149,0,v149
v_exp_f32 v158,v158 clamp
v_max_f32 v150,0,v150
v_exp_f32 v159,v159 clamp
v_max_f32 v151,0,v151
pa v[152:153],v[152:153],v[144:145]
pa v[154:155],v[154:155],v[146:147]
pa v[156:157],v[156:157],v[148:149]
pa v[158:159],v[158:159],v[150:151]
pa v[152:153],v[152:153],s[80:81] op_sel:[0,1]
pa v[154:155],v[154:155],s[80:81] op_sel:[0,1]
pa v[156:157],v[156:157],s[80:81] op_sel:[0,1]
pa v[158:159],v[158:159],s[80:81] op_sel:[0,1]
cv v116,v152,v153
cv v117,v154,v155
cv v118,v156,v157
cv v119,v158,v159
s_nop 1
mm v[140:143],v[84:87],v[116:119],0
mm v[132:135],v[76:79],v[116:119],0
mm v[136:139],v[80:83],v[116:119],0
v_add_f32 v128,s81,v128
v_rcp_f32 v128,v128
s_nop 0
pm v[120:121],v[120:121],v[128:129] op_sel_hi:[1,0]
pm v[122:123],v[122:123],v[128:129] op_sel_hi:[1,0]
pm v[124:125],v[124:125],v[128:129] op_sel_hi:[1,0]
pm v[126:127],v[126:127],v[128:129] op_sel_hi:[1,0]
cv v168,v120,v121
cv v169,v122,v123
cv v170,v124,v125
cv v171,v126,v127
s_xor_b32 s49,s48,413696
w4 v[168:171],v28,s[8:11],s49 offen sc1
ar v144,a208
ar v145,a209
ar v146,a210
ar v147,a211
ar v148,a212
ar v149,a213
ar v150,a214
ar v151,a215
pm v[152:153],v[144:145],s[80:81] op_sel_hi:[1,0]
pm v[154:155],v[146:147],s[80:81] op_sel_hi:[1,0]
pm v[156:157],v[148:149],s[80:81] op_sel_hi:[1,0]
pm v[158:159],v[150:151],s[80:81] op_sel_hi:[1,0]
v_exp_f32 v152,v152 clamp
v_max_f32 v144,0,v144
v_exp_f32 v153,v153 clamp
v_max_f32 v145,0,v145
v_exp_f32 v154,v154 clamp
v_max_f32 v146,0,v146
v_exp_f32 v155,v155 clamp
v_max_f32 v147,0,v147
v_exp_f32 v156,v156 clamp
v_max_f32 v148,0,v148
v_exp_f32 v157,v157 clamp
v_max_f32 v149,0,v149
v_exp_f32 v158,v158 clamp
v_max_f32 v150,0,v150
v_exp_f32 v159,v159 clamp
v_max_f32 v151,0,v151
pa v[152:153],v[152:153],v[144:145]
pa v[154:155],v[154:155],v[146:147]
pa v[156:157],v[156:157],v[148:149]
pa v[158:159],v[158:159],v[150:151]
pa v[152:153],v[152:153],s[80:81] op_sel:[0,1]
pa v[154:155],v[154:155],s[80:81] op_sel:[0,1]
pa v[156:157],v[156:157],s[80:81] op_sel:[0,1]
pa v[158:159],v[158:159],s[80:81] op_sel:[0,1]
cv v112,v152,v153
cv v113,v154,v155
cv v114,v156,v157
cv v115,v158,v159
s_nop 1
mm v[128:131],v[96:99],v[112:115],0
mm v[120:123],v[88:91],v[112:115],0
mm v[124:127],v[92:95],v[112:115],0
v_add_f32 v140,s81,v140
v_rcp_f32 v140,v140
s_nop 0
pm v[132:133],v[132:133],v[140:141] op_sel_hi:[1,0]
pm v[134:135],v[134:135],v[140:141] op_sel_hi:[1,0]
pm v[136:137],v[136:137],v[140:141] op_sel_hi:[1,0]
pm v[138:139],v[138:139],v[140:141] op_sel_hi:[1,0]
cv v172,v132,v133
cv v173,v134,v135
cv v174,v136,v137
cv v175,v138,v139
s_xor_b32 s49,s48,413696
w4 v[172:175],v28,s[8:11],s49 offen offset:2048 sc1
ar v144,a216
ar v145,a217
ar v146,a218
ar v147,a219
ar v148,a220
ar v149,a221
ar v150,a222
ar v151,a223
pm v[152:153],v[144:145],s[80:81] op_sel_hi:[1,0]
pm v[154:155],v[146:147],s[80:81] op_sel_hi:[1,0]
pm v[156:157],v[148:149],s[80:81] op_sel_hi:[1,0]
pm v[158:159],v[150:151],s[80:81] op_sel_hi:[1,0]
v_exp_f32 v152,v152 clamp
v_max_f32 v144,0,v144
v_exp_f32 v153,v153 clamp
v_max_f32 v145,0,v145
v_exp_f32 v154,v154 clamp
v_max_f32 v146,0,v146
v_exp_f32 v155,v155 clamp
v_max_f32 v147,0,v147
v_exp_f32 v156,v156 clamp
v_max_f32 v148,0,v148
v_exp_f32 v157,v157 clamp
v_max_f32 v149,0,v149
v_exp_f32 v158,v158 clamp
v_max_f32 v150,0,v150
v_exp_f32 v159,v159 clamp
v_max_f32 v151,0,v151
pa v[152:153],v[152:153],v[144:145]
pa v[154:155],v[154:155],v[146:147]
pa v[156:157],v[156:157],v[148:149]
pa v[158:159],v[158:159],v[150:151]
pa v[152:153],v[152:153],s[80:81] op_sel:[0,1]
pa v[154:155],v[154:155],s[80:81] op_sel:[0,1]
pa v[156:157],v[156:157],s[80:81] op_sel:[0,1]
pa v[158:159],v[158:159],s[80:81] op_sel:[0,1]
cv v116,v152,v153
cv v117,v154,v155
cv v118,v156,v157
cv v119,v158,v159
s_nop 1
mm v[140:143],v[108:111],v[116:119],0
mm v[132:135],v[100:103],v[116:119],0
mm v[136:139],v[104:107],v[116:119],0
v_add_f32 v128,s81,v128
v_rcp_f32 v128,v128
s_nop 0
pm v[120:121],v[120:121],v[128:129] op_sel_hi:[1,0]
pm v[122:123],v[122:123],v[128:129] op_sel_hi:[1,0]
pm v[124:125],v[124:125],v[128:129] op_sel_hi:[1,0]
pm v[126:127],v[126:127],v[128:129] op_sel_hi:[1,0]
cv v168,v120,v121
cv v169,v122,v123
cv v170,v124,v125
cv v171,v126,v127
s_xor_b32 s49,s48,409600
w4 v[168:171],v28,s[8:11],s49 offen sc1
ar v144,a224
ar v145,a225
ar v146,a226
ar v147,a227
ar v148,a228
ar v149,a229
ar v150,a230
ar v151,a231
pm v[152:153],v[144:145],s[80:81] op_sel_hi:[1,0]
pm v[154:155],v[146:147],s[80:81] op_sel_hi:[1,0]
pm v[156:157],v[148:149],s[80:81] op_sel_hi:[1,0]
pm v[158:159],v[150:151],s[80:81] op_sel_hi:[1,0]
v_exp_f32 v152,v152 clamp
v_max_f32 v144,0,v144
v_exp_f32 v153,v153 clamp
v_max_f32 v145,0,v145
v_exp_f32 v154,v154 clamp
v_max_f32 v146,0,v146
v_exp_f32 v155,v155 clamp
v_max_f32 v147,0,v147
v_exp_f32 v156,v156 clamp
v_max_f32 v148,0,v148
v_exp_f32 v157,v157 clamp
v_max_f32 v149,0,v149
v_exp_f32 v158,v158 clamp
v_max_f32 v150,0,v150
v_exp_f32 v159,v159 clamp
v_max_f32 v151,0,v151
pa v[152:153],v[152:153],v[144:145]
pa v[154:155],v[154:155],v[146:147]
pa v[156:157],v[156:157],v[148:149]
pa v[158:159],v[158:159],v[150:151]
pa v[152:153],v[152:153],s[80:81] op_sel:[0,1]
pa v[154:155],v[154:155],s[80:81] op_sel:[0,1]
pa v[156:157],v[156:157],s[80:81] op_sel:[0,1]
pa v[158:159],v[158:159],s[80:81] op_sel:[0,1]
cv v112,v152,v153
cv v113,v154,v155
cv v114,v156,v157
cv v115,v158,v159
s_nop 1
mm v[128:131],v[72:75],v[112:115],0
mm v[120:123],v[64:67],v[112:115],0
mm v[124:127],v[68:71],v[112:115],0
v_add_f32 v140,s81,v140
v_rcp_f32 v140,v140
s_nop 0
pm v[132:133],v[132:133],v[140:141] op_sel_hi:[1,0]
pm v[134:135],v[134:135],v[140:141] op_sel_hi:[1,0]
pm v[136:137],v[136:137],v[140:141] op_sel_hi:[1,0]
pm v[138:139],v[138:139],v[140:141] op_sel_hi:[1,0]
cv v172,v132,v133
cv v173,v134,v135
cv v174,v136,v137
cv v175,v138,v139
s_xor_b32 s49,s48,409600
w4 v[172:175],v28,s[8:11],s49 offen offset:2048 sc1
ar v144,a232
ar v145,a233
ar v146,a234
ar v147,a235
ar v148,a236
ar v149,a237
ar v150,a238
ar v151,a239
pm v[152:153],v[144:145],s[80:81] op_sel_hi:[1,0]
pm v[154:155],v[146:147],s[80:81] op_sel_hi:[1,0]
pm v[156:157],v[148:149],s[80:81] op_sel_hi:[1,0]
pm v[158:159],v[150:151],s[80:81] op_sel_hi:[1,0]
v_exp_f32 v152,v152 clamp
v_max_f32 v144,0,v144
v_exp_f32 v153,v153 clamp
v_max_f32 v145,0,v145
v_exp_f32 v154,v154 clamp
v_max_f32 v146,0,v146
v_exp_f32 v155,v155 clamp
v_max_f32 v147,0,v147
v_exp_f32 v156,v156 clamp
v_max_f32 v148,0,v148
v_exp_f32 v157,v157 clamp
v_max_f32 v149,0,v149
v_exp_f32 v158,v158 clamp
v_max_f32 v150,0,v150
v_exp_f32 v159,v159 clamp
v_max_f32 v151,0,v151
pa v[152:153],v[152:153],v[144:145]
pa v[154:155],v[154:155],v[146:147]
pa v[156:157],v[156:157],v[148:149]
pa v[158:159],v[158:159],v[150:151]
pa v[152:153],v[152:153],s[80:81] op_sel:[0,1]
pa v[154:155],v[154:155],s[80:81] op_sel:[0,1]
pa v[156:157],v[156:157],s[80:81] op_sel:[0,1]
pa v[158:159],v[158:159],s[80:81] op_sel:[0,1]
cv v116,v152,v153
cv v117,v154,v155
cv v118,v156,v157
cv v119,v158,v159
s_nop 1
mm v[140:143],v[84:87],v[116:119],0
mm v[132:135],v[76:79],v[116:119],0
mm v[136:139],v[80:83],v[116:119],0
v_add_f32 v128,s81,v128
v_rcp_f32 v128,v128
s_nop 0
pm v[120:121],v[120:121],v[128:129] op_sel_hi:[1,0]
pm v[122:123],v[122:123],v[128:129] op_sel_hi:[1,0]
pm v[124:125],v[124:125],v[128:129] op_sel_hi:[1,0]
pm v[126:127],v[126:127],v[128:129] op_sel_hi:[1,0]
cv v168,v120,v121
cv v169,v122,v123
cv v170,v124,v125
cv v171,v126,v127
s_xor_b32 s49,s48,413696
w4 v[168:171],v28,s[8:11],s49 offen offset:256 sc1
ar v144,a240
ar v145,a241
ar v146,a242
ar v147,a243
ar v148,a244
ar v149,a245
ar v150,a246
ar v151,a247
pm v[152:153],v[144:145],s[80:81] op_sel_hi:[1,0]
pm v[154:155],v[146:147],s[80:81] op_sel_hi:[1,0]
pm v[156:157],v[148:149],s[80:81] op_sel_hi:[1,0]
pm v[158:159],v[150:151],s[80:81] op_sel_hi:[1,0]
v_exp_f32 v152,v152 clamp
v_max_f32 v144,0,v144
v_exp_f32 v153,v153 clamp
v_max_f32 v145,0,v145
v_exp_f32 v154,v154 clamp
v_max_f32 v146,0,v146
v_exp_f32 v155,v155 clamp
v_max_f32 v147,0,v147
v_exp_f32 v156,v156 clamp
v_max_f32 v148,0,v148
v_exp_f32 v157,v157 clamp
v_max_f32 v149,0,v149
v_exp_f32 v158,v158 clamp
v_max_f32 v150,0,v150
v_exp_f32 v159,v159 clamp
v_max_f32 v151,0,v151
pa v[152:153],v[152:153],v[144:145]
pa v[154:155],v[154:155],v[146:147]
pa v[156:157],v[156:157],v[148:149]
pa v[158:159],v[158:159],v[150:151]
pa v[152:153],v[152:153],s[80:81] op_sel:[0,1]
pa v[154:155],v[154:155],s[80:81] op_sel:[0,1]
pa v[156:157],v[156:157],s[80:81] op_sel:[0,1]
pa v[158:159],v[158:159],s[80:81] op_sel:[0,1]
cv v112,v152,v153
cv v113,v154,v155
cv v114,v156,v157
cv v115,v158,v159
s_nop 1
mm v[128:131],v[96:99],v[112:115],0
mm v[120:123],v[88:91],v[112:115],0
mm v[124:127],v[92:95],v[112:115],0
v_add_f32 v140,s81,v140
v_rcp_f32 v140,v140
s_nop 0
pm v[132:133],v[132:133],v[140:141] op_sel_hi:[1,0]
pm v[134:135],v[134:135],v[140:141] op_sel_hi:[1,0]
pm v[136:137],v[136:137],v[140:141] op_sel_hi:[1,0]
pm v[138:139],v[138:139],v[140:141] op_sel_hi:[1,0]
cv v172,v132,v133
cv v173,v134,v135
cv v174,v136,v137
cv v175,v138,v139
s_xor_b32 s49,s48,413696
w4 v[172:175],v28,s[8:11],s49 offen offset:2304 sc1
ar v144,a248
ar v145,a249
ar v146,a250
ar v147,a251
ar v148,a252
ar v149,a253
ar v150,a254
ar v151,a255
pm v[152:153],v[144:145],s[80:81] op_sel_hi:[1,0]
pm v[154:155],v[146:147],s[80:81] op_sel_hi:[1,0]
pm v[156:157],v[148:149],s[80:81] op_sel_hi:[1,0]
pm v[158:159],v[150:151],s[80:81] op_sel_hi:[1,0]
v_exp_f32 v152,v152 clamp
v_max_f32 v144,0,v144
v_exp_f32 v153,v153 clamp
v_max_f32 v145,0,v145
v_exp_f32 v154,v154 clamp
v_max_f32 v146,0,v146
v_exp_f32 v155,v155 clamp
v_max_f32 v147,0,v147
v_exp_f32 v156,v156 clamp
v_max_f32 v148,0,v148
v_exp_f32 v157,v157 clamp
v_max_f32 v149,0,v149
v_exp_f32 v158,v158 clamp
v_max_f32 v150,0,v150
v_exp_f32 v159,v159 clamp
v_max_f32 v151,0,v151
pa v[152:153],v[152:153],v[144:145]
pa v[154:155],v[154:155],v[146:147]
pa v[156:157],v[156:157],v[148:149]
pa v[158:159],v[158:159],v[150:151]
pa v[152:153],v[152:153],s[80:81] op_sel:[0,1]
pa v[154:155],v[154:155],s[80:81] op_sel:[0,1]
pa v[156:157],v[156:157],s[80:81] op_sel:[0,1]
pa v[158:159],v[158:159],s[80:81] op_sel:[0,1]
cv v116,v152,v153
cv v117,v154,v155
cv v118,v156,v157
cv v119,v158,v159
s_nop 1
mm v[140:143],v[108:111],v[116:119],0
mm v[132:135],v[100:103],v[116:119],0
mm v[136:139],v[104:107],v[116:119],0
v_add_f32 v128,s81,v128
v_rcp_f32 v128,v128
s_nop 0
pm v[120:121],v[120:121],v[128:129] op_sel_hi:[1,0]
pm v[122:123],v[122:123],v[128:129] op_sel_hi:[1,0]
pm v[124:125],v[124:125],v[128:129] op_sel_hi:[1,0]
pm v[126:127],v[126:127],v[128:129] op_sel_hi:[1,0]
cv v168,v120,v121
cv v169,v122,v123
cv v170,v124,v125
cv v171,v126,v127
s_xor_b32 s49,s48,409600
w4 v[168:171],v28,s[8:11],s49 offen offset:256 sc1
v_add_f32 v140,s81,v140
v_rcp_f32 v140,v140
s_nop 0
pm v[132:133],v[132:133],v[140:141] op_sel_hi:[1,0]
pm v[134:135],v[134:135],v[140:141] op_sel_hi:[1,0]
pm v[136:137],v[136:137],v[140:141] op_sel_hi:[1,0]
pm v[138:139],v[138:139],v[140:141] op_sel_hi:[1,0]
cv v172,v132,v133
cv v173,v134,v135
cv v174,v136,v137
cv v175,v138,v139
s_xor_b32 s49,s48,409600
w4 v[172:175],v28,s[8:11],s49 offen offset:2304 sc1
v_mov_b32 v44,0
wt vmcnt(0)
s_barrier
s_cmp_eq_u32 s14,0
s_cbranch_scc0 G_bq_s
v_mul_u32_u24 v30,0,v1
v_mov_b32 v31,1
s_mov_b64 exec,1
buffer_atomic_add v31,v30,s[8:11],s96 offen sc1
s_mov_b64 exec,-1
G_bq_s:
s_branch G_have
G_bkv:
s_lshl_b32 s48,s14,4
v_bfe_u32 v30,v1,5,1
v_add_u32 v30,s48,v30
v_mul_lo_u32 v30,v30,s47
v_bfe_u32 v31,v1,0,1
v_lshlrev_b32 v31,4,v31
v_add_u32 v30,v30,v31
v_bfe_u32 v31,v1,1,4
v_bfe_u32 v32,v1,5,1
v_xor_b32 v31,v31,v32
v_xor_b32 v32,0,v31
v_bfe_u32 v33,v32,1,1
v_lshlrev_b32 v33,11,v33
v_bfe_u32 v34,v32,2,2
v_lshl_add_u32 v33,v34,6,v33
v_bfe_u32 v34,v32,0,1
v_lshl_add_u32 v33,v34,5,v33
v_add_u32 v32,v33,v30
s_mul_i32 s48,s47,0
s_sub_u32 s48,s48,0
v_add_u32 v10,s48,v32
v_xor_b32 v32,2,v31
v_bfe_u32 v33,v32,1,1
v_lshlrev_b32 v33,11,v33
v_bfe_u32 v34,v32,2,2
v_lshl_add_u32 v33,v34,6,v33
v_bfe_u32 v34,v32,0,1
v_lshl_add_u32 v33,v34,5,v33
v_add_u32 v32,v33,v30
s_mul_i32 s48,s47,2
s_sub_u32 s48,s48,1024
v_add_u32 v11,s48,v32
v_xor_b32 v32,0,v31
v_bfe_u32 v33,v32,1,1
v_lshlrev_b32 v33,11,v33
v_bfe_u32 v34,v32,2,2
v_lshl_add_u32 v33,v34,6,v33
v_bfe_u32 v34,v32,0,1
v_lshl_add_u32 v33,v34,5,v33
v_add_u32 v32,v33,v30
s_mul_i32 s48,s47,4
s_sub_u32 s48,s48,2048
v_add_u32 v12,s48,v32
v_xor_b32 v32,2,v31
v_bfe_u32 v33,v32,1,1
v_lshlrev_b32 v33,11,v33
v_bfe_u32 v34,v32,2,2
v_lshl_add_u32 v33,v34,6,v33
v_bfe_u32 v34,v32,0,1
v_lshl_add_u32 v33,v34,5,v33
v_add_u32 v32,v33,v30
s_mul_i32 s48,s47,6
s_sub_u32 s48,s48,3072
v_add_u32 v13,s48,v32
v_xor_b32 v32,4,v31
v_bfe_u32 v33,v32,1,1
v_lshlrev_b32 v33,11,v33
v_bfe_u32 v34,v32,2,2
v_lshl_add_u32 v33,v34,6,v33
v_bfe_u32 v34,v32,0,1
v_lshl_add_u32 v33,v34,5,v33
v_add_u32 v32,v33,v30
s_mul_i32 s48,s47,8
s_sub_u32 s48,s48,0
v_add_u32 v14,s48,v32
v_xor_b32 v32,6,v31
v_bfe_u32 v33,v32,1,1
v_lshlrev_b32 v33,11,v33
v_bfe_u32 v34,v32,2,2
v_lshl_add_u32 v33,v34,6,v33
v_bfe_u32 v34,v32,0,1
v_lshl_add_u32 v33,v34,5,v33
v_add_u32 v32,v33,v30
s_mul_i32 s48,s47,10
s_sub_u32 s48,s48,1024
v_add_u32 v15,s48,v32
v_xor_b32 v32,4,v31
v_bfe_u32 v33,v32,1,1
v_lshlrev_b32 v33,11,v33
v_bfe_u32 v34,v32,2,2
v_lshl_add_u32 v33,v34,6,v33
v_bfe_u32 v34,v32,0,1
v_lshl_add_u32 v33,v34,5,v33
v_add_u32 v32,v33,v30
s_mul_i32 s48,s47,12
s_sub_u32 s48,s48,2048
v_add_u32 v16,s48,v32
v_xor_b32 v32,6,v31
v_bfe_u32 v33,v32,1,1
v_lshlrev_b32 v33,11,v33
v_bfe_u32 v34,v32,2,2
v_lshl_add_u32 v33,v34,6,v33
v_bfe_u32 v34,v32,0,1
v_lshl_add_u32 v33,v34,5,v33
v_add_u32 v32,v33,v30
s_mul_i32 s48,s47,14
s_sub_u32 s48,s48,3072
v_add_u32 v17,s48,v32
s_lshl_b32 s46,s47,6
s_mul_i32 s44,s14,8192
s_add_u32 s44,s44,65536
v_bfe_u32 v30,v1,4,2
v_lshlrev_b32 v30,12,v30
v_bfe_u32 v32,v1,2,2
v_lshl_add_u32 v30,v32,9,v30
v_bfe_u32 v32,v1,0,2
v_lshl_add_u32 v30,v32,3,v30
v_add_u32 v30,65536,v30
v_bfe_u32 v31,v1,2,2
v_bfe_u32 v32,v1,4,1
v_lshl_add_u32 v31,v32,2,v31
s_mul_i32 s48,s77,8
v_xor_b32 v31,s48,v31
v_xor_b32 v32,0,v31
v_lshl_add_u32 v20,v32,5,v30
v_xor_b32 v32,1,v31
v_lshl_add_u32 v21,v32,5,v30
v_xor_b32 v32,2,v31
v_lshl_add_u32 v22,v32,5,v30
v_xor_b32 v32,3,v31
v_lshl_add_u32 v23,v32,5,v30
v_xor_b32 v32,4,v31
v_lshl_add_u32 v24,v32,5,v30
v_xor_b32 v32,5,v31
v_lshl_add_u32 v25,v32,5,v30
v_xor_b32 v32,6,v31
v_lshl_add_u32 v26,v32,5,v30
v_xor_b32 v32,7,v31
v_lshl_add_u32 v27,v32,5,v30
s_mul_i32 s43,s14,8192
s_mul_i32 s48,s14,131072
v_bfe_u32 v30,v1,3,3
v_lshlrev_b32 v30,11,v30
v_add_u32 v30,s48,v30
v_bfe_u32 v31,v1,0,3
v_bfe_u32 v32,v1,4,2
v_xor_b32 v31,v31,v32
v_xor_b32 v32,0,v31
v_lshl_add_u32 v32,v32,4,v30
v_add_u32 v2,0,v32
v_xor_b32 v32,4,v31
v_lshl_add_u32 v32,v32,4,v30
v_add_u32 v3,15360,v32
v_xor_b32 v32,0,v31
v_lshl_add_u32 v32,v32,4,v30
v_add_u32 v4,30720,v32
v_xor_b32 v32,4,v31
v_lshl_add_u32 v32,v32,4,v30
v_add_u32 v5,46080,v32
v_xor_b32 v32,0,v31
v_lshl_add_u32 v32,v32,4,v30
v_add_u32 v6,65536,v32
v_xor_b32 v32,4,v31
v_lshl_add_u32 v32,v32,4,v30
v_add_u32 v7,80896,v32
v_xor_b32 v32,0,v31
v_lshl_add_u32 v32,v32,4,v30
v_add_u32 v8,96256,v32
v_xor_b32 v32,4,v31
v_lshl_add_u32 v32,v32,4,v30
v_add_u32 v9,111616,v32
s_mul_i32 s48,s76,16384
v_bfe_u32 v30,v1,0,4
v_lshlrev_b32 v30,7,v30
v_add_u32 v30,s48,v30
v_bfe_u32 v31,v1,1,3
v_bfe_u32 v32,v1,4,2
v_xor_b32 v31,v31,v32
v_xor_b32 v32,0,v31
v_lshl_add_u32 v18,v32,4,v30
v_xor_b32 v32,4,v31
v_lshl_add_u32 v19,v32,4,v30
s_barrier
s_add_u32 m0,s43,0
s_nop 0
l4 v2,s[28:31],s40 offen lds
l4 v3,s[28:31],s40 offen offset:1024 lds
l4 v4,s[28:31],s40 offen offset:2048 lds
l4 v5,s[28:31],s40 offen offset:3072 lds
s_add_u32 m0,s43,4096
s_nop 0
l4 v6,s[28:31],s40 offen lds
l4 v7,s[28:31],s40 offen offset:1024 lds
l4 v8,s[28:31],s40 offen offset:2048 lds
l4 v9,s[28:31],s40 offen offset:3072 lds
s_add_u32 s40,s40,128
s_add_u32 m0,s44,0
s_nop 0
l4 v10,s[32:35],s41 offen lds
l4 v11,s[32:35],s41 offen offset:1024 lds
l4 v12,s[32:35],s41 offen offset:2048 lds
l4 v13,s[32:35],s41 offen offset:3072 lds
s_add_u32 m0,s44,4096
s_nop 0
l4 v14,s[32:35],s41 offen lds
l4 v15,s[32:35],s41 offen offset:1024 lds
l4 v16,s[32:35],s41 offen offset:2048 lds
l4 v17,s[32:35],s41 offen offset:3072 lds
s_add_u32 s41,s41,s46
s_add_u32 m0,s43,32768
s_nop 0
l4 v2,s[28:31],s40 offen lds
l4 v3,s[28:31],s40 offen offset:1024 lds
l4 v4,s[28:31],s40 offen offset:2048 lds
l4 v5,s[28:31],s40 offen offset:3072 lds
s_add_u32 m0,s43,36864
s_nop 0
l4 v6,s[28:31],s40 offen lds
l4 v7,s[28:31],s40 offen offset:1024 lds
l4 v8,s[28:31],s40 offen offset:2048 lds
l4 v9,s[28:31],s40 offen offset:3072 lds
s_add_u32 s40,s40,128
s_add_u32 m0,s44,32768
s_nop 0
l4 v10,s[32:35],s41 offen lds
l4 v11,s[32:35],s41 offen offset:1024 lds
l4 v12,s[32:35],s41 offen offset:2048 lds
l4 v13,s[32:35],s41 offen offset:3072 lds
s_add_u32 m0,s44,36864
s_nop 0
l4 v14,s[32:35],s41 offen lds
l4 v15,s[32:35],s41 offen offset:1024 lds
l4 v16,s[32:35],s41 offen offset:2048 lds
l4 v17,s[32:35],s41 offen offset:3072 lds
s_add_u32 s41,s41,s46
s_mov_b64 s[90:91],s[20:21]
s_mov_b64 s[92:93],s[22:23]
s_mov_b64 s[94:95],s[24:25]
s_mov_b64 s[96:97],s[26:27]
s_load_dwordx8 s[20:27],s[18:19],0
s_add_u32 s18,s18,32
s_addc_u32 s19,s19,0
wt vmcnt(16)
s_barrier
dt v[96:97],v20 offset:0
dt v[98:99],v20 offset:2048
dr v[64:67],v18 offset:0
dt v[100:101],v21 offset:0
dt v[102:103],v21 offset:2048
dr v[68:71],v18 offset:2048
dt v[104:105],v22 offset:0
dt v[106:107],v22 offset:2048
dr v[72:75],v18 offset:4096
dt v[108:109],v23 offset:0
dt v[110:111],v23 offset:2048
dr v[76:79],v18 offset:6144
dt v[112:113],v24 offset:0
dt v[114:115],v24 offset:2048
dr v[80:83],v18 offset:8192
dt v[116:117],v25 offset:0
dt v[118:119],v25 offset:2048
dr v[84:87],v18 offset:10240
dt v[120:121],v26 offset:0
dt v[122:123],v26 offset:2048
dr v[88:91],v18 offset:12288
dt v[124:125],v27 offset:0
dt v[126:127],v27 offset:2048
dr v[92:95],v18 offset:14336
wt lgkmcnt(0)
mm a[0:3],v[64:67],v[96:99],0
dt v[160:161],v20 offset:16384
mm a[4:7],v[64:67],v[100:103],0
mm a[8:11],v[64:67],v[104:107],0
dt v[162:163],v20 offset:18432
mm a[12:15],v[64:67],v[108:111],0
mm a[16:19],v[64:67],v[112:115],0
dr v[128:131],v19 offset:0
mm a[20:23],v[64:67],v[116:119],0
mm a[24:27],v[64:67],v[120:123],0
dt v[164:165],v21 offset:16384
mm a[28:31],v[64:67],v[124:127],0
mm a[60:63],v[68:71],v[124:127],0
dt v[166:167],v21 offset:18432
mm a[56:59],v[68:71],v[120:123],0
mm a[52:55],v[68:71],v[116:119],0
dr v[132:135],v19 offset:2048
mm a[48:51],v[68:71],v[112:115],0
mm a[44:47],v[68:71],v[108:111],0
dt v[168:169],v22 offset:16384
mm a[40:43],v[68:71],v[104:107],0
mm a[36:39],v[68:71],v[100:103],0
dt v[170:171],v22 offset:18432
mm a[32:35],v[68:71],v[96:99],0
mm a[64:67],v[72:75],v[96:99],0
dr v[136:139],v19 offset:4096
mm a[68:71],v[72:75],v[100:103],0
mm a[72:75],v[72:75],v[104:107],0
dt v[172:173],v23 offset:16384
mm a[76:79],v[72:75],v[108:111],0
mm a[80:83],v[72:75],v[112:115],0
dt v[174:175],v23 offset:18432
mm a[84:87],v[72:75],v[116:119],0
mm a[88:91],v[72:75],v[120:123],0
dr v[140:143],v19 offset:6144
mm a[92:95],v[72:75],v[124:127],0
mm a[124:127],v[76:79],v[124:127],0
dt v[176:177],v24 offset:16384
mm a[120:123],v[76:79],v[120:123],0
mm a[116:119],v[76:79],v[116:119],0
dt v[178:179],v24 offset:18432
mm a[112:115],v[76:79],v[112:115],0
mm a[108:111],v[76:79],v[108:111],0
dr v[144:147],v19 offset:8192
mm a[104:107],v[76:79],v[104:107],0
mm a[100:103],v[76:79],v[100:103],0
dt v[180:181],v25 offset:16384
mm a[96:99],v[76:79],v[96:99],0
mm a[128:131],v[80:83],v[96:99],0
dt v[182:183],v25 offset:18432
mm a[132:135],v[80:83],v[100:103],0
mm a[136:139],v[80:83],v[104:107],0
dr v[148:151],v19 offset:10240
mm a[140:143],v[80:83],v[108:111],0
mm a[144:147],v[80:83],v[112:115],0
dt v[184:185],v26 offset:16384
mm a[148:151],v[80:83],v[116:119],0
mm a[152:155],v[80:83],v[120:123],0
dt v[186:187],v26 offset:18432
mm a[156:159],v[80:83],v[124:127],0
mm a[188:191],v[84:87],v[124:127],0
dr v[152:155],v19 offset:12288
mm a[184:187],v[84:87],v[120:123],0
mm a[180:183],v[84:87],v[116:119],0
dt v[188:189],v27 offset:16384
mm a[176:179],v[84:87],v[112:115],0
mm a[172:175],v[84:87],v[108:111],0
dt v[190:191],v27 offset:18432
mm a[168:171],v[84:87],v[104:107],0
mm a[164:167],v[84:87],v[100:103],0
dr v[156:159],v19 offset:14336
mm a[160:163],v[84:87],v[96:99],0
mm a[192:195],v[88:91],v[96:99],0
mm a[196:199],v[88:91],v[100:103],0
mm a[200:203],v[88:91],v[104:107],0
mm a[204:207],v[88:91],v[108:111],0
mm a[208:211],v[88:91],v[112:115],0
mm a[212:215],v[88:91],v[116:119],0
mm a[216:219],v[88:91],v[120:123],0
mm a[220:223],v[88:91],v[124:127],0
mm a[252:255],v[92:95],v[124:127],0
mm a[248:251],v[92:95],v[120:123],0
mm a[244:247],v[92:95],v[116:119],0
mm a[240:243],v[92:95],v[112:115],0
mm a[236:239],v[92:95],v[108:111],0
mm a[232:235],v[92:95],v[104:107],0
mm a[228:231],v[92:95],v[100:103],0
mm a[224:227],v[92:95],v[96:99],0
wt vmcnt(0) lgkmcnt(0)
s_barrier
mm a[0:3],v[128:131],v[160:163],a[0:3]
dt v[96:97],v20 offset:32768
s_add_u32 m0,s43,0
mm a[4:7],v[128:131],v[164:167],a[4:7]
l4 v2,s[28:31],s40 offen lds
mm a[8:11],v[128:131],v[168:171],a[8:11]
dt v[98:99],v20 offset:34816
mm a[12:15],v[128:131],v[172:175],a[12:15]
mm a[16:19],v[128:131],v[176:179],a[16:19]
dr v[64:67],v18 offset:32768
mm a[20:23],v[128:131],v[180:183],a[20:23]
l4 v3,s[28:31],s40 offen offset:1024 lds
mm a[24:27],v[128:131],v[184:187],a[24:27]
dt v[100:101],v21 offset:32768
mm a[28:31],v[128:131],v[188:191],a[28:31]
mm a[60:63],v[132:135],v[188:191],a[60:63]
dt v[102:103],v21 offset:34816
mm a[56:59],v[132:135],v[184:187],a[56:59]
l4 v4,s[28:31],s40 offen offset:2048 lds
mm a[52:55],v[132:135],v[180:183],a[52:55]
dr v[68:71],v18 offset:34816
mm a[48:51],v[132:135],v[176:179],a[48:51]
mm a[44:47],v[132:135],v[172:175],a[44:47]
dt v[104:105],v22 offset:32768
mm a[40:43],v[132:135],v[168:171],a[40:43]
l4 v5,s[28:31],s40 offen offset:3072 lds
mm a[36:39],v[132:135],v[164:167],a[36:39]
dt v[106:107],v22 offset:34816
mm a[32:35],v[132:135],v[160:163],a[32:35]
s_add_u32 m0,s43,4096
mm a[64:67],v[136:139],v[160:163],a[64:67]
dr v[72:75],v18 offset:36864
mm a[68:71],v[136:139],v[164:167],a[68:71]
l4 v6,s[28:31],s40 offen lds
mm a[72:75],v[136:139],v[168:171],a[72:75]
dt v[108:109],v23 offset:32768
mm a[76:79],v[136:139],v[172:175],a[76:79]
mm a[80:83],v[136:139],v[176:179],a[80:83]
dt v[110:111],v23 offset:34816
mm a[84:87],v[136:139],v[180:183],a[84:87]
l4 v7,s[28:31],s40 offen offset:1024 lds
mm a[88:91],v[136:139],v[184:187],a[88:91]
dr v[76:79],v18 offset:38912
mm a[92:95],v[136:139],v[188:191],a[92:95]
mm a[124:127],v[140:143],v[188:191],a[124:127]
dt v[112:113],v24 offset:32768
mm a[120:123],v[140:143],v[184:187],a[120:123]
l4 v8,s[28:31],s40 offen offset:2048 lds
mm a[116:119],v[140:143],v[180:183],a[116:119]
dt v[114:115],v24 offset:34816
mm a[112:115],v[140:143],v[176:179],a[112:115]
mm a[108:111],v[140:143],v[172:175],a[108:111]
dr v[80:83],v18 offset:40960
mm a[104:107],v[140:143],v[168:171],a[104:107]
l4 v9,s[28:31],s40 offen offset:3072 lds
mm a[100:103],v[140:143],v[164:167],a[100:103]
dt v[116:117],v25 offset:32768
mm a[96:99],v[140:143],v[160:163],a[96:99]
s_add_u32 s40,s40,128
s_add_u32 m0,s44,0
mm a[128:131],v[144:147],v[160:163],a[128:131]
dt v[118:119],v25 offset:34816
mm a[132:135],v[144:147],v[164:167],a[132:135]
l4 v10,s[32:35],s41 offen lds
mm a[136:139],v[144:147],v[168:171],a[136:139]
dr v[84:87],v18 offset:43008
mm a[140:143],v[144:147],v[172:175],a[140:143]
mm a[144:147],v[144:147],v[176:179],a[144:147]
dt v[120:121],v26 offset:32768
mm a[148:151],v[144:147],v[180:183],a[148:151]
l4 v11,s[32:35],s41 offen offset:1024 lds
mm a[152:155],v[144:147],v[184:187],a[152:155]
dt v[122:123],v26 offset:34816
mm a[156:159],v[144:147],v[188:191],a[156:159]
mm a[188:191],v[148:151],v[188:191],a[188:191]
dr v[88:91],v18 offset:45056
mm a[184:187],v[148:151],v[184:187],a[184:187]
l4 v12,s[32:35],s41 offen offset:2048 lds
mm a[180:183],v[148:151],v[180:183],a[180:183]
dt v[124:125],v27 offset:32768
mm a[176:179],v[148:151],v[176:179],a[176:179]
mm a[172:175],v[148:151],v[172:175],a[172:175]
dt v[126:127],v27 offset:34816
mm a[168:171],v[148:151],v[168:171],a[168:171]
l4 v13,s[32:35],s41 offen offset:3072 lds
mm a[164:167],v[148:151],v[164:167],a[164:167]
dr v[92:95],v18 offset:47104
mm a[160:163],v[148:151],v[160:163],a[160:163]
s_add_u32 m0,s44,4096
mm a[192:195],v[152:155],v[160:163],a[192:195]
l4 v14,s[32:35],s41 offen lds
mm a[196:199],v[152:155],v[164:167],a[196:199]
mm a[200:203],v[152:155],v[168:171],a[200:203]
mm a[204:207],v[152:155],v[172:175],a[204:207]
l4 v15,s[32:35],s41 offen offset:1024 lds
mm a[208:211],v[152:155],v[176:179],a[208:211]
mm a[212:215],v[152:155],v[180:183],a[212:215]
mm a[216:219],v[152:155],v[184:187],a[216:219]
l4 v16,s[32:35],s41 offen offset:2048 lds
mm a[220:223],v[152:155],v[188:191],a[220:223]
mm a[252:255],v[156:159],v[188:191],a[252:255]
mm a[248:251],v[156:159],v[184:187],a[248:251]
l4 v17,s[32:35],s41 offen offset:3072 lds
mm a[244:247],v[156:159],v[180:183],a[244:247]
s_add_u32 s41,s41,s46
mm a[240:243],v[156:159],v[176:179],a[240:243]
mm a[236:239],v[156:159],v[172:175],a[236:239]
wt lgkmcnt(0)
mm a[232:235],v[156:159],v[168:171],a[232:235]
mm a[228:231],v[156:159],v[164:167],a[228:231]
mm a[224:227],v[156:159],v[160:163],a[224:227]
mm a[0:3],v[64:67],v[96:99],a[0:3]
dt v[160:161],v20 offset:49152
mm a[4:7],v[64:67],v[100:103],a[4:7]
mm a[8:11],v[64:67],v[104:107],a[8:11]
dt v[162:163],v20 offset:51200
mm a[12:15],v[64:67],v[108:111],a[12:15]
mm a[16:19],v[64:67],v[112:115],a[16:19]
dr v[128:131],v19 offset:32768
mm a[20:23],v[64:67],v[116:119],a[20:23]
mm a[24:27],v[64:67],v[120:123],a[24:27]
dt v[164:165],v21 offset:49152
mm a[28:31],v[64:67],v[124:127],a[28:31]
mm a[60:63],v[68:71],v[124:127],a[60:63]
dt v[166:167],v21 offset:51200
mm a[56:59],v[68:71],v[120:123],a[56:59]
mm a[52:55],v[68:71],v[116:119],a[52:55]
dr v[132:135],v19 offset:34816
mm a[48:51],v[68:71],v[112:115],a[48:51]
mm a[44:47],v[68:71],v[108:111],a[44:47]
dt v[168:169],v22 offset:49152
mm a[40:43],v[68:71],v[104:107],a[40:43]
mm a[36:39],v[68:71],v[100:103],a[36:39]
dt v[170:171],v22 offset:51200
mm a[32:35],v[68:71],v[96:99],a[32:35]
mm a[64:67],v[72:75],v[96:99],a[64:67]
dr v[136:139],v19 offset:36864
mm a[68:71],v[72:75],v[100:103],a[68:71]
mm a[72:75],v[72:75],v[104:107],a[72:75]
dt v[172:173],v23 offset:49152
mm a[76:79],v[72:75],v[108:111],a[76:79]
mm a[80:83],v[72:75],v[112:115],a[80:83]
dt v[174:175],v23 offset:51200
mm a[84:87],v[72:75],v[116:119],a[84:87]
mm a[88:91],v[72:75],v[120:123],a[88:91]
dr v[140:143],v19 offset:38912
mm a[92:95],v[72:75],v[124:127],a[92:95]
mm a[124:127],v[76:79],v[124:127],a[124:127]
dt v[176:177],v24 offset:49152
mm a[120:123],v[76:79],v[120:123],a[120:123]
mm a[116:119],v[76:79],v[116:119],a[116:119]
dt v[178:179],v24 offset:51200
mm a[112:115],v[76:79],v[112:115],a[112:115]
mm a[108:111],v[76:79],v[108:111],a[108:111]
dr v[144:147],v19 offset:40960
mm a[104:107],v[76:79],v[104:107],a[104:107]
mm a[100:103],v[76:79],v[100:103],a[100:103]
dt v[180:181],v25 offset:49152
mm a[96:99],v[76:79],v[96:99],a[96:99]
mm a[128:131],v[80:83],v[96:99],a[128:131]
dt v[182:183],v25 offset:51200
mm a[132:135],v[80:83],v[100:103],a[132:135]
mm a[136:139],v[80:83],v[104:107],a[136:139]
dr v[148:151],v19 offset:43008
mm a[140:143],v[80:83],v[108:111],a[140:143]
mm a[144:147],v[80:83],v[112:115],a[144:147]
dt v[184:185],v26 offset:49152
mm a[148:151],v[80:83],v[116:119],a[148:151]
mm a[152:155],v[80:83],v[120:123],a[152:155]
dt v[186:187],v26 offset:51200
mm a[156:159],v[80:83],v[124:127],a[156:159]
mm a[188:191],v[84:87],v[124:127],a[188:191]
dr v[152:155],v19 offset:45056
mm a[184:187],v[84:87],v[120:123],a[184:187]
mm a[180:183],v[84:87],v[116:119],a[180:183]
dt v[188:189],v27 offset:49152
mm a[176:179],v[84:87],v[112:115],a[176:179]
mm a[172:175],v[84:87],v[108:111],a[172:175]
dt v[190:191],v27 offset:51200
mm a[168:171],v[84:87],v[104:107],a[168:171]
mm a[164:167],v[84:87],v[100:103],a[164:167]
dr v[156:159],v19 offset:47104
mm a[160:163],v[84:87],v[96:99],a[160:163]
mm a[192:195],v[88:91],v[96:99],a[192:195]
mm a[196:199],v[88:91],v[100:103],a[196:199]
mm a[200:203],v[88:91],v[104:107],a[200:203]
mm a[204:207],v[88:91],v[108:111],a[204:207]
mm a[208:211],v[88:91],v[112:115],a[208:211]
mm a[212:215],v[88:91],v[116:119],a[212:215]
mm a[216:219],v[88:91],v[120:123],a[216:219]
mm a[220:223],v[88:91],v[124:127],a[220:223]
mm a[252:255],v[92:95],v[124:127],a[252:255]
mm a[248:251],v[92:95],v[120:123],a[248:251]
mm a[244:247],v[92:95],v[116:119],a[244:247]
mm a[240:243],v[92:95],v[112:115],a[240:243]
mm a[236:239],v[92:95],v[108:111],a[236:239]
mm a[232:235],v[92:95],v[104:107],a[232:235]
mm a[228:231],v[92:95],v[100:103],a[228:231]
mm a[224:227],v[92:95],v[96:99],a[224:227]
wt vmcnt(0) lgkmcnt(0)
s_barrier
mm a[0:3],v[128:131],v[160:163],a[0:3]
dt v[96:97],v20 offset:0
s_add_u32 m0,s43,32768
mm a[4:7],v[128:131],v[164:167],a[4:7]
l4 v2,s[28:31],s40 offen lds
mm a[8:11],v[128:131],v[168:171],a[8:11]
dt v[98:99],v20 offset:2048
mm a[12:15],v[128:131],v[172:175],a[12:15]
mm a[16:19],v[128:131],v[176:179],a[16:19]
dr v[64:67],v18 offset:0
mm a[20:23],v[128:131],v[180:183],a[20:23]
l4 v3,s[28:31],s40 offen offset:1024 lds
mm a[24:27],v[128:131],v[184:187],a[24:27]
dt v[100:101],v21 offset:0
mm a[28:31],v[128:131],v[188:191],a[28:31]
mm a[60:63],v[132:135],v[188:191],a[60:63]
dt v[102:103],v21 offset:2048
mm a[56:59],v[132:135],v[184:187],a[56:59]
l4 v4,s[28:31],s40 offen offset:2048 lds
mm a[52:55],v[132:135],v[180:183],a[52:55]
dr v[68:71],v18 offset:2048
mm a[48:51],v[132:135],v[176:179],a[48:51]
mm a[44:47],v[132:135],v[172:175],a[44:47]
dt v[104:105],v22 offset:0
mm a[40:43],v[132:135],v[168:171],a[40:43]
l4 v5,s[28:31],s40 offen offset:3072 lds
mm a[36:39],v[132:135],v[164:167],a[36:39]
dt v[106:107],v22 offset:2048
mm a[32:35],v[132:135],v[160:163],a[32:35]
s_add_u32 m0,s43,36864
mm a[64:67],v[136:139],v[160:163],a[64:67]
dr v[72:75],v18 offset:4096
mm a[68:71],v[136:139],v[164:167],a[68:71]
l4 v6,s[28:31],s40 offen lds
mm a[72:75],v[136:139],v[168:171],a[72:75]
dt v[108:109],v23 offset:0
mm a[76:79],v[136:139],v[172:175],a[76:79]
mm a[80:83],v[136:139],v[176:179],a[80:83]
dt v[110:111],v23 offset:2048
mm a[84:87],v[136:139],v[180:183],a[84:87]
l4 v7,s[28:31],s40 offen offset:1024 lds
mm a[88:91],v[136:139],v[184:187],a[88:91]
dr v[76:79],v18 offset:6144
mm a[92:95],v[136:139],v[188:191],a[92:95]
mm a[124:127],v[140:143],v[188:191],a[124:127]
dt v[112:113],v24 offset:0
mm a[120:123],v[140:143],v[184:187],a[120:123]
l4 v8,s[28:31],s40 offen offset:2048 lds
mm a[116:119],v[140:143],v[180:183],a[116:119]
dt v[114:115],v24 offset:2048
mm a[112:115],v[140:143],v[176:179],a[112:115]
mm a[108:111],v[140:143],v[172:175],a[108:111]
dr v[80:83],v18 offset:8192
mm a[104:107],v[140:143],v[168:171],a[104:107]
l4 v9,s[28:31],s40 offen offset:3072 lds
mm a[100:103],v[140:143],v[164:167],a[100:103]
dt v[116:117],v25 offset:0
mm a[96:99],v[140:143],v[160:163],a[96:99]
s_add_u32 s40,s40,128
s_add_u32 m0,s44,32768
mm a[128:131],v[144:147],v[160:163],a[128:131]
dt v[118:119],v25 offset:2048
mm a[132:135],v[144:147],v[164:167],a[132:135]
l4 v10,s[32:35],s41 offen lds
mm a[136:139],v[144:147],v[168:171],a[136:139]
dr v[84:87],v18 offset:10240
mm a[140:143],v[144:147],v[172:175],a[140:143]
mm a[144:147],v[144:147],v[176:179],a[144:147]
dt v[120:121],v26 offset:0
mm a[148:151],v[144:147],v[180:183],a[148:151]
l4 v11,s[32:35],s41 offen offset:1024 lds
mm a[152:155],v[144:147],v[184:187],a[152:155]
dt v[122:123],v26 offset:2048
mm a[156:159],v[144:147],v[188:191],a[156:159]
mm a[188:191],v[148:151],v[188:191],a[188:191]
dr v[88:91],v18 offset:12288
mm a[184:187],v[148:151],v[184:187],a[184:187]
l4 v12,s[32:35],s41 offen offset:2048 lds
mm a[180:183],v[148:151],v[180:183],a[180:183]
dt v[124:125],v27 offset:0
mm a[176:179],v[148:151],v[176:179],a[176:179]
mm a[172:175],v[148:151],v[172:175],a[172:175]
dt v[126:127],v27 offset:2048
mm a[168:171],v[148:151],v[168:171],a[168:171]
l4 v13,s[32:35],s41 offen offset:3072 lds
mm a[164:167],v[148:151],v[164:167],a[164:167]
dr v[92:95],v18 offset:14336
mm a[160:163],v[148:151],v[160:163],a[160:163]
s_add_u32 m0,s44,36864
mm a[192:195],v[152:155],v[160:163],a[192:195]
l4 v14,s[32:35],s41 offen lds
mm a[196:199],v[152:155],v[164:167],a[196:199]
mm a[200:203],v[152:155],v[168:171],a[200:203]
mm a[204:207],v[152:155],v[172:175],a[204:207]
l4 v15,s[32:35],s41 offen offset:1024 lds
mm a[208:211],v[152:155],v[176:179],a[208:211]
mm a[212:215],v[152:155],v[180:183],a[212:215]
mm a[216:219],v[152:155],v[184:187],a[216:219]
l4 v16,s[32:35],s41 offen offset:2048 lds
mm a[220:223],v[152:155],v[188:191],a[220:223]
mm a[252:255],v[156:159],v[188:191],a[252:255]
mm a[248:251],v[156:159],v[184:187],a[248:251]
l4 v17,s[32:35],s41 offen offset:3072 lds
mm a[244:247],v[156:159],v[180:183],a[244:247]
s_add_u32 s41,s41,s46
mm a[240:243],v[156:159],v[176:179],a[240:243]
mm a[236:239],v[156:159],v[172:175],a[236:239]
wt lgkmcnt(0)
mm a[232:235],v[156:159],v[168:171],a[232:235]
mm a[228:231],v[156:159],v[164:167],a[228:231]
mm a[224:227],v[156:159],v[160:163],a[224:227]
s_sub_u32 s42,s42,2
GKV_k:
mm a[0:3],v[64:67],v[96:99],a[0:3]
dt v[160:161],v20 offset:16384
mm a[4:7],v[64:67],v[100:103],a[4:7]
mm a[8:11],v[64:67],v[104:107],a[8:11]
dt v[162:163],v20 offset:18432
mm a[12:15],v[64:67],v[108:111],a[12:15]
mm a[16:19],v[64:67],v[112:115],a[16:19]
dr v[128:131],v19 offset:0
mm a[20:23],v[64:67],v[116:119],a[20:23]
mm a[24:27],v[64:67],v[120:123],a[24:27]
dt v[164:165],v21 offset:16384
mm a[28:31],v[64:67],v[124:127],a[28:31]
mm a[60:63],v[68:71],v[124:127],a[60:63]
dt v[166:167],v21 offset:18432
mm a[56:59],v[68:71],v[120:123],a[56:59]
mm a[52:55],v[68:71],v[116:119],a[52:55]
dr v[132:135],v19 offset:2048
mm a[48:51],v[68:71],v[112:115],a[48:51]
mm a[44:47],v[68:71],v[108:111],a[44:47]
dt v[168:169],v22 offset:16384
mm a[40:43],v[68:71],v[104:107],a[40:43]
mm a[36:39],v[68:71],v[100:103],a[36:39]
dt v[170:171],v22 offset:18432
mm a[32:35],v[68:71],v[96:99],a[32:35]
mm a[64:67],v[72:75],v[96:99],a[64:67]
dr v[136:139],v19 offset:4096
mm a[68:71],v[72:75],v[100:103],a[68:71]
mm a[72:75],v[72:75],v[104:107],a[72:75]
dt v[172:173],v23 offset:16384
mm a[76:79],v[72:75],v[108:111],a[76:79]
mm a[80:83],v[72:75],v[112:115],a[80:83]
dt v[174:175],v23 offset:18432
mm a[84:87],v[72:75],v[116:119],a[84:87]
mm a[88:91],v[72:75],v[120:123],a[88:91]
dr v[140:143],v19 offset:6144
mm a[92:95],v[72:75],v[124:127],a[92:95]
mm a[124:127],v[76:79],v[124:127],a[124:127]
dt v[176:177],v24 offset:16384
mm a[120:123],v[76:79],v[120:123],a[120:123]
mm a[116:119],v[76:79],v[116:119],a[116:119]
dt v[178:179],v24 offset:18432
mm a[112:115],v[76:79],v[112:115],a[112:115]
mm a[108:111],v[76:79],v[108:111],a[108:111]
dr v[144:147],v19 offset:8192
mm a[104:107],v[76:79],v[104:107],a[104:107]
mm a[100:103],v[76:79],v[100:103],a[100:103]
dt v[180:181],v25 offset:16384
mm a[96:99],v[76:79],v[96:99],a[96:99]
mm a[128:131],v[80:83],v[96:99],a[128:131]
dt v[182:183],v25 offset:18432
mm a[132:135],v[80:83],v[100:103],a[132:135]
mm a[136:139],v[80:83],v[104:107],a[136:139]
dr v[148:151],v19 offset:10240
mm a[140:143],v[80:83],v[108:111],a[140:143]
mm a[144:147],v[80:83],v[112:115],a[144:147]
dt v[184:185],v26 offset:16384
mm a[148:151],v[80:83],v[116:119],a[148:151]
mm a[152:155],v[80:83],v[120:123],a[152:155]
dt v[186:187],v26 offset:18432
mm a[156:159],v[80:83],v[124:127],a[156:159]
mm a[188:191],v[84:87],v[124:127],a[188:191]
dr v[152:155],v19 offset:12288
mm a[184:187],v[84:87],v[120:123],a[184:187]
mm a[180:183],v[84:87],v[116:119],a[180:183]
dt v[188:189],v27 offset:16384
mm a[176:179],v[84:87],v[112:115],a[176:179]
mm a[172:175],v[84:87],v[108:111],a[172:175]
dt v[190:191],v27 offset:18432
mm a[168:171],v[84:87],v[104:107],a[168:171]
mm a[164:167],v[84:87],v[100:103],a[164:167]
dr v[156:159],v19 offset:14336
mm a[160:163],v[84:87],v[96:99],a[160:163]
mm a[192:195],v[88:91],v[96:99],a[192:195]
mm a[196:199],v[88:91],v[100:103],a[196:199]
mm a[200:203],v[88:91],v[104:107],a[200:203]
mm a[204:207],v[88:91],v[108:111],a[204:207]
mm a[208:211],v[88:91],v[112:115],a[208:211]
mm a[212:215],v[88:91],v[116:119],a[212:215]
mm a[216:219],v[88:91],v[120:123],a[216:219]
mm a[220:223],v[88:91],v[124:127],a[220:223]
mm a[252:255],v[92:95],v[124:127],a[252:255]
mm a[248:251],v[92:95],v[120:123],a[248:251]
mm a[244:247],v[92:95],v[116:119],a[244:247]
mm a[240:243],v[92:95],v[112:115],a[240:243]
mm a[236:239],v[92:95],v[108:111],a[236:239]
mm a[232:235],v[92:95],v[104:107],a[232:235]
mm a[228:231],v[92:95],v[100:103],a[228:231]
mm a[224:227],v[92:95],v[96:99],a[224:227]
wt vmcnt(0) lgkmcnt(0)
s_barrier
mm a[0:3],v[128:131],v[160:163],a[0:3]
dt v[96:97],v20 offset:32768
s_add_u32 m0,s43,0
mm a[4:7],v[128:131],v[164:167],a[4:7]
l4 v2,s[28:31],s40 offen lds
mm a[8:11],v[128:131],v[168:171],a[8:11]
dt v[98:99],v20 offset:34816
mm a[12:15],v[128:131],v[172:175],a[12:15]
mm a[16:19],v[128:131],v[176:179],a[16:19]
dr v[64:67],v18 offset:32768
mm a[20:23],v[128:131],v[180:183],a[20:23]
l4 v3,s[28:31],s40 offen offset:1024 lds
mm a[24:27],v[128:131],v[184:187],a[24:27]
dt v[100:101],v21 offset:32768
mm a[28:31],v[128:131],v[188:191],a[28:31]
mm a[60:63],v[132:135],v[188:191],a[60:63]
dt v[102:103],v21 offset:34816
mm a[56:59],v[132:135],v[184:187],a[56:59]
l4 v4,s[28:31],s40 offen offset:2048 lds
mm a[52:55],v[132:135],v[180:183],a[52:55]
dr v[68:71],v18 offset:34816
mm a[48:51],v[132:135],v[176:179],a[48:51]
mm a[44:47],v[132:135],v[172:175],a[44:47]
dt v[104:105],v22 offset:32768
mm a[40:43],v[132:135],v[168:171],a[40:43]
l4 v5,s[28:31],s40 offen offset:3072 lds
mm a[36:39],v[132:135],v[164:167],a[36:39]
dt v[106:107],v22 offset:34816
mm a[32:35],v[132:135],v[160:163],a[32:35]
s_add_u32 m0,s43,4096
mm a[64:67],v[136:139],v[160:163],a[64:67]
dr v[72:75],v18 offset:36864
mm a[68:71],v[136:139],v[164:167],a[68:71]
l4 v6,s[28:31],s40 offen lds
mm a[72:75],v[136:139],v[168:171],a[72:75]
dt v[108:109],v23 offset:32768
mm a[76:79],v[136:139],v[172:175],a[76:79]
mm a[80:83],v[136:139],v[176:179],a[80:83]
dt v[110:111],v23 offset:34816
mm a[84:87],v[136:139],v[180:183],a[84:87]
l4 v7,s[28:31],s40 offen offset:1024 lds
mm a[88:91],v[136:139],v[184:187],a[88:91]
dr v[76:79],v18 offset:38912
mm a[92:95],v[136:139],v[188:191],a[92:95]
mm a[124:127],v[140:143],v[188:191],a[124:127]
dt v[112:113],v24 offset:32768
mm a[120:123],v[140:143],v[184:187],a[120:123]
l4 v8,s[28:31],s40 offen offset:2048 lds
mm a[116:119],v[140:143],v[180:183],a[116:119]
dt v[114:115],v24 offset:34816
mm a[112:115],v[140:143],v[176:179],a[112:115]
mm a[108:111],v[140:143],v[172:175],a[108:111]
dr v[80:83],v18 offset:40960
mm a[104:107],v[140:143],v[168:171],a[104:107]
l4 v9,s[28:31],s40 offen offset:3072 lds
mm a[100:103],v[140:143],v[164:167],a[100:103]
dt v[116:117],v25 offset:32768
mm a[96:99],v[140:143],v[160:163],a[96:99]
s_add_u32 s40,s40,128
s_add_u32 m0,s44,0
mm a[128:131],v[144:147],v[160:163],a[128:131]
dt v[118:119],v25 offset:34816
mm a[132:135],v[144:147],v[164:167],a[132:135]
l4 v10,s[32:35],s41 offen lds
mm a[136:139],v[144:147],v[168:171],a[136:139]
dr v[84:87],v18 offset:43008
mm a[140:143],v[144:147],v[172:175],a[140:143]
mm a[144:147],v[144:147],v[176:179],a[144:147]
dt v[120:121],v26 offset:32768
mm a[148:151],v[144:147],v[180:183],a[148:151]
l4 v11,s[32:35],s41 offen offset:1024 lds
mm a[152:155],v[144:147],v[184:187],a[152:155]
dt v[122:123],v26 offset:34816
mm a[156:159],v[144:147],v[188:191],a[156:159]
mm a[188:191],v[148:151],v[188:191],a[188:191]
dr v[88:91],v18 offset:45056
mm a[184:187],v[148:151],v[184:187],a[184:187]
l4 v12,s[32:35],s41 offen offset:2048 lds
mm a[180:183],v[148:151],v[180:183],a[180:183]
dt v[124:125],v27 offset:32768
mm a[176:179],v[148:151],v[176:179],a[176:179]
mm a[172:175],v[148:151],v[172:175],a[172:175]
dt v[126:127],v27 offset:34816
mm a[168:171],v[148:151],v[168:171],a[168:171]
l4 v13,s[32:35],s41 offen offset:3072 lds
mm a[164:167],v[148:151],v[164:167],a[164:167]
dr v[92:95],v18 offset:47104
mm a[160:163],v[148:151],v[160:163],a[160:163]
s_add_u32 m0,s44,4096
mm a[192:195],v[152:155],v[160:163],a[192:195]
l4 v14,s[32:35],s41 offen lds
mm a[196:199],v[152:155],v[164:167],a[196:199]
mm a[200:203],v[152:155],v[168:171],a[200:203]
mm a[204:207],v[152:155],v[172:175],a[204:207]
l4 v15,s[32:35],s41 offen offset:1024 lds
mm a[208:211],v[152:155],v[176:179],a[208:211]
mm a[212:215],v[152:155],v[180:183],a[212:215]
mm a[216:219],v[152:155],v[184:187],a[216:219]
l4 v16,s[32:35],s41 offen offset:2048 lds
mm a[220:223],v[152:155],v[188:191],a[220:223]
mm a[252:255],v[156:159],v[188:191],a[252:255]
mm a[248:251],v[156:159],v[184:187],a[248:251]
l4 v17,s[32:35],s41 offen offset:3072 lds
mm a[244:247],v[156:159],v[180:183],a[244:247]
s_add_u32 s41,s41,s46
mm a[240:243],v[156:159],v[176:179],a[240:243]
mm a[236:239],v[156:159],v[172:175],a[236:239]
wt lgkmcnt(0)
mm a[232:235],v[156:159],v[168:171],a[232:235]
mm a[228:231],v[156:159],v[164:167],a[228:231]
mm a[224:227],v[156:159],v[160:163],a[224:227]
mm a[0:3],v[64:67],v[96:99],a[0:3]
dt v[160:161],v20 offset:49152
mm a[4:7],v[64:67],v[100:103],a[4:7]
mm a[8:11],v[64:67],v[104:107],a[8:11]
dt v[162:163],v20 offset:51200
mm a[12:15],v[64:67],v[108:111],a[12:15]
mm a[16:19],v[64:67],v[112:115],a[16:19]
dr v[128:131],v19 offset:32768
mm a[20:23],v[64:67],v[116:119],a[20:23]
mm a[24:27],v[64:67],v[120:123],a[24:27]
dt v[164:165],v21 offset:49152
mm a[28:31],v[64:67],v[124:127],a[28:31]
mm a[60:63],v[68:71],v[124:127],a[60:63]
dt v[166:167],v21 offset:51200
mm a[56:59],v[68:71],v[120:123],a[56:59]
mm a[52:55],v[68:71],v[116:119],a[52:55]
dr v[132:135],v19 offset:34816
mm a[48:51],v[68:71],v[112:115],a[48:51]
mm a[44:47],v[68:71],v[108:111],a[44:47]
dt v[168:169],v22 offset:49152
mm a[40:43],v[68:71],v[104:107],a[40:43]
mm a[36:39],v[68:71],v[100:103],a[36:39]
dt v[170:171],v22 offset:51200
mm a[32:35],v[68:71],v[96:99],a[32:35]
mm a[64:67],v[72:75],v[96:99],a[64:67]
dr v[136:139],v19 offset:36864
mm a[68:71],v[72:75],v[100:103],a[68:71]
mm a[72:75],v[72:75],v[104:107],a[72:75]
dt v[172:173],v23 offset:49152
mm a[76:79],v[72:75],v[108:111],a[76:79]
mm a[80:83],v[72:75],v[112:115],a[80:83]
dt v[174:175],v23 offset:51200
mm a[84:87],v[72:75],v[116:119],a[84:87]
mm a[88:91],v[72:75],v[120:123],a[88:91]
dr v[140:143],v19 offset:38912
mm a[92:95],v[72:75],v[124:127],a[92:95]
mm a[124:127],v[76:79],v[124:127],a[124:127]
dt v[176:177],v24 offset:49152
mm a[120:123],v[76:79],v[120:123],a[120:123]
mm a[116:119],v[76:79],v[116:119],a[116:119]
dt v[178:179],v24 offset:51200
mm a[112:115],v[76:79],v[112:115],a[112:115]
mm a[108:111],v[76:79],v[108:111],a[108:111]
dr v[144:147],v19 offset:40960
mm a[104:107],v[76:79],v[104:107],a[104:107]
mm a[100:103],v[76:79],v[100:103],a[100:103]
dt v[180:181],v25 offset:49152
mm a[96:99],v[76:79],v[96:99],a[96:99]
mm a[128:131],v[80:83],v[96:99],a[128:131]
dt v[182:183],v25 offset:51200
mm a[132:135],v[80:83],v[100:103],a[132:135]
mm a[136:139],v[80:83],v[104:107],a[136:139]
dr v[148:151],v19 offset:43008
mm a[140:143],v[80:83],v[108:111],a[140:143]
mm a[144:147],v[80:83],v[112:115],a[144:147]
dt v[184:185],v26 offset:49152
mm a[148:151],v[80:83],v[116:119],a[148:151]
mm a[152:155],v[80:83],v[120:123],a[152:155]
dt v[186:187],v26 offset:51200
mm a[156:159],v[80:83],v[124:127],a[156:159]
mm a[188:191],v[84:87],v[124:127],a[188:191]
dr v[152:155],v19 offset:45056
mm a[184:187],v[84:87],v[120:123],a[184:187]
mm a[180:183],v[84:87],v[116:119],a[180:183]
dt v[188:189],v27 offset:49152
mm a[176:179],v[84:87],v[112:115],a[176:179]
mm a[172:175],v[84:87],v[108:111],a[172:175]
dt v[190:191],v27 offset:51200
mm a[168:171],v[84:87],v[104:107],a[168:171]
mm a[164:167],v[84:87],v[100:103],a[164:167]
dr v[156:159],v19 offset:47104
mm a[160:163],v[84:87],v[96:99],a[160:163]
mm a[192:195],v[88:91],v[96:99],a[192:195]
mm a[196:199],v[88:91],v[100:103],a[196:199]
mm a[200:203],v[88:91],v[104:107],a[200:203]
mm a[204:207],v[88:91],v[108:111],a[204:207]
mm a[208:211],v[88:91],v[112:115],a[208:211]
mm a[212:215],v[88:91],v[116:119],a[212:215]
mm a[216:219],v[88:91],v[120:123],a[216:219]
mm a[220:223],v[88:91],v[124:127],a[220:223]
mm a[252:255],v[92:95],v[124:127],a[252:255]
mm a[248:251],v[92:95],v[120:123],a[248:251]
mm a[244:247],v[92:95],v[116:119],a[244:247]
mm a[240:243],v[92:95],v[112:115],a[240:243]
mm a[236:239],v[92:95],v[108:111],a[236:239]
mm a[232:235],v[92:95],v[104:107],a[232:235]
mm a[228:231],v[92:95],v[100:103],a[228:231]
mm a[224:227],v[92:95],v[96:99],a[224:227]
wt vmcnt(0) lgkmcnt(0)
s_barrier
mm a[0:3],v[128:131],v[160:163],a[0:3]
dt v[96:97],v20 offset:0
s_add_u32 m0,s43,32768
mm a[4:7],v[128:131],v[164:167],a[4:7]
l4 v2,s[28:31],s40 offen lds
mm a[8:11],v[128:131],v[168:171],a[8:11]
dt v[98:99],v20 offset:2048
mm a[12:15],v[128:131],v[172:175],a[12:15]
mm a[16:19],v[128:131],v[176:179],a[16:19]
dr v[64:67],v18 offset:0
mm a[20:23],v[128:131],v[180:183],a[20:23]
l4 v3,s[28:31],s40 offen offset:1024 lds
mm a[24:27],v[128:131],v[184:187],a[24:27]
dt v[100:101],v21 offset:0
mm a[28:31],v[128:131],v[188:191],a[28:31]
mm a[60:63],v[132:135],v[188:191],a[60:63]
dt v[102:103],v21 offset:2048
mm a[56:59],v[132:135],v[184:187],a[56:59]
l4 v4,s[28:31],s40 offen offset:2048 lds
mm a[52:55],v[132:135],v[180:183],a[52:55]
dr v[68:71],v18 offset:2048
mm a[48:51],v[132:135],v[176:179],a[48:51]
mm a[44:47],v[132:135],v[172:175],a[44:47]
dt v[104:105],v22 offset:0
mm a[40:43],v[132:135],v[168:171],a[40:43]
l4 v5,s[28:31],s40 offen offset:3072 lds
mm a[36:39],v[132:135],v[164:167],a[36:39]
dt v[106:107],v22 offset:2048
mm a[32:35],v[132:135],v[160:163],a[32:35]
s_add_u32 m0,s43,36864
mm a[64:67],v[136:139],v[160:163],a[64:67]
dr v[72:75],v18 offset:4096
mm a[68:71],v[136:139],v[164:167],a[68:71]
l4 v6,s[28:31],s40 offen lds
mm a[72:75],v[136:139],v[168:171],a[72:75]
dt v[108:109],v23 offset:0
mm a[76:79],v[136:139],v[172:175],a[76:79]
mm a[80:83],v[136:139],v[176:179],a[80:83]
dt v[110:111],v23 offset:2048
mm a[84:87],v[136:139],v[180:183],a[84:87]
l4 v7,s[28:31],s40 offen offset:1024 lds
mm a[88:91],v[136:139],v[184:187],a[88:91]
dr v[76:79],v18 offset:6144
mm a[92:95],v[136:139],v[188:191],a[92:95]
mm a[124:127],v[140:143],v[188:191],a[124:127]
dt v[112:113],v24 offset:0
mm a[120:123],v[140:143],v[184:187],a[120:123]
l4 v8,s[28:31],s40 offen offset:2048 lds
mm a[116:119],v[140:143],v[180:183],a[116:119]
dt v[114:115],v24 offset:2048
mm a[112:115],v[140:143],v[176:179],a[112:115]
mm a[108:111],v[140:143],v[172:175],a[108:111]
dr v[80:83],v18 offset:8192
mm a[104:107],v[140:143],v[168:171],a[104:107]
l4 v9,s[28:31],s40 offen offset:3072 lds
mm a[100:103],v[140:143],v[164:167],a[100:103]
dt v[116:117],v25 offset:0
mm a[96:99],v[140:143],v[160:163],a[96:99]
s_add_u32 s40,s40,128
s_add_u32 m0,s44,32768
mm a[128:131],v[144:147],v[160:163],a[128:131]
dt v[118:119],v25 offset:2048
mm a[132:135],v[144:147],v[164:167],a[132:135]
l4 v10,s[32:35],s41 offen lds
mm a[136:139],v[144:147],v[168:171],a[136:139]
dr v[84:87],v18 offset:10240
mm a[140:143],v[144:147],v[172:175],a[140:143]
mm a[144:147],v[144:147],v[176:179],a[144:147]
dt v[120:121],v26 offset:0
mm a[148:151],v[144:147],v[180:183],a[148:151]
l4 v11,s[32:35],s41 offen offset:1024 lds
mm a[152:155],v[144:147],v[184:187],a[152:155]
dt v[122:123],v26 offset:2048
mm a[156:159],v[144:147],v[188:191],a[156:159]
mm a[188:191],v[148:151],v[188:191],a[188:191]
dr v[88:91],v18 offset:12288
mm a[184:187],v[148:151],v[184:187],a[184:187]
l4 v12,s[32:35],s41 offen offset:2048 lds
mm a[180:183],v[148:151],v[180:183],a[180:183]
dt v[124:125],v27 offset:0
mm a[176:179],v[148:151],v[176:179],a[176:179]
mm a[172:175],v[148:151],v[172:175],a[172:175]
dt v[126:127],v27 offset:2048
mm a[168:171],v[148:151],v[168:171],a[168:171]
l4 v13,s[32:35],s41 offen offset:3072 lds
mm a[164:167],v[148:151],v[164:167],a[164:167]
dr v[92:95],v18 offset:14336
mm a[160:163],v[148:151],v[160:163],a[160:163]
s_add_u32 m0,s44,36864
mm a[192:195],v[152:155],v[160:163],a[192:195]
l4 v14,s[32:35],s41 offen lds
mm a[196:199],v[152:155],v[164:167],a[196:199]
mm a[200:203],v[152:155],v[168:171],a[200:203]
mm a[204:207],v[152:155],v[172:175],a[204:207]
l4 v15,s[32:35],s41 offen offset:1024 lds
mm a[208:211],v[152:155],v[176:179],a[208:211]
mm a[212:215],v[152:155],v[180:183],a[212:215]
mm a[216:219],v[152:155],v[184:187],a[216:219]
l4 v16,s[32:35],s41 offen offset:2048 lds
mm a[220:223],v[152:155],v[188:191],a[220:223]
mm a[252:255],v[156:159],v[188:191],a[252:255]
mm a[248:251],v[156:159],v[184:187],a[248:251]
l4 v17,s[32:35],s41 offen offset:3072 lds
mm a[244:247],v[156:159],v[180:183],a[244:247]
s_add_u32 s41,s41,s46
mm a[240:243],v[156:159],v[176:179],a[240:243]
mm a[236:239],v[156:159],v[172:175],a[236:239]
wt lgkmcnt(0)
s_sub_u32 s42,s42,1
mm a[232:235],v[156:159],v[168:171],a[232:235]
s_cmp_lg_u32 s42,0
mm a[228:231],v[156:159],v[164:167],a[228:231]
mm a[224:227],v[156:159],v[160:163],a[224:227]
s_cbranch_scc1 GKV_k
mm a[0:3],v[64:67],v[96:99],a[0:3]
dt v[160:161],v20 offset:16384
mm a[4:7],v[64:67],v[100:103],a[4:7]
mm a[8:11],v[64:67],v[104:107],a[8:11]
dt v[162:163],v20 offset:18432
mm a[12:15],v[64:67],v[108:111],a[12:15]
mm a[16:19],v[64:67],v[112:115],a[16:19]
dr v[128:131],v19 offset:0
mm a[20:23],v[64:67],v[116:119],a[20:23]
mm a[24:27],v[64:67],v[120:123],a[24:27]
dt v[164:165],v21 offset:16384
mm a[28:31],v[64:67],v[124:127],a[28:31]
mm a[60:63],v[68:71],v[124:127],a[60:63]
dt v[166:167],v21 offset:18432
mm a[56:59],v[68:71],v[120:123],a[56:59]
mm a[52:55],v[68:71],v[116:119],a[52:55]
dr v[132:135],v19 offset:2048
mm a[48:51],v[68:71],v[112:115],a[48:51]
mm a[44:47],v[68:71],v[108:111],a[44:47]
dt v[168:169],v22 offset:16384
mm a[40:43],v[68:71],v[104:107],a[40:43]
mm a[36:39],v[68:71],v[100:103],a[36:39]
dt v[170:171],v22 offset:18432
mm a[32:35],v[68:71],v[96:99],a[32:35]
mm a[64:67],v[72:75],v[96:99],a[64:67]
dr v[136:139],v19 offset:4096
mm a[68:71],v[72:75],v[100:103],a[68:71]
mm a[72:75],v[72:75],v[104:107],a[72:75]
dt v[172:173],v23 offset:16384
mm a[76:79],v[72:75],v[108:111],a[76:79]
mm a[80:83],v[72:75],v[112:115],a[80:83]
dt v[174:175],v23 offset:18432
mm a[84:87],v[72:75],v[116:119],a[84:87]
mm a[88:91],v[72:75],v[120:123],a[88:91]
dr v[140:143],v19 offset:6144
mm a[92:95],v[72:75],v[124:127],a[92:95]
mm a[124:127],v[76:79],v[124:127],a[124:127]
dt v[176:177],v24 offset:16384
mm a[120:123],v[76:79],v[120:123],a[120:123]
mm a[116:119],v[76:79],v[116:119],a[116:119]
dt v[178:179],v24 offset:18432
mm a[112:115],v[76:79],v[112:115],a[112:115]
mm a[108:111],v[76:79],v[108:111],a[108:111]
dr v[144:147],v19 offset:8192
mm a[104:107],v[76:79],v[104:107],a[104:107]
mm a[100:103],v[76:79],v[100:103],a[100:103]
dt v[180:181],v25 offset:16384
mm a[96:99],v[76:79],v[96:99],a[96:99]
mm a[128:131],v[80:83],v[96:99],a[128:131]
dt v[182:183],v25 offset:18432
mm a[132:135],v[80:83],v[100:103],a[132:135]
mm a[136:139],v[80:83],v[104:107],a[136:139]
dr v[148:151],v19 offset:10240
mm a[140:143],v[80:83],v[108:111],a[140:143]
mm a[144:147],v[80:83],v[112:115],a[144:147]
dt v[184:185],v26 offset:16384
mm a[148:151],v[80:83],v[116:119],a[148:151]
mm a[152:155],v[80:83],v[120:123],a[152:155]
dt v[186:187],v26 offset:18432
mm a[156:159],v[80:83],v[124:127],a[156:159]
mm a[188:191],v[84:87],v[124:127],a[188:191]
dr v[152:155],v19 offset:12288
mm a[184:187],v[84:87],v[120:123],a[184:187]
mm a[180:183],v[84:87],v[116:119],a[180:183]
dt v[188:189],v27 offset:16384
mm a[176:179],v[84:87],v[112:115],a[176:179]
mm a[172:175],v[84:87],v[108:111],a[172:175]
dt v[190:191],v27 offset:18432
mm a[168:171],v[84:87],v[104:107],a[168:171]
mm a[164:167],v[84:87],v[100:103],a[164:167]
dr v[156:159],v19 offset:14336
mm a[160:163],v[84:87],v[96:99],a[160:163]
mm a[192:195],v[88:91],v[96:99],a[192:195]
mm a[196:199],v[88:91],v[100:103],a[196:199]
mm a[200:203],v[88:91],v[104:107],a[200:203]
mm a[204:207],v[88:91],v[108:111],a[204:207]
mm a[208:211],v[88:91],v[112:115],a[208:211]
mm a[212:215],v[88:91],v[116:119],a[212:215]
mm a[216:219],v[88:91],v[120:123],a[216:219]
mm a[220:223],v[88:91],v[124:127],a[220:223]
mm a[252:255],v[92:95],v[124:127],a[252:255]
mm a[248:251],v[92:95],v[120:123],a[248:251]
mm a[244:247],v[92:95],v[116:119],a[244:247]
mm a[240:243],v[92:95],v[112:115],a[240:243]
mm a[236:239],v[92:95],v[108:111],a[236:239]
mm a[232:235],v[92:95],v[104:107],a[232:235]
mm a[228:231],v[92:95],v[100:103],a[228:231]
mm a[224:227],v[92:95],v[96:99],a[224:227]
wt vmcnt(0) lgkmcnt(0)
s_barrier
mm a[0:3],v[128:131],v[160:163],a[0:3]
dt v[96:97],v20 offset:32768
mm a[4:7],v[128:131],v[164:167],a[4:7]
mm a[8:11],v[128:131],v[168:171],a[8:11]
dt v[98:99],v20 offset:34816
mm a[12:15],v[128:131],v[172:175],a[12:15]
mm a[16:19],v[128:131],v[176:179],a[16:19]
dr v[64:67],v18 offset:32768
mm a[20:23],v[128:131],v[180:183],a[20:23]
mm a[24:27],v[128:131],v[184:187],a[24:27]
dt v[100:101],v21 offset:32768
mm a[28:31],v[128:131],v[188:191],a[28:31]
mm a[60:63],v[132:135],v[188:191],a[60:63]
dt v[102:103],v21 offset:34816
mm a[56:59],v[132:135],v[184:187],a[56:59]
mm a[52:55],v[132:135],v[180:183],a[52:55]
dr v[68:71],v18 offset:34816
mm a[48:51],v[132:135],v[176:179],a[48:51]
mm a[44:47],v[132:135],v[172:175],a[44:47]
dt v[104:105],v22 offset:32768
mm a[40:43],v[132:135],v[168:171],a[40:43]
mm a[36:39],v[132:135],v[164:167],a[36:39]
dt v[106:107],v22 offset:34816
mm a[32:35],v[132:135],v[160:163],a[32:35]
mm a[64:67],v[136:139],v[160:163],a[64:67]
dr v[72:75],v18 offset:36864
mm a[68:71],v[136:139],v[164:167],a[68:71]
mm a[72:75],v[136:139],v[168:171],a[72:75]
dt v[108:109],v23 offset:32768
mm a[76:79],v[136:139],v[172:175],a[76:79]
mm a[80:83],v[136:139],v[176:179],a[80:83]
dt v[110:111],v23 offset:34816
mm a[84:87],v[136:139],v[180:183],a[84:87]
mm a[88:91],v[136:139],v[184:187],a[88:91]
dr v[76:79],v18 offset:38912
mm a[92:95],v[136:139],v[188:191],a[92:95]
mm a[124:127],v[140:143],v[188:191],a[124:127]
dt v[112:113],v24 offset:32768
mm a[120:123],v[140:143],v[184:187],a[120:123]
mm a[116:119],v[140:143],v[180:183],a[116:119]
dt v[114:115],v24 offset:34816
mm a[112:115],v[140:143],v[176:179],a[112:115]
mm a[108:111],v[140:143],v[172:175],a[108:111]
dr v[80:83],v18 offset:40960
mm a[104:107],v[140:143],v[168:171],a[104:107]
mm a[100:103],v[140:143],v[164:167],a[100:103]
dt v[116:117],v25 offset:32768
mm a[96:99],v[140:143],v[160:163],a[96:99]
mm a[128:131],v[144:147],v[160:163],a[128:131]
dt v[118:119],v25 offset:34816
mm a[132:135],v[144:147],v[164:167],a[132:135]
mm a[136:139],v[144:147],v[168:171],a[136:139]
dr v[84:87],v18 offset:43008
mm a[140:143],v[144:147],v[172:175],a[140:143]
mm a[144:147],v[144:147],v[176:179],a[144:147]
dt v[120:121],v26 offset:32768
mm a[148:151],v[144:147],v[180:183],a[148:151]
mm a[152:155],v[144:147],v[184:187],a[152:155]
dt v[122:123],v26 offset:34816
mm a[156:159],v[144:147],v[188:191],a[156:159]
mm a[188:191],v[148:151],v[188:191],a[188:191]
dr v[88:91],v18 offset:45056
mm a[184:187],v[148:151],v[184:187],a[184:187]
mm a[180:183],v[148:151],v[180:183],a[180:183]
dt v[124:125],v27 offset:32768
mm a[176:179],v[148:151],v[176:179],a[176:179]
mm a[172:175],v[148:151],v[172:175],a[172:175]
dt v[126:127],v27 offset:34816
mm a[168:171],v[148:151],v[168:171],a[168:171]
mm a[164:167],v[148:151],v[164:167],a[164:167]
dr v[92:95],v18 offset:47104
mm a[160:163],v[148:151],v[160:163],a[160:163]
mm a[192:195],v[152:155],v[160:163],a[192:195]
mm a[196:199],v[152:155],v[164:167],a[196:199]
mm a[200:203],v[152:155],v[168:171],a[200:203]
mm a[204:207],v[152:155],v[172:175],a[204:207]
mm a[208:211],v[152:155],v[176:179],a[208:211]
mm a[212:215],v[152:155],v[180:183],a[212:215]
mm a[216:219],v[152:155],v[184:187],a[216:219]
mm a[220:223],v[152:155],v[188:191],a[220:223]
mm a[252:255],v[156:159],v[188:191],a[252:255]
mm a[248:251],v[156:159],v[184:187],a[248:251]
mm a[244:247],v[156:159],v[180:183],a[244:247]
mm a[240:243],v[156:159],v[176:179],a[240:243]
mm a[236:239],v[156:159],v[172:175],a[236:239]
mm a[232:235],v[156:159],v[168:171],a[232:235]
mm a[228:231],v[156:159],v[164:167],a[228:231]
mm a[224:227],v[156:159],v[160:163],a[224:227]
wt lgkmcnt(0)
mm a[0:3],v[64:67],v[96:99],a[0:3]
dt v[160:161],v20 offset:49152
mm a[4:7],v[64:67],v[100:103],a[4:7]
mm a[8:11],v[64:67],v[104:107],a[8:11]
dt v[162:163],v20 offset:51200
mm a[12:15],v[64:67],v[108:111],a[12:15]
mm a[16:19],v[64:67],v[112:115],a[16:19]
dr v[128:131],v19 offset:32768
mm a[20:23],v[64:67],v[116:119],a[20:23]
mm a[24:27],v[64:67],v[120:123],a[24:27]
dt v[164:165],v21 offset:49152
mm a[28:31],v[64:67],v[124:127],a[28:31]
mm a[60:63],v[68:71],v[124:127],a[60:63]
dt v[166:167],v21 offset:51200
mm a[56:59],v[68:71],v[120:123],a[56:59]
mm a[52:55],v[68:71],v[116:119],a[52:55]
dr v[132:135],v19 offset:34816
mm a[48:51],v[68:71],v[112:115],a[48:51]
mm a[44:47],v[68:71],v[108:111],a[44:47]
dt v[168:169],v22 offset:49152
mm a[40:43],v[68:71],v[104:107],a[40:43]
mm a[36:39],v[68:71],v[100:103],a[36:39]
dt v[170:171],v22 offset:51200
mm a[32:35],v[68:71],v[96:99],a[32:35]
mm a[64:67],v[72:75],v[96:99],a[64:67]
dr v[136:139],v19 offset:36864
mm a[68:71],v[72:75],v[100:103],a[68:71]
mm a[72:75],v[72:75],v[104:107],a[72:75]
dt v[172:173],v23 offset:49152
mm a[76:79],v[72:75],v[108:111],a[76:79]
mm a[80:83],v[72:75],v[112:115],a[80:83]
dt v[174:175],v23 offset:51200
mm a[84:87],v[72:75],v[116:119],a[84:87]
mm a[88:91],v[72:75],v[120:123],a[88:91]
dr v[140:143],v19 offset:38912
mm a[92:95],v[72:75],v[124:127],a[92:95]
mm a[124:127],v[76:79],v[124:127],a[124:127]
dt v[176:177],v24 offset:49152
mm a[120:123],v[76:79],v[120:123],a[120:123]
mm a[116:119],v[76:79],v[116:119],a[116:119]
dt v[178:179],v24 offset:51200
mm a[112:115],v[76:79],v[112:115],a[112:115]
mm a[108:111],v[76:79],v[108:111],a[108:111]
dr v[144:147],v19 offset:40960
mm a[104:107],v[76:79],v[104:107],a[104:107]
mm a[100:103],v[76:79],v[100:103],a[100:103]
dt v[180:181],v25 offset:49152
mm a[96:99],v[76:79],v[96:99],a[96:99]
mm a[128:131],v[80:83],v[96:99],a[128:131]
dt v[182:183],v25 offset:51200
mm a[132:135],v[80:83],v[100:103],a[132:135]
mm a[136:139],v[80:83],v[104:107],a[136:139]
dr v[148:151],v19 offset:43008
mm a[140:143],v[80:83],v[108:111],a[140:143]
mm a[144:147],v[80:83],v[112:115],a[144:147]
dt v[184:185],v26 offset:49152
mm a[148:151],v[80:83],v[116:119],a[148:151]
mm a[152:155],v[80:83],v[120:123],a[152:155]
dt v[186:187],v26 offset:51200
mm a[156:159],v[80:83],v[124:127],a[156:159]
mm a[188:191],v[84:87],v[124:127],a[188:191]
dr v[152:155],v19 offset:45056
mm a[184:187],v[84:87],v[120:123],a[184:187]
mm a[180:183],v[84:87],v[116:119],a[180:183]
dt v[188:189],v27 offset:49152
mm a[176:179],v[84:87],v[112:115],a[176:179]
mm a[172:175],v[84:87],v[108:111],a[172:175]
dt v[190:191],v27 offset:51200
mm a[168:171],v[84:87],v[104:107],a[168:171]
mm a[164:167],v[84:87],v[100:103],a[164:167]
dr v[156:159],v19 offset:47104
mm a[160:163],v[84:87],v[96:99],a[160:163]
mm a[192:195],v[88:91],v[96:99],a[192:195]
mm a[196:199],v[88:91],v[100:103],a[196:199]
mm a[200:203],v[88:91],v[104:107],a[200:203]
mm a[204:207],v[88:91],v[108:111],a[204:207]
mm a[208:211],v[88:91],v[112:115],a[208:211]
mm a[212:215],v[88:91],v[116:119],a[212:215]
mm a[216:219],v[88:91],v[120:123],a[216:219]
mm a[220:223],v[88:91],v[124:127],a[220:223]
mm a[252:255],v[92:95],v[124:127],a[252:255]
mm a[248:251],v[92:95],v[120:123],a[248:251]
mm a[244:247],v[92:95],v[116:119],a[244:247]
mm a[240:243],v[92:95],v[112:115],a[240:243]
mm a[236:239],v[92:95],v[108:111],a[236:239]
mm a[232:235],v[92:95],v[104:107],a[232:235]
mm a[228:231],v[92:95],v[100:103],a[228:231]
mm a[224:227],v[92:95],v[96:99],a[224:227]
wt lgkmcnt(0)
mm a[0:3],v[128:131],v[160:163],a[0:3]
mm a[4:7],v[128:131],v[164:167],a[4:7]
mm a[8:11],v[128:131],v[168:171],a[8:11]
mm a[12:15],v[128:131],v[172:175],a[12:15]
mm a[16:19],v[128:131],v[176:179],a[16:19]
mm a[20:23],v[128:131],v[180:183],a[20:23]
mm a[24:27],v[128:131],v[184:187],a[24:27]
mm a[28:31],v[128:131],v[188:191],a[28:31]
mm a[60:63],v[132:135],v[188:191],a[60:63]
mm a[56:59],v[132:135],v[184:187],a[56:59]
mm a[52:55],v[132:135],v[180:183],a[52:55]
mm a[48:51],v[132:135],v[176:179],a[48:51]
mm a[44:47],v[132:135],v[172:175],a[44:47]
mm a[40:43],v[132:135],v[168:171],a[40:43]
mm a[36:39],v[132:135],v[164:167],a[36:39]
mm a[32:35],v[132:135],v[160:163],a[32:35]
mm a[64:67],v[136:139],v[160:163],a[64:67]
mm a[68:71],v[136:139],v[164:167],a[68:71]
mm a[72:75],v[136:139],v[168:171],a[72:75]
mm a[76:79],v[136:139],v[172:175],a[76:79]
mm a[80:83],v[136:139],v[176:179],a[80:83]
mm a[84:87],v[136:139],v[180:183],a[84:87]
mm a[88:91],v[136:139],v[184:187],a[88:91]
mm a[92:95],v[136:139],v[188:191],a[92:95]
mm a[124:127],v[140:143],v[188:191],a[124:127]
mm a[120:123],v[140:143],v[184:187],a[120:123]
mm a[116:119],v[140:143],v[180:183],a[116:119]
mm a[112:115],v[140:143],v[176:179],a[112:115]
mm a[108:111],v[140:143],v[172:175],a[108:111]
mm a[104:107],v[140:143],v[168:171],a[104:107]
mm a[100:103],v[140:143],v[164:167],a[100:103]
mm a[96:99],v[140:143],v[160:163],a[96:99]
mm a[128:131],v[144:147],v[160:163],a[128:131]
mm a[132:135],v[144:147],v[164:167],a[132:135]
mm a[136:139],v[144:147],v[168:171],a[136:139]
mm a[140:143],v[144:147],v[172:175],a[140:143]
mm a[144:147],v[144:147],v[176:179],a[144:147]
mm a[148:151],v[144:147],v[180:183],a[148:151]
mm a[152:155],v[144:147],v[184:187],a[152:155]
mm a[156:159],v[144:147],v[188:191],a[156:159]
mm a[188:191],v[148:151],v[188:191],a[188:191]
mm a[184:187],v[148:151],v[184:187],a[184:187]
mm a[180:183],v[148:151],v[180:183],a[180:183]
mm a[176:179],v[148:151],v[176:179],a[176:179]
mm a[172:175],v[148:151],v[172:175],a[172:175]
mm a[168:171],v[148:151],v[168:171],a[168:171]
mm a[164:167],v[148:151],v[164:167],a[164:167]
mm a[160:163],v[148:151],v[160:163],a[160:163]
mm a[192:195],v[152:155],v[160:163],a[192:195]
mm a[196:199],v[152:155],v[164:167],a[196:199]
mm a[200:203],v[152:155],v[168:171],a[200:203]
mm a[204:207],v[152:155],v[172:175],a[204:207]
mm a[208:211],v[152:155],v[176:179],a[208:211]
mm a[212:215],v[152:155],v[180:183],a[212:215]
mm a[216:219],v[152:155],v[184:187],a[216:219]
mm a[220:223],v[152:155],v[188:191],a[220:223]
mm a[252:255],v[156:159],v[188:191],a[252:255]
mm a[248:251],v[156:159],v[184:187],a[248:251]
mm a[244:247],v[156:159],v[180:183],a[244:247]
mm a[240:243],v[156:159],v[176:179],a[240:243]
mm a[236:239],v[156:159],v[172:175],a[236:239]
mm a[232:235],v[156:159],v[168:171],a[232:235]
mm a[228:231],v[156:159],v[164:167],a[228:231]
mm a[224:227],v[156:159],v[160:163],a[224:227]
v_mov_b32 v64,0x3f803f80
v_mov_b32 v65,0x3f803f80
v_mov_b32 v66,0x3f803f80
v_mov_b32 v67,0x3f803f80
s_mul_i32 s48,s76,196608
s_mul_i32 s49,s77,12288
s_add_u32 s48,s48,s49
s_add_u32 s48,s48,s93
v_bfe_u32 v30,v1,0,6
v_lshlrev_b32 v30,4,v30
ar v108,a0
ar v109,a1
ar v110,a2
ar v111,a3
ar v112,a32
ar v113,a33
ar v114,a34
ar v115,a35
pm v[116:117],v[108:109],s[80:81] op_sel_hi:[1,0]
pm v[118:119],v[110:111],s[80:81] op_sel_hi:[1,0]
pm v[120:121],v[112:113],s[80:81] op_sel_hi:[1,0]
pm v[122:123],v[114:115],s[80:81] op_sel_hi:[1,0]
v_exp_f32 v116,v116 clamp
v_max_f32 v108,0,v108
v_exp_f32 v117,v117 clamp
v_max_f32 v109,0,v109
v_exp_f32 v118,v118 clamp
v_max_f32 v110,0,v110
v_exp_f32 v119,v119 clamp
v_max_f32 v111,0,v111
v_exp_f32 v120,v120 clamp
v_max_f32 v112,0,v112
v_exp_f32 v121,v121 clamp
v_max_f32 v113,0,v113
v_exp_f32 v122,v122 clamp
v_max_f32 v114,0,v114
v_exp_f32 v123,v123 clamp
v_max_f32 v115,0,v115
pa v[116:117],v[116:117],v[108:109]
pa v[118:119],v[118:119],v[110:111]
pa v[120:121],v[120:121],v[112:113]
pa v[122:123],v[122:123],v[114:115]
pa v[116:117],v[116:117],s[80:81] op_sel:[0,1]
pa v[118:119],v[118:119],s[80:81] op_sel:[0,1]
pa v[120:121],v[120:121],s[80:81] op_sel:[0,1]
pa v[122:123],v[122:123],s[80:81] op_sel:[0,1]
cv v92,v116,v117
cv v93,v118,v119
cv v94,v120,v121
cv v95,v122,v123
ar v108,a4
ar v109,a5
ar v110,a6
ar v111,a7
ar v112,a36
ar v113,a37
ar v114,a38
ar v115,a39
pm v[116:117],v[108:109],s[80:81] op_sel_hi:[1,0]
pm v[118:119],v[110:111],s[80:81] op_sel_hi:[1,0]
pm v[120:121],v[112:113],s[80:81] op_sel_hi:[1,0]
pm v[122:123],v[114:115],s[80:81] op_sel_hi:[1,0]
v_exp_f32 v116,v116 clamp
v_max_f32 v108,0,v108
v_exp_f32 v117,v117 clamp
v_max_f32 v109,0,v109
v_exp_f32 v118,v118 clamp
v_max_f32 v110,0,v110
v_exp_f32 v119,v119 clamp
v_max_f32 v111,0,v111
v_exp_f32 v120,v120 clamp
v_max_f32 v112,0,v112
v_exp_f32 v121,v121 clamp
v_max_f32 v113,0,v113
v_exp_f32 v122,v122 clamp
v_max_f32 v114,0,v114
v_exp_f32 v123,v123 clamp
v_max_f32 v115,0,v115
pa v[116:117],v[116:117],v[108:109]
pa v[118:119],v[118:119],v[110:111]
pa v[120:121],v[120:121],v[112:113]
pa v[122:123],v[122:123],v[114:115]
pa v[116:117],v[116:117],s[80:81] op_sel:[0,1]
pa v[118:119],v[118:119],s[80:81] op_sel:[0,1]
pa v[120:121],v[120:121],s[80:81] op_sel:[0,1]
pa v[122:123],v[122:123],s[80:81] op_sel:[0,1]
cv v96,v116,v117
cv v97,v118,v119
cv v98,v120,v121
cv v99,v122,v123
ar v108,a8
ar v109,a9
ar v110,a10
ar v111,a11
ar v112,a40
ar v113,a41
ar v114,a42
ar v115,a43
cv v100,v108,v109
cv v101,v110,v111
cv v102,v112,v113
cv v103,v114,v115
ar v108,a12
ar v109,a13
ar v110,a14
ar v111,a15
ar v112,a44
ar v113,a45
ar v114,a46
ar v115,a47
cv v104,v108,v109
cv v105,v110,v111
cv v106,v112,v113
cv v107,v114,v115
mm v[84:87],v[92:95],v[64:67],0
mm v[88:91],v[96:99],v[64:67],0
mm v[68:71],v[92:95],v[100:103],0
mm v[72:75],v[96:99],v[100:103],0
mm v[76:79],v[92:95],v[104:107],0
mm v[80:83],v[96:99],v[104:107],0
ar v108,a64
ar v109,a65
ar v110,a66
ar v111,a67
ar v112,a96
ar v113,a97
ar v114,a98
ar v115,a99
pm v[116:117],v[108:109],s[80:81] op_sel_hi:[1,0]
pm v[118:119],v[110:111],s[80:81] op_sel_hi:[1,0]
pm v[120:121],v[112:113],s[80:81] op_sel_hi:[1,0]
pm v[122:123],v[114:115],s[80:81] op_sel_hi:[1,0]
v_exp_f32 v116,v116 clamp
v_max_f32 v108,0,v108
v_exp_f32 v117,v117 clamp
v_max_f32 v109,0,v109
v_exp_f32 v118,v118 clamp
v_max_f32 v110,0,v110
v_exp_f32 v119,v119 clamp
v_max_f32 v111,0,v111
v_exp_f32 v120,v120 clamp
v_max_f32 v112,0,v112
v_exp_f32 v121,v121 clamp
v_max_f32 v113,0,v113
v_exp_f32 v122,v122 clamp
v_max_f32 v114,0,v114
v_exp_f32 v123,v123 clamp
v_max_f32 v115,0,v115
pa v[116:117],v[116:117],v[108:109]
pa v[118:119],v[118:119],v[110:111]
pa v[120:121],v[120:121],v[112:113]
pa v[122:123],v[122:123],v[114:115]
pa v[116:117],v[116:117],s[80:81] op_sel:[0,1]
pa v[118:119],v[118:119],s[80:81] op_sel:[0,1]
pa v[120:121],v[120:121],s[80:81] op_sel:[0,1]
pa v[122:123],v[122:123],s[80:81] op_sel:[0,1]
cv v92,v116,v117
cv v93,v118,v119
cv v94,v120,v121
cv v95,v122,v123
ar v108,a68
ar v109,a69
ar v110,a70
ar v111,a71
ar v112,a100
ar v113,a101
ar v114,a102
ar v115,a103
pm v[116:117],v[108:109],s[80:81] op_sel_hi:[1,0]
pm v[118:119],v[110:111],s[80:81] op_sel_hi:[1,0]
pm v[120:121],v[112:113],s[80:81] op_sel_hi:[1,0]
pm v[122:123],v[114:115],s[80:81] op_sel_hi:[1,0]
v_exp_f32 v116,v116 clamp
v_max_f32 v108,0,v108
v_exp_f32 v117,v117 clamp
v_max_f32 v109,0,v109
v_exp_f32 v118,v118 clamp
v_max_f32 v110,0,v110
v_exp_f32 v119,v119 clamp
v_max_f32 v111,0,v111
v_exp_f32 v120,v120 clamp
v_max_f32 v112,0,v112
v_exp_f32 v121,v121 clamp
v_max_f32 v113,0,v113
v_exp_f32 v122,v122 clamp
v_max_f32 v114,0,v114
v_exp_f32 v123,v123 clamp
v_max_f32 v115,0,v115
pa v[116:117],v[116:117],v[108:109]
pa v[118:119],v[118:119],v[110:111]
pa v[120:121],v[120:121],v[112:113]
pa v[122:123],v[122:123],v[114:115]
pa v[116:117],v[116:117],s[80:81] op_sel:[0,1]
pa v[118:119],v[118:119],s[80:81] op_sel:[0,1]
pa v[120:121],v[120:121],s[80:81] op_sel:[0,1]
pa v[122:123],v[122:123],s[80:81] op_sel:[0,1]
cv v96,v116,v117
cv v97,v118,v119
cv v98,v120,v121
cv v99,v122,v123
ar v108,a72
ar v109,a73
ar v110,a74
ar v111,a75
ar v112,a104
ar v113,a105
ar v114,a106
ar v115,a107
cv v100,v108,v109
cv v101,v110,v111
cv v102,v112,v113
cv v103,v114,v115
ar v108,a76
ar v109,a77
ar v110,a78
ar v111,a79
ar v112,a108
ar v113,a109
ar v114,a110
ar v115,a111
cv v104,v108,v109
cv v105,v110,v111
cv v106,v112,v113
cv v107,v114,v115
mm v[84:87],v[92:95],v[64:67],v[84:87]
mm v[88:91],v[96:99],v[64:67],v[88:91]
mm v[68:71],v[92:95],v[100:103],v[68:71]
mm v[72:75],v[96:99],v[100:103],v[72:75]
mm v[76:79],v[92:95],v[104:107],v[76:79]
mm v[80:83],v[96:99],v[104:107],v[80:83]
ar v108,a128
ar v109,a129
ar v110,a130
ar v111,a131
ar v112,a160
ar v113,a161
ar v114,a162
ar v115,a163
pm v[116:117],v[108:109],s[80:81] op_sel_hi:[1,0]
pm v[118:119],v[110:111],s[80:81] op_sel_hi:[1,0]
pm v[120:121],v[112:113],s[80:81] op_sel_hi:[1,0]
pm v[122:123],v[114:115],s[80:81] op_sel_hi:[1,0]
v_exp_f32 v116,v116 clamp
v_max_f32 v108,0,v108
v_exp_f32 v117,v117 clamp
v_max_f32 v109,0,v109
v_exp_f32 v118,v118 clamp
v_max_f32 v110,0,v110
v_exp_f32 v119,v119 clamp
v_max_f32 v111,0,v111
v_exp_f32 v120,v120 clamp
v_max_f32 v112,0,v112
v_exp_f32 v121,v121 clamp
v_max_f32 v113,0,v113
v_exp_f32 v122,v122 clamp
v_max_f32 v114,0,v114
v_exp_f32 v123,v123 clamp
v_max_f32 v115,0,v115
pa v[116:117],v[116:117],v[108:109]
pa v[118:119],v[118:119],v[110:111]
pa v[120:121],v[120:121],v[112:113]
pa v[122:123],v[122:123],v[114:115]
pa v[116:117],v[116:117],s[80:81] op_sel:[0,1]
pa v[118:119],v[118:119],s[80:81] op_sel:[0,1]
pa v[120:121],v[120:121],s[80:81] op_sel:[0,1]
pa v[122:123],v[122:123],s[80:81] op_sel:[0,1]
cv v92,v116,v117
cv v93,v118,v119
cv v94,v120,v121
cv v95,v122,v123
ar v108,a132
ar v109,a133
ar v110,a134
ar v111,a135
ar v112,a164
ar v113,a165
ar v114,a166
ar v115,a167
pm v[116:117],v[108:109],s[80:81] op_sel_hi:[1,0]
pm v[118:119],v[110:111],s[80:81] op_sel_hi:[1,0]
pm v[120:121],v[112:113],s[80:81] op_sel_hi:[1,0]
pm v[122:123],v[114:115],s[80:81] op_sel_hi:[1,0]
v_exp_f32 v116,v116 clamp
v_max_f32 v108,0,v108
v_exp_f32 v117,v117 clamp
v_max_f32 v109,0,v109
v_exp_f32 v118,v118 clamp
v_max_f32 v110,0,v110
v_exp_f32 v119,v119 clamp
v_max_f32 v111,0,v111
v_exp_f32 v120,v120 clamp
v_max_f32 v112,0,v112
v_exp_f32 v121,v121 clamp
v_max_f32 v113,0,v113
v_exp_f32 v122,v122 clamp
v_max_f32 v114,0,v114
v_exp_f32 v123,v123 clamp
v_max_f32 v115,0,v115
pa v[116:117],v[116:117],v[108:109]
pa v[118:119],v[118:119],v[110:111]
pa v[120:121],v[120:121],v[112:113]
pa v[122:123],v[122:123],v[114:115]
pa v[116:117],v[116:117],s[80:81] op_sel:[0,1]
pa v[118:119],v[118:119],s[80:81] op_sel:[0,1]
pa v[120:121],v[120:121],s[80:81] op_sel:[0,1]
pa v[122:123],v[122:123],s[80:81] op_sel:[0,1]
cv v96,v116,v117
cv v97,v118,v119
cv v98,v120,v121
cv v99,v122,v123
ar v108,a136
ar v109,a137
ar v110,a138
ar v111,a139
ar v112,a168
ar v113,a169
ar v114,a170
ar v115,a171
cv v100,v108,v109
cv v101,v110,v111
cv v102,v112,v113
cv v103,v114,v115
ar v108,a140
ar v109,a141
ar v110,a142
ar v111,a143
ar v112,a172
ar v113,a173
ar v114,a174
ar v115,a175
cv v104,v108,v109
cv v105,v110,v111
cv v106,v112,v113
cv v107,v114,v115
mm v[84:87],v[92:95],v[64:67],v[84:87]
mm v[88:91],v[96:99],v[64:67],v[88:91]
mm v[68:71],v[92:95],v[100:103],v[68:71]
mm v[72:75],v[96:99],v[100:103],v[72:75]
mm v[76:79],v[92:95],v[104:107],v[76:79]
mm v[80:83],v[96:99],v[104:107],v[80:83]
ar v108,a192
ar v109,a193
ar v110,a194
ar v111,a195
ar v112,a224
ar v113,a225
ar v114,a226
ar v115,a227
pm v[116:117],v[108:109],s[80:81] op_sel_hi:[1,0]
pm v[118:119],v[110:111],s[80:81] op_sel_hi:[1,0]
pm v[120:121],v[112:113],s[80:81] op_sel_hi:[1,0]
pm v[122:123],v[114:115],s[80:81] op_sel_hi:[1,0]
v_exp_f32 v116,v116 clamp
v_max_f32 v108,0,v108
v_exp_f32 v117,v117 clamp
v_max_f32 v109,0,v109
v_exp_f32 v118,v118 clamp
v_max_f32 v110,0,v110
v_exp_f32 v119,v119 clamp
v_max_f32 v111,0,v111
v_exp_f32 v120,v120 clamp
v_max_f32 v112,0,v112
v_exp_f32 v121,v121 clamp
v_max_f32 v113,0,v113
v_exp_f32 v122,v122 clamp
v_max_f32 v114,0,v114
v_exp_f32 v123,v123 clamp
v_max_f32 v115,0,v115
pa v[116:117],v[116:117],v[108:109]
pa v[118:119],v[118:119],v[110:111]
pa v[120:121],v[120:121],v[112:113]
pa v[122:123],v[122:123],v[114:115]
pa v[116:117],v[116:117],s[80:81] op_sel:[0,1]
pa v[118:119],v[118:119],s[80:81] op_sel:[0,1]
pa v[120:121],v[120:121],s[80:81] op_sel:[0,1]
pa v[122:123],v[122:123],s[80:81] op_sel:[0,1]
cv v92,v116,v117
cv v93,v118,v119
cv v94,v120,v121
cv v95,v122,v123
ar v108,a196
ar v109,a197
ar v110,a198
ar v111,a199
ar v112,a228
ar v113,a229
ar v114,a230
ar v115,a231
pm v[116:117],v[108:109],s[80:81] op_sel_hi:[1,0]
pm v[118:119],v[110:111],s[80:81] op_sel_hi:[1,0]
pm v[120:121],v[112:113],s[80:81] op_sel_hi:[1,0]
pm v[122:123],v[114:115],s[80:81] op_sel_hi:[1,0]
v_exp_f32 v116,v116 clamp
v_max_f32 v108,0,v108
v_exp_f32 v117,v117 clamp
v_max_f32 v109,0,v109
v_exp_f32 v118,v118 clamp
v_max_f32 v110,0,v110
v_exp_f32 v119,v119 clamp
v_max_f32 v111,0,v111
v_exp_f32 v120,v120 clamp
v_max_f32 v112,0,v112
v_exp_f32 v121,v121 clamp
v_max_f32 v113,0,v113
v_exp_f32 v122,v122 clamp
v_max_f32 v114,0,v114
v_exp_f32 v123,v123 clamp
v_max_f32 v115,0,v115
pa v[116:117],v[116:117],v[108:109]
pa v[118:119],v[118:119],v[110:111]
pa v[120:121],v[120:121],v[112:113]
pa v[122:123],v[122:123],v[114:115]
pa v[116:117],v[116:117],s[80:81] op_sel:[0,1]
pa v[118:119],v[118:119],s[80:81] op_sel:[0,1]
pa v[120:121],v[120:121],s[80:81] op_sel:[0,1]
pa v[122:123],v[122:123],s[80:81] op_sel:[0,1]
cv v96,v116,v117
cv v97,v118,v119
cv v98,v120,v121
cv v99,v122,v123
ar v108,a200
ar v109,a201
ar v110,a202
ar v111,a203
ar v112,a232
ar v113,a233
ar v114,a234
ar v115,a235
cv v100,v108,v109
cv v101,v110,v111
cv v102,v112,v113
cv v103,v114,v115
ar v108,a204
ar v109,a205
ar v110,a206
ar v111,a207
ar v112,a236
ar v113,a237
ar v114,a238
ar v115,a239
cv v104,v108,v109
cv v105,v110,v111
cv v106,v112,v113
cv v107,v114,v115
mm v[84:87],v[92:95],v[64:67],v[84:87]
mm v[88:91],v[96:99],v[64:67],v[88:91]
mm v[68:71],v[92:95],v[100:103],v[68:71]
mm v[72:75],v[96:99],v[100:103],v[72:75]
mm v[76:79],v[92:95],v[104:107],v[76:79]
mm v[80:83],v[96:99],v[104:107],v[80:83]
s_add_u32 s49,s48,4096
w4 v[84:87],v30,s[8:11],s49 offen sc1
s_add_u32 s49,s48,4096
w4 v[88:91],v30,s[8:11],s49 offen offset:1024 sc1
s_add_u32 s49,s48,0
w4 v[68:71],v30,s[8:11],s49 offen sc1
s_add_u32 s49,s48,0
w4 v[72:75],v30,s[8:11],s49 offen offset:1024 sc1
s_add_u32 s49,s48,0
w4 v[76:79],v30,s[8:11],s49 offen offset:2048 sc1
s_add_u32 s49,s48,0
w4 v[80:83],v30,s[8:11],s49 offen offset:3072 sc1
ar v108,a16
ar v109,a17
ar v110,a18
ar v111,a19
ar v112,a48
ar v113,a49
ar v114,a50
ar v115,a51
pm v[116:117],v[108:109],s[80:81] op_sel_hi:[1,0]
pm v[118:119],v[110:111],s[80:81] op_sel_hi:[1,0]
pm v[120:121],v[112:113],s[80:81] op_sel_hi:[1,0]
pm v[122:123],v[114:115],s[80:81] op_sel_hi:[1,0]
v_exp_f32 v116,v116 clamp
v_max_f32 v108,0,v108
v_exp_f32 v117,v117 clamp
v_max_f32 v109,0,v109
v_exp_f32 v118,v118 clamp
v_max_f32 v110,0,v110
v_exp_f32 v119,v119 clamp
v_max_f32 v111,0,v111
v_exp_f32 v120,v120 clamp
v_max_f32 v112,0,v112
v_exp_f32 v121,v121 clamp
v_max_f32 v113,0,v113
v_exp_f32 v122,v122 clamp
v_max_f32 v114,0,v114
v_exp_f32 v123,v123 clamp
v_max_f32 v115,0,v115
pa v[116:117],v[116:117],v[108:109]
pa v[118:119],v[118:119],v[110:111]
pa v[120:121],v[120:121],v[112:113]
pa v[122:123],v[122:123],v[114:115]
pa v[116:117],v[116:117],s[80:81] op_sel:[0,1]
pa v[118:119],v[118:119],s[80:81] op_sel:[0,1]
pa v[120:121],v[120:121],s[80:81] op_sel:[0,1]
pa v[122:123],v[122:123],s[80:81] op_sel:[0,1]
cv v92,v116,v117
cv v93,v118,v119
cv v94,v120,v121
cv v95,v122,v123
ar v108,a20
ar v109,a21
ar v110,a22
ar v111,a23
ar v112,a52
ar v113,a53
ar v114,a54
ar v115,a55
pm v[116:117],v[108:109],s[80:81] op_sel_hi:[1,0]
pm v[118:119],v[110:111],s[80:81] op_sel_hi:[1,0]
pm v[120:121],v[112:113],s[80:81] op_sel_hi:[1,0]
pm v[122:123],v[114:115],s[80:81] op_sel_hi:[1,0]
v_exp_f32 v116,v116 clamp
v_max_f32 v108,0,v108
v_exp_f32 v117,v117 clamp
v_max_f32 v109,0,v109
v_exp_f32 v118,v118 clamp
v_max_f32 v110,0,v110
v_exp_f32 v119,v119 clamp
v_max_f32 v111,0,v111
v_exp_f32 v120,v120 clamp
v_max_f32 v112,0,v112
v_exp_f32 v121,v121 clamp
v_max_f32 v113,0,v113
v_exp_f32 v122,v122 clamp
v_max_f32 v114,0,v114
v_exp_f32 v123,v123 clamp
v_max_f32 v115,0,v115
pa v[116:117],v[116:117],v[108:109]
pa v[118:119],v[118:119],v[110:111]
pa v[120:121],v[120:121],v[112:113]
pa v[122:123],v[122:123],v[114:115]
pa v[116:117],v[116:117],s[80:81] op_sel:[0,1]
pa v[118:119],v[118:119],s[80:81] op_sel:[0,1]
pa v[120:121],v[120:121],s[80:81] op_sel:[0,1]
pa v[122:123],v[122:123],s[80:81] op_sel:[0,1]
cv v96,v116,v117
cv v97,v118,v119
cv v98,v120,v121
cv v99,v122,v123
ar v108,a24
ar v109,a25
ar v110,a26
ar v111,a27
ar v112,a56
ar v113,a57
ar v114,a58
ar v115,a59
cv v100,v108,v109
cv v101,v110,v111
cv v102,v112,v113
cv v103,v114,v115
ar v108,a28
ar v109,a29
ar v110,a30
ar v111,a31
ar v112,a60
ar v113,a61
ar v114,a62
ar v115,a63
cv v104,v108,v109
cv v105,v110,v111
cv v106,v112,v113
cv v107,v114,v115
mm v[84:87],v[92:95],v[64:67],0
mm v[88:91],v[96:99],v[64:67],0
mm v[68:71],v[92:95],v[100:103],0
mm v[72:75],v[96:99],v[100:103],0
mm v[76:79],v[92:95],v[104:107],0
mm v[80:83],v[96:99],v[104:107],0
ar v108,a80
ar v109,a81
ar v110,a82
ar v111,a83
ar v112,a112
ar v113,a113
ar v114,a114
ar v115,a115
pm v[116:117],v[108:109],s[80:81] op_sel_hi:[1,0]
pm v[118:119],v[110:111],s[80:81] op_sel_hi:[1,0]
pm v[120:121],v[112:113],s[80:81] op_sel_hi:[1,0]
pm v[122:123],v[114:115],s[80:81] op_sel_hi:[1,0]
v_exp_f32 v116,v116 clamp
v_max_f32 v108,0,v108
v_exp_f32 v117,v117 clamp
v_max_f32 v109,0,v109
v_exp_f32 v118,v118 clamp
v_max_f32 v110,0,v110
v_exp_f32 v119,v119 clamp
v_max_f32 v111,0,v111
v_exp_f32 v120,v120 clamp
v_max_f32 v112,0,v112
v_exp_f32 v121,v121 clamp
v_max_f32 v113,0,v113
v_exp_f32 v122,v122 clamp
v_max_f32 v114,0,v114
v_exp_f32 v123,v123 clamp
v_max_f32 v115,0,v115
pa v[116:117],v[116:117],v[108:109]
pa v[118:119],v[118:119],v[110:111]
pa v[120:121],v[120:121],v[112:113]
pa v[122:123],v[122:123],v[114:115]
pa v[116:117],v[116:117],s[80:81] op_sel:[0,1]
pa v[118:119],v[118:119],s[80:81] op_sel:[0,1]
pa v[120:121],v[120:121],s[80:81] op_sel:[0,1]
pa v[122:123],v[122:123],s[80:81] op_sel:[0,1]
cv v92,v116,v117
cv v93,v118,v119
cv v94,v120,v121
cv v95,v122,v123
ar v108,a84
ar v109,a85
ar v110,a86
ar v111,a87
ar v112,a116
ar v113,a117
ar v114,a118
ar v115,a119
pm v[116:117],v[108:109],s[80:81] op_sel_hi:[1,0]
pm v[118:119],v[110:111],s[80:81] op_sel_hi:[1,0]
pm v[120:121],v[112:113],s[80:81] op_sel_hi:[1,0]
pm v[122:123],v[114:115],s[80:81] op_sel_hi:[1,0]
v_exp_f32 v116,v116 clamp
v_max_f32 v108,0,v108
v_exp_f32 v117,v117 clamp
v_max_f32 v109,0,v109
v_exp_f32 v118,v118 clamp
v_max_f32 v110,0,v110
v_exp_f32 v119,v119 clamp
v_max_f32 v111,0,v111
v_exp_f32 v120,v120 clamp
v_max_f32 v112,0,v112
v_exp_f32 v121,v121 clamp
v_max_f32 v113,0,v113
v_exp_f32 v122,v122 clamp
v_max_f32 v114,0,v114
v_exp_f32 v123,v123 clamp
v_max_f32 v115,0,v115
pa v[116:117],v[116:117],v[108:109]
pa v[118:119],v[118:119],v[110:111]
pa v[120:121],v[120:121],v[112:113]
pa v[122:123],v[122:123],v[114:115]
pa v[116:117],v[116:117],s[80:81] op_sel:[0,1]
pa v[118:119],v[118:119],s[80:81] op_sel:[0,1]
pa v[120:121],v[120:121],s[80:81] op_sel:[0,1]
pa v[122:123],v[122:123],s[80:81] op_sel:[0,1]
cv v96,v116,v117
cv v97,v118,v119
cv v98,v120,v121
cv v99,v122,v123
ar v108,a88
ar v109,a89
ar v110,a90
ar v111,a91
ar v112,a120
ar v113,a121
ar v114,a122
ar v115,a123
cv v100,v108,v109
cv v101,v110,v111
cv v102,v112,v113
cv v103,v114,v115
ar v108,a92
ar v109,a93
ar v110,a94
ar v111,a95
ar v112,a124
ar v113,a125
ar v114,a126
ar v115,a127
cv v104,v108,v109
cv v105,v110,v111
cv v106,v112,v113
cv v107,v114,v115
mm v[84:87],v[92:95],v[64:67],v[84:87]
mm v[88:91],v[96:99],v[64:67],v[88:91]
mm v[68:71],v[92:95],v[100:103],v[68:71]
mm v[72:75],v[96:99],v[100:103],v[72:75]
mm v[76:79],v[92:95],v[104:107],v[76:79]
mm v[80:83],v[96:99],v[104:107],v[80:83]
ar v108,a144
ar v109,a145
ar v110,a146
ar v111,a147
ar v112,a176
ar v113,a177
ar v114,a178
ar v115,a179
pm v[116:117],v[108:109],s[80:81] op_sel_hi:[1,0]
pm v[118:119],v[110:111],s[80:81] op_sel_hi:[1,0]
pm v[120:121],v[112:113],s[80:81] op_sel_hi:[1,0]
pm v[122:123],v[114:115],s[80:81] op_sel_hi:[1,0]
v_exp_f32 v116,v116 clamp
v_max_f32 v108,0,v108
v_exp_f32 v117,v117 clamp
v_max_f32 v109,0,v109
v_exp_f32 v118,v118 clamp
v_max_f32 v110,0,v110
v_exp_f32 v119,v119 clamp
v_max_f32 v111,0,v111
v_exp_f32 v120,v120 clamp
v_max_f32 v112,0,v112
v_exp_f32 v121,v121 clamp
v_max_f32 v113,0,v113
v_exp_f32 v122,v122 clamp
v_max_f32 v114,0,v114
v_exp_f32 v123,v123 clamp
v_max_f32 v115,0,v115
pa v[116:117],v[116:117],v[108:109]
pa v[118:119],v[118:119],v[110:111]
pa v[120:121],v[120:121],v[112:113]
pa v[122:123],v[122:123],v[114:115]
pa v[116:117],v[116:117],s[80:81] op_sel:[0,1]
pa v[118:119],v[118:119],s[80:81] op_sel:[0,1]
pa v[120:121],v[120:121],s[80:81] op_sel:[0,1]
pa v[122:123],v[122:123],s[80:81] op_sel:[0,1]
cv v92,v116,v117
cv v93,v118,v119
cv v94,v120,v121
cv v95,v122,v123
ar v108,a148
ar v109,a149
ar v110,a150
ar v111,a151
ar v112,a180
ar v113,a181
ar v114,a182
ar v115,a183
pm v[116:117],v[108:109],s[80:81] op_sel_hi:[1,0]
pm v[118:119],v[110:111],s[80:81] op_sel_hi:[1,0]
pm v[120:121],v[112:113],s[80:81] op_sel_hi:[1,0]
pm v[122:123],v[114:115],s[80:81] op_sel_hi:[1,0]
v_exp_f32 v116,v116 clamp
v_max_f32 v108,0,v108
v_exp_f32 v117,v117 clamp
v_max_f32 v109,0,v109
v_exp_f32 v118,v118 clamp
v_max_f32 v110,0,v110
v_exp_f32 v119,v119 clamp
v_max_f32 v111,0,v111
v_exp_f32 v120,v120 clamp
v_max_f32 v112,0,v112
v_exp_f32 v121,v121 clamp
v_max_f32 v113,0,v113
v_exp_f32 v122,v122 clamp
v_max_f32 v114,0,v114
v_exp_f32 v123,v123 clamp
v_max_f32 v115,0,v115
pa v[116:117],v[116:117],v[108:109]
pa v[118:119],v[118:119],v[110:111]
pa v[120:121],v[120:121],v[112:113]
pa v[122:123],v[122:123],v[114:115]
pa v[116:117],v[116:117],s[80:81] op_sel:[0,1]
pa v[118:119],v[118:119],s[80:81] op_sel:[0,1]
pa v[120:121],v[120:121],s[80:81] op_sel:[0,1]
pa v[122:123],v[122:123],s[80:81] op_sel:[0,1]
cv v96,v116,v117
cv v97,v118,v119
cv v98,v120,v121
cv v99,v122,v123
ar v108,a152
ar v109,a153
ar v110,a154
ar v111,a155
ar v112,a184
ar v113,a185
ar v114,a186
ar v115,a187
cv v100,v108,v109
cv v101,v110,v111
cv v102,v112,v113
cv v103,v114,v115
ar v108,a156
ar v109,a157
ar v110,a158
ar v111,a159
ar v112,a188
ar v113,a189
ar v114,a190
ar v115,a191
cv v104,v108,v109
cv v105,v110,v111
cv v106,v112,v113
cv v107,v114,v115
mm v[84:87],v[92:95],v[64:67],v[84:87]
mm v[88:91],v[96:99],v[64:67],v[88:91]
mm v[68:71],v[92:95],v[100:103],v[68:71]
mm v[72:75],v[96:99],v[100:103],v[72:75]
mm v[76:79],v[92:95],v[104:107],v[76:79]
mm v[80:83],v[96:99],v[104:107],v[80:83]
ar v108,a208
ar v109,a209
ar v110,a210
ar v111,a211
ar v112,a240
ar v113,a241
ar v114,a242
ar v115,a243
pm v[116:117],v[108:109],s[80:81] op_sel_hi:[1,0]
pm v[118:119],v[110:111],s[80:81] op_sel_hi:[1,0]
pm v[120:121],v[112:113],s[80:81] op_sel_hi:[1,0]
pm v[122:123],v[114:115],s[80:81] op_sel_hi:[1,0]
v_exp_f32 v116,v116 clamp
v_max_f32 v108,0,v108
v_exp_f32 v117,v117 clamp
v_max_f32 v109,0,v109
v_exp_f32 v118,v118 clamp
v_max_f32 v110,0,v110
v_exp_f32 v119,v119 clamp
v_max_f32 v111,0,v111
v_exp_f32 v120,v120 clamp
v_max_f32 v112,0,v112
v_exp_f32 v121,v121 clamp
v_max_f32 v113,0,v113
v_exp_f32 v122,v122 clamp
v_max_f32 v114,0,v114
v_exp_f32 v123,v123 clamp
v_max_f32 v115,0,v115
pa v[116:117],v[116:117],v[108:109]
pa v[118:119],v[118:119],v[110:111]
pa v[120:121],v[120:121],v[112:113]
pa v[122:123],v[122:123],v[114:115]
pa v[116:117],v[116:117],s[80:81] op_sel:[0,1]
pa v[118:119],v[118:119],s[80:81] op_sel:[0,1]
pa v[120:121],v[120:121],s[80:81] op_sel:[0,1]
pa v[122:123],v[122:123],s[80:81] op_sel:[0,1]
cv v92,v116,v117
cv v93,v118,v119
cv v94,v120,v121
cv v95,v122,v123
ar v108,a212
ar v109,a213
ar v110,a214
ar v111,a215
ar v112,a244
ar v113,a245
ar v114,a246
ar v115,a247
pm v[116:117],v[108:109],s[80:81] op_sel_hi:[1,0]
pm v[118:119],v[110:111],s[80:81] op_sel_hi:[1,0]
pm v[120:121],v[112:113],s[80:81] op_sel_hi:[1,0]
pm v[122:123],v[114:115],s[80:81] op_sel_hi:[1,0]
v_exp_f32 v116,v116 clamp
v_max_f32 v108,0,v108
v_exp_f32 v117,v117 clamp
v_max_f32 v109,0,v109
v_exp_f32 v118,v118 clamp
v_max_f32 v110,0,v110
v_exp_f32 v119,v119 clamp
v_max_f32 v111,0,v111
v_exp_f32 v120,v120 clamp
v_max_f32 v112,0,v112
v_exp_f32 v121,v121 clamp
v_max_f32 v113,0,v113
v_exp_f32 v122,v122 clamp
v_max_f32 v114,0,v114
v_exp_f32 v123,v123 clamp
v_max_f32 v115,0,v115
pa v[116:117],v[116:117],v[108:109]
pa v[118:119],v[118:119],v[110:111]
pa v[120:121],v[120:121],v[112:113]
pa v[122:123],v[122:123],v[114:115]
pa v[116:117],v[116:117],s[80:81] op_sel:[0,1]
pa v[118:119],v[118:119],s[80:81] op_sel:[0,1]
pa v[120:121],v[120:121],s[80:81] op_sel:[0,1]
pa v[122:123],v[122:123],s[80:81] op_sel:[0,1]
cv v96,v116,v117
cv v97,v118,v119
cv v98,v120,v121
cv v99,v122,v123
ar v108,a216
ar v109,a217
ar v110,a218
ar v111,a219
ar v112,a248
ar v113,a249
ar v114,a250
ar v115,a251
cv v100,v108,v109
cv v101,v110,v111
cv v102,v112,v113
cv v103,v114,v115
ar v108,a220
ar v109,a221
ar v110,a222
ar v111,a223
ar v112,a252
ar v113,a253
ar v114,a254
ar v115,a255
cv v104,v108,v109
cv v105,v110,v111
cv v106,v112,v113
cv v107,v114,v115
mm v[84:87],v[92:95],v[64:67],v[84:87]
mm v[88:91],v[96:99],v[64:67],v[88:91]
mm v[68:71],v[92:95],v[100:103],v[68:71]
mm v[72:75],v[96:99],v[100:103],v[72:75]
mm v[76:79],v[92:95],v[104:107],v[76:79]
mm v[80:83],v[96:99],v[104:107],v[80:83]
s_add_u32 s49,s48,8192
w4 v[84:87],v30,s[8:11],s49 offen offset:2048 sc1
s_add_u32 s49,s48,8192
w4 v[88:91],v30,s[8:11],s49 offen offset:3072 sc1
s_add_u32 s49,s48,4096
w4 v[68:71],v30,s[8:11],s49 offen offset:2048 sc1
s_add_u32 s49,s48,4096
w4 v[72:75],v30,s[8:11],s49 offen offset:3072 sc1
s_add_u32 s49,s48,8192
w4 v[76:79],v30,s[8:11],s49 offen sc1
s_add_u32 s49,s48,8192
w4 v[80:83],v30,s[8:11],s49 offen offset:1024 sc1
v_mov_b32 v44,0
wt vmcnt(0)
s_barrier
s_cmp_eq_u32 s14,0
s_cbranch_scc0 G_bkv_s
v_mul_u32_u24 v30,0,v1
v_mov_b32 v31,1
s_mov_b64 exec,1
buffer_atomic_add v31,v30,s[8:11],s96 offen sc1
s_mov_b64 exec,-1
G_bkv_s:
s_branch G_have
GKV_fused:
ar v192,a0
ar v193,a1
ar v194,a2
ar v195,a3
ar v196,a4
ar v197,a5
ar v198,a6
ar v199,a7
mm a[0:3],v[64:67],v[96:99],0
cv v200,v192,v193
cv v201,v194,v195
mm a[4:7],v[64:67],v[100:103],0
cv v202,v196,v197
cv v203,v198,v199
w4 v[200:203],v28,s[8:11],s79 offen sc1
dt v[160:161],v20 offset:16384
ar v204,a8
ar v205,a9
ar v206,a10
ar v207,a11
ar v208,a12
ar v209,a13
ar v210,a14
ar v211,a15
mm a[8:11],v[64:67],v[104:107],0
cv v212,v204,v205
cv v213,v206,v207
mm a[12:15],v[64:67],v[108:111],0
cv v214,v208,v209
cv v215,v210,v211
w4 v[212:215],v28,s[8:11],s79 offen offset:2048 sc1
dt v[162:163],v20 offset:18432
ar v216,a16
ar v217,a17
ar v218,a18
ar v219,a19
ar v220,a20
ar v221,a21
ar v222,a22
ar v223,a23
mm a[16:19],v[64:67],v[112:115],0
cv v224,v216,v217
cv v225,v218,v219
mm a[20:23],v[64:67],v[116:119],0
cv v226,v220,v221
cv v227,v222,v223
s_add_u32 s79,s79,4096
w4 v[224:227],v28,s[8:11],s79 offen sc1
dr v[128:131],v19 offset:0
ar v228,a24
ar v229,a25
ar v230,a26
ar v231,a27
ar v232,a28
ar v233,a29
ar v234,a30
ar v235,a31
mm a[24:27],v[64:67],v[120:123],0
cv v236,v228,v229
cv v237,v230,v231
mm a[28:31],v[64:67],v[124:127],0
cv v238,v232,v233
cv v239,v234,v235
w4 v[236:239],v28,s[8:11],s79 offen offset:2048 sc1
dt v[164:165],v21 offset:16384
s_add_u32 s79,s79,-4096
ar v192,a32
ar v193,a33
ar v194,a34
ar v195,a35
ar v196,a36
ar v197,a37
ar v198,a38
ar v199,a39
mm a[32:35],v[68:71],v[96:99],0
cv v200,v192,v193
cv v201,v194,v195
mm a[36:39],v[68:71],v[100:103],0
cv v202,v196,v197
cv v203,v198,v199
w4 v[200:203],v28,s[8:11],s79 offen offset:256 sc1
dt v[166:167],v21 offset:18432
ar v204,a40
ar v205,a41
ar v206,a42
ar v207,a43
ar v208,a44
ar v209,a45
ar v210,a46
ar v211,a47
mm a[40:43],v[68:71],v[104:107],0
cv v212,v204,v205
cv v213,v206,v207
mm a[44:47],v[68:71],v[108:111],0
cv v214,v208,v209
cv v215,v210,v211
w4 v[212:215],v28,s[8:11],s79 offen offset:2304 sc1
dr v[132:135],v19 offset:2048
ar v216,a48
ar v217,a49
ar v218,a50
ar v219,a51
ar v220,a52
ar v221,a53
ar v222,a54
ar v223,a55
mm a[48:51],v[68:71],v[112:115],0
cv v224,v216,v217
cv v225,v218,v219
mm a[52:55],v[68:71],v[116:119],0
cv v226,v220,v221
cv v227,v222,v223
s_add_u32 s79,s79,4096
w4 v[224:227],v28,s[8:11],s79 offen offset:256 sc1
dt v[168:169],v22 offset:16384
ar v228,a56
ar v229,a57
ar v230,a58
ar v231,a59
ar v232,a60
ar v233,a61
ar v234,a62
ar v235,a63
mm a[56:59],v[68:71],v[120:123],0
cv v236,v228,v229
cv v237,v230,v231
mm a[60:63],v[68:71],v[124:127],0
cv v238,v232,v233
cv v239,v234,v235
w4 v[236:239],v28,s[8:11],s79 offen offset:2304 sc1
dt v[170:171],v22 offset:18432
s_add_u32 s79,s79,520192
ar v192,a64
ar v193,a65
ar v194,a66
ar v195,a67
ar v196,a68
ar v197,a69
ar v198,a70
ar v199,a71
mm a[64:67],v[72:75],v[96:99],0
cv v200,v192,v193
cv v201,v194,v195
mm a[68:71],v[72:75],v[100:103],0
cv v202,v196,v197
cv v203,v198,v199
w4 v[200:203],v28,s[8:11],s79 offen sc1
dr v[136:139],v19 offset:4096
ar v204,a72
ar v205,a73
ar v206,a74
ar v207,a75
ar v208,a76
ar v209,a77
ar v210,a78
ar v211,a79
mm a[72:75],v[72:75],v[104:107],0
cv v212,v204,v205
cv v213,v206,v207
mm a[76:79],v[72:75],v[108:111],0
cv v214,v208,v209
cv v215,v210,v211
w4 v[212:215],v28,s[8:11],s79 offen offset:2048 sc1
dt v[172:173],v23 offset:16384
ar v216,a80
ar v217,a81
ar v218,a82
ar v219,a83
ar v220,a84
ar v221,a85
ar v222,a86
ar v223,a87
mm a[80:83],v[72:75],v[112:115],0
cv v224,v216,v217
cv v225,v218,v219
mm a[84:87],v[72:75],v[116:119],0
cv v226,v220,v221
cv v227,v222,v223
s_add_u32 s79,s79,4096
w4 v[224:227],v28,s[8:11],s79 offen sc1
dt v[174:175],v23 offset:18432
ar v228,a88
ar v229,a89
ar v230,a90
ar v231,a91
ar v232,a92
ar v233,a93
ar v234,a94
ar v235,a95
mm a[88:91],v[72:75],v[120:123],0
cv v236,v228,v229
cv v237,v230,v231
mm a[92:95],v[72:75],v[124:127],0
cv v238,v232,v233
cv v239,v234,v235
w4 v[236:239],v28,s[8:11],s79 offen offset:2048 sc1
dr v[140:143],v19 offset:6144
s_add_u32 s79,s79,-4096
ar v192,a96
ar v193,a97
ar v194,a98
ar v195,a99
ar v196,a100
ar v197,a101
ar v198,a102
ar v199,a103
mm a[96:99],v[76:79],v[96:99],0
cv v200,v192,v193
cv v201,v194,v195
mm a[100:103],v[76:79],v[100:103],0
cv v202,v196,v197
cv v203,v198,v199
w4 v[200:203],v28,s[8:11],s79 offen offset:256 sc1
dt v[176:177],v24 offset:16384
ar v204,a104
ar v205,a105
ar v206,a106
ar v207,a107
ar v208,a108
ar v209,a109
ar v210,a110
ar v211,a111
mm a[104:107],v[76:79],v[104:107],0
cv v212,v204,v205
cv v213,v206,v207
mm a[108:111],v[76:79],v[108:111],0
cv v214,v208,v209
cv v215,v210,v211
w4 v[212:215],v28,s[8:11],s79 offen offset:2304 sc1
dt v[178:179],v24 offset:18432
ar v216,a112
ar v217,a113
ar v218,a114
ar v219,a115
ar v220,a116
ar v221,a117
ar v222,a118
ar v223,a119
mm a[112:115],v[76:79],v[112:115],0
cv v224,v216,v217
cv v225,v218,v219
mm a[116:119],v[76:79],v[116:119],0
cv v226,v220,v221
cv v227,v222,v223
s_add_u32 s79,s79,4096
w4 v[224:227],v28,s[8:11],s79 offen offset:256 sc1
dr v[144:147],v19 offset:8192
ar v228,a120
ar v229,a121
ar v230,a122
ar v231,a123
ar v232,a124
ar v233,a125
ar v234,a126
ar v235,a127
mm a[120:123],v[76:79],v[120:123],0
cv v236,v228,v229
cv v237,v230,v231
mm a[124:127],v[76:79],v[124:127],0
cv v238,v232,v233
cv v239,v234,v235
w4 v[236:239],v28,s[8:11],s79 offen offset:2304 sc1
dt v[180:181],v25 offset:16384
s_add_u32 s79,s79,520192
ar v192,a128
ar v193,a129
ar v194,a130
ar v195,a131
ar v196,a132
ar v197,a133
ar v198,a134
ar v199,a135
mm a[128:131],v[80:83],v[96:99],0
cv v200,v192,v193
cv v201,v194,v195
mm a[132:135],v[80:83],v[100:103],0
cv v202,v196,v197
cv v203,v198,v199
w4 v[200:203],v28,s[8:11],s79 offen sc1
dt v[182:183],v25 offset:18432
ar v204,a136
ar v205,a137
ar v206,a138
ar v207,a139
ar v208,a140
ar v209,a141
ar v210,a142
ar v211,a143
mm a[136:139],v[80:83],v[104:107],0
cv v212,v204,v205
cv v213,v206,v207
mm a[140:143],v[80:83],v[108:111],0
cv v214,v208,v209
cv v215,v210,v211
w4 v[212:215],v28,s[8:11],s79 offen offset:2048 sc1
dr v[148:151],v19 offset:10240
ar v216,a144
ar v217,a145
ar v218,a146
ar v219,a147
ar v220,a148
ar v221,a149
ar v222,a150
ar v223,a151
mm a[144:147],v[80:83],v[112:115],0
cv v224,v216,v217
cv v225,v218,v219
mm a[148:151],v[80:83],v[116:119],0
cv v226,v220,v221
cv v227,v222,v223
s_add_u32 s79,s79,4096
w4 v[224:227],v28,s[8:11],s79 offen sc1
dt v[184:185],v26 offset:16384
ar v228,a152
ar v229,a153
ar v230,a154
ar v231,a155
ar v232,a156
ar v233,a157
ar v234,a158
ar v235,a159
mm a[152:155],v[80:83],v[120:123],0
cv v236,v228,v229
cv v237,v230,v231
mm a[156:159],v[80:83],v[124:127],0
cv v238,v232,v233
cv v239,v234,v235
w4 v[236:239],v28,s[8:11],s79 offen offset:2048 sc1
dt v[186:187],v26 offset:18432
s_add_u32 s79,s79,-4096
ar v192,a160
ar v193,a161
ar v194,a162
ar v195,a163
ar v196,a164
ar v197,a165
ar v198,a166
ar v199,a167
mm a[160:163],v[84:87],v[96:99],0
cv v200,v192,v193
cv v201,v194,v195
mm a[164:167],v[84:87],v[100:103],0
cv v202,v196,v197
cv v203,v198,v199
w4 v[200:203],v28,s[8:11],s79 offen offset:256 sc1
dr v[152:155],v19 offset:12288
ar v204,a168
ar v205,a169
ar v206,a170
ar v207,a171
ar v208,a172
ar v209,a173
ar v210,a174
ar v211,a175
mm a[168:171],v[84:87],v[104:107],0
cv v212,v204,v205
cv v213,v206,v207
mm a[172:175],v[84:87],v[108:111],0
cv v214,v208,v209
cv v215,v210,v211
w4 v[212:215],v28,s[8:11],s79 offen offset:2304 sc1
dt v[188:189],v27 offset:16384
ar v216,a176
ar v217,a177
ar v218,a178
ar v219,a179
ar v220,a180
ar v221,a181
ar v222,a182
ar v223,a183
mm a[176:179],v[84:87],v[112:115],0
cv v224,v216,v217
cv v225,v218,v219
mm a[180:183],v[84:87],v[116:119],0
cv v226,v220,v221
cv v227,v222,v223
s_add_u32 s79,s79,4096
w4 v[224:227],v28,s[8:11],s79 offen offset:256 sc1
dt v[190:191],v27 offset:18432
ar v228,a184
ar v229,a185
ar v230,a186
ar v231,a187
ar v232,a188
ar v233,a189
ar v234,a190
ar v235,a191
mm a[184:187],v[84:87],v[120:123],0
cv v236,v228,v229
cv v237,v230,v231
mm a[188:191],v[84:87],v[124:127],0
cv v238,v232,v233
cv v239,v234,v235
w4 v[236:239],v28,s[8:11],s79 offen offset:2304 sc1
dr v[156:159],v19 offset:14336
s_add_u32 s79,s79,520192
ar v192,a192
ar v193,a193
ar v194,a194
ar v195,a195
ar v196,a196
ar v197,a197
ar v198,a198
ar v199,a199
mm a[192:195],v[88:91],v[96:99],0
cv v200,v192,v193
cv v201,v194,v195
mm a[196:199],v[88:91],v[100:103],0
cv v202,v196,v197
cv v203,v198,v199
w4 v[200:203],v28,s[8:11],s79 offen sc1
ar v204,a200
ar v205,a201
ar v206,a202
ar v207,a203
ar v208,a204
ar v209,a205
ar v210,a206
ar v211,a207
mm a[200:203],v[88:91],v[104:107],0
cv v212,v204,v205
cv v213,v206,v207
mm a[204:207],v[88:91],v[108:111],0
cv v214,v208,v209
cv v215,v210,v211
w4 v[212:215],v28,s[8:11],s79 offen offset:2048 sc1
ar v216,a208
ar v217,a209
ar v218,a210
ar v219,a211
ar v220,a212
ar v221,a213
ar v222,a214
ar v223,a215
mm a[208:211],v[88:91],v[112:115],0
cv v224,v216,v217
cv v225,v218,v219
mm a[212:215],v[88:91],v[116:119],0
cv v226,v220,v221
cv v227,v222,v223
s_add_u32 s79,s79,4096
w4 v[224:227],v28,s[8:11],s79 offen sc1
ar v228,a216
ar v229,a217
ar v230,a218
ar v231,a219
ar v232,a220
ar v233,a221
ar v234,a222
ar v235,a223
mm a[216:219],v[88:91],v[120:123],0
cv v236,v228,v229
cv v237,v230,v231
mm a[220:223],v[88:91],v[124:127],0
cv v238,v232,v233
cv v239,v234,v235
w4 v[236:239],v28,s[8:11],s79 offen offset:2048 sc1
s_add_u32 s79,s79,-4096
ar v192,a224
ar v193,a225
ar v194,a226
ar v195,a227
ar v196,a228
ar v197,a229
ar v198,a230
ar v199,a231
mm a[224:227],v[92:95],v[96:99],0
cv v200,v192,v193
cv v201,v194,v195
mm a[228:231],v[92:95],v[100:103],0
cv v202,v196,v197
cv v203,v198,v199
w4 v[200:203],v28,s[8:11],s79 offen offset:256 sc1
ar v204,a232
ar v205,a233
ar v206,a234
ar v207,a235
ar v208,a236
ar v209,a237
ar v210,a238
ar v211,a239
mm a[232:235],v[92:95],v[104:107],0
cv v212,v204,v205
cv v213,v206,v207
mm a[236:239],v[92:95],v[108:111],0
cv v214,v208,v209
cv v215,v210,v211
w4 v[212:215],v28,s[8:11],s79 offen offset:2304 sc1
ar v216,a240
ar v217,a241
ar v218,a242
ar v219,a243
ar v220,a244
ar v221,a245
ar v222,a246
ar v223,a247
mm a[240:243],v[92:95],v[112:115],0
cv v224,v216,v217
cv v225,v218,v219
mm a[244:247],v[92:95],v[116:119],0
cv v226,v220,v221
cv v227,v222,v223
s_add_u32 s79,s79,4096
w4 v[224:227],v28,s[8:11],s79 offen offset:256 sc1
ar v228,a248
ar v229,a249
ar v230,a250
ar v231,a251
ar v232,a252
ar v233,a253
ar v234,a254
ar v235,a255
mm a[248:251],v[92:95],v[120:123],0
cv v236,v228,v229
cv v237,v230,v231
mm a[252:255],v[92:95],v[124:127],0
cv v238,v232,v233
cv v239,v234,v235
w4 v[236:239],v28,s[8:11],s79 offen offset:2304 sc1
s_add_u32 s79,s79,520192
wt vmcnt(32) lgkmcnt(0)
s_barrier
mm a[0:3],v[128:131],v[160:163],a[0:3]
dt v[96:97],v20 offset:32768
s_add_u32 m0,s43,0
mm a[4:7],v[128:131],v[164:167],a[4:7]
l4 v2,s[28:31],s40 offen lds
mm a[8:11],v[128:131],v[168:171],a[8:11]
dt v[98:99],v20 offset:34816
mm a[12:15],v[128:131],v[172:175],a[12:15]
mm a[16:19],v[128:131],v[176:179],a[16:19]
dr v[64:67],v18 offset:32768
mm a[20:23],v[128:131],v[180:183],a[20:23]
l4 v3,s[28:31],s40 offen offset:1024 lds
mm a[24:27],v[128:131],v[184:187],a[24:27]
dt v[100:101],v21 offset:32768
mm a[28:31],v[128:131],v[188:191],a[28:31]
mm a[60:63],v[132:135],v[188:191],a[60:63]
dt v[102:103],v21 offset:34816
mm a[56:59],v[132:135],v[184:187],a[56:59]
l4 v4,s[28:31],s40 offen offset:2048 lds
mm a[52:55],v[132:135],v[180:183],a[52:55]
dr v[68:71],v18 offset:34816
mm a[48:51],v[132:135],v[176:179],a[48:51]
mm a[44:47],v[132:135],v[172:175],a[44:47]
dt v[104:105],v22 offset:32768
mm a[40:43],v[132:135],v[168:171],a[40:43]
l4 v5,s[28:31],s40 offen offset:3072 lds
mm a[36:39],v[132:135],v[164:167],a[36:39]
dt v[106:107],v22 offset:34816
mm a[32:35],v[132:135],v[160:163],a[32:35]
s_add_u32 m0,s43,4096
mm a[64:67],v[136:139],v[160:163],a[64:67]
dr v[72:75],v18 offset:36864
mm a[68:71],v[136:139],v[164:167],a[68:71]
l4 v6,s[28:31],s40 offen lds
mm a[72:75],v[136:139],v[168:171],a[72:75]
dt v[108:109],v23 offset:32768
mm a[76:79],v[136:139],v[172:175],a[76:79]
mm a[80:83],v[136:139],v[176:179],a[80:83]
dt v[110:111],v23 offset:34816
mm a[84:87],v[136:139],v[180:183],a[84:87]
l4 v7,s[28:31],s40 offen offset:1024 lds
mm a[88:91],v[136:139],v[184:187],a[88:91]
dr v[76:79],v18 offset:38912
mm a[92:95],v[136:139],v[188:191],a[92:95]
mm a[124:127],v[140:143],v[188:191],a[124:127]
dt v[112:113],v24 offset:32768
mm a[120:123],v[140:143],v[184:187],a[120:123]
l4 v8,s[28:31],s40 offen offset:2048 lds
mm a[116:119],v[140:143],v[180:183],a[116:119]
dt v[114:115],v24 offset:34816
mm a[112:115],v[140:143],v[176:179],a[112:115]
mm a[108:111],v[140:143],v[172:175],a[108:111]
dr v[80:83],v18 offset:40960
mm a[104:107],v[140:143],v[168:171],a[104:107]
l4 v9,s[28:31],s40 offen offset:3072 lds
mm a[100:103],v[140:143],v[164:167],a[100:103]
dt v[116:117],v25 offset:32768
mm a[96:99],v[140:143],v[160:163],a[96:99]
s_add_u32 s40,s40,128
s_add_u32 m0,s44,0
mm a[128:131],v[144:147],v[160:163],a[128:131]
dt v[118:119],v25 offset:34816
mm a[132:135],v[144:147],v[164:167],a[132:135]
l4 v10,s[32:35],s41 offen lds
mm a[136:139],v[144:147],v[168:171],a[136:139]
dr v[84:87],v18 offset:43008
mm a[140:143],v[144:147],v[172:175],a[140:143]
mm a[144:147],v[144:147],v[176:179],a[144:147]
dt v[120:121],v26 offset:32768
mm a[148:151],v[144:147],v[180:183],a[148:151]
l4 v11,s[32:35],s41 offen offset:1024 lds
mm a[152:155],v[144:147],v[184:187],a[152:155]
dt v[122:123],v26 offset:34816
mm a[156:159],v[144:147],v[188:191],a[156:159]
mm a[188:191],v[148:151],v[188:191],a[188:191]
dr v[88:91],v18 offset:45056
mm a[184:187],v[148:151],v[184:187],a[184:187]
l4 v12,s[32:35],s41 offen offset:2048 lds
mm a[180:183],v[148:151],v[180:183],a[180:183]
dt v[124:125],v27 offset:32768
mm a[176:179],v[148:151],v[176:179],a[176:179]
mm a[172:175],v[148:151],v[172:175],a[172:175]
dt v[126:127],v27 offset:34816
mm a[168:171],v[148:151],v[168:171],a[168:171]
l4 v13,s[32:35],s41 offen offset:3072 lds
mm a[164:167],v[148:151],v[164:167],a[164:167]
dr v[92:95],v18 offset:47104
mm a[160:163],v[148:151],v[160:163],a[160:163]
s_add_u32 m0,s44,4096
mm a[192:195],v[152:155],v[160:163],a[192:195]
l4 v14,s[32:35],s41 offen lds
mm a[196:199],v[152:155],v[164:167],a[196:199]
mm a[200:203],v[152:155],v[168:171],a[200:203]
mm a[204:207],v[152:155],v[172:175],a[204:207]
l4 v15,s[32:35],s41 offen offset:1024 lds
mm a[208:211],v[152:155],v[176:179],a[208:211]
mm a[212:215],v[152:155],v[180:183],a[212:215]
mm a[216:219],v[152:155],v[184:187],a[216:219]
l4 v16,s[32:35],s41 offen offset:2048 lds
mm a[220:223],v[152:155],v[188:191],a[220:223]
mm a[252:255],v[156:159],v[188:191],a[252:255]
mm a[248:251],v[156:159],v[184:187],a[248:251]
l4 v17,s[32:35],s41 offen offset:3072 lds
mm a[244:247],v[156:159],v[180:183],a[244:247]
s_add_u32 s41,s41,s46
mm a[240:243],v[156:159],v[176:179],a[240:243]
mm a[236:239],v[156:159],v[172:175],a[236:239]
mm a[232:235],v[156:159],v[168:171],a[232:235]
mm a[228:231],v[156:159],v[164:167],a[228:231]
mm a[224:227],v[156:159],v[160:163],a[224:227]
wt lgkmcnt(0)
mm a[0:3],v[64:67],v[96:99],a[0:3]
dt v[160:161],v20 offset:49152
mm a[4:7],v[64:67],v[100:103],a[4:7]
mm a[8:11],v[64:67],v[104:107],a[8:11]
dt v[162:163],v20 offset:51200
mm a[12:15],v[64:67],v[108:111],a[12:15]
mm a[16:19],v[64:67],v[112:115],a[16:19]
dr v[128:131],v19 offset:32768
mm a[20:23],v[64:67],v[116:119],a[20:23]
mm a[24:27],v[64:67],v[120:123],a[24:27]
dt v[164:165],v21 offset:49152
mm a[28:31],v[64:67],v[124:127],a[28:31]
mm a[60:63],v[68:71],v[124:127],a[60:63]
dt v[166:167],v21 offset:51200
mm a[56:59],v[68:71],v[120:123],a[56:59]
mm a[52:55],v[68:71],v[116:119],a[52:55]
dr v[132:135],v19 offset:34816
mm a[48:51],v[68:71],v[112:115],a[48:51]
mm a[44:47],v[68:71],v[108:111],a[44:47]
dt v[168:169],v22 offset:49152
mm a[40:43],v[68:71],v[104:107],a[40:43]
mm a[36:39],v[68:71],v[100:103],a[36:39]
dt v[170:171],v22 offset:51200
mm a[32:35],v[68:71],v[96:99],a[32:35]
mm a[64:67],v[72:75],v[96:99],a[64:67]
dr v[136:139],v19 offset:36864
mm a[68:71],v[72:75],v[100:103],a[68:71]
mm a[72:75],v[72:75],v[104:107],a[72:75]
dt v[172:173],v23 offset:49152
mm a[76:79],v[72:75],v[108:111],a[76:79]
mm a[80:83],v[72:75],v[112:115],a[80:83]
dt v[174:175],v23 offset:51200
mm a[84:87],v[72:75],v[116:119],a[84:87]
mm a[88:91],v[72:75],v[120:123],a[88:91]
dr v[140:143],v19 offset:38912
mm a[92:95],v[72:75],v[124:127],a[92:95]
mm a[124:127],v[76:79],v[124:127],a[124:127]
dt v[176:177],v24 offset:49152
mm a[120:123],v[76:79],v[120:123],a[120:123]
mm a[116:119],v[76:79],v[116:119],a[116:119]
dt v[178:179],v24 offset:51200
mm a[112:115],v[76:79],v[112:115],a[112:115]
mm a[108:111],v[76:79],v[108:111],a[108:111]
dr v[144:147],v19 offset:40960
mm a[104:107],v[76:79],v[104:107],a[104:107]
mm a[100:103],v[76:79],v[100:103],a[100:103]
dt v[180:181],v25 offset:49152
mm a[96:99],v[76:79],v[96:99],a[96:99]
mm a[128:131],v[80:83],v[96:99],a[128:131]
dt v[182:183],v25 offset:51200
mm a[132:135],v[80:83],v[100:103],a[132:135]
mm a[136:139],v[80:83],v[104:107],a[136:139]
dr v[148:151],v19 offset:43008
mm a[140:143],v[80:83],v[108:111],a[140:143]
mm a[144:147],v[80:83],v[112:115],a[144:147]
dt v[184:185],v26 offset:49152
mm a[148:151],v[80:83],v[116:119],a[148:151]
mm a[152:155],v[80:83],v[120:123],a[152:155]
dt v[186:187],v26 offset:51200
mm a[156:159],v[80:83],v[124:127],a[156:159]
mm a[188:191],v[84:87],v[124:127],a[188:191]
dr v[152:155],v19 offset:45056
mm a[184:187],v[84:87],v[120:123],a[184:187]
mm a[180:183],v[84:87],v[116:119],a[180:183]
dt v[188:189],v27 offset:49152
mm a[176:179],v[84:87],v[112:115],a[176:179]
mm a[172:175],v[84:87],v[108:111],a[172:175]
dt v[190:191],v27 offset:51200
mm a[168:171],v[84:87],v[104:107],a[168:171]
mm a[164:167],v[84:87],v[100:103],a[164:167]
dr v[156:159],v19 offset:47104
mm a[160:163],v[84:87],v[96:99],a[160:163]
mm a[192:195],v[88:91],v[96:99],a[192:195]
mm a[196:199],v[88:91],v[100:103],a[196:199]
mm a[200:203],v[88:91],v[104:107],a[200:203]
mm a[204:207],v[88:91],v[108:111],a[204:207]
mm a[208:211],v[88:91],v[112:115],a[208:211]
mm a[212:215],v[88:91],v[116:119],a[212:215]
mm a[216:219],v[88:91],v[120:123],a[216:219]
mm a[220:223],v[88:91],v[124:127],a[220:223]
mm a[252:255],v[92:95],v[124:127],a[252:255]
mm a[248:251],v[92:95],v[120:123],a[248:251]
mm a[244:247],v[92:95],v[116:119],a[244:247]
mm a[240:243],v[92:95],v[112:115],a[240:243]
mm a[236:239],v[92:95],v[108:111],a[236:239]
mm a[232:235],v[92:95],v[104:107],a[232:235]
mm a[228:231],v[92:95],v[100:103],a[228:231]
mm a[224:227],v[92:95],v[96:99],a[224:227]
wt vmcnt(0) lgkmcnt(0)
s_barrier
s_cmp_eq_u32 s14,0
s_cbranch_scc0 GKV_fs
v_mul_u32_u24 v30,2048,v1
v_mov_b32 v31,s101
s_mov_b64 exec,3
buffer_atomic_add v31,v30,s[8:11],s100 offen sc1
s_mov_b64 exec,-1
GKV_fs:
s_mov_b32 s101,0
mm a[0:3],v[128:131],v[160:163],a[0:3]
dt v[96:97],v20 offset:0
s_add_u32 m0,s43,32768
mm a[4:7],v[128:131],v[164:167],a[4:7]
l4 v2,s[28:31],s40 offen lds
mm a[8:11],v[128:131],v[168:171],a[8:11]
dt v[98:99],v20 offset:2048
mm a[12:15],v[128:131],v[172:175],a[12:15]
mm a[16:19],v[128:131],v[176:179],a[16:19]
dr v[64:67],v18 offset:0
mm a[20:23],v[128:131],v[180:183],a[20:23]
l4 v3,s[28:31],s40 offen offset:1024 lds
mm a[24:27],v[128:131],v[184:187],a[24:27]
dt v[100:101],v21 offset:0
mm a[28:31],v[128:131],v[188:191],a[28:31]
mm a[60:63],v[132:135],v[188:191],a[60:63]
dt v[102:103],v21 offset:2048
mm a[56:59],v[132:135],v[184:187],a[56:59]
l4 v4,s[28:31],s40 offen offset:2048 lds
mm a[52:55],v[132:135],v[180:183],a[52:55]
dr v[68:71],v18 offset:2048
mm a[48:51],v[132:135],v[176:179],a[48:51]
mm a[44:47],v[132:135],v[172:175],a[44:47]
dt v[104:105],v22 offset:0
mm a[40:43],v[132:135],v[168:171],a[40:43]
l4 v5,s[28:31],s40 offen offset:3072 lds
mm a[36:39],v[132:135],v[164:167],a[36:39]
dt v[106:107],v22 offset:2048
mm a[32:35],v[132:135],v[160:163],a[32:35]
s_add_u32 m0,s43,36864
mm a[64:67],v[136:139],v[160:163],a[64:67]
dr v[72:75],v18 offset:4096
mm a[68:71],v[136:139],v[164:167],a[68:71]
l4 v6,s[28:31],s40 offen lds
mm a[72:75],v[136:139],v[168:171],a[72:75]
dt v[108:109],v23 offset:0
mm a[76:79],v[136:139],v[172:175],a[76:79]
mm a[80:83],v[136:139],v[176:179],a[80:83]
dt v[110:111],v23 offset:2048
mm a[84:87],v[136:139],v[180:183],a[84:87]
l4 v7,s[28:31],s40 offen offset:1024 lds
mm a[88:91],v[136:139],v[184:187],a[88:91]
dr v[76:79],v18 offset:6144
mm a[92:95],v[136:139],v[188:191],a[92:95]
mm a[124:127],v[140:143],v[188:191],a[124:127]
dt v[112:113],v24 offset:0
mm a[120:123],v[140:143],v[184:187],a[120:123]
l4 v8,s[28:31],s40 offen offset:2048 lds
mm a[116:119],v[140:143],v[180:183],a[116:119]
dt v[114:115],v24 offset:2048
mm a[112:115],v[140:143],v[176:179],a[112:115]
mm a[108:111],v[140:143],v[172:175],a[108:111]
dr v[80:83],v18 offset:8192
mm a[104:107],v[140:143],v[168:171],a[104:107]
l4 v9,s[28:31],s40 offen offset:3072 lds
mm a[100:103],v[140:143],v[164:167],a[100:103]
dt v[116:117],v25 offset:0
mm a[96:99],v[140:143],v[160:163],a[96:99]
s_add_u32 s40,s40,128
s_add_u32 m0,s44,32768
mm a[128:131],v[144:147],v[160:163],a[128:131]
dt v[118:119],v25 offset:2048
mm a[132:135],v[144:147],v[164:167],a[132:135]
l4 v10,s[32:35],s41 offen lds
mm a[136:139],v[144:147],v[168:171],a[136:139]
dr v[84:87],v18 offset:10240
mm a[140:143],v[144:147],v[172:175],a[140:143]
mm a[144:147],v[144:147],v[176:179],a[144:147]
dt v[120:121],v26 offset:0
mm a[148:151],v[144:147],v[180:183],a[148:151]
l4 v11,s[32:35],s41 offen offset:1024 lds
mm a[152:155],v[144:147],v[184:187],a[152:155]
dt v[122:123],v26 offset:2048
mm a[156:159],v[144:147],v[188:191],a[156:159]
mm a[188:191],v[148:151],v[188:191],a[188:191]
dr v[88:91],v18 offset:12288
mm a[184:187],v[148:151],v[184:187],a[184:187]
l4 v12,s[32:35],s41 offen offset:2048 lds
mm a[180:183],v[148:151],v[180:183],a[180:183]
dt v[124:125],v27 offset:0
mm a[176:179],v[148:151],v[176:179],a[176:179]
mm a[172:175],v[148:151],v[172:175],a[172:175]
dt v[126:127],v27 offset:2048
mm a[168:171],v[148:151],v[168:171],a[168:171]
l4 v13,s[32:35],s41 offen offset:3072 lds
mm a[164:167],v[148:151],v[164:167],a[164:167]
dr v[92:95],v18 offset:14336
mm a[160:163],v[148:151],v[160:163],a[160:163]
s_add_u32 m0,s44,36864
mm a[192:195],v[152:155],v[160:163],a[192:195]
l4 v14,s[32:35],s41 offen lds
mm a[196:199],v[152:155],v[164:167],a[196:199]
mm a[200:203],v[152:155],v[168:171],a[200:203]
mm a[204:207],v[152:155],v[172:175],a[204:207]
l4 v15,s[32:35],s41 offen offset:1024 lds
mm a[208:211],v[152:155],v[176:179],a[208:211]
mm a[212:215],v[152:155],v[180:183],a[212:215]
mm a[216:219],v[152:155],v[184:187],a[216:219]
l4 v16,s[32:35],s41 offen offset:2048 lds
mm a[220:223],v[152:155],v[188:191],a[220:223]
mm a[252:255],v[156:159],v[188:191],a[252:255]
mm a[248:251],v[156:159],v[184:187],a[248:251]
l4 v17,s[32:35],s41 offen offset:3072 lds
mm a[244:247],v[156:159],v[180:183],a[244:247]
s_add_u32 s41,s41,s46
mm a[240:243],v[156:159],v[176:179],a[240:243]
mm a[236:239],v[156:159],v[172:175],a[236:239]
wt lgkmcnt(0)
mm a[232:235],v[156:159],v[168:171],a[232:235]
mm a[228:231],v[156:159],v[164:167],a[228:231]
mm a[224:227],v[156:159],v[160:163],a[224:227]
s_mov_b32 s42,6
s_branch GKV_k
G_tail:
s_mov_b64 s[32:33],s[74:75]
s_mov_b32 s34,0x200000
s_mov_b32 s57,0x20000
s_mov_b32 s47,2048
s_lshl_b32 s48,s14,4
v_bfe_u32 v30,v1,5,1
v_add_u32 v30,s48,v30
v_mul_lo_u32 v30,v30,s47
v_bfe_u32 v31,v1,0,1
v_lshlrev_b32 v31,4,v31
v_add_u32 v30,v30,v31
v_bfe_u32 v31,v1,1,4
v_bfe_u32 v32,v1,5,1
v_xor_b32 v31,v31,v32
v_xor_b32 v32,0,v31
v_lshl_add_u32 v32,v32,5,v30
s_mul_i32 s48,s47,0
s_sub_u32 s48,s48,0
v_add_u32 v10,s48,v32
v_xor_b32 v32,2,v31
v_lshl_add_u32 v32,v32,5,v30
s_mul_i32 s48,s47,2
s_sub_u32 s48,s48,1024
v_add_u32 v11,s48,v32
v_xor_b32 v32,4,v31
v_lshl_add_u32 v32,v32,5,v30
s_mul_i32 s48,s47,4
s_sub_u32 s48,s48,2048
v_add_u32 v12,s48,v32
v_xor_b32 v32,6,v31
v_lshl_add_u32 v32,v32,5,v30
s_mul_i32 s48,s47,6
s_sub_u32 s48,s48,3072
v_add_u32 v13,s48,v32
v_xor_b32 v32,0,v31
v_lshl_add_u32 v32,v32,5,v30
s_mul_i32 s48,s47,8
s_sub_u32 s48,s48,0
v_add_u32 v14,s48,v32
v_xor_b32 v32,2,v31
v_lshl_add_u32 v32,v32,5,v30
s_mul_i32 s48,s47,10
s_sub_u32 s48,s48,1024
v_add_u32 v15,s48,v32
v_xor_b32 v32,4,v31
v_lshl_add_u32 v32,v32,5,v30
s_mul_i32 s48,s47,12
s_sub_u32 s48,s48,2048
v_add_u32 v16,s48,v32
v_xor_b32 v32,6,v31
v_lshl_add_u32 v32,v32,5,v30
s_mul_i32 s48,s47,14
s_sub_u32 s48,s48,3072
v_add_u32 v17,s48,v32
s_lshl_b32 s46,s47,6
s_mul_i32 s44,s14,8192
s_add_u32 s44,s44,65536
v_bfe_u32 v30,v1,4,2
v_lshlrev_b32 v30,11,v30
v_bfe_u32 v32,v1,2,2
v_lshl_add_u32 v30,v32,9,v30
v_bfe_u32 v32,v1,0,2
v_lshl_add_u32 v30,v32,3,v30
v_add_u32 v30,65536,v30
v_bfe_u32 v31,v1,2,2
v_bfe_u32 v32,v1,4,1
v_lshl_add_u32 v31,v32,2,v31
s_mul_i32 s48,s77,8
v_xor_b32 v31,s48,v31
v_xor_b32 v32,0,v31
v_lshl_add_u32 v20,v32,5,v30
v_xor_b32 v32,1,v31
v_lshl_add_u32 v21,v32,5,v30
v_xor_b32 v32,2,v31
v_lshl_add_u32 v22,v32,5,v30
v_xor_b32 v32,3,v31
v_lshl_add_u32 v23,v32,5,v30
v_xor_b32 v32,4,v31
v_lshl_add_u32 v24,v32,5,v30
v_xor_b32 v32,5,v31
v_lshl_add_u32 v25,v32,5,v30
v_xor_b32 v32,6,v31
v_lshl_add_u32 v26,v32,5,v30
v_xor_b32 v32,7,v31
v_lshl_add_u32 v27,v32,5,v30
s_mul_i32 s43,s14,8192
s_mul_i32 s48,s14,s57
s_lshl_b32 s48,s48,1
v_bfe_u32 v2,v1,0,6
v_lshlrev_b32 v2,4,v2
v_add_u32 v2,s48,v2
v_add_u32 v3,s57,v2
s_mul_i32 s48,s76,16384
v_add_u32 v18,s48,v28
s_lshl_b32 s48,s14,1
s_and_b32 s49,s48,2
s_lshl_b32 s49,s49,13
s_and_b32 s45,s48,1
s_lshl_b32 s45,s45,12
s_or_b32 s45,s45,s49
s_xor_b32 s45,s45,s7
s_barrier
s_add_u32 m0,s43,0
s_xor_b32 s79,s40,s45
l4 v2,s[8:11],s79 offen sc1 lds
l4 v2,s[8:11],s79 offen offset:1024 sc1 lds
l4 v2,s[8:11],s79 offen offset:2048 sc1 lds
l4 v2,s[8:11],s79 offen offset:3072 sc1 lds
s_add_u32 m0,s43,4096
s_xor_b32 s79,s79,4096
l4 v3,s[8:11],s79 offen sc1 lds
l4 v3,s[8:11],s79 offen offset:1024 sc1 lds
l4 v3,s[8:11],s79 offen offset:2048 sc1 lds
l4 v3,s[8:11],s79 offen offset:3072 sc1 lds
s_add_u32 s40,s40,4096
s_add_u32 m0,s44,0
s_nop 0
l4 v10,s[32:35],s41 offen lds
l4 v11,s[32:35],s41 offen offset:1024 lds
l4 v12,s[32:35],s41 offen offset:2048 lds
l4 v13,s[32:35],s41 offen offset:3072 lds
s_add_u32 m0,s44,4096
s_nop 0
l4 v14,s[32:35],s41 offen lds
l4 v15,s[32:35],s41 offen offset:1024 lds
l4 v16,s[32:35],s41 offen offset:2048 lds
l4 v17,s[32:35],s41 offen offset:3072 lds
s_add_u32 s41,s41,s46
s_add_u32 m0,s43,32768
s_xor_b32 s79,s40,s45
l4 v2,s[8:11],s79 offen sc1 lds
l4 v2,s[8:11],s79 offen offset:1024 sc1 lds
l4 v2,s[8:11],s79 offen offset:2048 sc1 lds
l4 v2,s[8:11],s79 offen offset:3072 sc1 lds
s_add_u32 m0,s43,36864
s_xor_b32 s79,s79,4096
l4 v3,s[8:11],s79 offen sc1 lds
l4 v3,s[8:11],s79 offen offset:1024 sc1 lds
l4 v3,s[8:11],s79 offen offset:2048 sc1 lds
l4 v3,s[8:11],s79 offen offset:3072 sc1 lds
s_add_u32 s40,s40,12288
s_add_u32 m0,s44,32768
s_nop 0
l4 v10,s[32:35],s41 offen lds
l4 v11,s[32:35],s41 offen offset:1024 lds
l4 v12,s[32:35],s41 offen offset:2048 lds
l4 v13,s[32:35],s41 offen offset:3072 lds
s_add_u32 m0,s44,36864
s_nop 0
l4 v14,s[32:35],s41 offen lds
l4 v15,s[32:35],s41 offen offset:1024 lds
l4 v16,s[32:35],s41 offen offset:2048 lds
l4 v17,s[32:35],s41 offen offset:3072 lds
s_add_u32 s41,s41,s46
s_mov_b64 s[90:91],s[20:21]
s_mov_b64 s[92:93],s[22:23]
s_mov_b64 s[94:95],s[24:25]
s_mov_b64 s[96:97],s[26:27]
s_load_dwordx8 s[20:27],s[18:19],0
s_add_u32 s18,s18,32
s_addc_u32 s19,s19,0
wt vmcnt(16)
s_barrier
dt v[96:97],v20 offset:0
dt v[98:99],v20 offset:8192
dr v[64:67],v18 offset:0
dt v[100:101],v21 offset:0
dt v[102:103],v21 offset:8192
dr v[68:71],v18 offset:256
dt v[104:105],v22 offset:0
dt v[106:107],v22 offset:8192
dr v[72:75],v18 offset:4096
dt v[108:109],v23 offset:0
dt v[110:111],v23 offset:8192
dr v[76:79],v18 offset:4352
dt v[112:113],v24 offset:0
dt v[114:115],v24 offset:8192
dr v[80:83],v18 offset:8192
dt v[116:117],v25 offset:0
dt v[118:119],v25 offset:8192
dr v[84:87],v18 offset:8448
dt v[120:121],v26 offset:0
dt v[122:123],v26 offset:8192
dr v[88:91],v18 offset:12288
dt v[124:125],v27 offset:0
dt v[126:127],v27 offset:8192
dr v[92:95],v18 offset:12544
wt lgkmcnt(0)
mm a[0:3],v[96:99],v[64:67],0
dt v[160:161],v20 offset:16384
mm a[4:7],v[100:103],v[64:67],0
mm a[8:11],v[104:107],v[64:67],0
dt v[162:163],v20 offset:24576
mm a[12:15],v[108:111],v[64:67],0
mm a[16:19],v[112:115],v[64:67],0
dr v[128:131],v18 offset:2048
mm a[20:23],v[116:119],v[64:67],0
mm a[24:27],v[120:123],v[64:67],0
dt v[164:165],v21 offset:16384
mm a[28:31],v[124:127],v[64:67],0
mm a[60:63],v[124:127],v[68:71],0
dt v[166:167],v21 offset:24576
mm a[56:59],v[120:123],v[68:71],0
mm a[52:55],v[116:119],v[68:71],0
dr v[132:135],v18 offset:2304
mm a[48:51],v[112:115],v[68:71],0
mm a[44:47],v[108:111],v[68:71],0
dt v[168:169],v22 offset:16384
mm a[40:43],v[104:107],v[68:71],0
mm a[36:39],v[100:103],v[68:71],0
dt v[170:171],v22 offset:24576
mm a[32:35],v[96:99],v[68:71],0
mm a[64:67],v[96:99],v[72:75],0
dr v[136:139],v18 offset:6144
mm a[68:71],v[100:103],v[72:75],0
mm a[72:75],v[104:107],v[72:75],0
dt v[172:173],v23 offset:16384
mm a[76:79],v[108:111],v[72:75],0
mm a[80:83],v[112:115],v[72:75],0
dt v[174:175],v23 offset:24576
mm a[84:87],v[116:119],v[72:75],0
mm a[88:91],v[120:123],v[72:75],0
dr v[140:143],v18 offset:6400
mm a[92:95],v[124:127],v[72:75],0
mm a[124:127],v[124:127],v[76:79],0
dt v[176:177],v24 offset:16384
mm a[120:123],v[120:123],v[76:79],0
mm a[116:119],v[116:119],v[76:79],0
dt v[178:179],v24 offset:24576
mm a[112:115],v[112:115],v[76:79],0
mm a[108:111],v[108:111],v[76:79],0
dr v[144:147],v18 offset:10240
mm a[104:107],v[104:107],v[76:79],0
mm a[100:103],v[100:103],v[76:79],0
dt v[180:181],v25 offset:16384
mm a[96:99],v[96:99],v[76:79],0
mm a[128:131],v[96:99],v[80:83],0
dt v[182:183],v25 offset:24576
mm a[132:135],v[100:103],v[80:83],0
mm a[136:139],v[104:107],v[80:83],0
dr v[148:151],v18 offset:10496
mm a[140:143],v[108:111],v[80:83],0
mm a[144:147],v[112:115],v[80:83],0
dt v[184:185],v26 offset:16384
mm a[148:151],v[116:119],v[80:83],0
mm a[152:155],v[120:123],v[80:83],0
dt v[186:187],v26 offset:24576
mm a[156:159],v[124:127],v[80:83],0
mm a[188:191],v[124:127],v[84:87],0
dr v[152:155],v18 offset:14336
mm a[184:187],v[120:123],v[84:87],0
mm a[180:183],v[116:119],v[84:87],0
dt v[188:189],v27 offset:16384
mm a[176:179],v[112:115],v[84:87],0
mm a[172:175],v[108:111],v[84:87],0
dt v[190:191],v27 offset:24576
mm a[168:171],v[104:107],v[84:87],0
mm a[164:167],v[100:103],v[84:87],0
dr v[156:159],v18 offset:14592
mm a[160:163],v[96:99],v[84:87],0
mm a[192:195],v[96:99],v[88:91],0
mm a[196:199],v[100:103],v[88:91],0
mm a[200:203],v[104:107],v[88:91],0
mm a[204:207],v[108:111],v[88:91],0
mm a[208:211],v[112:115],v[88:91],0
mm a[212:215],v[116:119],v[88:91],0
mm a[216:219],v[120:123],v[88:91],0
mm a[220:223],v[124:127],v[88:91],0
mm a[252:255],v[124:127],v[92:95],0
mm a[248:251],v[120:123],v[92:95],0
mm a[244:247],v[116:119],v[92:95],0
mm a[240:243],v[112:115],v[92:95],0
mm a[236:239],v[108:111],v[92:95],0
mm a[232:235],v[104:107],v[92:95],0
mm a[228:231],v[100:103],v[92:95],0
mm a[224:227],v[96:99],v[92:95],0
wt vmcnt(0) lgkmcnt(0)
s_barrier
mm a[0:3],v[160:163],v[128:131],a[0:3]
dt v[96:97],v20 offset:32768
s_add_u32 m0,s43,0
s_xor_b32 s79,s40,s45
mm a[4:7],v[164:167],v[128:131],a[4:7]
l4 v2,s[8:11],s79 offen sc1 lds
mm a[8:11],v[168:171],v[128:131],a[8:11]
dt v[98:99],v20 offset:40960
mm a[12:15],v[172:175],v[128:131],a[12:15]
mm a[16:19],v[176:179],v[128:131],a[16:19]
dr v[64:67],v18 offset:32768
mm a[20:23],v[180:183],v[128:131],a[20:23]
l4 v2,s[8:11],s79 offen offset:1024 sc1 lds
mm a[24:27],v[184:187],v[128:131],a[24:27]
dt v[100:101],v21 offset:32768
mm a[28:31],v[188:191],v[128:131],a[28:31]
mm a[60:63],v[188:191],v[132:135],a[60:63]
dt v[102:103],v21 offset:40960
mm a[56:59],v[184:187],v[132:135],a[56:59]
l4 v2,s[8:11],s79 offen offset:2048 sc1 lds
mm a[52:55],v[180:183],v[132:135],a[52:55]
dr v[68:71],v18 offset:33024
mm a[48:51],v[176:179],v[132:135],a[48:51]
mm a[44:47],v[172:175],v[132:135],a[44:47]
dt v[104:105],v22 offset:32768
mm a[40:43],v[168:171],v[132:135],a[40:43]
l4 v2,s[8:11],s79 offen offset:3072 sc1 lds
mm a[36:39],v[164:167],v[132:135],a[36:39]
dt v[106:107],v22 offset:40960
mm a[32:35],v[160:163],v[132:135],a[32:35]
s_add_u32 m0,s43,4096
s_xor_b32 s79,s79,4096
mm a[64:67],v[160:163],v[136:139],a[64:67]
dr v[72:75],v18 offset:36864
mm a[68:71],v[164:167],v[136:139],a[68:71]
l4 v3,s[8:11],s79 offen sc1 lds
mm a[72:75],v[168:171],v[136:139],a[72:75]
dt v[108:109],v23 offset:32768
mm a[76:79],v[172:175],v[136:139],a[76:79]
mm a[80:83],v[176:179],v[136:139],a[80:83]
dt v[110:111],v23 offset:40960
mm a[84:87],v[180:183],v[136:139],a[84:87]
l4 v3,s[8:11],s79 offen offset:1024 sc1 lds
mm a[88:91],v[184:187],v[136:139],a[88:91]
dr v[76:79],v18 offset:37120
mm a[92:95],v[188:191],v[136:139],a[92:95]
mm a[124:127],v[188:191],v[140:143],a[124:127]
dt v[112:113],v24 offset:32768
mm a[120:123],v[184:187],v[140:143],a[120:123]
l4 v3,s[8:11],s79 offen offset:2048 sc1 lds
mm a[116:119],v[180:183],v[140:143],a[116:119]
dt v[114:115],v24 offset:40960
mm a[112:115],v[176:179],v[140:143],a[112:115]
mm a[108:111],v[172:175],v[140:143],a[108:111]
dr v[80:83],v18 offset:40960
mm a[104:107],v[168:171],v[140:143],a[104:107]
l4 v3,s[8:11],s79 offen offset:3072 sc1 lds
mm a[100:103],v[164:167],v[140:143],a[100:103]
dt v[116:117],v25 offset:32768
mm a[96:99],v[160:163],v[140:143],a[96:99]
s_add_u32 s40,s40,4096
s_add_u32 m0,s44,0
mm a[128:131],v[160:163],v[144:147],a[128:131]
dt v[118:119],v25 offset:40960
mm a[132:135],v[164:167],v[144:147],a[132:135]
l4 v10,s[32:35],s41 offen lds
mm a[136:139],v[168:171],v[144:147],a[136:139]
dr v[84:87],v18 offset:41216
mm a[140:143],v[172:175],v[144:147],a[140:143]
mm a[144:147],v[176:179],v[144:147],a[144:147]
dt v[120:121],v26 offset:32768
mm a[148:151],v[180:183],v[144:147],a[148:151]
l4 v11,s[32:35],s41 offen offset:1024 lds
mm a[152:155],v[184:187],v[144:147],a[152:155]
dt v[122:123],v26 offset:40960
mm a[156:159],v[188:191],v[144:147],a[156:159]
mm a[188:191],v[188:191],v[148:151],a[188:191]
dr v[88:91],v18 offset:45056
mm a[184:187],v[184:187],v[148:151],a[184:187]
l4 v12,s[32:35],s41 offen offset:2048 lds
mm a[180:183],v[180:183],v[148:151],a[180:183]
dt v[124:125],v27 offset:32768
mm a[176:179],v[176:179],v[148:151],a[176:179]
mm a[172:175],v[172:175],v[148:151],a[172:175]
dt v[126:127],v27 offset:40960
mm a[168:171],v[168:171],v[148:151],a[168:171]
l4 v13,s[32:35],s41 offen offset:3072 lds
mm a[164:167],v[164:167],v[148:151],a[164:167]
dr v[92:95],v18 offset:45312
mm a[160:163],v[160:163],v[148:151],a[160:163]
s_add_u32 m0,s44,4096
mm a[192:195],v[160:163],v[152:155],a[192:195]
l4 v14,s[32:35],s41 offen lds
mm a[196:199],v[164:167],v[152:155],a[196:199]
mm a[200:203],v[168:171],v[152:155],a[200:203]
mm a[204:207],v[172:175],v[152:155],a[204:207]
l4 v15,s[32:35],s41 offen offset:1024 lds
mm a[208:211],v[176:179],v[152:155],a[208:211]
mm a[212:215],v[180:183],v[152:155],a[212:215]
mm a[216:219],v[184:187],v[152:155],a[216:219]
l4 v16,s[32:35],s41 offen offset:2048 lds
mm a[220:223],v[188:191],v[152:155],a[220:223]
mm a[252:255],v[188:191],v[156:159],a[252:255]
mm a[248:251],v[184:187],v[156:159],a[248:251]
l4 v17,s[32:35],s41 offen offset:3072 lds
mm a[244:247],v[180:183],v[156:159],a[244:247]
s_add_u32 s41,s41,s46
mm a[240:243],v[176:179],v[156:159],a[240:243]
mm a[236:239],v[172:175],v[156:159],a[236:239]
wt lgkmcnt(0)
mm a[232:235],v[168:171],v[156:159],a[232:235]
mm a[228:231],v[164:167],v[156:159],a[228:231]
mm a[224:227],v[160:163],v[156:159],a[224:227]
mm a[0:3],v[96:99],v[64:67],a[0:3]
dt v[160:161],v20 offset:49152
mm a[4:7],v[100:103],v[64:67],a[4:7]
mm a[8:11],v[104:107],v[64:67],a[8:11]
dt v[162:163],v20 offset:57344
mm a[12:15],v[108:111],v[64:67],a[12:15]
mm a[16:19],v[112:115],v[64:67],a[16:19]
dr v[128:131],v18 offset:34816
mm a[20:23],v[116:119],v[64:67],a[20:23]
mm a[24:27],v[120:123],v[64:67],a[24:27]
dt v[164:165],v21 offset:49152
mm a[28:31],v[124:127],v[64:67],a[28:31]
mm a[60:63],v[124:127],v[68:71],a[60:63]
dt v[166:167],v21 offset:57344
mm a[56:59],v[120:123],v[68:71],a[56:59]
mm a[52:55],v[116:119],v[68:71],a[52:55]
dr v[132:135],v18 offset:35072
mm a[48:51],v[112:115],v[68:71],a[48:51]
mm a[44:47],v[108:111],v[68:71],a[44:47]
dt v[168:169],v22 offset:49152
mm a[40:43],v[104:107],v[68:71],a[40:43]
mm a[36:39],v[100:103],v[68:71],a[36:39]
dt v[170:171],v22 offset:57344
mm a[32:35],v[96:99],v[68:71],a[32:35]
mm a[64:67],v[96:99],v[72:75],a[64:67]
dr v[136:139],v18 offset:38912
mm a[68:71],v[100:103],v[72:75],a[68:71]
mm a[72:75],v[104:107],v[72:75],a[72:75]
dt v[172:173],v23 offset:49152
mm a[76:79],v[108:111],v[72:75],a[76:79]
mm a[80:83],v[112:115],v[72:75],a[80:83]
dt v[174:175],v23 offset:57344
mm a[84:87],v[116:119],v[72:75],a[84:87]
mm a[88:91],v[120:123],v[72:75],a[88:91]
dr v[140:143],v18 offset:39168
mm a[92:95],v[124:127],v[72:75],a[92:95]
mm a[124:127],v[124:127],v[76:79],a[124:127]
dt v[176:177],v24 offset:49152
mm a[120:123],v[120:123],v[76:79],a[120:123]
mm a[116:119],v[116:119],v[76:79],a[116:119]
dt v[178:179],v24 offset:57344
mm a[112:115],v[112:115],v[76:79],a[112:115]
mm a[108:111],v[108:111],v[76:79],a[108:111]
dr v[144:147],v18 offset:43008
mm a[104:107],v[104:107],v[76:79],a[104:107]
mm a[100:103],v[100:103],v[76:79],a[100:103]
dt v[180:181],v25 offset:49152
mm a[96:99],v[96:99],v[76:79],a[96:99]
mm a[128:131],v[96:99],v[80:83],a[128:131]
dt v[182:183],v25 offset:57344
mm a[132:135],v[100:103],v[80:83],a[132:135]
mm a[136:139],v[104:107],v[80:83],a[136:139]
dr v[148:151],v18 offset:43264
mm a[140:143],v[108:111],v[80:83],a[140:143]
mm a[144:147],v[112:115],v[80:83],a[144:147]
dt v[184:185],v26 offset:49152
mm a[148:151],v[116:119],v[80:83],a[148:151]
mm a[152:155],v[120:123],v[80:83],a[152:155]
dt v[186:187],v26 offset:57344
mm a[156:159],v[124:127],v[80:83],a[156:159]
mm a[188:191],v[124:127],v[84:87],a[188:191]
dr v[152:155],v18 offset:47104
mm a[184:187],v[120:123],v[84:87],a[184:187]
mm a[180:183],v[116:119],v[84:87],a[180:183]
dt v[188:189],v27 offset:49152
mm a[176:179],v[112:115],v[84:87],a[176:179]
mm a[172:175],v[108:111],v[84:87],a[172:175]
dt v[190:191],v27 offset:57344
mm a[168:171],v[104:107],v[84:87],a[168:171]
mm a[164:167],v[100:103],v[84:87],a[164:167]
dr v[156:159],v18 offset:47360
mm a[160:163],v[96:99],v[84:87],a[160:163]
mm a[192:195],v[96:99],v[88:91],a[192:195]
mm a[196:199],v[100:103],v[88:91],a[196:199]
mm a[200:203],v[104:107],v[88:91],a[200:203]
mm a[204:207],v[108:111],v[88:91],a[204:207]
mm a[208:211],v[112:115],v[88:91],a[208:211]
mm a[212:215],v[116:119],v[88:91],a[212:215]
mm a[216:219],v[120:123],v[88:91],a[216:219]
mm a[220:223],v[124:127],v[88:91],a[220:223]
mm a[252:255],v[124:127],v[92:95],a[252:255]
mm a[248:251],v[120:123],v[92:95],a[248:251]
mm a[244:247],v[116:119],v[92:95],a[244:247]
mm a[240:243],v[112:115],v[92:95],a[240:243]
mm a[236:239],v[108:111],v[92:95],a[236:239]
mm a[232:235],v[104:107],v[92:95],a[232:235]
mm a[228:231],v[100:103],v[92:95],a[228:231]
mm a[224:227],v[96:99],v[92:95],a[224:227]
wt vmcnt(0) lgkmcnt(0)
s_barrier
mm a[0:3],v[160:163],v[128:131],a[0:3]
dt v[96:97],v20 offset:0
s_add_u32 m0,s43,32768
s_xor_b32 s79,s40,s45
mm a[4:7],v[164:167],v[128:131],a[4:7]
l4 v2,s[8:11],s79 offen sc1 lds
mm a[8:11],v[168:171],v[128:131],a[8:11]
dt v[98:99],v20 offset:8192
mm a[12:15],v[172:175],v[128:131],a[12:15]
mm a[16:19],v[176:179],v[128:131],a[16:19]
dr v[64:67],v18 offset:0
mm a[20:23],v[180:183],v[128:131],a[20:23]
l4 v2,s[8:11],s79 offen offset:1024 sc1 lds
mm a[24:27],v[184:187],v[128:131],a[24:27]
dt v[100:101],v21 offset:0
mm a[28:31],v[188:191],v[128:131],a[28:31]
mm a[60:63],v[188:191],v[132:135],a[60:63]
dt v[102:103],v21 offset:8192
mm a[56:59],v[184:187],v[132:135],a[56:59]
l4 v2,s[8:11],s79 offen offset:2048 sc1 lds
mm a[52:55],v[180:183],v[132:135],a[52:55]
dr v[68:71],v18 offset:256
mm a[48:51],v[176:179],v[132:135],a[48:51]
mm a[44:47],v[172:175],v[132:135],a[44:47]
dt v[104:105],v22 offset:0
mm a[40:43],v[168:171],v[132:135],a[40:43]
l4 v2,s[8:11],s79 offen offset:3072 sc1 lds
mm a[36:39],v[164:167],v[132:135],a[36:39]
dt v[106:107],v22 offset:8192
mm a[32:35],v[160:163],v[132:135],a[32:35]
s_add_u32 m0,s43,36864
s_xor_b32 s79,s79,4096
mm a[64:67],v[160:163],v[136:139],a[64:67]
dr v[72:75],v18 offset:4096
mm a[68:71],v[164:167],v[136:139],a[68:71]
l4 v3,s[8:11],s79 offen sc1 lds
mm a[72:75],v[168:171],v[136:139],a[72:75]
dt v[108:109],v23 offset:0
mm a[76:79],v[172:175],v[136:139],a[76:79]
mm a[80:83],v[176:179],v[136:139],a[80:83]
dt v[110:111],v23 offset:8192
mm a[84:87],v[180:183],v[136:139],a[84:87]
l4 v3,s[8:11],s79 offen offset:1024 sc1 lds
mm a[88:91],v[184:187],v[136:139],a[88:91]
dr v[76:79],v18 offset:4352
mm a[92:95],v[188:191],v[136:139],a[92:95]
mm a[124:127],v[188:191],v[140:143],a[124:127]
dt v[112:113],v24 offset:0
mm a[120:123],v[184:187],v[140:143],a[120:123]
l4 v3,s[8:11],s79 offen offset:2048 sc1 lds
mm a[116:119],v[180:183],v[140:143],a[116:119]
dt v[114:115],v24 offset:8192
mm a[112:115],v[176:179],v[140:143],a[112:115]
mm a[108:111],v[172:175],v[140:143],a[108:111]
dr v[80:83],v18 offset:8192
mm a[104:107],v[168:171],v[140:143],a[104:107]
l4 v3,s[8:11],s79 offen offset:3072 sc1 lds
mm a[100:103],v[164:167],v[140:143],a[100:103]
dt v[116:117],v25 offset:0
mm a[96:99],v[160:163],v[140:143],a[96:99]
s_add_u32 s40,s40,12288
s_add_u32 m0,s44,32768
mm a[128:131],v[160:163],v[144:147],a[128:131]
dt v[118:119],v25 offset:8192
mm a[132:135],v[164:167],v[144:147],a[132:135]
l4 v10,s[32:35],s41 offen lds
mm a[136:139],v[168:171],v[144:147],a[136:139]
dr v[84:87],v18 offset:8448
mm a[140:143],v[172:175],v[144:147],a[140:143]
mm a[144:147],v[176:179],v[144:147],a[144:147]
dt v[120:121],v26 offset:0
mm a[148:151],v[180:183],v[144:147],a[148:151]
l4 v11,s[32:35],s41 offen offset:1024 lds
mm a[152:155],v[184:187],v[144:147],a[152:155]
dt v[122:123],v26 offset:8192
mm a[156:159],v[188:191],v[144:147],a[156:159]
mm a[188:191],v[188:191],v[148:151],a[188:191]
dr v[88:91],v18 offset:12288
mm a[184:187],v[184:187],v[148:151],a[184:187]
l4 v12,s[32:35],s41 offen offset:2048 lds
mm a[180:183],v[180:183],v[148:151],a[180:183]
dt v[124:125],v27 offset:0
mm a[176:179],v[176:179],v[148:151],a[176:179]
mm a[172:175],v[172:175],v[148:151],a[172:175]
dt v[126:127],v27 offset:8192
mm a[168:171],v[168:171],v[148:151],a[168:171]
l4 v13,s[32:35],s41 offen offset:3072 lds
mm a[164:167],v[164:167],v[148:151],a[164:167]
dr v[92:95],v18 offset:12544
mm a[160:163],v[160:163],v[148:151],a[160:163]
s_add_u32 m0,s44,36864
mm a[192:195],v[160:163],v[152:155],a[192:195]
l4 v14,s[32:35],s41 offen lds
mm a[196:199],v[164:167],v[152:155],a[196:199]
mm a[200:203],v[168:171],v[152:155],a[200:203]
mm a[204:207],v[172:175],v[152:155],a[204:207]
l4 v15,s[32:35],s41 offen offset:1024 lds
mm a[208:211],v[176:179],v[152:155],a[208:211]
mm a[212:215],v[180:183],v[152:155],a[212:215]
mm a[216:219],v[184:187],v[152:155],a[216:219]
l4 v16,s[32:35],s41 offen offset:2048 lds
mm a[220:223],v[188:191],v[152:155],a[220:223]
mm a[252:255],v[188:191],v[156:159],a[252:255]
mm a[248:251],v[184:187],v[156:159],a[248:251]
l4 v17,s[32:35],s41 offen offset:3072 lds
mm a[244:247],v[180:183],v[156:159],a[244:247]
s_add_u32 s41,s41,s46
mm a[240:243],v[176:179],v[156:159],a[240:243]
mm a[236:239],v[172:175],v[156:159],a[236:239]
wt lgkmcnt(0)
mm a[232:235],v[168:171],v[156:159],a[232:235]
mm a[228:231],v[164:167],v[156:159],a[228:231]
mm a[224:227],v[160:163],v[156:159],a[224:227]
s_sub_u32 s42,s42,2
G3F_k:
mm a[0:3],v[96:99],v[64:67],a[0:3]
dt v[160:161],v20 offset:16384
mm a[4:7],v[100:103],v[64:67],a[4:7]
mm a[8:11],v[104:107],v[64:67],a[8:11]
dt v[162:163],v20 offset:24576
mm a[12:15],v[108:111],v[64:67],a[12:15]
mm a[16:19],v[112:115],v[64:67],a[16:19]
dr v[128:131],v18 offset:2048
mm a[20:23],v[116:119],v[64:67],a[20:23]
mm a[24:27],v[120:123],v[64:67],a[24:27]
dt v[164:165],v21 offset:16384
mm a[28:31],v[124:127],v[64:67],a[28:31]
mm a[60:63],v[124:127],v[68:71],a[60:63]
dt v[166:167],v21 offset:24576
mm a[56:59],v[120:123],v[68:71],a[56:59]
mm a[52:55],v[116:119],v[68:71],a[52:55]
dr v[132:135],v18 offset:2304
mm a[48:51],v[112:115],v[68:71],a[48:51]
mm a[44:47],v[108:111],v[68:71],a[44:47]
dt v[168:169],v22 offset:16384
mm a[40:43],v[104:107],v[68:71],a[40:43]
mm a[36:39],v[100:103],v[68:71],a[36:39]
dt v[170:171],v22 offset:24576
mm a[32:35],v[96:99],v[68:71],a[32:35]
mm a[64:67],v[96:99],v[72:75],a[64:67]
dr v[136:139],v18 offset:6144
mm a[68:71],v[100:103],v[72:75],a[68:71]
mm a[72:75],v[104:107],v[72:75],a[72:75]
dt v[172:173],v23 offset:16384
mm a[76:79],v[108:111],v[72:75],a[76:79]
mm a[80:83],v[112:115],v[72:75],a[80:83]
dt v[174:175],v23 offset:24576
mm a[84:87],v[116:119],v[72:75],a[84:87]
mm a[88:91],v[120:123],v[72:75],a[88:91]
dr v[140:143],v18 offset:6400
mm a[92:95],v[124:127],v[72:75],a[92:95]
mm a[124:127],v[124:127],v[76:79],a[124:127]
dt v[176:177],v24 offset:16384
mm a[120:123],v[120:123],v[76:79],a[120:123]
mm a[116:119],v[116:119],v[76:79],a[116:119]
dt v[178:179],v24 offset:24576
mm a[112:115],v[112:115],v[76:79],a[112:115]
mm a[108:111],v[108:111],v[76:79],a[108:111]
dr v[144:147],v18 offset:10240
mm a[104:107],v[104:107],v[76:79],a[104:107]
mm a[100:103],v[100:103],v[76:79],a[100:103]
dt v[180:181],v25 offset:16384
mm a[96:99],v[96:99],v[76:79],a[96:99]
mm a[128:131],v[96:99],v[80:83],a[128:131]
dt v[182:183],v25 offset:24576
mm a[132:135],v[100:103],v[80:83],a[132:135]
mm a[136:139],v[104:107],v[80:83],a[136:139]
dr v[148:151],v18 offset:10496
mm a[140:143],v[108:111],v[80:83],a[140:143]
mm a[144:147],v[112:115],v[80:83],a[144:147]
dt v[184:185],v26 offset:16384
mm a[148:151],v[116:119],v[80:83],a[148:151]
mm a[152:155],v[120:123],v[80:83],a[152:155]
dt v[186:187],v26 offset:24576
mm a[156:159],v[124:127],v[80:83],a[156:159]
mm a[188:191],v[124:127],v[84:87],a[188:191]
dr v[152:155],v18 offset:14336
mm a[184:187],v[120:123],v[84:87],a[184:187]
mm a[180:183],v[116:119],v[84:87],a[180:183]
dt v[188:189],v27 offset:16384
mm a[176:179],v[112:115],v[84:87],a[176:179]
mm a[172:175],v[108:111],v[84:87],a[172:175]
dt v[190:191],v27 offset:24576
mm a[168:171],v[104:107],v[84:87],a[168:171]
mm a[164:167],v[100:103],v[84:87],a[164:167]
dr v[156:159],v18 offset:14592
mm a[160:163],v[96:99],v[84:87],a[160:163]
mm a[192:195],v[96:99],v[88:91],a[192:195]
mm a[196:199],v[100:103],v[88:91],a[196:199]
mm a[200:203],v[104:107],v[88:91],a[200:203]
mm a[204:207],v[108:111],v[88:91],a[204:207]
mm a[208:211],v[112:115],v[88:91],a[208:211]
mm a[212:215],v[116:119],v[88:91],a[212:215]
mm a[216:219],v[120:123],v[88:91],a[216:219]
mm a[220:223],v[124:127],v[88:91],a[220:223]
mm a[252:255],v[124:127],v[92:95],a[252:255]
mm a[248:251],v[120:123],v[92:95],a[248:251]
mm a[244:247],v[116:119],v[92:95],a[244:247]
mm a[240:243],v[112:115],v[92:95],a[240:243]
mm a[236:239],v[108:111],v[92:95],a[236:239]
mm a[232:235],v[104:107],v[92:95],a[232:235]
mm a[228:231],v[100:103],v[92:95],a[228:231]
mm a[224:227],v[96:99],v[92:95],a[224:227]
wt vmcnt(0) lgkmcnt(0)
s_barrier
mm a[0:3],v[160:163],v[128:131],a[0:3]
dt v[96:97],v20 offset:32768
s_add_u32 m0,s43,0
s_xor_b32 s79,s40,s45
mm a[4:7],v[164:167],v[128:131],a[4:7]
l4 v2,s[8:11],s79 offen sc1 lds
mm a[8:11],v[168:171],v[128:131],a[8:11]
dt v[98:99],v20 offset:40960
mm a[12:15],v[172:175],v[128:131],a[12:15]
mm a[16:19],v[176:179],v[128:131],a[16:19]
dr v[64:67],v18 offset:32768
mm a[20:23],v[180:183],v[128:131],a[20:23]
l4 v2,s[8:11],s79 offen offset:1024 sc1 lds
mm a[24:27],v[184:187],v[128:131],a[24:27]
dt v[100:101],v21 offset:32768
mm a[28:31],v[188:191],v[128:131],a[28:31]
mm a[60:63],v[188:191],v[132:135],a[60:63]
dt v[102:103],v21 offset:40960
mm a[56:59],v[184:187],v[132:135],a[56:59]
l4 v2,s[8:11],s79 offen offset:2048 sc1 lds
mm a[52:55],v[180:183],v[132:135],a[52:55]
dr v[68:71],v18 offset:33024
mm a[48:51],v[176:179],v[132:135],a[48:51]
mm a[44:47],v[172:175],v[132:135],a[44:47]
dt v[104:105],v22 offset:32768
mm a[40:43],v[168:171],v[132:135],a[40:43]
l4 v2,s[8:11],s79 offen offset:3072 sc1 lds
mm a[36:39],v[164:167],v[132:135],a[36:39]
dt v[106:107],v22 offset:40960
mm a[32:35],v[160:163],v[132:135],a[32:35]
s_add_u32 m0,s43,4096
s_xor_b32 s79,s79,4096
mm a[64:67],v[160:163],v[136:139],a[64:67]
dr v[72:75],v18 offset:36864
mm a[68:71],v[164:167],v[136:139],a[68:71]
l4 v3,s[8:11],s79 offen sc1 lds
mm a[72:75],v[168:171],v[136:139],a[72:75]
dt v[108:109],v23 offset:32768
mm a[76:79],v[172:175],v[136:139],a[76:79]
mm a[80:83],v[176:179],v[136:139],a[80:83]
dt v[110:111],v23 offset:40960
mm a[84:87],v[180:183],v[136:139],a[84:87]
l4 v3,s[8:11],s79 offen offset:1024 sc1 lds
mm a[88:91],v[184:187],v[136:139],a[88:91]
dr v[76:79],v18 offset:37120
mm a[92:95],v[188:191],v[136:139],a[92:95]
mm a[124:127],v[188:191],v[140:143],a[124:127]
dt v[112:113],v24 offset:32768
mm a[120:123],v[184:187],v[140:143],a[120:123]
l4 v3,s[8:11],s79 offen offset:2048 sc1 lds
mm a[116:119],v[180:183],v[140:143],a[116:119]
dt v[114:115],v24 offset:40960
mm a[112:115],v[176:179],v[140:143],a[112:115]
mm a[108:111],v[172:175],v[140:143],a[108:111]
dr v[80:83],v18 offset:40960
mm a[104:107],v[168:171],v[140:143],a[104:107]
l4 v3,s[8:11],s79 offen offset:3072 sc1 lds
mm a[100:103],v[164:167],v[140:143],a[100:103]
dt v[116:117],v25 offset:32768
mm a[96:99],v[160:163],v[140:143],a[96:99]
s_add_u32 s40,s40,4096
s_add_u32 m0,s44,0
mm a[128:131],v[160:163],v[144:147],a[128:131]
dt v[118:119],v25 offset:40960
mm a[132:135],v[164:167],v[144:147],a[132:135]
l4 v10,s[32:35],s41 offen lds
mm a[136:139],v[168:171],v[144:147],a[136:139]
dr v[84:87],v18 offset:41216
mm a[140:143],v[172:175],v[144:147],a[140:143]
mm a[144:147],v[176:179],v[144:147],a[144:147]
dt v[120:121],v26 offset:32768
mm a[148:151],v[180:183],v[144:147],a[148:151]
l4 v11,s[32:35],s41 offen offset:1024 lds
mm a[152:155],v[184:187],v[144:147],a[152:155]
dt v[122:123],v26 offset:40960
mm a[156:159],v[188:191],v[144:147],a[156:159]
mm a[188:191],v[188:191],v[148:151],a[188:191]
dr v[88:91],v18 offset:45056
mm a[184:187],v[184:187],v[148:151],a[184:187]
l4 v12,s[32:35],s41 offen offset:2048 lds
mm a[180:183],v[180:183],v[148:151],a[180:183]
dt v[124:125],v27 offset:32768
mm a[176:179],v[176:179],v[148:151],a[176:179]
mm a[172:175],v[172:175],v[148:151],a[172:175]
dt v[126:127],v27 offset:40960
mm a[168:171],v[168:171],v[148:151],a[168:171]
l4 v13,s[32:35],s41 offen offset:3072 lds
mm a[164:167],v[164:167],v[148:151],a[164:167]
dr v[92:95],v18 offset:45312
mm a[160:163],v[160:163],v[148:151],a[160:163]
s_add_u32 m0,s44,4096
mm a[192:195],v[160:163],v[152:155],a[192:195]
l4 v14,s[32:35],s41 offen lds
mm a[196:199],v[164:167],v[152:155],a[196:199]
mm a[200:203],v[168:171],v[152:155],a[200:203]
mm a[204:207],v[172:175],v[152:155],a[204:207]
l4 v15,s[32:35],s41 offen offset:1024 lds
mm a[208:211],v[176:179],v[152:155],a[208:211]
mm a[212:215],v[180:183],v[152:155],a[212:215]
mm a[216:219],v[184:187],v[152:155],a[216:219]
l4 v16,s[32:35],s41 offen offset:2048 lds
mm a[220:223],v[188:191],v[152:155],a[220:223]
mm a[252:255],v[188:191],v[156:159],a[252:255]
mm a[248:251],v[184:187],v[156:159],a[248:251]
l4 v17,s[32:35],s41 offen offset:3072 lds
mm a[244:247],v[180:183],v[156:159],a[244:247]
s_add_u32 s41,s41,s46
mm a[240:243],v[176:179],v[156:159],a[240:243]
mm a[236:239],v[172:175],v[156:159],a[236:239]
wt lgkmcnt(0)
mm a[232:235],v[168:171],v[156:159],a[232:235]
mm a[228:231],v[164:167],v[156:159],a[228:231]
mm a[224:227],v[160:163],v[156:159],a[224:227]
mm a[0:3],v[96:99],v[64:67],a[0:3]
dt v[160:161],v20 offset:49152
mm a[4:7],v[100:103],v[64:67],a[4:7]
mm a[8:11],v[104:107],v[64:67],a[8:11]
dt v[162:163],v20 offset:57344
mm a[12:15],v[108:111],v[64:67],a[12:15]
mm a[16:19],v[112:115],v[64:67],a[16:19]
dr v[128:131],v18 offset:34816
mm a[20:23],v[116:119],v[64:67],a[20:23]
mm a[24:27],v[120:123],v[64:67],a[24:27]
dt v[164:165],v21 offset:49152
mm a[28:31],v[124:127],v[64:67],a[28:31]
mm a[60:63],v[124:127],v[68:71],a[60:63]
dt v[166:167],v21 offset:57344
mm a[56:59],v[120:123],v[68:71],a[56:59]
mm a[52:55],v[116:119],v[68:71],a[52:55]
dr v[132:135],v18 offset:35072
mm a[48:51],v[112:115],v[68:71],a[48:51]
mm a[44:47],v[108:111],v[68:71],a[44:47]
dt v[168:169],v22 offset:49152
mm a[40:43],v[104:107],v[68:71],a[40:43]
mm a[36:39],v[100:103],v[68:71],a[36:39]
dt v[170:171],v22 offset:57344
mm a[32:35],v[96:99],v[68:71],a[32:35]
mm a[64:67],v[96:99],v[72:75],a[64:67]
dr v[136:139],v18 offset:38912
mm a[68:71],v[100:103],v[72:75],a[68:71]
mm a[72:75],v[104:107],v[72:75],a[72:75]
dt v[172:173],v23 offset:49152
mm a[76:79],v[108:111],v[72:75],a[76:79]
mm a[80:83],v[112:115],v[72:75],a[80:83]
dt v[174:175],v23 offset:57344
mm a[84:87],v[116:119],v[72:75],a[84:87]
mm a[88:91],v[120:123],v[72:75],a[88:91]
dr v[140:143],v18 offset:39168
mm a[92:95],v[124:127],v[72:75],a[92:95]
mm a[124:127],v[124:127],v[76:79],a[124:127]
dt v[176:177],v24 offset:49152
mm a[120:123],v[120:123],v[76:79],a[120:123]
mm a[116:119],v[116:119],v[76:79],a[116:119]
dt v[178:179],v24 offset:57344
mm a[112:115],v[112:115],v[76:79],a[112:115]
mm a[108:111],v[108:111],v[76:79],a[108:111]
dr v[144:147],v18 offset:43008
mm a[104:107],v[104:107],v[76:79],a[104:107]
mm a[100:103],v[100:103],v[76:79],a[100:103]
dt v[180:181],v25 offset:49152
mm a[96:99],v[96:99],v[76:79],a[96:99]
mm a[128:131],v[96:99],v[80:83],a[128:131]
dt v[182:183],v25 offset:57344
mm a[132:135],v[100:103],v[80:83],a[132:135]
mm a[136:139],v[104:107],v[80:83],a[136:139]
dr v[148:151],v18 offset:43264
mm a[140:143],v[108:111],v[80:83],a[140:143]
mm a[144:147],v[112:115],v[80:83],a[144:147]
dt v[184:185],v26 offset:49152
mm a[148:151],v[116:119],v[80:83],a[148:151]
mm a[152:155],v[120:123],v[80:83],a[152:155]
dt v[186:187],v26 offset:57344
mm a[156:159],v[124:127],v[80:83],a[156:159]
mm a[188:191],v[124:127],v[84:87],a[188:191]
dr v[152:155],v18 offset:47104
mm a[184:187],v[120:123],v[84:87],a[184:187]
mm a[180:183],v[116:119],v[84:87],a[180:183]
dt v[188:189],v27 offset:49152
mm a[176:179],v[112:115],v[84:87],a[176:179]
mm a[172:175],v[108:111],v[84:87],a[172:175]
dt v[190:191],v27 offset:57344
mm a[168:171],v[104:107],v[84:87],a[168:171]
mm a[164:167],v[100:103],v[84:87],a[164:167]
dr v[156:159],v18 offset:47360
mm a[160:163],v[96:99],v[84:87],a[160:163]
mm a[192:195],v[96:99],v[88:91],a[192:195]
mm a[196:199],v[100:103],v[88:91],a[196:199]
mm a[200:203],v[104:107],v[88:91],a[200:203]
mm a[204:207],v[108:111],v[88:91],a[204:207]
mm a[208:211],v[112:115],v[88:91],a[208:211]
mm a[212:215],v[116:119],v[88:91],a[212:215]
mm a[216:219],v[120:123],v[88:91],a[216:219]
mm a[220:223],v[124:127],v[88:91],a[220:223]
mm a[252:255],v[124:127],v[92:95],a[252:255]
mm a[248:251],v[120:123],v[92:95],a[248:251]
mm a[244:247],v[116:119],v[92:95],a[244:247]
mm a[240:243],v[112:115],v[92:95],a[240:243]
mm a[236:239],v[108:111],v[92:95],a[236:239]
mm a[232:235],v[104:107],v[92:95],a[232:235]
mm a[228:231],v[100:103],v[92:95],a[228:231]
mm a[224:227],v[96:99],v[92:95],a[224:227]
wt vmcnt(0) lgkmcnt(0)
s_barrier
mm a[0:3],v[160:163],v[128:131],a[0:3]
dt v[96:97],v20 offset:0
s_add_u32 m0,s43,32768
s_xor_b32 s79,s40,s45
mm a[4:7],v[164:167],v[128:131],a[4:7]
l4 v2,s[8:11],s79 offen sc1 lds
mm a[8:11],v[168:171],v[128:131],a[8:11]
dt v[98:99],v20 offset:8192
mm a[12:15],v[172:175],v[128:131],a[12:15]
mm a[16:19],v[176:179],v[128:131],a[16:19]
dr v[64:67],v18 offset:0
mm a[20:23],v[180:183],v[128:131],a[20:23]
l4 v2,s[8:11],s79 offen offset:1024 sc1 lds
mm a[24:27],v[184:187],v[128:131],a[24:27]
dt v[100:101],v21 offset:0
mm a[28:31],v[188:191],v[128:131],a[28:31]
mm a[60:63],v[188:191],v[132:135],a[60:63]
dt v[102:103],v21 offset:8192
mm a[56:59],v[184:187],v[132:135],a[56:59]
l4 v2,s[8:11],s79 offen offset:2048 sc1 lds
mm a[52:55],v[180:183],v[132:135],a[52:55]
dr v[68:71],v18 offset:256
mm a[48:51],v[176:179],v[132:135],a[48:51]
mm a[44:47],v[172:175],v[132:135],a[44:47]
dt v[104:105],v22 offset:0
mm a[40:43],v[168:171],v[132:135],a[40:43]
l4 v2,s[8:11],s79 offen offset:3072 sc1 lds
mm a[36:39],v[164:167],v[132:135],a[36:39]
dt v[106:107],v22 offset:8192
mm a[32:35],v[160:163],v[132:135],a[32:35]
s_add_u32 m0,s43,36864
s_xor_b32 s79,s79,4096
mm a[64:67],v[160:163],v[136:139],a[64:67]
dr v[72:75],v18 offset:4096
mm a[68:71],v[164:167],v[136:139],a[68:71]
l4 v3,s[8:11],s79 offen sc1 lds
mm a[72:75],v[168:171],v[136:139],a[72:75]
dt v[108:109],v23 offset:0
mm a[76:79],v[172:175],v[136:139],a[76:79]
mm a[80:83],v[176:179],v[136:139],a[80:83]
dt v[110:111],v23 offset:8192
mm a[84:87],v[180:183],v[136:139],a[84:87]
l4 v3,s[8:11],s79 offen offset:1024 sc1 lds
mm a[88:91],v[184:187],v[136:139],a[88:91]
dr v[76:79],v18 offset:4352
mm a[92:95],v[188:191],v[136:139],a[92:95]
mm a[124:127],v[188:191],v[140:143],a[124:127]
dt v[112:113],v24 offset:0
mm a[120:123],v[184:187],v[140:143],a[120:123]
l4 v3,s[8:11],s79 offen offset:2048 sc1 lds
mm a[116:119],v[180:183],v[140:143],a[116:119]
dt v[114:115],v24 offset:8192
mm a[112:115],v[176:179],v[140:143],a[112:115]
mm a[108:111],v[172:175],v[140:143],a[108:111]
dr v[80:83],v18 offset:8192
mm a[104:107],v[168:171],v[140:143],a[104:107]
l4 v3,s[8:11],s79 offen offset:3072 sc1 lds
mm a[100:103],v[164:167],v[140:143],a[100:103]
dt v[116:117],v25 offset:0
mm a[96:99],v[160:163],v[140:143],a[96:99]
s_add_u32 s40,s40,12288
s_add_u32 m0,s44,32768
mm a[128:131],v[160:163],v[144:147],a[128:131]
dt v[118:119],v25 offset:8192
mm a[132:135],v[164:167],v[144:147],a[132:135]
l4 v10,s[32:35],s41 offen lds
mm a[136:139],v[168:171],v[144:147],a[136:139]
dr v[84:87],v18 offset:8448
mm a[140:143],v[172:175],v[144:147],a[140:143]
mm a[144:147],v[176:179],v[144:147],a[144:147]
dt v[120:121],v26 offset:0
mm a[148:151],v[180:183],v[144:147],a[148:151]
l4 v11,s[32:35],s41 offen offset:1024 lds
mm a[152:155],v[184:187],v[144:147],a[152:155]
dt v[122:123],v26 offset:8192
mm a[156:159],v[188:191],v[144:147],a[156:159]
mm a[188:191],v[188:191],v[148:151],a[188:191]
dr v[88:91],v18 offset:12288
mm a[184:187],v[184:187],v[148:151],a[184:187]
l4 v12,s[32:35],s41 offen offset:2048 lds
mm a[180:183],v[180:183],v[148:151],a[180:183]
dt v[124:125],v27 offset:0
mm a[176:179],v[176:179],v[148:151],a[176:179]
mm a[172:175],v[172:175],v[148:151],a[172:175]
dt v[126:127],v27 offset:8192
mm a[168:171],v[168:171],v[148:151],a[168:171]
l4 v13,s[32:35],s41 offen offset:3072 lds
mm a[164:167],v[164:167],v[148:151],a[164:167]
dr v[92:95],v18 offset:12544
mm a[160:163],v[160:163],v[148:151],a[160:163]
s_add_u32 m0,s44,36864
mm a[192:195],v[160:163],v[152:155],a[192:195]
l4 v14,s[32:35],s41 offen lds
mm a[196:199],v[164:167],v[152:155],a[196:199]
mm a[200:203],v[168:171],v[152:155],a[200:203]
mm a[204:207],v[172:175],v[152:155],a[204:207]
l4 v15,s[32:35],s41 offen offset:1024 lds
mm a[208:211],v[176:179],v[152:155],a[208:211]
mm a[212:215],v[180:183],v[152:155],a[212:215]
mm a[216:219],v[184:187],v[152:155],a[216:219]
l4 v16,s[32:35],s41 offen offset:2048 lds
mm a[220:223],v[188:191],v[152:155],a[220:223]
mm a[252:255],v[188:191],v[156:159],a[252:255]
mm a[248:251],v[184:187],v[156:159],a[248:251]
l4 v17,s[32:35],s41 offen offset:3072 lds
mm a[244:247],v[180:183],v[156:159],a[244:247]
s_add_u32 s41,s41,s46
mm a[240:243],v[176:179],v[156:159],a[240:243]
mm a[236:239],v[172:175],v[156:159],a[236:239]
wt lgkmcnt(0)
s_sub_u32 s42,s42,1
mm a[232:235],v[168:171],v[156:159],a[232:235]
s_cmp_lg_u32 s42,0
mm a[228:231],v[164:167],v[156:159],a[228:231]
mm a[224:227],v[160:163],v[156:159],a[224:227]
s_cbranch_scc1 G3F_k
mm a[0:3],v[96:99],v[64:67],a[0:3]
dt v[160:161],v20 offset:16384
mm a[4:7],v[100:103],v[64:67],a[4:7]
mm a[8:11],v[104:107],v[64:67],a[8:11]
dt v[162:163],v20 offset:24576
mm a[12:15],v[108:111],v[64:67],a[12:15]
mm a[16:19],v[112:115],v[64:67],a[16:19]
dr v[128:131],v18 offset:2048
mm a[20:23],v[116:119],v[64:67],a[20:23]
mm a[24:27],v[120:123],v[64:67],a[24:27]
dt v[164:165],v21 offset:16384
mm a[28:31],v[124:127],v[64:67],a[28:31]
mm a[60:63],v[124:127],v[68:71],a[60:63]
dt v[166:167],v21 offset:24576
mm a[56:59],v[120:123],v[68:71],a[56:59]
mm a[52:55],v[116:119],v[68:71],a[52:55]
dr v[132:135],v18 offset:2304
mm a[48:51],v[112:115],v[68:71],a[48:51]
mm a[44:47],v[108:111],v[68:71],a[44:47]
dt v[168:169],v22 offset:16384
mm a[40:43],v[104:107],v[68:71],a[40:43]
mm a[36:39],v[100:103],v[68:71],a[36:39]
dt v[170:171],v22 offset:24576
mm a[32:35],v[96:99],v[68:71],a[32:35]
mm a[64:67],v[96:99],v[72:75],a[64:67]
dr v[136:139],v18 offset:6144
mm a[68:71],v[100:103],v[72:75],a[68:71]
mm a[72:75],v[104:107],v[72:75],a[72:75]
dt v[172:173],v23 offset:16384
mm a[76:79],v[108:111],v[72:75],a[76:79]
mm a[80:83],v[112:115],v[72:75],a[80:83]
dt v[174:175],v23 offset:24576
mm a[84:87],v[116:119],v[72:75],a[84:87]
mm a[88:91],v[120:123],v[72:75],a[88:91]
dr v[140:143],v18 offset:6400
mm a[92:95],v[124:127],v[72:75],a[92:95]
mm a[124:127],v[124:127],v[76:79],a[124:127]
dt v[176:177],v24 offset:16384
mm a[120:123],v[120:123],v[76:79],a[120:123]
mm a[116:119],v[116:119],v[76:79],a[116:119]
dt v[178:179],v24 offset:24576
mm a[112:115],v[112:115],v[76:79],a[112:115]
mm a[108:111],v[108:111],v[76:79],a[108:111]
dr v[144:147],v18 offset:10240
mm a[104:107],v[104:107],v[76:79],a[104:107]
mm a[100:103],v[100:103],v[76:79],a[100:103]
dt v[180:181],v25 offset:16384
mm a[96:99],v[96:99],v[76:79],a[96:99]
mm a[128:131],v[96:99],v[80:83],a[128:131]
dt v[182:183],v25 offset:24576
mm a[132:135],v[100:103],v[80:83],a[132:135]
mm a[136:139],v[104:107],v[80:83],a[136:139]
dr v[148:151],v18 offset:10496
mm a[140:143],v[108:111],v[80:83],a[140:143]
mm a[144:147],v[112:115],v[80:83],a[144:147]
dt v[184:185],v26 offset:16384
mm a[148:151],v[116:119],v[80:83],a[148:151]
mm a[152:155],v[120:123],v[80:83],a[152:155]
dt v[186:187],v26 offset:24576
mm a[156:159],v[124:127],v[80:83],a[156:159]
mm a[188:191],v[124:127],v[84:87],a[188:191]
dr v[152:155],v18 offset:14336
mm a[184:187],v[120:123],v[84:87],a[184:187]
mm a[180:183],v[116:119],v[84:87],a[180:183]
dt v[188:189],v27 offset:16384
mm a[176:179],v[112:115],v[84:87],a[176:179]
mm a[172:175],v[108:111],v[84:87],a[172:175]
dt v[190:191],v27 offset:24576
mm a[168:171],v[104:107],v[84:87],a[168:171]
mm a[164:167],v[100:103],v[84:87],a[164:167]
dr v[156:159],v18 offset:14592
mm a[160:163],v[96:99],v[84:87],a[160:163]
mm a[192:195],v[96:99],v[88:91],a[192:195]
mm a[196:199],v[100:103],v[88:91],a[196:199]
mm a[200:203],v[104:107],v[88:91],a[200:203]
mm a[204:207],v[108:111],v[88:91],a[204:207]
mm a[208:211],v[112:115],v[88:91],a[208:211]
mm a[212:215],v[116:119],v[88:91],a[212:215]
mm a[216:219],v[120:123],v[88:91],a[216:219]
mm a[220:223],v[124:127],v[88:91],a[220:223]
mm a[252:255],v[124:127],v[92:95],a[252:255]
mm a[248:251],v[120:123],v[92:95],a[248:251]
mm a[244:247],v[116:119],v[92:95],a[244:247]
mm a[240:243],v[112:115],v[92:95],a[240:243]
mm a[236:239],v[108:111],v[92:95],a[236:239]
mm a[232:235],v[104:107],v[92:95],a[232:235]
mm a[228:231],v[100:103],v[92:95],a[228:231]
mm a[224:227],v[96:99],v[92:95],a[224:227]
wt vmcnt(0) lgkmcnt(0)
s_barrier
mm a[0:3],v[160:163],v[128:131],a[0:3]
dt v[96:97],v20 offset:32768
mm a[4:7],v[164:167],v[128:131],a[4:7]
mm a[8:11],v[168:171],v[128:131],a[8:11]
dt v[98:99],v20 offset:40960
mm a[12:15],v[172:175],v[128:131],a[12:15]
mm a[16:19],v[176:179],v[128:131],a[16:19]
dr v[64:67],v18 offset:32768
mm a[20:23],v[180:183],v[128:131],a[20:23]
mm a[24:27],v[184:187],v[128:131],a[24:27]
dt v[100:101],v21 offset:32768
mm a[28:31],v[188:191],v[128:131],a[28:31]
mm a[60:63],v[188:191],v[132:135],a[60:63]
dt v[102:103],v21 offset:40960
mm a[56:59],v[184:187],v[132:135],a[56:59]
mm a[52:55],v[180:183],v[132:135],a[52:55]
dr v[68:71],v18 offset:33024
mm a[48:51],v[176:179],v[132:135],a[48:51]
mm a[44:47],v[172:175],v[132:135],a[44:47]
dt v[104:105],v22 offset:32768
mm a[40:43],v[168:171],v[132:135],a[40:43]
mm a[36:39],v[164:167],v[132:135],a[36:39]
dt v[106:107],v22 offset:40960
mm a[32:35],v[160:163],v[132:135],a[32:35]
mm a[64:67],v[160:163],v[136:139],a[64:67]
dr v[72:75],v18 offset:36864
mm a[68:71],v[164:167],v[136:139],a[68:71]
mm a[72:75],v[168:171],v[136:139],a[72:75]
dt v[108:109],v23 offset:32768
mm a[76:79],v[172:175],v[136:139],a[76:79]
mm a[80:83],v[176:179],v[136:139],a[80:83]
dt v[110:111],v23 offset:40960
mm a[84:87],v[180:183],v[136:139],a[84:87]
mm a[88:91],v[184:187],v[136:139],a[88:91]
dr v[76:79],v18 offset:37120
mm a[92:95],v[188:191],v[136:139],a[92:95]
mm a[124:127],v[188:191],v[140:143],a[124:127]
dt v[112:113],v24 offset:32768
mm a[120:123],v[184:187],v[140:143],a[120:123]
mm a[116:119],v[180:183],v[140:143],a[116:119]
dt v[114:115],v24 offset:40960
mm a[112:115],v[176:179],v[140:143],a[112:115]
mm a[108:111],v[172:175],v[140:143],a[108:111]
dr v[80:83],v18 offset:40960
mm a[104:107],v[168:171],v[140:143],a[104:107]
mm a[100:103],v[164:167],v[140:143],a[100:103]
dt v[116:117],v25 offset:32768
mm a[96:99],v[160:163],v[140:143],a[96:99]
mm a[128:131],v[160:163],v[144:147],a[128:131]
dt v[118:119],v25 offset:40960
mm a[132:135],v[164:167],v[144:147],a[132:135]
mm a[136:139],v[168:171],v[144:147],a[136:139]
dr v[84:87],v18 offset:41216
mm a[140:143],v[172:175],v[144:147],a[140:143]
mm a[144:147],v[176:179],v[144:147],a[144:147]
dt v[120:121],v26 offset:32768
mm a[148:151],v[180:183],v[144:147],a[148:151]
mm a[152:155],v[184:187],v[144:147],a[152:155]
dt v[122:123],v26 offset:40960
mm a[156:159],v[188:191],v[144:147],a[156:159]
mm a[188:191],v[188:191],v[148:151],a[188:191]
dr v[88:91],v18 offset:45056
mm a[184:187],v[184:187],v[148:151],a[184:187]
mm a[180:183],v[180:183],v[148:151],a[180:183]
dt v[124:125],v27 offset:32768
mm a[176:179],v[176:179],v[148:151],a[176:179]
mm a[172:175],v[172:175],v[148:151],a[172:175]
dt v[126:127],v27 offset:40960
mm a[168:171],v[168:171],v[148:151],a[168:171]
mm a[164:167],v[164:167],v[148:151],a[164:167]
dr v[92:95],v18 offset:45312
mm a[160:163],v[160:163],v[148:151],a[160:163]
mm a[192:195],v[160:163],v[152:155],a[192:195]
mm a[196:199],v[164:167],v[152:155],a[196:199]
mm a[200:203],v[168:171],v[152:155],a[200:203]
mm a[204:207],v[172:175],v[152:155],a[204:207]
mm a[208:211],v[176:179],v[152:155],a[208:211]
mm a[212:215],v[180:183],v[152:155],a[212:215]
mm a[216:219],v[184:187],v[152:155],a[216:219]
mm a[220:223],v[188:191],v[152:155],a[220:223]
mm a[252:255],v[188:191],v[156:159],a[252:255]
mm a[248:251],v[184:187],v[156:159],a[248:251]
mm a[244:247],v[180:183],v[156:159],a[244:247]
mm a[240:243],v[176:179],v[156:159],a[240:243]
mm a[236:239],v[172:175],v[156:159],a[236:239]
mm a[232:235],v[168:171],v[156:159],a[232:235]
mm a[228:231],v[164:167],v[156:159],a[228:231]
mm a[224:227],v[160:163],v[156:159],a[224:227]
wt lgkmcnt(0)
mm a[0:3],v[96:99],v[64:67],a[0:3]
dt v[160:161],v20 offset:49152
mm a[4:7],v[100:103],v[64:67],a[4:7]
mm a[8:11],v[104:107],v[64:67],a[8:11]
dt v[162:163],v20 offset:57344
mm a[12:15],v[108:111],v[64:67],a[12:15]
mm a[16:19],v[112:115],v[64:67],a[16:19]
dr v[128:131],v18 offset:34816
mm a[20:23],v[116:119],v[64:67],a[20:23]
mm a[24:27],v[120:123],v[64:67],a[24:27]
dt v[164:165],v21 offset:49152
mm a[28:31],v[124:127],v[64:67],a[28:31]
mm a[60:63],v[124:127],v[68:71],a[60:63]
dt v[166:167],v21 offset:57344
mm a[56:59],v[120:123],v[68:71],a[56:59]
mm a[52:55],v[116:119],v[68:71],a[52:55]
dr v[132:135],v18 offset:35072
mm a[48:51],v[112:115],v[68:71],a[48:51]
mm a[44:47],v[108:111],v[68:71],a[44:47]
dt v[168:169],v22 offset:49152
mm a[40:43],v[104:107],v[68:71],a[40:43]
mm a[36:39],v[100:103],v[68:71],a[36:39]
dt v[170:171],v22 offset:57344
mm a[32:35],v[96:99],v[68:71],a[32:35]
mm a[64:67],v[96:99],v[72:75],a[64:67]
dr v[136:139],v18 offset:38912
mm a[68:71],v[100:103],v[72:75],a[68:71]
mm a[72:75],v[104:107],v[72:75],a[72:75]
dt v[172:173],v23 offset:49152
mm a[76:79],v[108:111],v[72:75],a[76:79]
mm a[80:83],v[112:115],v[72:75],a[80:83]
dt v[174:175],v23 offset:57344
mm a[84:87],v[116:119],v[72:75],a[84:87]
mm a[88:91],v[120:123],v[72:75],a[88:91]
dr v[140:143],v18 offset:39168
mm a[92:95],v[124:127],v[72:75],a[92:95]
mm a[124:127],v[124:127],v[76:79],a[124:127]
dt v[176:177],v24 offset:49152
mm a[120:123],v[120:123],v[76:79],a[120:123]
mm a[116:119],v[116:119],v[76:79],a[116:119]
dt v[178:179],v24 offset:57344
mm a[112:115],v[112:115],v[76:79],a[112:115]
mm a[108:111],v[108:111],v[76:79],a[108:111]
dr v[144:147],v18 offset:43008
mm a[104:107],v[104:107],v[76:79],a[104:107]
mm a[100:103],v[100:103],v[76:79],a[100:103]
dt v[180:181],v25 offset:49152
mm a[96:99],v[96:99],v[76:79],a[96:99]
mm a[128:131],v[96:99],v[80:83],a[128:131]
dt v[182:183],v25 offset:57344
mm a[132:135],v[100:103],v[80:83],a[132:135]
mm a[136:139],v[104:107],v[80:83],a[136:139]
dr v[148:151],v18 offset:43264
mm a[140:143],v[108:111],v[80:83],a[140:143]
mm a[144:147],v[112:115],v[80:83],a[144:147]
dt v[184:185],v26 offset:49152
mm a[148:151],v[116:119],v[80:83],a[148:151]
mm a[152:155],v[120:123],v[80:83],a[152:155]
dt v[186:187],v26 offset:57344
mm a[156:159],v[124:127],v[80:83],a[156:159]
mm a[188:191],v[124:127],v[84:87],a[188:191]
dr v[152:155],v18 offset:47104
mm a[184:187],v[120:123],v[84:87],a[184:187]
mm a[180:183],v[116:119],v[84:87],a[180:183]
dt v[188:189],v27 offset:49152
mm a[176:179],v[112:115],v[84:87],a[176:179]
mm a[172:175],v[108:111],v[84:87],a[172:175]
dt v[190:191],v27 offset:57344
mm a[168:171],v[104:107],v[84:87],a[168:171]
mm a[164:167],v[100:103],v[84:87],a[164:167]
dr v[156:159],v18 offset:47360
mm a[160:163],v[96:99],v[84:87],a[160:163]
mm a[192:195],v[96:99],v[88:91],a[192:195]
mm a[196:199],v[100:103],v[88:91],a[196:199]
mm a[200:203],v[104:107],v[88:91],a[200:203]
mm a[204:207],v[108:111],v[88:91],a[204:207]
mm a[208:211],v[112:115],v[88:91],a[208:211]
mm a[212:215],v[116:119],v[88:91],a[212:215]
mm a[216:219],v[120:123],v[88:91],a[216:219]
mm a[220:223],v[124:127],v[88:91],a[220:223]
mm a[252:255],v[124:127],v[92:95],a[252:255]
mm a[248:251],v[120:123],v[92:95],a[248:251]
mm a[244:247],v[116:119],v[92:95],a[244:247]
mm a[240:243],v[112:115],v[92:95],a[240:243]
mm a[236:239],v[108:111],v[92:95],a[236:239]
mm a[232:235],v[104:107],v[92:95],a[232:235]
mm a[228:231],v[100:103],v[92:95],a[228:231]
mm a[224:227],v[96:99],v[92:95],a[224:227]
wt lgkmcnt(0)
mm a[0:3],v[160:163],v[128:131],a[0:3]
mm a[4:7],v[164:167],v[128:131],a[4:7]
mm a[8:11],v[168:171],v[128:131],a[8:11]
mm a[12:15],v[172:175],v[128:131],a[12:15]
mm a[16:19],v[176:179],v[128:131],a[16:19]
mm a[20:23],v[180:183],v[128:131],a[20:23]
mm a[24:27],v[184:187],v[128:131],a[24:27]
mm a[28:31],v[188:191],v[128:131],a[28:31]
mm a[60:63],v[188:191],v[132:135],a[60:63]
mm a[56:59],v[184:187],v[132:135],a[56:59]
mm a[52:55],v[180:183],v[132:135],a[52:55]
mm a[48:51],v[176:179],v[132:135],a[48:51]
mm a[44:47],v[172:175],v[132:135],a[44:47]
mm a[40:43],v[168:171],v[132:135],a[40:43]
mm a[36:39],v[164:167],v[132:135],a[36:39]
mm a[32:35],v[160:163],v[132:135],a[32:35]
mm a[64:67],v[160:163],v[136:139],a[64:67]
mm a[68:71],v[164:167],v[136:139],a[68:71]
mm a[72:75],v[168:171],v[136:139],a[72:75]
mm a[76:79],v[172:175],v[136:139],a[76:79]
mm a[80:83],v[176:179],v[136:139],a[80:83]
mm a[84:87],v[180:183],v[136:139],a[84:87]
mm a[88:91],v[184:187],v[136:139],a[88:91]
mm a[92:95],v[188:191],v[136:139],a[92:95]
mm a[124:127],v[188:191],v[140:143],a[124:127]
mm a[120:123],v[184:187],v[140:143],a[120:123]
mm a[116:119],v[180:183],v[140:143],a[116:119]
mm a[112:115],v[176:179],v[140:143],a[112:115]
mm a[108:111],v[172:175],v[140:143],a[108:111]
mm a[104:107],v[168:171],v[140:143],a[104:107]
mm a[100:103],v[164:167],v[140:143],a[100:103]
mm a[96:99],v[160:163],v[140:143],a[96:99]
mm a[128:131],v[160:163],v[144:147],a[128:131]
mm a[132:135],v[164:167],v[144:147],a[132:135]
mm a[136:139],v[168:171],v[144:147],a[136:139]
mm a[140:143],v[172:175],v[144:147],a[140:143]
mm a[144:147],v[176:179],v[144:147],a[144:147]
mm a[148:151],v[180:183],v[144:147],a[148:151]
mm a[152:155],v[184:187],v[144:147],a[152:155]
mm a[156:159],v[188:191],v[144:147],a[156:159]
mm a[188:191],v[188:191],v[148:151],a[188:191]
mm a[184:187],v[184:187],v[148:151],a[184:187]
mm a[180:183],v[180:183],v[148:151],a[180:183]
mm a[176:179],v[176:179],v[148:151],a[176:179]
mm a[172:175],v[172:175],v[148:151],a[172:175]
mm a[168:171],v[168:171],v[148:151],a[168:171]
mm a[164:167],v[164:167],v[148:151],a[164:167]
mm a[160:163],v[160:163],v[148:151],a[160:163]
mm a[192:195],v[160:163],v[152:155],a[192:195]
mm a[196:199],v[164:167],v[152:155],a[196:199]
mm a[200:203],v[168:171],v[152:155],a[200:203]
mm a[204:207],v[172:175],v[152:155],a[204:207]
mm a[208:211],v[176:179],v[152:155],a[208:211]
mm a[212:215],v[180:183],v[152:155],a[212:215]
mm a[216:219],v[184:187],v[152:155],a[216:219]
mm a[220:223],v[188:191],v[152:155],a[220:223]
mm a[252:255],v[188:191],v[156:159],a[252:255]
mm a[248:251],v[184:187],v[156:159],a[248:251]
mm a[244:247],v[180:183],v[156:159],a[244:247]
mm a[240:243],v[176:179],v[156:159],a[240:243]
mm a[236:239],v[172:175],v[156:159],a[236:239]
mm a[232:235],v[168:171],v[156:159],a[232:235]
mm a[228:231],v[164:167],v[156:159],a[228:231]
mm a[224:227],v[160:163],v[156:159],a[224:227]
v_mov_b32 v45,0
buffer_load_dword v44,v45,s[8:11],s24 offen sc1
v_bfe_u32 v30,v1,0,4
v_lshlrev_b32 v30,12,v30
v_bfe_u32 v31,v1,4,1
v_lshl_add_u32 v30,v31,5,v30
v_bfe_u32 v31,v1,5,1
v_lshl_add_u32 v30,v31,4,v30
s_mul_i32 s48,s76,524288
s_mul_i32 s49,s77,256
s_add_u32 s48,s48,s49
s_add_u32 s48,s48,s93
ar v192,a0
ar v193,a1
ar v194,a2
ar v195,a3
ar v196,a4
ar v197,a5
ar v198,a6
ar v199,a7
cv v200,v192,v193
cv v201,v194,v195
cv v202,v196,v197
cv v203,v198,v199
ar v204,a8
ar v205,a9
ar v206,a10
ar v207,a11
ar v208,a12
ar v209,a13
ar v210,a14
ar v211,a15
v_permlane16_swap_b32 v200,v202
v_permlane16_swap_b32 v201,v203
w4 v[200:203],v30,s[36:39],s48 offen sc1
cv v212,v204,v205
cv v213,v206,v207
cv v214,v208,v209
cv v215,v210,v211
ar v216,a16
ar v217,a17
ar v218,a18
ar v219,a19
ar v220,a20
ar v221,a21
ar v222,a22
ar v223,a23
v_permlane16_swap_b32 v212,v214
v_permlane16_swap_b32 v213,v215
w4 v[212:215],v30,s[36:39],s48 offen offset:64 sc1
cv v224,v216,v217
cv v225,v218,v219
cv v226,v220,v221
cv v227,v222,v223
ar v228,a24
ar v229,a25
ar v230,a26
ar v231,a27
ar v232,a28
ar v233,a29
ar v234,a30
ar v235,a31
v_permlane16_swap_b32 v224,v226
v_permlane16_swap_b32 v225,v227
w4 v[224:227],v30,s[36:39],s48 offen offset:128 sc1
cv v236,v228,v229
cv v237,v230,v231
cv v238,v232,v233
cv v239,v234,v235
ar v192,a32
ar v193,a33
ar v194,a34
ar v195,a35
ar v196,a36
ar v197,a37
ar v198,a38
ar v199,a39
v_permlane16_swap_b32 v236,v238
v_permlane16_swap_b32 v237,v239
w4 v[236:239],v30,s[36:39],s48 offen offset:192 sc1
s_add_u32 s48,s48,65536
cv v200,v192,v193
cv v201,v194,v195
cv v202,v196,v197
cv v203,v198,v199
ar v204,a40
ar v205,a41
ar v206,a42
ar v207,a43
ar v208,a44
ar v209,a45
ar v210,a46
ar v211,a47
v_permlane16_swap_b32 v200,v202
v_permlane16_swap_b32 v201,v203
w4 v[200:203],v30,s[36:39],s48 offen sc1
cv v212,v204,v205
cv v213,v206,v207
cv v214,v208,v209
cv v215,v210,v211
ar v216,a48
ar v217,a49
ar v218,a50
ar v219,a51
ar v220,a52
ar v221,a53
ar v222,a54
ar v223,a55
v_permlane16_swap_b32 v212,v214
v_permlane16_swap_b32 v213,v215
w4 v[212:215],v30,s[36:39],s48 offen offset:64 sc1
cv v224,v216,v217
cv v225,v218,v219
cv v226,v220,v221
cv v227,v222,v223
ar v228,a56
ar v229,a57
ar v230,a58
ar v231,a59
ar v232,a60
ar v233,a61
ar v234,a62
ar v235,a63
v_permlane16_swap_b32 v224,v226
v_permlane16_swap_b32 v225,v227
w4 v[224:227],v30,s[36:39],s48 offen offset:128 sc1
cv v236,v228,v229
cv v237,v230,v231
cv v238,v232,v233
cv v239,v234,v235
ar v192,a64
ar v193,a65
ar v194,a66
ar v195,a67
ar v196,a68
ar v197,a69
ar v198,a70
ar v199,a71
v_permlane16_swap_b32 v236,v238
v_permlane16_swap_b32 v237,v239
w4 v[236:239],v30,s[36:39],s48 offen offset:192 sc1
s_add_u32 s48,s48,65536
cv v200,v192,v193
cv v201,v194,v195
cv v202,v196,v197
cv v203,v198,v199
ar v204,a72
ar v205,a73
ar v206,a74
ar v207,a75
ar v208,a76
ar v209,a77
ar v210,a78
ar v211,a79
v_permlane16_swap_b32 v200,v202
v_permlane16_swap_b32 v201,v203
w4 v[200:203],v30,s[36:39],s48 offen sc1
cv v212,v204,v205
cv v213,v206,v207
cv v214,v208,v209
cv v215,v210,v211
ar v216,a80
ar v217,a81
ar v218,a82
ar v219,a83
ar v220,a84
ar v221,a85
ar v222,a86
ar v223,a87
v_permlane16_swap_b32 v212,v214
v_permlane16_swap_b32 v213,v215
w4 v[212:215],v30,s[36:39],s48 offen offset:64 sc1
cv v224,v216,v217
cv v225,v218,v219
cv v226,v220,v221
cv v227,v222,v223
ar v228,a88
ar v229,a89
ar v230,a90
ar v231,a91
ar v232,a92
ar v233,a93
ar v234,a94
ar v235,a95
v_permlane16_swap_b32 v224,v226
v_permlane16_swap_b32 v225,v227
w4 v[224:227],v30,s[36:39],s48 offen offset:128 sc1
cv v236,v228,v229
cv v237,v230,v231
cv v238,v232,v233
cv v239,v234,v235
ar v192,a96
ar v193,a97
ar v194,a98
ar v195,a99
ar v196,a100
ar v197,a101
ar v198,a102
ar v199,a103
v_permlane16_swap_b32 v236,v238
v_permlane16_swap_b32 v237,v239
w4 v[236:239],v30,s[36:39],s48 offen offset:192 sc1
s_add_u32 s48,s48,65536
cv v200,v192,v193
cv v201,v194,v195
cv v202,v196,v197
cv v203,v198,v199
ar v204,a104
ar v205,a105
ar v206,a106
ar v207,a107
ar v208,a108
ar v209,a109
ar v210,a110
ar v211,a111
v_permlane16_swap_b32 v200,v202
v_permlane16_swap_b32 v201,v203
w4 v[200:203],v30,s[36:39],s48 offen sc1
cv v212,v204,v205
cv v213,v206,v207
cv v214,v208,v209
cv v215,v210,v211
ar v216,a112
ar v217,a113
ar v218,a114
ar v219,a115
ar v220,a116
ar v221,a117
ar v222,a118
ar v223,a119
v_permlane16_swap_b32 v212,v214
v_permlane16_swap_b32 v213,v215
w4 v[212:215],v30,s[36:39],s48 offen offset:64 sc1
cv v224,v216,v217
cv v225,v218,v219
cv v226,v220,v221
cv v227,v222,v223
ar v228,a120
ar v229,a121
ar v230,a122
ar v231,a123
ar v232,a124
ar v233,a125
ar v234,a126
ar v235,a127
v_permlane16_swap_b32 v224,v226
v_permlane16_swap_b32 v225,v227
w4 v[224:227],v30,s[36:39],s48 offen offset:128 sc1
cv v236,v228,v229
cv v237,v230,v231
cv v238,v232,v233
cv v239,v234,v235
ar v192,a128
ar v193,a129
ar v194,a130
ar v195,a131
ar v196,a132
ar v197,a133
ar v198,a134
ar v199,a135
v_permlane16_swap_b32 v236,v238
v_permlane16_swap_b32 v237,v239
w4 v[236:239],v30,s[36:39],s48 offen offset:192 sc1
s_add_u32 s48,s48,65536
cv v200,v192,v193
cv v201,v194,v195
cv v202,v196,v197
cv v203,v198,v199
ar v204,a136
ar v205,a137
ar v206,a138
ar v207,a139
ar v208,a140
ar v209,a141
ar v210,a142
ar v211,a143
v_permlane16_swap_b32 v200,v202
v_permlane16_swap_b32 v201,v203
w4 v[200:203],v30,s[36:39],s48 offen sc1
cv v212,v204,v205
cv v213,v206,v207
cv v214,v208,v209
cv v215,v210,v211
ar v216,a144
ar v217,a145
ar v218,a146
ar v219,a147
ar v220,a148
ar v221,a149
ar v222,a150
ar v223,a151
v_permlane16_swap_b32 v212,v214
v_permlane16_swap_b32 v213,v215
w4 v[212:215],v30,s[36:39],s48 offen offset:64 sc1
cv v224,v216,v217
cv v225,v218,v219
cv v226,v220,v221
cv v227,v222,v223
ar v228,a152
ar v229,a153
ar v230,a154
ar v231,a155
ar v232,a156
ar v233,a157
ar v234,a158
ar v235,a159
v_permlane16_swap_b32 v224,v226
v_permlane16_swap_b32 v225,v227
w4 v[224:227],v30,s[36:39],s48 offen offset:128 sc1
cv v236,v228,v229
cv v237,v230,v231
cv v238,v232,v233
cv v239,v234,v235
ar v192,a160
ar v193,a161
ar v194,a162
ar v195,a163
ar v196,a164
ar v197,a165
ar v198,a166
ar v199,a167
v_permlane16_swap_b32 v236,v238
v_permlane16_swap_b32 v237,v239
w4 v[236:239],v30,s[36:39],s48 offen offset:192 sc1
s_add_u32 s48,s48,65536
cv v200,v192,v193
cv v201,v194,v195
cv v202,v196,v197
cv v203,v198,v199
ar v204,a168
ar v205,a169
ar v206,a170
ar v207,a171
ar v208,a172
ar v209,a173
ar v210,a174
ar v211,a175
v_permlane16_swap_b32 v200,v202
v_permlane16_swap_b32 v201,v203
w4 v[200:203],v30,s[36:39],s48 offen sc1
cv v212,v204,v205
cv v213,v206,v207
cv v214,v208,v209
cv v215,v210,v211
ar v216,a176
ar v217,a177
ar v218,a178
ar v219,a179
ar v220,a180
ar v221,a181
ar v222,a182
ar v223,a183
v_permlane16_swap_b32 v212,v214
v_permlane16_swap_b32 v213,v215
w4 v[212:215],v30,s[36:39],s48 offen offset:64 sc1
cv v224,v216,v217
cv v225,v218,v219
cv v226,v220,v221
cv v227,v222,v223
ar v228,a184
ar v229,a185
ar v230,a186
ar v231,a187
ar v232,a188
ar v233,a189
ar v234,a190
ar v235,a191
v_permlane16_swap_b32 v224,v226
v_permlane16_swap_b32 v225,v227
w4 v[224:227],v30,s[36:39],s48 offen offset:128 sc1
cv v236,v228,v229
cv v237,v230,v231
cv v238,v232,v233
cv v239,v234,v235
ar v192,a192
ar v193,a193
ar v194,a194
ar v195,a195
ar v196,a196
ar v197,a197
ar v198,a198
ar v199,a199
v_permlane16_swap_b32 v236,v238
v_permlane16_swap_b32 v237,v239
w4 v[236:239],v30,s[36:39],s48 offen offset:192 sc1
s_add_u32 s48,s48,65536
cv v200,v192,v193
cv v201,v194,v195
cv v202,v196,v197
cv v203,v198,v199
ar v204,a200
ar v205,a201
ar v206,a202
ar v207,a203
ar v208,a204
ar v209,a205
ar v210,a206
ar v211,a207
v_permlane16_swap_b32 v200,v202
v_permlane16_swap_b32 v201,v203
w4 v[200:203],v30,s[36:39],s48 offen sc1
cv v212,v204,v205
cv v213,v206,v207
cv v214,v208,v209
cv v215,v210,v211
ar v216,a208
ar v217,a209
ar v218,a210
ar v219,a211
ar v220,a212
ar v221,a213
ar v222,a214
ar v223,a215
v_permlane16_swap_b32 v212,v214
v_permlane16_swap_b32 v213,v215
w4 v[212:215],v30,s[36:39],s48 offen offset:64 sc1
cv v224,v216,v217
cv v225,v218,v219
cv v226,v220,v221
cv v227,v222,v223
ar v228,a216
ar v229,a217
ar v230,a218
ar v231,a219
ar v232,a220
ar v233,a221
ar v234,a222
ar v235,a223
v_permlane16_swap_b32 v224,v226
v_permlane16_swap_b32 v225,v227
w4 v[224:227],v30,s[36:39],s48 offen offset:128 sc1
cv v236,v228,v229
cv v237,v230,v231
cv v238,v232,v233
cv v239,v234,v235
ar v192,a224
ar v193,a225
ar v194,a226
ar v195,a227
ar v196,a228
ar v197,a229
ar v198,a230
ar v199,a231
v_permlane16_swap_b32 v236,v238
v_permlane16_swap_b32 v237,v239
w4 v[236:239],v30,s[36:39],s48 offen offset:192 sc1
s_add_u32 s48,s48,65536
cv v200,v192,v193
cv v201,v194,v195
cv v202,v196,v197
cv v203,v198,v199
ar v204,a232
ar v205,a233
ar v206,a234
ar v207,a235
ar v208,a236
ar v209,a237
ar v210,a238
ar v211,a239
v_permlane16_swap_b32 v200,v202
v_permlane16_swap_b32 v201,v203
w4 v[200:203],v30,s[36:39],s48 offen sc1
cv v212,v204,v205
cv v213,v206,v207
cv v214,v208,v209
cv v215,v210,v211
ar v216,a240
ar v217,a241
ar v218,a242
ar v219,a243
ar v220,a244
ar v221,a245
ar v222,a246
ar v223,a247
v_permlane16_swap_b32 v212,v214
v_permlane16_swap_b32 v213,v215
w4 v[212:215],v30,s[36:39],s48 offen offset:64 sc1
cv v224,v216,v217
cv v225,v218,v219
cv v226,v220,v221
cv v227,v222,v223
ar v228,a248
ar v229,a249
ar v230,a250
ar v231,a251
ar v232,a252
ar v233,a253
ar v234,a254
ar v235,a255
v_permlane16_swap_b32 v224,v226
v_permlane16_swap_b32 v225,v227
w4 v[224:227],v30,s[36:39],s48 offen offset:128 sc1
cv v236,v228,v229
cv v237,v230,v231
cv v238,v232,v233
cv v239,v234,v235
s_nop 0
v_permlane16_swap_b32 v236,v238
v_permlane16_swap_b32 v237,v239
w4 v[236:239],v30,s[36:39],s48 offen offset:192 sc1
s_add_u32 s48,s48,65536
wt vmcnt(32)
s_branch G_have
G_end:
s_endpgm
.p2align 6
.type G_table,@object
G_table:
.long 1,0,0,0x1000000,0x40000000,0,0x408000,9
.long 1,0x80000,0x100,0x1804000,0x40000000,0,0x409000,1
.long 1,0xc0000,0x200,0x1c08000,0x40000000,0,0x409800,1
.long 0xff0202,0x200000,0,0x3000000,0x40000000,0,0x40c000,1
.long 0x403,0,0x800,0x9800000,0x40000000,0,0x401000,0
.long 8,0x9800000,0,0x9c00000,0x401000,8,0x401800,0x1000
.long 4,0,0,0x9000000,0x401800,8,0x402000,0x9c00000
.long 6,0x9000000,0,0x800,0x402000,4,0,0
.long 0,0,0,0,0x40000000,0,0,0
.long 0,0,0,0,0x40000000,0,0,0
.long 1,0,0x100,0x1004000,0x40000000,0,0x408000,9
.long 1,0x80000,0,0x1800000,0x40000000,0,0x409000,1
.long 1,0xc0000,0x300,0x1c0c000,0x40000000,0,0x409800,1
.long 0xfe0202,0x200000,0x200,0x3008000,0x40000000,0,0x40c000,1
.long 0x403,0,0x900,0x9806000,0x40000000,0,0x401100,0
.long 8,0x9801800,1,0x9c00c00,0x401000,8,0x401800,0x1000
.long 4,0,0x200,0x9008000,0x401900,8,0x402000,0x9c06000
.long 6,0x9000000,0x200,0xa00,0x402000,4,0,0
.long 0,0,0,0,0x40000000,0,0,0
.long 0,0,0,0,0x40000000,0,0,0
.long 1,0,0x200,0x1008000,0x40000000,0,0x408000,9
.long 1,0x80000,0x300,0x180c000,0x40000000,0,0x409000,1
.long 1,0xc0000,0,0x1c00000,0x40000000,0,0x409800,1
.long 0xfd0202,0x200000,0x400,0x3010000,0x40000000,0,0x40c100,1
.long 0x403,0,0xa00,0x980c000,0x40000000,0,0x401200,0
.long 8,0x9803000,2,0x9c01800,0x401000,8,0x401800,0x1000
.long 4,0,0x400,0x9010000,0x401a00,8,0x402000,0x9c0c000
.long 6,0x9000000,0x400,0xc00,0x402000,4,0,0
.long 0,0,0,0,0x40000000,0,0,0
.long 0,0,0,0,0x40000000,0,0,0
.long 1,0,0x300,0x100c000,0x40000000,0,0x408000,9
.long 1,0x80000,0x200,0x1808000,0x40000000,0,0x409000,1
.long 1,0xc0000,0x100,0x1c04000,0x40000000,0,0x409800,1
.long 0xfc0202,0x200000,0x600,0x3018000,0x40000000,0,0x40c100,1
.long 0x403,0,0xb00,0x9812000,0x40000000,0,0x401300,0
.long 8,0x9804800,3,0x9c02400,0x401000,8,0x401800,0x1000
.long 4,0,0x600,0x9018000,0x401b00,8,0x402000,0x9c12000
.long 6,0x9000000,0x600,0xe00,0x402000,4,0,0
.long 0,0,0,0,0x40000000,0,0,0
.long 0,0,0,0,0x40000000,0,0,0
.long 1,0,0x400,0x1010000,0x40000000,0,0x408100,9
.long 1,0x80000,0x500,0x1814000,0x40000000,0,0x409100,1
.long 1,0xc0000,0x600,0x1c18000,0x40000000,0,0x409900,1
.long 0xfb0202,0x200000,0,0x3202000,0x40000000,0,0x40c000,2
.long 0x403,0x80000,0x800,0x9860000,0x40000000,0,0x401000,0
.long 8,0x9806000,4,0x9c03000,0x401100,8,0x401800,0x1000
.long 4,0x80000,0,0x9100000,0x401800,8,0x402100,0x9c00000
.long 6,0x9100000,0,0x100800,0x402100,4,0,0
.long 0,0,0,0,0x40000000,0,0,0
.long 0,0,0,0,0x40000000,0,0,0
.long 1,0,0x500,0x1014000,0x40000000,0,0x408100,9
.long 1,0x80000,0x400,0x1810000,0x40000000,0,0x409100,1
.long 1,0xc0000,0x700,0x1c1c000,0x40000000,0,0x409900,1
.long 0xfa0202,0x200000,0x200,0x320a000,0x40000000,0,0x40c000,2
.long 0x403,0x80000,0x900,0x9866000,0x40000000,0,0x401100,0
.long 8,0x9807800,5,0x9c03c00,0x401100,8,0x401800,0x1000
.long 4,0x80000,0x200,0x9108000,0x401900,8,0x402100,0x9c06000
.long 6,0x9100000,0x200,0x100a00,0x402100,4,0,0
.long 0,0,0,0,0x40000000,0,0,0
.long 0,0,0,0,0x40000000,0,0,0
.long 1,0,0x600,0x1018000,0x40000000,0,0x408100,9
.long 1,0x80000,0x700,0x181c000,0x40000000,0,0x409100,1
.long 1,0xc0000,0x400,0x1c10000,0x40000000,0,0x409900,1
.long 0xf90202,0x200000,0x400,0x3212000,0x40000000,0,0x40c100,2
.long 0x403,0x80000,0xa00,0x986c000,0x40000000,0,0x401200,0
.long 8,0x9809000,6,0x9c04800,0x401100,8,0x401800,0x1000
.long 4,0x80000,0x400,0x9110000,0x401a00,8,0x402100,0x9c0c000
.long 6,0x9100000,0x400,0x100c00,0x402100,4,0,0
.long 0,0,0,0,0x40000000,0,0,0
.long 0,0,0,0,0x40000000,0,0,0
.long 1,0,0x700,0x101c000,0x40000000,0,0x408100,9
.long 1,0x80000,0x600,0x1818000,0x40000000,0,0x409100,1
.long 1,0xc0000,0x500,0x1c14000,0x40000000,0,0x409900,1
.long 0xf80202,0x200000,0x600,0x321a000,0x40000000,0,0x40c100,2
.long 0x403,0x80000,0xb00,0x9872000,0x40000000,0,0x401300,0
.long 8,0x980a800,7,0x9c05400,0x401100,8,0x401800,0x1000
.long 4,0x80000,0x600,0x9118000,0x401b00,8,0x402100,0x9c12000
.long 6,0x9100000,0x600,0x100e00,0x402100,4,0,0
.long 0,0,0,0,0x40000000,0,0,0
.long 0,0,0,0,0x40000000,0,0,0
.long 1,0,0,0x1202000,0x40000000,0,0x408000,0xa
.long 1,0x80000,0x100,0x1a06000,0x40000000,0,0x409000,2
.long 1,0xc0000,0x200,0x1e0a000,0x40000000,0,0x409800,2
.long 0xf70202,0x280000,0,0x3800000,0x40000000,0,0x40d000,1
.long 0x403,0x100000,0x800,0x98c0000,0x40000000,0,0x401000,0
.long 0xa,0,0,0x20,0x40000000,0,0,4
.long 0xa,0x20,0,0x30,0x40000000,0,0,4
.long 5,0x7202000,0,0x400000,0x403800,0x80,0,1
.long 0,0,0,0,0x40000000,0,0,0
.long 0,0,0,0,0x40000000,0,0,0
.long 1,0,0x100,0x1206000,0x40000000,0,0x408000,0xa
.long 1,0x80000,0,0x1a02000,0x40000000,0,0x409000,2
.long 1,0xc0000,0x300,0x1e0e000,0x40000000,0,0x409800,2
.long 0xf60202,0x280000,0x200,0x3808000,0x40000000,0,0x40d000,1
.long 0x403,0x100000,0x900,0x98c6000,0x40000000,0,0x401100,0
.long 0xa,0,1,0x20,0x40000000,0,0,4
.long 0xa,0x20,1,0x30,0x40000000,0,0,4
.long 9,0,0,0,0x402800,0x20,0,0
.long 5,0x7202000,0xc000000,0x400100,0x403800,0x80,0,2
.long 0,0,0,0,0x40000000,0,0,0
.long 1,0,0x200,0x120a000,0x40000000,0,0x408000,0xa
.long 1,0x80000,0x300,0x1a0e000,0x40000000,0,0x409000,2
.long 1,0xc0000,0,0x1e02000,0x40000000,0,0x409800,2
.long 0xf50202,0x280000,0x400,0x3810000,0x40000000,0,0x40d100,1
.long 0x403,0x100000,0xa00,0x98cc000,0x40000000,0,0x401200,0
.long 0xa,1,0,0x20,0x40000000,0,0,4
.long 0xa,0x21,0,0x30,0x40000000,0,0,4
.long 5,0x7202000,0x200,0x400200,0x403800,0x80,0,1
.long 0,0,0,0,0x40000000,0,0,0
.long 0,0,0,0,0x40000000,0,0,0
.long 1,0,0x300,0x120e000,0x40000000,0,0x408000,0xa
.long 1,0x80000,0x200,0x1a0a000,0x40000000,0,0x409000,2
.long 1,0xc0000,0x100,0x1e06000,0x40000000,0,0x409800,2
.long 0xf40202,0x280000,0x600,0x3818000,0x40000000,0,0x40d100,1
.long 0x403,0x100000,0xb00,0x98d2000,0x40000000,0,0x401300,0
.long 0xa,1,1,0x20,0x40000000,0,0,4
.long 0xa,0x21,1,0x30,0x40000000,0,0,4
.long 5,0x7202000,0x300,0x400300,0x403800,0x80,0,1
.long 0,0,0,0,0x40000000,0,0,0
.long 0,0,0,0,0x40000000,0,0,0
.long 1,0,0x400,0x1212000,0x40000000,0,0x408100,0xa
.long 1,0x80000,0x500,0x1a16000,0x40000000,0,0x409100,2
.long 1,0xc0000,0x600,0x1e1a000,0x40000000,0,0x409900,2
.long 0xf30202,0x280000,0,0x3a02000,0x40000000,0,0x40d000,2
.long 0x403,0x180000,0x800,0x9920000,0x40000000,0,0x401000,0
.long 0xa,2,0,0x20,0x40000000,0,0,4
.long 0xa,0x22,0,0x30,0x40000000,0,0,4
.long 0xa,0x30,0,0x40,0x40000000,0,0,2
.long 0,0,0,0,0x40000000,0,0,0
.long 0,0,0,0,0x40000000,0,0,0
.long 1,0,0x500,0x1216000,0x40000000,0,0x408100,0xa
.long 1,0x80000,0x400,0x1a12000,0x40000000,0,0x409100,2
.long 1,0xc0000,0x700,0x1e1e000,0x40000000,0,0x409900,2
.long 0xf20202,0x280000,0x200,0x3a0a000,0x40000000,0,0x40d000,2
.long 0x403,0x180000,0x900,0x9926000,0x40000000,0,0x401100,0
.long 0xa,2,1,0x20,0x40000000,0,0,4
.long 0xa,0x22,1,0x30,0x40000000,0,0,4
.long 0xa,0x30,1,0x40,0x40000000,0,0,2
.long 0,0,0,0,0x40000000,0,0,0
.long 0,0,0,0,0x40000000,0,0,0
.long 1,0,0x600,0x121a000,0x40000000,0,0x408100,0xa
.long 1,0x80000,0x700,0x1a1e000,0x40000000,0,0x409100,2
.long 1,0xc0000,0x400,0x1e12000,0x40000000,0,0x409900,2
.long 0xf10202,0x280000,0x400,0x3a12000,0x40000000,0,0x40d100,2
.long 0x403,0x180000,0xa00,0x992c000,0x40000000,0,0x401200,0
.long 0xa,3,0,0x20,0x40000000,0,0,4
.long 0xa,0x23,0,0x30,0x40000000,0,0,4
.long 0xa,0x31,0,0x40,0x40000000,0,0,2
.long 0,0,0,0,0x40000000,0,0,0
.long 0,0,0,0,0x40000000,0,0,0
.long 1,0,0x700,0x121e000,0x40000000,0,0x408100,0xa
.long 1,0x80000,0x600,0x1a1a000,0x40000000,0,0x409100,2
.long 1,0xc0000,0x500,0x1e16000,0x40000000,0,0x409900,2
.long 0xf00202,0x280000,0x600,0x3a1a000,0x40000000,0,0x40d100,2
.long 0x403,0x180000,0xb00,0x9932000,0x40000000,0,0x401300,0
.long 0xa,3,1,0x20,0x40000000,0,0,4
.long 0xa,0x23,1,0x30,0x40000000,0,0,4
.long 0xa,0x31,1,0x40,0x40000000,0,0,2
.long 0,0,0,0,0x40000000,0,0,0
.long 0,0,0,0,0x40000000,0,0,0
.long 1,0x40000,0,0x1400000,0x40000000,0,0x408800,9
.long 0xbf0002,0x100000,0,0x2000000,0x40000000,0,0x40a000,1
.long 0xff0502,0,0,0x5000000,0x40000000,0,0x408000,0
.long 0xff0702,0x300000,0,0x4000000,0x40000000,0,0x40e000,1
.long 0x402,0x200000,0,0x7000000,0x40000000,0,0x40c000,0x20
.long 5,0x5202000,0x300,0x300,0x403000,0x80,0,1
.long 7,0x7a02000,0,0x500000,0x407400,0x40,0,1
.long 0,0,0,0,0x40000000,0,0,0
.long 0,0,0,0,0x40000000,0,0,0
.long 0,0,0,0,0x40000000,0,0,0
.long 1,0x40000,0x100,0x1404000,0x40000000,0,0x408800,9
.long 0xbe0002,0x100000,0x200,0x2008000,0x40000000,0,0x40a000,1
.long 0xfe0502,0,0x200,0x5008000,0x40000000,0,0x408000,0
.long 0xfe0702,0x300000,0x200,0x4008000,0x40000000,0,0x40e000,1
.long 0x402,0x200000,0x200,0x7008000,0x40000000,0,0x40c000,0x20
.long 5,0x5202000,0x200,0x200,0x403000,0x80,0,1
.long 9,0,0,0,0x402800,0x20,0,0
.long 7,0x7a02000,0xc000000,0x500100,0x407400,0x40,0,2
.long 0,0,0,0,0x40000000,0,0,0
.long 0,0,0,0,0x40000000,0,0,0
.long 1,0x40000,0x200,0x1408000,0x40000000,0,0x408800,9
.long 0xbd0002,0x100000,0x400,0x2010000,0x40000000,0,0x40a100,1
.long 0xfd0502,0,0x400,0x5010000,0x40000000,0,0x408100,0
.long 0xfd0702,0x300000,0x400,0x4010000,0x40000000,0,0x40e100,1
.long 0x402,0x200000,0x400,0x7010000,0x40000000,0,0x40c100,0x20
.long 9,0,0,0,0x402800,0x20,0,0
.long 5,0x5202000,0xc000000,0x100,0x403000,0x80,0,2
.long 7,0x7a02000,0x200,0x500200,0x407400,0x40,0,1
.long 0,0,0,0,0x40000000,0,0,0
.long 0,0,0,0,0x40000000,0,0,0
.long 1,0x40000,0x300,0x140c000,0x40000000,0,0x408800,9
.long 0xbc0002,0x100000,0x600,0x2018000,0x40000000,0,0x40a100,1
.long 0xfc0502,0,0x600,0x5018000,0x40000000,0,0x408100,0
.long 0xfc0702,0x300000,0x600,0x4018000,0x40000000,0,0x40e100,1
.long 0x402,0x200000,0x600,0x7018000,0x40000000,0,0x40c100,0x20
.long 5,0x5202000,0,0,0x403000,0x80,0,1
.long 7,0x7a02000,0x300,0x500300,0x407400,0x40,0,1
.long 0,0,0,0,0x40000000,0,0,0
.long 0,0,0,0,0x40000000,0,0,0
.long 0,0,0,0,0x40000000,0,0,0
.long 1,0x40000,0x400,0x1410000,0x40000000,0,0x408900,9
.long 0xbb0002,0x100000,0,0x2202000,0x40000000,0,0x40a000,2
.long 0xfb0502,0x80000,0,0x5800000,0x40000000,0,0x409000,0
.long 0xfb0702,0x300000,0,0x4202000,0x40000000,0,0x40e000,2
.long 0x402,0x280000,0,0x7800000,0x40000000,0,0x40d000,0x20
.long 5,0x5602000,0x300,0x80300,0x403100,0x80,0,1
.long 7,0x7b02000,0,0x540000,0x407500,0x40,0,1
.long 0,0,0,0,0x40000000,0,0,0
.long 0,0,0,0,0x40000000,0,0,0
.long 0,0,0,0,0x40000000,0,0,0
.long 1,0x40000,0x500,0x1414000,0x40000000,0,0x408900,9
.long 0xba0002,0x100000,0x200,0x220a000,0x40000000,0,0x40a000,2
.long 0xfa0502,0x80000,0x200,0x5808000,0x40000000,0,0x409000,0
.long 0xfa0702,0x300000,0x200,0x420a000,0x40000000,0,0x40e000,2
.long 0x402,0x280000,0x200,0x7808000,0x40000000,0,0x40d000,0x20
.long 5,0x5602000,0x200,0x80200,0x403100,0x80,0,1
.long 9,0,0,0,0x402800,0x20,0,0
.long 7,0x7b02000,0xc000000,0x540100,0x407500,0x40,0,2
.long 0,0,0,0,0x40000000,0,0,0
.long 0,0,0,0,0x40000000,0,0,0
.long 1,0x40000,0x600,0x1418000,0x40000000,0,0x408900,9
.long 0xb90002,0x100000,0x400,0x2212000,0x40000000,0,0x40a100,2
.long 0xf90502,0x80000,0x400,0x5810000,0x40000000,0,0x409100,0
.long 0xf90702,0x300000,0x400,0x4212000,0x40000000,0,0x40e100,2
.long 0x402,0x280000,0x400,0x7810000,0x40000000,0,0x40d100,0x20
.long 9,0,0,0,0x402800,0x20,0,0
.long 5,0x5602000,0xc000000,0x80100,0x403100,0x80,0,2
.long 7,0x7b02000,0x200,0x540200,0x407500,0x40,0,1
.long 0,0,0,0,0x40000000,0,0,0
.long 0,0,0,0,0x40000000,0,0,0
.long 1,0x40000,0x700,0x141c000,0x40000000,0,0x408900,9
.long 0xb80002,0x100000,0x600,0x221a000,0x40000000,0,0x40a100,2
.long 0xf80502,0x80000,0x600,0x5818000,0x40000000,0,0x409100,0
.long 0xf80702,0x300000,0x600,0x421a000,0x40000000,0,0x40e100,2
.long 0x402,0x280000,0x600,0x7818000,0x40000000,0,0x40d100,0x20
.long 5,0x5602000,0,0x80000,0x403100,0x80,0,1
.long 7,0x7b02000,0x300,0x540300,0x407500,0x40,0,1
.long 0,0,0,0,0x40000000,0,0,0
.long 0,0,0,0,0x40000000,0,0,0
.long 0,0,0,0,0x40000000,0,0,0
.long 1,0x40000,0,0x1602000,0x40000000,0,0x408800,0xa
.long 0xb70002,0x180000,0,0x2800000,0x40000000,0,0x40b000,1
.long 0xf70502,0x100000,0,0x6000000,0x40000000,0,0x40a000,0
.long 0xf70702,0x380000,0,0x4800000,0x40000000,0,0x40f000,1
.long 0x402,0x300000,0,0x8000000,0x40000000,0,0x40e000,0x20
.long 5,0x5a02000,0x300,0x100300,0x403200,0x80,0,1
.long 7,0x8202000,0,0x600000,0x407800,0x40,0,1
.long 0,0,0,0,0x40000000,0,0,0
.long 0,0,0,0,0x40000000,0,0,0
.long 0,0,0,0,0x40000000,0,0,0
.long 1,0x40000,0x100,0x1606000,0x40000000,0,0x408800,0xa
.long 0xb60002,0x180000,0x200,0x2808000,0x40000000,0,0x40b000,1
.long 0xf60502,0x100000,0x200,0x6008000,0x40000000,0,0x40a000,0
.long 0xf60702,0x380000,0x200,0x4808000,0x40000000,0,0x40f000,1
.long 0x402,0x300000,0x200,0x8008000,0x40000000,0,0x40e000,0x20
.long 5,0x5a02000,0x200,0x100200,0x403200,0x80,0,1
.long 9,0,0,0,0x402800,0x20,0,0
.long 7,0x8202000,0xc000000,0x600100,0x407800,0x40,0,2
.long 0,0,0,0,0x40000000,0,0,0
.long 0,0,0,0,0x40000000,0,0,0
.long 1,0x40000,0x200,0x160a000,0x40000000,0,0x408800,0xa
.long 0xb50002,0x180000,0x400,0x2810000,0x40000000,0,0x40b100,1
.long 0xf50502,0x100000,0x400,0x6010000,0x40000000,0,0x40a100,0
.long 0xf50702,0x380000,0x400,0x4810000,0x40000000,0,0x40f100,1
.long 0x402,0x300000,0x400,0x8010000,0x40000000,0,0x40e100,0x20
.long 9,0,0,0,0x402800,0x20,0,0
.long 5,0x5a02000,0xc000000,0x100100,0x403200,0x80,0,2
.long 7,0x8202000,0x200,0x600200,0x407800,0x40,0,1
.long 0,0,0,0,0x40000000,0,0,0
.long 0,0,0,0,0x40000000,0,0,0
.long 1,0x40000,0x300,0x160e000,0x40000000,0,0x408800,0xa
.long 0xb40002,0x180000,0x600,0x2818000,0x40000000,0,0x40b100,1
.long 0xf40502,0x100000,0x600,0x6018000,0x40000000,0,0x40a100,0
.long 0xf40702,0x380000,0x600,0x4818000,0x40000000,0,0x40f100,1
.long 0x402,0x300000,0x600,0x8018000,0x40000000,0,0x40e100,0x20
.long 5,0x5a02000,0,0x100000,0x403200,0x80,0,1
.long 7,0x8202000,0x300,0x600300,0x407800,0x40,0,1
.long 0,0,0,0,0x40000000,0,0,0
.long 0,0,0,0,0x40000000,0,0,0
.long 0,0,0,0,0x40000000,0,0,0
.long 1,0x40000,0x400,0x1612000,0x40000000,0,0x408900,0xa
.long 0xb30002,0x180000,0,0x2a02000,0x40000000,0,0x40b000,2
.long 0xf30502,0x180000,0,0x6800000,0x40000000,0,0x40b000,0
.long 0xf30702,0x380000,0,0x4a02000,0x40000000,0,0x40f000,2
.long 0x402,0x380000,0,0x8800000,0x40000000,0,0x40f000,0x20
.long 5,0x5e02000,0x300,0x180300,0x403300,0x80,0,1
.long 7,0x8602000,0,0x680000,0x407a00,0x40,0,1
.long 0,0,0,0,0x40000000,0,0,0
.long 0,0,0,0,0x40000000,0,0,0
.long 0,0,0,0,0x40000000,0,0,0
.long 1,0x40000,0x500,0x1616000,0x40000000,0,0x408900,0xa
.long 0xb20002,0x180000,0x200,0x2a0a000,0x40000000,0,0x40b000,2
.long 0xf20502,0x180000,0x200,0x6808000,0x40000000,0,0x40b000,0
.long 0xf20702,0x380000,0x200,0x4a0a000,0x40000000,0,0x40f000,2
.long 0x402,0x380000,0x200,0x8808000,0x40000000,0,0x40f000,0x20
.long 5,0x5e02000,0x200,0x180200,0x403300,0x80,0,1
.long 9,0,0,0,0x402800,0x20,0,0
.long 7,0x8602000,0xc000000,0x680100,0x407a00,0x40,0,2
.long 0,0,0,0,0x40000000,0,0,0
.long 0,0,0,0,0x40000000,0,0,0
.long 1,0x40000,0x600,0x161a000,0x40000000,0,0x408900,0xa
.long 0xb10002,0x180000,0x400,0x2a12000,0x40000000,0,0x40b100,2
.long 0xf10502,0x180000,0x400,0x6810000,0x40000000,0,0x40b100,0
.long 0xf10702,0x380000,0x400,0x4a12000,0x40000000,0,0x40f100,2
.long 0x402,0x380000,0x400,0x8810000,0x40000000,0,0x40f100,0x20
.long 9,0,0,0,0x402800,0x20,0,0
.long 5,0x5e02000,0xc000000,0x180100,0x403300,0x80,0,2
.long 7,0x8602000,0x200,0x680200,0x407a00,0x40,0,1
.long 0,0,0,0,0x40000000,0,0,0
.long 0,0,0,0,0x40000000,0,0,0
.long 1,0x40000,0x700,0x161e000,0x40000000,0,0x408900,0xa
.long 0xb00002,0x180000,0x600,0x2a1a000,0x40000000,0,0x40b100,2
.long 0xf00502,0x180000,0x600,0x6818000,0x40000000,0,0x40b100,0
.long 0xf00702,0x380000,0x600,0x4a1a000,0x40000000,0,0x40f100,2
.long 0x402,0x380000,0x600,0x8818000,0x40000000,0,0x40f100,0x20
.long 5,0x5e02000,0,0x180000,0x403300,0x80,0,1
.long 7,0x8602000,0x300,0x680300,0x407a00,0x40,0,1
.long 0,0,0,0,0x40000000,0,0,0
.long 0,0,0,0,0x40000000,0,0,0
.long 0,0,0,0,0x40000000,0,0,0
.long 1,0,0x800,0x1020000,0x40000000,0,0x408200,9
.long 1,0x80000,0x900,0x1824000,0x40000000,0,0x409200,1
.long 1,0xc0000,0xa00,0x1c28000,0x40000000,0,0x409a00,1
.long 0xef0202,0x200000,0x800,0x3020000,0x40000000,0,0x40c200,1
.long 0x403,0,0xc00,0x9818000,0x40000000,0,0x401400,0
.long 8,0x980c000,8,0x9c06000,0x401200,8,0x401900,0xf00
.long 4,0x100000,0,0x9202000,0x401800,8,0x402200,0x9c00000
.long 6,0x9202000,0,0x200800,0x402200,4,0,0
.long 0,0,0,0,0x40000000,0,0,0
.long 0,0,0,0,0x40000000,0,0,0
.long 1,0,0x900,0x1024000,0x40000000,0,0x408200,9
.long 1,0x80000,0x800,0x1820000,0x40000000,0,0x409200,1
.long 1,0xc0000,0xb00,0x1c2c000,0x40000000,0,0x409a00,1
.long 0xee0202,0x200000,0xa00,0x3028000,0x40000000,0,0x40c200,1
.long 0x403,0,0xd00,0x981e000,0x40000000,0,0x401500,0
.long 8,0x980d800,9,0x9c06c00,0x401200,8,0x401900,0xf00
.long 4,0x100000,0x200,0x920a000,0x401900,8,0x402200,0x9c06000
.long 6,0x9202000,0x200,0x200a00,0x402200,4,0,0
.long 0,0,0,0,0x40000000,0,0,0
.long 0,0,0,0,0x40000000,0,0,0
.long 1,0,0xa00,0x1028000,0x40000000,0,0x408200,9
.long 1,0x80000,0xb00,0x182c000,0x40000000,0,0x409200,1
.long 1,0xc0000,0x800,0x1c20000,0x40000000,0,0x409a00,1
.long 0xed0202,0x200000,0xc00,0x3030000,0x40000000,0,0x40c300,1
.long 0x403,0,0xe00,0x9824000,0x40000000,0,0x401600,0
.long 8,0x980f000,0xa,0x9c07800,0x401200,8,0x401900,0xf00
.long 4,0x100000,0x400,0x9212000,0x401a00,8,0x402200,0x9c0c000
.long 6,0x9202000,0x400,0x200c00,0x402200,4,0,0
.long 0,0,0,0,0x40000000,0,0,0
.long 0,0,0,0,0x40000000,0,0,0
.long 1,0,0xb00,0x102c000,0x40000000,0,0x408200,9
.long 1,0x80000,0xa00,0x1828000,0x40000000,0,0x409200,1
.long 1,0xc0000,0x900,0x1c24000,0x40000000,0,0x409a00,1
.long 0xec0202,0x200000,0xe00,0x3038000,0x40000000,0,0x40c300,1
.long 0x403,0,0xf00,0x982a000,0x40000000,0,0x401700,0
.long 8,0x9810800,0xb,0x9c08400,0x401200,8,0x401900,0xf00
.long 4,0x100000,0x600,0x921a000,0x401b00,8,0x402200,0x9c12000
.long 6,0x9202000,0x600,0x200e00,0x402200,4,0,0
.long 0,0,0,0,0x40000000,0,0,0
.long 0,0,0,0,0x40000000,0,0,0
.long 1,0,0xc00,0x1030000,0x40000000,0,0x408300,9
.long 1,0x80000,0xd00,0x1834000,0x40000000,0,0x409300,1
.long 1,0xc0000,0xe00,0x1c38000,0x40000000,0,0x409b00,1
.long 0xeb0202,0x200000,0x800,0x3222000,0x40000000,0,0x40c200,2
.long 0x403,0x80000,0xc00,0x9878000,0x40000000,0,0x401400,0
.long 8,0x9812000,0xc,0x9c09000,0x401300,8,0x401900,0xf00
.long 4,0x180000,0,0x9302000,0x401800,8,0x402300,0x9c00000
.long 6,0x9302000,0,0x300800,0x402300,4,0,0
.long 0,0,0,0,0x40000000,0,0,0
.long 0,0,0,0,0x40000000,0,0,0
.long 1,0,0xd00,0x1034000,0x40000000,0,0x408300,9
.long 1,0x80000,0xc00,0x1830000,0x40000000,0,0x409300,1
.long 1,0xc0000,0xf00,0x1c3c000,0x40000000,0,0x409b00,1
.long 0xea0202,0x200000,0xa00,0x322a000,0x40000000,0,0x40c200,2
.long 0x403,0x80000,0xd00,0x987e000,0x40000000,0,0x401500,0
.long 8,0x9813800,0xd,0x9c09c00,0x401300,8,0x401900,0xf00
.long 4,0x180000,0x200,0x930a000,0x401900,8,0x402300,0x9c06000
.long 6,0x9302000,0x200,0x300a00,0x402300,4,0,0
.long 0,0,0,0,0x40000000,0,0,0
.long 0,0,0,0,0x40000000,0,0,0
.long 1,0,0xe00,0x1038000,0x40000000,0,0x408300,9
.long 1,0x80000,0xf00,0x183c000,0x40000000,0,0x409300,1
.long 1,0xc0000,0xc00,0x1c30000,0x40000000,0,0x409b00,1
.long 0xe90202,0x200000,0xc00,0x3232000,0x40000000,0,0x40c300,2
.long 0x403,0x80000,0xe00,0x9884000,0x40000000,0,0x401600,0
.long 8,0x9815000,0xe,0x9c0a800,0x401300,8,0x401900,0xf00
.long 4,0x180000,0x400,0x9312000,0x401a00,8,0x402300,0x9c0c000
.long 6,0x9302000,0x400,0x300c00,0x402300,4,0,0
.long 0,0,0,0,0x40000000,0,0,0
.long 0,0,0,0,0x40000000,0,0,0
.long 1,0,0xf00,0x103c000,0x40000000,0,0x408300,9
.long 1,0x80000,0xe00,0x1838000,0x40000000,0,0x409300,1
.long 1,0xc0000,0xd00,0x1c34000,0x40000000,0,0x409b00,1
.long 0xe80202,0x200000,0xe00,0x323a000,0x40000000,0,0x40c300,2
.long 0x403,0x80000,0xf00,0x988a000,0x40000000,0,0x401700,0
.long 8,0x9816800,0xf,0x9c0b400,0x401300,8,0x401900,0xf00
.long 4,0x180000,0x600,0x931a000,0x401b00,8,0x402300,0x9c12000
.long 6,0x9302000,0x600,0x300e00,0x402300,4,0,0
.long 0,0,0,0,0x40000000,0,0,0
.long 0,0,0,0,0x40000000,0,0,0
.long 1,0,0x800,0x1222000,0x40000000,0,0x408200,0xa
.long 1,0x80000,0x900,0x1a26000,0x40000000,0,0x409200,2
.long 1,0xc0000,0xa00,0x1e2a000,0x40000000,0,0x409a00,2
.long 0xe70202,0x280000,0x800,0x3820000,0x40000000,0,0x40d200,1
.long 0x403,0x100000,0xc00,0x98d8000,0x40000000,0,0x401400,0
.long 0xa,0,2,0x20,0x40000000,0,0,4
.long 0xa,0x20,2,0x30,0x40000000,0,0,4
.long 5,0x7202000,0x400,0x400400,0x403800,0x80,0,1
.long 0,0,0,0,0x40000000,0,0,0
.long 0,0,0,0,0x40000000,0,0,0
.long 1,0,0x900,0x1226000,0x40000000,0,0x408200,0xa
.long 1,0x80000,0x800,0x1a22000,0x40000000,0,0x409200,2
.long 1,0xc0000,0xb00,0x1e2e000,0x40000000,0,0x409a00,2
.long 0xe60202,0x280000,0xa00,0x3828000,0x40000000,0,0x40d200,1
.long 0x403,0x100000,0xd00,0x98de000,0x40000000,0,0x401500,0
.long 0xa,0,3,0x20,0x40000000,0,0,4
.long 0xa,0x20,3,0x30,0x40000000,0,0,4
.long 9,0,0,0,0x402800,0x20,0,0
.long 5,0x7202000,0xc200000,0x400500,0x403800,0x80,0,2
.long 0,0,0,0,0x40000000,0,0,0
.long 1,0,0xa00,0x122a000,0x40000000,0,0x408200,0xa
.long 1,0x80000,0xb00,0x1a2e000,0x40000000,0,0x409200,2
.long 1,0xc0000,0x800,0x1e22000,0x40000000,0,0x409a00,2
.long 0xe50202,0x280000,0xc00,0x3830000,0x40000000,0,0x40d300,1
.long 0x403,0x100000,0xe00,0x98e4000,0x40000000,0,0x401600,0
.long 0xa,1,2,0x20,0x40000000,0,0,4
.long 0xa,0x21,2,0x30,0x40000000,0,0,4
.long 5,0x7202000,0x600,0x400600,0x403800,0x80,0,1
.long 0,0,0,0,0x40000000,0,0,0
.long 0,0,0,0,0x40000000,0,0,0
.long 1,0,0xb00,0x122e000,0x40000000,0,0x408200,0xa
.long 1,0x80000,0xa00,0x1a2a000,0x40000000,0,0x409200,2
.long 1,0xc0000,0x900,0x1e26000,0x40000000,0,0x409a00,2
.long 0xe40202,0x280000,0xe00,0x3838000,0x40000000,0,0x40d300,1
.long 0x403,0x100000,0xf00,0x98ea000,0x40000000,0,0x401700,0
.long 0xa,1,3,0x20,0x40000000,0,0,4
.long 0xa,0x21,3,0x30,0x40000000,0,0,4
.long 5,0x7202000,0x700,0x400700,0x403800,0x80,0,1
.long 0,0,0,0,0x40000000,0,0,0
.long 0,0,0,0,0x40000000,0,0,0
.long 1,0,0xc00,0x1232000,0x40000000,0,0x408300,0xa
.long 1,0x80000,0xd00,0x1a36000,0x40000000,0,0x409300,2
.long 1,0xc0000,0xe00,0x1e3a000,0x40000000,0,0x409b00,2
.long 0xe30202,0x280000,0x800,0x3a22000,0x40000000,0,0x40d200,2
.long 0x403,0x180000,0xc00,0x9938000,0x40000000,0,0x401400,0
.long 0xa,2,2,0x20,0x40000000,0,0,4
.long 0xa,0x22,2,0x30,0x40000000,0,0,4
.long 0xa,0x30,2,0x40,0x40000000,0,0,2
.long 0,0,0,0,0x40000000,0,0,0
.long 0,0,0,0,0x40000000,0,0,0
.long 1,0,0xd00,0x1236000,0x40000000,0,0x408300,0xa
.long 1,0x80000,0xc00,0x1a32000,0x40000000,0,0x409300,2
.long 1,0xc0000,0xf00,0x1e3e000,0x40000000,0,0x409b00,2
.long 0xe20202,0x280000,0xa00,0x3a2a000,0x40000000,0,0x40d200,2
.long 0x403,0x180000,0xd00,0x993e000,0x40000000,0,0x401500,0
.long 0xa,2,3,0x20,0x40000000,0,0,4
.long 0xa,0x22,3,0x30,0x40000000,0,0,4
.long 0xa,0x30,3,0x40,0x40000000,0,0,2
.long 0,0,0,0,0x40000000,0,0,0
.long 0,0,0,0,0x40000000,0,0,0
.long 1,0,0xe00,0x123a000,0x40000000,0,0x408300,0xa
.long 1,0x80000,0xf00,0x1a3e000,0x40000000,0,0x409300,2
.long 1,0xc0000,0xc00,0x1e32000,0x40000000,0,0x409b00,2
.long 0xe10202,0x280000,0xc00,0x3a32000,0x40000000,0,0x40d300,2
.long 0x403,0x180000,0xe00,0x9944000,0x40000000,0,0x401600,0
.long 0xa,3,2,0x20,0x40000000,0,0,4
.long 0xa,0x23,2,0x30,0x40000000,0,0,4
.long 0xa,0x31,2,0x40,0x40000000,0,0,2
.long 0,0,0,0,0x40000000,0,0,0
.long 0,0,0,0,0x40000000,0,0,0
.long 1,0,0xf00,0x123e000,0x40000000,0,0x408300,0xa
.long 1,0x80000,0xe00,0x1a3a000,0x40000000,0,0x409300,2
.long 1,0xc0000,0xd00,0x1e36000,0x40000000,0,0x409b00,2
.long 0xe00202,0x280000,0xe00,0x3a3a000,0x40000000,0,0x40d300,2
.long 0x403,0x180000,0xf00,0x994a000,0x40000000,0,0x401700,0
.long 0xa,3,3,0x20,0x40000000,0,0,4
.long 0xa,0x23,3,0x30,0x40000000,0,0,4
.long 0xa,0x31,3,0x40,0x40000000,0,0,2
.long 0,0,0,0,0x40000000,0,0,0
.long 0,0,0,0,0x40000000,0,0,0
.long 1,0x40000,0x800,0x1420000,0x40000000,0,0x408a00,9
.long 0xaf0002,0x100000,0x800,0x2020000,0x40000000,0,0x40a200,1
.long 0xef0502,0,0x800,0x5020000,0x40000000,0,0x408200,0
.long 0xef0702,0x300000,0x800,0x4020000,0x40000000,0,0x40e200,1
.long 0x402,0x200000,0x800,0x7020000,0x40000000,0,0x40c200,0x20
.long 5,0x5202000,0x700,0x700,0x403000,0x80,0,1
.long 7,0x7a02000,0x400,0x500400,0x407400,0x40,0,1
.long 0,0,0,0,0x40000000,0,0,0
.long 0,0,0,0,0x40000000,0,0,0
.long 0,0,0,0,0x40000000,0,0,0
.long 1,0x40000,0x900,0x1424000,0x40000000,0,0x408a00,9
.long 0xae0002,0x100000,0xa00,0x2028000,0x40000000,0,0x40a200,1
.long 0xee0502,0,0xa00,0x5028000,0x40000000,0,0x408200,0
.long 0xee0702,0x300000,0xa00,0x4028000,0x40000000,0,0x40e200,1
.long 0x402,0x200000,0xa00,0x7028000,0x40000000,0,0x40c200,0x20
.long 5,0x5202000,0x600,0x600,0x403000,0x80,0,1
.long 9,0,0,0,0x402800,0x20,0,0
.long 7,0x7a02000,0xc200000,0x500500,0x407400,0x40,0,2
.long 0,0,0,0,0x40000000,0,0,0
.long 0,0,0,0,0x40000000,0,0,0
.long 1,0x40000,0xa00,0x1428000,0x40000000,0,0x408a00,9
.long 0xad0002,0x100000,0xc00,0x2030000,0x40000000,0,0x40a300,1
.long 0xed0502,0,0xc00,0x5030000,0x40000000,0,0x408300,0
.long 0xed0702,0x300000,0xc00,0x4030000,0x40000000,0,0x40e300,1
.long 0x402,0x200000,0xc00,0x7030000,0x40000000,0,0x40c300,0x20
.long 9,0,0,0,0x402800,0x20,0,0
.long 5,0x5202000,0xc200000,0x500,0x403000,0x80,0,2
.long 7,0x7a02000,0x600,0x500600,0x407400,0x40,0,1
.long 0,0,0,0,0x40000000,0,0,0
.long 0,0,0,0,0x40000000,0,0,0
.long 1,0x40000,0xb00,0x142c000,0x40000000,0,0x408a00,9
.long 0xac0002,0x100000,0xe00,0x2038000,0x40000000,0,0x40a300,1
.long 0xec0502,0,0xe00,0x5038000,0x40000000,0,0x408300,0
.long 0xec0702,0x300000,0xe00,0x4038000,0x40000000,0,0x40e300,1
.long 0x402,0x200000,0xe00,0x7038000,0x40000000,0,0x40c300,0x20
.long 5,0x5202000,0x400,0x400,0x403000,0x80,0,1
.long 7,0x7a02000,0x700,0x500700,0x407400,0x40,0,1
.long 0,0,0,0,0x40000000,0,0,0
.long 0,0,0,0,0x40000000,0,0,0
.long 0,0,0,0,0x40000000,0,0,0
.long 1,0x40000,0xc00,0x1430000,0x40000000,0,0x408b00,9
.long 0xab0002,0x100000,0x800,0x2222000,0x40000000,0,0x40a200,2
.long 0xeb0502,0x80000,0x800,0x5820000,0x40000000,0,0x409200,0
.long 0xeb0702,0x300000,0x800,0x4222000,0x40000000,0,0x40e200,2
.long 0x402,0x280000,0x800,0x7820000,0x40000000,0,0x40d200,0x20
.long 5,0x5602000,0x700,0x80700,0x403100,0x80,0,1
.long 7,0x7b02000,0x400,0x540400,0x407500,0x40,0,1
.long 0,0,0,0,0x40000000,0,0,0
.long 0,0,0,0,0x40000000,0,0,0
.long 0,0,0,0,0x40000000,0,0,0
.long 1,0x40000,0xd00,0x1434000,0x40000000,0,0x408b00,9
.long 0xaa0002,0x100000,0xa00,0x222a000,0x40000000,0,0x40a200,2
.long 0xea0502,0x80000,0xa00,0x5828000,0x40000000,0,0x409200,0
.long 0xea0702,0x300000,0xa00,0x422a000,0x40000000,0,0x40e200,2
.long 0x402,0x280000,0xa00,0x7828000,0x40000000,0,0x40d200,0x20
.long 5,0x5602000,0x600,0x80600,0x403100,0x80,0,1
.long 9,0,0,0,0x402800,0x20,0,0
.long 7,0x7b02000,0xc200000,0x540500,0x407500,0x40,0,2
.long 0,0,0,0,0x40000000,0,0,0
.long 0,0,0,0,0x40000000,0,0,0
.long 1,0x40000,0xe00,0x1438000,0x40000000,0,0x408b00,9
.long 0xa90002,0x100000,0xc00,0x2232000,0x40000000,0,0x40a300,2
.long 0xe90502,0x80000,0xc00,0x5830000,0x40000000,0,0x409300,0
.long 0xe90702,0x300000,0xc00,0x4232000,0x40000000,0,0x40e300,2
.long 0x402,0x280000,0xc00,0x7830000,0x40000000,0,0x40d300,0x20
.long 9,0,0,0,0x402800,0x20,0,0
.long 5,0x5602000,0xc200000,0x80500,0x403100,0x80,0,2
.long 7,0x7b02000,0x600,0x540600,0x407500,0x40,0,1
.long 0,0,0,0,0x40000000,0,0,0
.long 0,0,0,0,0x40000000,0,0,0
.long 1,0x40000,0xf00,0x143c000,0x40000000,0,0x408b00,9
.long 0xa80002,0x100000,0xe00,0x223a000,0x40000000,0,0x40a300,2
.long 0xe80502,0x80000,0xe00,0x5838000,0x40000000,0,0x409300,0
.long 0xe80702,0x300000,0xe00,0x423a000,0x40000000,0,0x40e300,2
.long 0x402,0x280000,0xe00,0x7838000,0x40000000,0,0x40d300,0x20
.long 5,0x5602000,0x400,0x80400,0x403100,0x80,0,1
.long 7,0x7b02000,0x700,0x540700,0x407500,0x40,0,1
.long 0,0,0,0,0x40000000,0,0,0
.long 0,0,0,0,0x40000000,0,0,0
.long 0,0,0,0,0x40000000,0,0,0
.long 1,0x40000,0x800,0x1622000,0x40000000,0,0x408a00,0xa
.long 0xa70002,0x180000,0x800,0x2820000,0x40000000,0,0x40b200,1
.long 0xe70502,0x100000,0x800,0x6020000,0x40000000,0,0x40a200,0
.long 0xe70702,0x380000,0x800,0x4820000,0x40000000,0,0x40f200,1
.long 0x402,0x300000,0x800,0x8020000,0x40000000,0,0x40e200,0x20
.long 5,0x5a02000,0x700,0x100700,0x403200,0x80,0,1
.long 7,0x8202000,0x400,0x600400,0x407800,0x40,0,1
.long 0,0,0,0,0x40000000,0,0,0
.long 0,0,0,0,0x40000000,0,0,0
.long 0,0,0,0,0x40000000,0,0,0
.long 1,0x40000,0x900,0x1626000,0x40000000,0,0x408a00,0xa
.long 0xa60002,0x180000,0xa00,0x2828000,0x40000000,0,0x40b200,1
.long 0xe60502,0x100000,0xa00,0x6028000,0x40000000,0,0x40a200,0
.long 0xe60702,0x380000,0xa00,0x4828000,0x40000000,0,0x40f200,1
.long 0x402,0x300000,0xa00,0x8028000,0x40000000,0,0x40e200,0x20
.long 5,0x5a02000,0x600,0x100600,0x403200,0x80,0,1
.long 9,0,0,0,0x402800,0x20,0,0
.long 7,0x8202000,0xc200000,0x600500,0x407800,0x40,0,2
.long 0,0,0,0,0x40000000,0,0,0
.long 0,0,0,0,0x40000000,0,0,0
.long 1,0x40000,0xa00,0x162a000,0x40000000,0,0x408a00,0xa
.long 0xa50002,0x180000,0xc00,0x2830000,0x40000000,0,0x40b300,1
.long 0xe50502,0x100000,0xc00,0x6030000,0x40000000,0,0x40a300,0
.long 0xe50702,0x380000,0xc00,0x4830000,0x40000000,0,0x40f300,1
.long 0x402,0x300000,0xc00,0x8030000,0x40000000,0,0x40e300,0x20
.long 9,0,0,0,0x402800,0x20,0,0
.long 5,0x5a02000,0xc200000,0x100500,0x403200,0x80,0,2
.long 7,0x8202000,0x600,0x600600,0x407800,0x40,0,1
.long 0,0,0,0,0x40000000,0,0,0
.long 0,0,0,0,0x40000000,0,0,0
.long 1,0x40000,0xb00,0x162e000,0x40000000,0,0x408a00,0xa
.long 0xa40002,0x180000,0xe00,0x2838000,0x40000000,0,0x40b300,1
.long 0xe40502,0x100000,0xe00,0x6038000,0x40000000,0,0x40a300,0
.long 0xe40702,0x380000,0xe00,0x4838000,0x40000000,0,0x40f300,1
.long 0x402,0x300000,0xe00,0x8038000,0x40000000,0,0x40e300,0x20
.long 5,0x5a02000,0x400,0x100400,0x403200,0x80,0,1
.long 7,0x8202000,0x700,0x600700,0x407800,0x40,0,1
.long 0,0,0,0,0x40000000,0,0,0
.long 0,0,0,0,0x40000000,0,0,0
.long 0,0,0,0,0x40000000,0,0,0
.long 1,0x40000,0xc00,0x1632000,0x40000000,0,0x408b00,0xa
.long 0xa30002,0x180000,0x800,0x2a22000,0x40000000,0,0x40b200,2
.long 0xe30502,0x180000,0x800,0x6820000,0x40000000,0,0x40b200,0
.long 0xe30702,0x380000,0x800,0x4a22000,0x40000000,0,0x40f200,2
.long 0x402,0x380000,0x800,0x8820000,0x40000000,0,0x40f200,0x20
.long 5,0x5e02000,0x700,0x180700,0x403300,0x80,0,1
.long 7,0x8602000,0x400,0x680400,0x407a00,0x40,0,1
.long 0,0,0,0,0x40000000,0,0,0
.long 0,0,0,0,0x40000000,0,0,0
.long 0,0,0,0,0x40000000,0,0,0
.long 1,0x40000,0xd00,0x1636000,0x40000000,0,0x408b00,0xa
.long 0xa20002,0x180000,0xa00,0x2a2a000,0x40000000,0,0x40b200,2
.long 0xe20502,0x180000,0xa00,0x6828000,0x40000000,0,0x40b200,0
.long 0xe20702,0x380000,0xa00,0x4a2a000,0x40000000,0,0x40f200,2
.long 0x402,0x380000,0xa00,0x8828000,0x40000000,0,0x40f200,0x20
.long 5,0x5e02000,0x600,0x180600,0x403300,0x80,0,1
.long 9,0,0,0,0x402800,0x20,0,0
.long 7,0x8602000,0xc200000,0x680500,0x407a00,0x40,0,2
.long 0,0,0,0,0x40000000,0,0,0
.long 0,0,0,0,0x40000000,0,0,0
.long 1,0x40000,0xe00,0x163a000,0x40000000,0,0x408b00,0xa
.long 0xa10002,0x180000,0xc00,0x2a32000,0x40000000,0,0x40b300,2
.long 0xe10502,0x180000,0xc00,0x6830000,0x40000000,0,0x40b300,0
.long 0xe10702,0x380000,0xc00,0x4a32000,0x40000000,0,0x40f300,2
.long 0x402,0x380000,0xc00,0x8830000,0x40000000,0,0x40f300,0x20
.long 9,0,0,0,0x402800,0x20,0,0
.long 5,0x5e02000,0xc200000,0x180500,0x403300,0x80,0,2
.long 7,0x8602000,0x600,0x680600,0x407a00,0x40,0,1
.long 0,0,0,0,0x40000000,0,0,0
.long 0,0,0,0,0x40000000,0,0,0
.long 1,0x40000,0xf00,0x163e000,0x40000000,0,0x408b00,0xa
.long 0xa00002,0x180000,0xe00,0x2a3a000,0x40000000,0,0x40b300,2
.long 0xe00502,0x180000,0xe00,0x6838000,0x40000000,0,0x40b300,0
.long 0xe00702,0x380000,0xe00,0x4a3a000,0x40000000,0,0x40f300,2
.long 0x402,0x380000,0xe00,0x8838000,0x40000000,0,0x40f300,0x20
.long 5,0x5e02000,0x400,0x180400,0x403300,0x80,0,1
.long 7,0x8602000,0x700,0x680700,0x407a00,0x40,0,1
.long 0,0,0,0,0x40000000,0,0,0
.long 0,0,0,0,0x40000000,0,0,0
.long 0,0,0,0,0x40000000,0,0,0
.long 1,0,0x1000,0x1040000,0x40000000,0,0x408400,9
.long 1,0x80000,0x1100,0x1844000,0x40000000,0,0x409400,1
.long 1,0xc0000,0x1200,0x1c48000,0x40000000,0,0x409c00,1
.long 0xdf0202,0x200000,0x1000,0x3040000,0x40000000,0,0x40c400,1
.long 0x403,0x200000,0x800,0x9980000,0x40000000,0,0x401000,0
.long 8,0x9818000,0x10,0x9c0c000,0x401400,8,0x401a00,0xe00
.long 4,0x200000,0,0x9400000,0x401800,8,0x402400,0x9c00000
.long 6,0x9400000,0,0x400800,0x402400,4,0,0
.long 0,0,0,0,0x40000000,0,0,0
.long 0,0,0,0,0x40000000,0,0,0
.long 1,0,0x1100,0x1044000,0x40000000,0,0x408400,9
.long 1,0x80000,0x1000,0x1840000,0x40000000,0,0x409400,1
.long 1,0xc0000,0x1300,0x1c4c000,0x40000000,0,0x409c00,1
.long 0xde0202,0x200000,0x1200,0x3048000,0x40000000,0,0x40c400,1
.long 0x403,0x200000,0x900,0x9986000,0x40000000,0,0x401100,0
.long 8,0x9819800,0x11,0x9c0cc00,0x401400,8,0x401a00,0xe00
.long 4,0x200000,0x200,0x9408000,0x401900,8,0x402400,0x9c06000
.long 6,0x9400000,0x200,0x400a00,0x402400,4,0,0
.long 0,0,0,0,0x40000000,0,0,0
.long 0,0,0,0,0x40000000,0,0,0
.long 1,0,0x1200,0x1048000,0x40000000,0,0x408400,9
.long 1,0x80000,0x1300,0x184c000,0x40000000,0,0x409400,1
.long 1,0xc0000,0x1000,0x1c40000,0x40000000,0,0x409c00,1
.long 0xdd0202,0x200000,0x1400,0x3050000,0x40000000,0,0x40c500,1
.long 0x403,0x200000,0xa00,0x998c000,0x40000000,0,0x401200,0
.long 8,0x981b000,0x12,0x9c0d800,0x401400,8,0x401a00,0xe00
.long 4,0x200000,0x400,0x9410000,0x401a00,8,0x402400,0x9c0c000
.long 6,0x9400000,0x400,0x400c00,0x402400,4,0,0
.long 0,0,0,0,0x40000000,0,0,0
.long 0,0,0,0,0x40000000,0,0,0
.long 1,0,0x1300,0x104c000,0x40000000,0,0x408400,9
.long 1,0x80000,0x1200,0x1848000,0x40000000,0,0x409400,1
.long 1,0xc0000,0x1100,0x1c44000,0x40000000,0,0x409c00,1
.long 0xdc0202,0x200000,0x1600,0x3058000,0x40000000,0,0x40c500,1
.long 0x403,0x200000,0xb00,0x9992000,0x40000000,0,0x401300,0
.long 8,0x981c800,0x13,0x9c0e400,0x401400,8,0x401a00,0xe00
.long 4,0x200000,0x600,0x9418000,0x401b00,8,0x402400,0x9c12000
.long 6,0x9400000,0x600,0x400e00,0x402400,4,0,0
.long 0,0,0,0,0x40000000,0,0,0
.long 0,0,0,0,0x40000000,0,0,0
.long 1,0,0x1400,0x1050000,0x40000000,0,0x408500,9
.long 1,0x80000,0x1500,0x1854000,0x40000000,0,0x409500,1
.long 1,0xc0000,0x1600,0x1c58000,0x40000000,0,0x409d00,1
.long 0xdb0202,0x200000,0x1000,0x3242000,0x40000000,0,0x40c400,2
.long 0x403,0x280000,0x800,0x99e0000,0x40000000,0,0x401000,0
.long 8,0x981e000,0x14,0x9c0f000,0x401500,8,0x401a00,0xe00
.long 4,0x280000,0,0x9500000,0x401800,8,0x402500,0x9c00000
.long 6,0x9500000,0,0x500800,0x402500,4,0,0
.long 0,0,0,0,0x40000000,0,0,0
.long 0,0,0,0,0x40000000,0,0,0
.long 1,0,0x1500,0x1054000,0x40000000,0,0x408500,9
.long 1,0x80000,0x1400,0x1850000,0x40000000,0,0x409500,1
.long 1,0xc0000,0x1700,0x1c5c000,0x40000000,0,0x409d00,1
.long 0xda0202,0x200000,0x1200,0x324a000,0x40000000,0,0x40c400,2
.long 0x403,0x280000,0x900,0x99e6000,0x40000000,0,0x401100,0
.long 8,0x981f800,0x15,0x9c0fc00,0x401500,8,0x401a00,0xe00
.long 4,0x280000,0x200,0x9508000,0x401900,8,0x402500,0x9c06000
.long 6,0x9500000,0x200,0x500a00,0x402500,4,0,0
.long 0,0,0,0,0x40000000,0,0,0
.long 0,0,0,0,0x40000000,0,0,0
.long 1,0,0x1600,0x1058000,0x40000000,0,0x408500,9
.long 1,0x80000,0x1700,0x185c000,0x40000000,0,0x409500,1
.long 1,0xc0000,0x1400,0x1c50000,0x40000000,0,0x409d00,1
.long 0xd90202,0x200000,0x1400,0x3252000,0x40000000,0,0x40c500,2
.long 0x403,0x280000,0xa00,0x99ec000,0x40000000,0,0x401200,0
.long 8,0x9821000,0x16,0x9c10800,0x401500,8,0x401a00,0xe00
.long 4,0x280000,0x400,0x9510000,0x401a00,8,0x402500,0x9c0c000
.long 6,0x9500000,0x400,0x500c00,0x402500,4,0,0
.long 0,0,0,0,0x40000000,0,0,0
.long 0,0,0,0,0x40000000,0,0,0
.long 1,0,0x1700,0x105c000,0x40000000,0,0x408500,9
.long 1,0x80000,0x1600,0x1858000,0x40000000,0,0x409500,1
.long 1,0xc0000,0x1500,0x1c54000,0x40000000,0,0x409d00,1
.long 0xd80202,0x200000,0x1600,0x325a000,0x40000000,0,0x40c500,2
.long 0x403,0x280000,0xb00,0x99f2000,0x40000000,0,0x401300,0
.long 8,0x9822800,0x17,0x9c11400,0x401500,8,0x401a00,0xe00
.long 4,0x280000,0x600,0x9518000,0x401b00,8,0x402500,0x9c12000
.long 6,0x9500000,0x600,0x500e00,0x402500,4,0,0
.long 0,0,0,0,0x40000000,0,0,0
.long 0,0,0,0,0x40000000,0,0,0
.long 1,0,0x1000,0x1242000,0x40000000,0,0x408400,0xa
.long 1,0x80000,0x1100,0x1a46000,0x40000000,0,0x409400,2
.long 1,0xc0000,0x1200,0x1e4a000,0x40000000,0,0x409c00,2
.long 0xd70202,0x280000,0x1000,0x3840000,0x40000000,0,0x40d400,1
.long 0x403,0x300000,0x800,0x9a40000,0x40000000,0,0x401000,0
.long 0xa,0,4,0x20,0x40000000,0,0,4
.long 0xa,0x20,4,0x30,0x40000000,0,0,4
.long 5,0x7602000,0,0x480000,0x403900,0x80,0,1
.long 0,0,0,0,0x40000000,0,0,0
.long 0,0,0,0,0x40000000,0,0,0
.long 1,0,0x1100,0x1246000,0x40000000,0,0x408400,0xa
.long 1,0x80000,0x1000,0x1a42000,0x40000000,0,0x409400,2
.long 1,0xc0000,0x1300,0x1e4e000,0x40000000,0,0x409c00,2
.long 0xd60202,0x280000,0x1200,0x3848000,0x40000000,0,0x40d400,1
.long 0x403,0x300000,0x900,0x9a46000,0x40000000,0,0x401100,0
.long 0xa,0,5,0x20,0x40000000,0,0,4
.long 0xa,0x20,5,0x30,0x40000000,0,0,4
.long 9,0,0,0,0x402800,0x20,0,0
.long 5,0x7602000,0xc000000,0x480100,0x403900,0x80,0,2
.long 0,0,0,0,0x40000000,0,0,0
.long 1,0,0x1200,0x124a000,0x40000000,0,0x408400,0xa
.long 1,0x80000,0x1300,0x1a4e000,0x40000000,0,0x409400,2
.long 1,0xc0000,0x1000,0x1e42000,0x40000000,0,0x409c00,2
.long 0xd50202,0x280000,0x1400,0x3850000,0x40000000,0,0x40d500,1
.long 0x403,0x300000,0xa00,0x9a4c000,0x40000000,0,0x401200,0
.long 0xa,1,4,0x20,0x40000000,0,0,4
.long 0xa,0x21,4,0x30,0x40000000,0,0,4
.long 5,0x7602000,0x200,0x480200,0x403900,0x80,0,1
.long 0,0,0,0,0x40000000,0,0,0
.long 0,0,0,0,0x40000000,0,0,0
.long 1,0,0x1300,0x124e000,0x40000000,0,0x408400,0xa
.long 1,0x80000,0x1200,0x1a4a000,0x40000000,0,0x409400,2
.long 1,0xc0000,0x1100,0x1e46000,0x40000000,0,0x409c00,2
.long 0xd40202,0x280000,0x1600,0x3858000,0x40000000,0,0x40d500,1
.long 0x403,0x300000,0xb00,0x9a52000,0x40000000,0,0x401300,0
.long 0xa,1,5,0x20,0x40000000,0,0,4
.long 0xa,0x21,5,0x30,0x40000000,0,0,4
.long 5,0x7602000,0x300,0x480300,0x403900,0x80,0,1
.long 0,0,0,0,0x40000000,0,0,0
.long 0,0,0,0,0x40000000,0,0,0
.long 1,0,0x1400,0x1252000,0x40000000,0,0x408500,0xa
.long 1,0x80000,0x1500,0x1a56000,0x40000000,0,0x409500,2
.long 1,0xc0000,0x1600,0x1e5a000,0x40000000,0,0x409d00,2
.long 0xd30202,0x280000,0x1000,0x3a42000,0x40000000,0,0x40d400,2
.long 0x403,0x380000,0x800,0x9aa0000,0x40000000,0,0x401000,0
.long 0xa,2,4,0x20,0x40000000,0,0,4
.long 0xa,0x22,4,0x30,0x40000000,0,0,4
.long 0xa,0x30,4,0x40,0x40000000,0,0,2
.long 0,0,0,0,0x40000000,0,0,0
.long 0,0,0,0,0x40000000,0,0,0
.long 1,0,0x1500,0x1256000,0x40000000,0,0x408500,0xa
.long 1,0x80000,0x1400,0x1a52000,0x40000000,0,0x409500,2
.long 1,0xc0000,0x1700,0x1e5e000,0x40000000,0,0x409d00,2
.long 0xd20202,0x280000,0x1200,0x3a4a000,0x40000000,0,0x40d400,2
.long 0x403,0x380000,0x900,0x9aa6000,0x40000000,0,0x401100,0
.long 0xa,2,5,0x20,0x40000000,0,0,4
.long 0xa,0x22,5,0x30,0x40000000,0,0,4
.long 0xa,0x30,5,0x40,0x40000000,0,0,2
.long 0,0,0,0,0x40000000,0,0,0
.long 0,0,0,0,0x40000000,0,0,0
.long 1,0,0x1600,0x125a000,0x40000000,0,0x408500,0xa
.long 1,0x80000,0x1700,0x1a5e000,0x40000000,0,0x409500,2
.long 1,0xc0000,0x1400,0x1e52000,0x40000000,0,0x409d00,2
.long 0xd10202,0x280000,0x1400,0x3a52000,0x40000000,0,0x40d500,2
.long 0x403,0x380000,0xa00,0x9aac000,0x40000000,0,0x401200,0
.long 0xa,3,4,0x20,0x40000000,0,0,4
.long 0xa,0x23,4,0x30,0x40000000,0,0,4
.long 0xa,0x31,4,0x40,0x40000000,0,0,2
.long 0,0,0,0,0x40000000,0,0,0
.long 0,0,0,0,0x40000000,0,0,0
.long 1,0,0x1700,0x125e000,0x40000000,0,0x408500,0xa
.long 1,0x80000,0x1600,0x1a5a000,0x40000000,0,0x409500,2
.long 1,0xc0000,0x1500,0x1e56000,0x40000000,0,0x409d00,2
.long 0xd00202,0x280000,0x1600,0x3a5a000,0x40000000,0,0x40d500,2
.long 0x403,0x380000,0xb00,0x9ab2000,0x40000000,0,0x401300,0
.long 0xa,3,5,0x20,0x40000000,0,0,4
.long 0xa,0x23,5,0x30,0x40000000,0,0,4
.long 0xa,0x31,5,0x40,0x40000000,0,0,2
.long 0,0,0,0,0x40000000,0,0,0
.long 0,0,0,0,0x40000000,0,0,0
.long 1,0x40000,0x1000,0x1440000,0x40000000,0,0x408c00,9
.long 0x9f0002,0x100000,0x1000,0x2040000,0x40000000,0,0x40a400,1
.long 0xdf0502,0,0x1000,0x5040000,0x40000000,0,0x408400,0
.long 0xdf0702,0x300000,0x1000,0x4040000,0x40000000,0,0x40e400,1
.long 0x402,0x200000,0x1000,0x7040000,0x40000000,0,0x40c400,0x20
.long 5,0x6202000,0x300,0x200300,0x403400,0x80,0,1
.long 7,0x7e02000,0,0x580000,0x407600,0x40,0,1
.long 0,0,0,0,0x40000000,0,0,0
.long 0,0,0,0,0x40000000,0,0,0
.long 0,0,0,0,0x40000000,0,0,0
.long 1,0x40000,0x1100,0x1444000,0x40000000,0,0x408c00,9
.long 0x9e0002,0x100000,0x1200,0x2048000,0x40000000,0,0x40a400,1
.long 0xde0502,0,0x1200,0x5048000,0x40000000,0,0x408400,0
.long 0xde0702,0x300000,0x1200,0x4048000,0x40000000,0,0x40e400,1
.long 0x402,0x200000,0x1200,0x7048000,0x40000000,0,0x40c400,0x20
.long 5,0x6202000,0x200,0x200200,0x403400,0x80,0,1
.long 9,0,0,0,0x402800,0x20,0,0
.long 7,0x7e02000,0xc000000,0x580100,0x407600,0x40,0,2
.long 0,0,0,0,0x40000000,0,0,0
.long 0,0,0,0,0x40000000,0,0,0
.long 1,0x40000,0x1200,0x1448000,0x40000000,0,0x408c00,9
.long 0x9d0002,0x100000,0x1400,0x2050000,0x40000000,0,0x40a500,1
.long 0xdd0502,0,0x1400,0x5050000,0x40000000,0,0x408500,0
.long 0xdd0702,0x300000,0x1400,0x4050000,0x40000000,0,0x40e500,1
.long 0x402,0x200000,0x1400,0x7050000,0x40000000,0,0x40c500,0x20
.long 9,0,0,0,0x402800,0x20,0,0
.long 5,0x6202000,0xc000000,0x200100,0x403400,0x80,0,2
.long 7,0x7e02000,0x200,0x580200,0x407600,0x40,0,1
.long 0,0,0,0,0x40000000,0,0,0
.long 0,0,0,0,0x40000000,0,0,0
.long 1,0x40000,0x1300,0x144c000,0x40000000,0,0x408c00,9
.long 0x9c0002,0x100000,0x1600,0x2058000,0x40000000,0,0x40a500,1
.long 0xdc0502,0,0x1600,0x5058000,0x40000000,0,0x408500,0
.long 0xdc0702,0x300000,0x1600,0x4058000,0x40000000,0,0x40e500,1
.long 0x402,0x200000,0x1600,0x7058000,0x40000000,0,0x40c500,0x20
.long 5,0x6202000,0,0x200000,0x403400,0x80,0,1
.long 7,0x7e02000,0x300,0x580300,0x407600,0x40,0,1
.long 0,0,0,0,0x40000000,0,0,0
.long 0,0,0,0,0x40000000,0,0,0
.long 0,0,0,0,0x40000000,0,0,0
.long 1,0x40000,0x1400,0x1450000,0x40000000,0,0x408d00,9
.long 0x9b0002,0x100000,0x1000,0x2242000,0x40000000,0,0x40a400,2
.long 0xdb0502,0x80000,0x1000,0x5840000,0x40000000,0,0x409400,0
.long 0xdb0702,0x300000,0x1000,0x4242000,0x40000000,0,0x40e400,2
.long 0x402,0x280000,0x1000,0x7840000,0x40000000,0,0x40d400,0x20
.long 5,0x6602000,0x300,0x280300,0x403500,0x80,0,1
.long 7,0x7f02000,0,0x5c0000,0x407700,0x40,0,1
.long 0,0,0,0,0x40000000,0,0,0
.long 0,0,0,0,0x40000000,0,0,0
.long 0,0,0,0,0x40000000,0,0,0
.long 1,0x40000,0x1500,0x1454000,0x40000000,0,0x408d00,9
.long 0x9a0002,0x100000,0x1200,0x224a000,0x40000000,0,0x40a400,2
.long 0xda0502,0x80000,0x1200,0x5848000,0x40000000,0,0x409400,0
.long 0xda0702,0x300000,0x1200,0x424a000,0x40000000,0,0x40e400,2
.long 0x402,0x280000,0x1200,0x7848000,0x40000000,0,0x40d400,0x20
.long 5,0x6602000,0x200,0x280200,0x403500,0x80,0,1
.long 9,0,0,0,0x402800,0x20,0,0
.long 7,0x7f02000,0xc000000,0x5c0100,0x407700,0x40,0,2
.long 0,0,0,0,0x40000000,0,0,0
.long 0,0,0,0,0x40000000,0,0,0
.long 1,0x40000,0x1600,0x1458000,0x40000000,0,0x408d00,9
.long 0x990002,0x100000,0x1400,0x2252000,0x40000000,0,0x40a500,2
.long 0xd90502,0x80000,0x1400,0x5850000,0x40000000,0,0x409500,0
.long 0xd90702,0x300000,0x1400,0x4252000,0x40000000,0,0x40e500,2
.long 0x402,0x280000,0x1400,0x7850000,0x40000000,0,0x40d500,0x20
.long 9,0,0,0,0x402800,0x20,0,0
.long 5,0x6602000,0xc000000,0x280100,0x403500,0x80,0,2
.long 7,0x7f02000,0x200,0x5c0200,0x407700,0x40,0,1
.long 0,0,0,0,0x40000000,0,0,0
.long 0,0,0,0,0x40000000,0,0,0
.long 1,0x40000,0x1700,0x145c000,0x40000000,0,0x408d00,9
.long 0x980002,0x100000,0x1600,0x225a000,0x40000000,0,0x40a500,2
.long 0xd80502,0x80000,0x1600,0x5858000,0x40000000,0,0x409500,0
.long 0xd80702,0x300000,0x1600,0x425a000,0x40000000,0,0x40e500,2
.long 0x402,0x280000,0x1600,0x7858000,0x40000000,0,0x40d500,0x20
.long 5,0x6602000,0,0x280000,0x403500,0x80,0,1
.long 7,0x7f02000,0x300,0x5c0300,0x407700,0x40,0,1
.long 0,0,0,0,0x40000000,0,0,0
.long 0,0,0,0,0x40000000,0,0,0
.long 0,0,0,0,0x40000000,0,0,0
.long 1,0x40000,0x1000,0x1642000,0x40000000,0,0x408c00,0xa
.long 0x970002,0x180000,0x1000,0x2840000,0x40000000,0,0x40b400,1
.long 0xd70502,0x100000,0x1000,0x6040000,0x40000000,0,0x40a400,0
.long 0xd70702,0x380000,0x1000,0x4840000,0x40000000,0,0x40f400,1
.long 0x402,0x300000,0x1000,0x8040000,0x40000000,0,0x40e400,0x20
.long 5,0x6a02000,0x300,0x300300,0x403600,0x80,0,1
.long 7,0x8302000,0,0x640000,0x407900,0x40,0,1
.long 0,0,0,0,0x40000000,0,0,0
.long 0,0,0,0,0x40000000,0,0,0
.long 0,0,0,0,0x40000000,0,0,0
.long 1,0x40000,0x1100,0x1646000,0x40000000,0,0x408c00,0xa
.long 0x960002,0x180000,0x1200,0x2848000,0x40000000,0,0x40b400,1
.long 0xd60502,0x100000,0x1200,0x6048000,0x40000000,0,0x40a400,0
.long 0xd60702,0x380000,0x1200,0x4848000,0x40000000,0,0x40f400,1
.long 0x402,0x300000,0x1200,0x8048000,0x40000000,0,0x40e400,0x20
.long 5,0x6a02000,0x200,0x300200,0x403600,0x80,0,1
.long 9,0,0,0,0x402800,0x20,0,0
.long 7,0x8302000,0xc000000,0x640100,0x407900,0x40,0,2
.long 0,0,0,0,0x40000000,0,0,0
.long 0,0,0,0,0x40000000,0,0,0
.long 1,0x40000,0x1200,0x164a000,0x40000000,0,0x408c00,0xa
.long 0x950002,0x180000,0x1400,0x2850000,0x40000000,0,0x40b500,1
.long 0xd50502,0x100000,0x1400,0x6050000,0x40000000,0,0x40a500,0
.long 0xd50702,0x380000,0x1400,0x4850000,0x40000000,0,0x40f500,1
.long 0x402,0x300000,0x1400,0x8050000,0x40000000,0,0x40e500,0x20
.long 9,0,0,0,0x402800,0x20,0,0
.long 5,0x6a02000,0xc000000,0x300100,0x403600,0x80,0,2
.long 7,0x8302000,0x200,0x640200,0x407900,0x40,0,1
.long 0,0,0,0,0x40000000,0,0,0
.long 0,0,0,0,0x40000000,0,0,0
.long 1,0x40000,0x1300,0x164e000,0x40000000,0,0x408c00,0xa
.long 0x940002,0x180000,0x1600,0x2858000,0x40000000,0,0x40b500,1
.long 0xd40502,0x100000,0x1600,0x6058000,0x40000000,0,0x40a500,0
.long 0xd40702,0x380000,0x1600,0x4858000,0x40000000,0,0x40f500,1
.long 0x402,0x300000,0x1600,0x8058000,0x40000000,0,0x40e500,0x20
.long 5,0x6a02000,0,0x300000,0x403600,0x80,0,1
.long 7,0x8302000,0x300,0x640300,0x407900,0x40,0,1
.long 0,0,0,0,0x40000000,0,0,0
.long 0,0,0,0,0x40000000,0,0,0
.long 0,0,0,0,0x40000000,0,0,0
.long 1,0x40000,0x1400,0x1652000,0x40000000,0,0x408d00,0xa
.long 0x930002,0x180000,0x1000,0x2a42000,0x40000000,0,0x40b400,2
.long 0xd30502,0x180000,0x1000,0x6840000,0x40000000,0,0x40b400,0
.long 0xd30702,0x380000,0x1000,0x4a42000,0x40000000,0,0x40f400,2
.long 0x402,0x380000,0x1000,0x8840000,0x40000000,0,0x40f400,0x20
.long 5,0x6e02000,0x300,0x380300,0x403700,0x80,0,1
.long 7,0x8702000,0,0x6c0000,0x407b00,0x40,0,1
.long 0,0,0,0,0x40000000,0,0,0
.long 0,0,0,0,0x40000000,0,0,0
.long 0,0,0,0,0x40000000,0,0,0
.long 1,0x40000,0x1500,0x1656000,0x40000000,0,0x408d00,0xa
.long 0x920002,0x180000,0x1200,0x2a4a000,0x40000000,0,0x40b400,2
.long 0xd20502,0x180000,0x1200,0x6848000,0x40000000,0,0x40b400,0
.long 0xd20702,0x380000,0x1200,0x4a4a000,0x40000000,0,0x40f400,2
.long 0x402,0x380000,0x1200,0x8848000,0x40000000,0,0x40f400,0x20
.long 5,0x6e02000,0x200,0x380200,0x403700,0x80,0,1
.long 9,0,0,0,0x402800,0x20,0,0
.long 7,0x8702000,0xc000000,0x6c0100,0x407b00,0x40,0,2
.long 0,0,0,0,0x40000000,0,0,0
.long 0,0,0,0,0x40000000,0,0,0
.long 1,0x40000,0x1600,0x165a000,0x40000000,0,0x408d00,0xa
.long 0x910002,0x180000,0x1400,0x2a52000,0x40000000,0,0x40b500,2
.long 0xd10502,0x180000,0x1400,0x6850000,0x40000000,0,0x40b500,0
.long 0xd10702,0x380000,0x1400,0x4a52000,0x40000000,0,0x40f500,2
.long 0x402,0x380000,0x1400,0x8850000,0x40000000,0,0x40f500,0x20
.long 9,0,0,0,0x402800,0x20,0,0
.long 5,0x6e02000,0xc000000,0x380100,0x403700,0x80,0,2
.long 7,0x8702000,0x200,0x6c0200,0x407b00,0x40,0,1
.long 0,0,0,0,0x40000000,0,0,0
.long 0,0,0,0,0x40000000,0,0,0
.long 1,0x40000,0x1700,0x165e000,0x40000000,0,0x408d00,0xa
.long 0x900002,0x180000,0x1600,0x2a5a000,0x40000000,0,0x40b500,2
.long 0xd00502,0x180000,0x1600,0x6858000,0x40000000,0,0x40b500,0
.long 0xd00702,0x380000,0x1600,0x4a5a000,0x40000000,0,0x40f500,2
.long 0x402,0x380000,0x1600,0x8858000,0x40000000,0,0x40f500,0x20
.long 5,0x6e02000,0,0x380000,0x403700,0x80,0,1
.long 7,0x8702000,0x300,0x6c0300,0x407b00,0x40,0,1
.long 0,0,0,0,0x40000000,0,0,0
.long 0,0,0,0,0x40000000,0,0,0
.long 0,0,0,0,0x40000000,0,0,0
.long 1,0,0x1800,0x1060000,0x40000000,0,0x408600,9
.long 1,0x80000,0x1900,0x1864000,0x40000000,0,0x409600,1
.long 1,0xc0000,0x1a00,0x1c68000,0x40000000,0,0x409e00,1
.long 0xcf0202,0x200000,0x1800,0x3060000,0x40000000,0,0x40c600,1
.long 0x403,0x200000,0xc00,0x9998000,0x40000000,0,0x401400,0
.long 8,0x9824000,0x18,0x9c12000,0x401600,8,0x401b00,0xd00
.long 4,0x300000,0,0x9602000,0x401800,8,0x402600,0x9c00000
.long 6,0x9602000,0,0x600800,0x402600,4,0,0
.long 0,0,0,0,0x40000000,0,0,0
.long 0,0,0,0,0x40000000,0,0,0
.long 1,0,0x1900,0x1064000,0x40000000,0,0x408600,9
.long 1,0x80000,0x1800,0x1860000,0x40000000,0,0x409600,1
.long 1,0xc0000,0x1b00,0x1c6c000,0x40000000,0,0x409e00,1
.long 0xce0202,0x200000,0x1a00,0x3068000,0x40000000,0,0x40c600,1
.long 0x403,0x200000,0xd00,0x999e000,0x40000000,0,0x401500,0
.long 8,0x9825800,0x19,0x9c12c00,0x401600,8,0x401b00,0xd00
.long 4,0x300000,0x200,0x960a000,0x401900,8,0x402600,0x9c06000
.long 6,0x9602000,0x200,0x600a00,0x402600,4,0,0
.long 0,0,0,0,0x40000000,0,0,0
.long 0,0,0,0,0x40000000,0,0,0
.long 1,0,0x1a00,0x1068000,0x40000000,0,0x408600,9
.long 1,0x80000,0x1b00,0x186c000,0x40000000,0,0x409600,1
.long 1,0xc0000,0x1800,0x1c60000,0x40000000,0,0x409e00,1
.long 0xcd0202,0x200000,0x1c00,0x3070000,0x40000000,0,0x40c700,1
.long 0x403,0x200000,0xe00,0x99a4000,0x40000000,0,0x401600,0
.long 8,0x9827000,0x1a,0x9c13800,0x401600,8,0x401b00,0xd00
.long 4,0x300000,0x400,0x9612000,0x401a00,8,0x402600,0x9c0c000
.long 6,0x9602000,0x400,0x600c00,0x402600,4,0,0
.long 0,0,0,0,0x40000000,0,0,0
.long 0,0,0,0,0x40000000,0,0,0
.long 1,0,0x1b00,0x106c000,0x40000000,0,0x408600,9
.long 1,0x80000,0x1a00,0x1868000,0x40000000,0,0x409600,1
.long 1,0xc0000,0x1900,0x1c64000,0x40000000,0,0x409e00,1
.long 0xcc0202,0x200000,0x1e00,0x3078000,0x40000000,0,0x40c700,1
.long 0x403,0x200000,0xf00,0x99aa000,0x40000000,0,0x401700,0
.long 8,0x9828800,0x1b,0x9c14400,0x401600,8,0x401b00,0xd00
.long 4,0x300000,0x600,0x961a000,0x401b00,8,0x402600,0x9c12000
.long 6,0x9602000,0x600,0x600e00,0x402600,4,0,0
.long 0,0,0,0,0x40000000,0,0,0
.long 0,0,0,0,0x40000000,0,0,0
.long 1,0,0x1c00,0x1070000,0x40000000,0,0x408700,9
.long 1,0x80000,0x1d00,0x1874000,0x40000000,0,0x409700,1
.long 1,0xc0000,0x1e00,0x1c78000,0x40000000,0,0x409f00,1
.long 0xcb0202,0x200000,0x1800,0x3262000,0x40000000,0,0x40c600,2
.long 0x403,0x280000,0xc00,0x99f8000,0x40000000,0,0x401400,0
.long 8,0x982a000,0x1c,0x9c15000,0x401700,8,0x401b00,0xd00
.long 4,0x380000,0,0x9702000,0x401800,8,0x402700,0x9c00000
.long 6,0x9702000,0,0x700800,0x402700,4,0,0
.long 0,0,0,0,0x40000000,0,0,0
.long 0,0,0,0,0x40000000,0,0,0
.long 1,0,0x1d00,0x1074000,0x40000000,0,0x408700,9
.long 1,0x80000,0x1c00,0x1870000,0x40000000,0,0x409700,1
.long 1,0xc0000,0x1f00,0x1c7c000,0x40000000,0,0x409f00,1
.long 0xca0202,0x200000,0x1a00,0x326a000,0x40000000,0,0x40c600,2
.long 0x403,0x280000,0xd00,0x99fe000,0x40000000,0,0x401500,0
.long 8,0x982b800,0x1d,0x9c15c00,0x401700,8,0x401b00,0xd00
.long 4,0x380000,0x200,0x970a000,0x401900,8,0x402700,0x9c06000
.long 6,0x9702000,0x200,0x700a00,0x402700,4,0,0
.long 0,0,0,0,0x40000000,0,0,0
.long 0,0,0,0,0x40000000,0,0,0
.long 1,0,0x1e00,0x1078000,0x40000000,0,0x408700,9
.long 1,0x80000,0x1f00,0x187c000,0x40000000,0,0x409700,1
.long 1,0xc0000,0x1c00,0x1c70000,0x40000000,0,0x409f00,1
.long 0xc90202,0x200000,0x1c00,0x3272000,0x40000000,0,0x40c700,2
.long 0x403,0x280000,0xe00,0x9a04000,0x40000000,0,0x401600,0
.long 8,0x982d000,0x1e,0x9c16800,0x401700,8,0x401b00,0xd00
.long 4,0x380000,0x400,0x9712000,0x401a00,8,0x402700,0x9c0c000
.long 6,0x9702000,0x400,0x700c00,0x402700,4,0,0
.long 0,0,0,0,0x40000000,0,0,0
.long 0,0,0,0,0x40000000,0,0,0
.long 1,0,0x1f00,0x107c000,0x40000000,0,0x408700,9
.long 1,0x80000,0x1e00,0x1878000,0x40000000,0,0x409700,1
.long 1,0xc0000,0x1d00,0x1c74000,0x40000000,0,0x409f00,1
.long 0xc80202,0x200000,0x1e00,0x327a000,0x40000000,0,0x40c700,2
.long 0x403,0x280000,0xf00,0x9a0a000,0x40000000,0,0x401700,0
.long 8,0x982e800,0x1f,0x9c17400,0x401700,8,0x401b00,0xd00
.long 4,0x380000,0x600,0x971a000,0x401b00,8,0x402700,0x9c12000
.long 6,0x9702000,0x600,0x700e00,0x402700,4,0,0
.long 0,0,0,0,0x40000000,0,0,0
.long 0,0,0,0,0x40000000,0,0,0
.long 1,0,0x1800,0x1262000,0x40000000,0,0x408600,0xa
.long 1,0x80000,0x1900,0x1a66000,0x40000000,0,0x409600,2
.long 1,0xc0000,0x1a00,0x1e6a000,0x40000000,0,0x409e00,2
.long 0xc70202,0x280000,0x1800,0x3860000,0x40000000,0,0x40d600,1
.long 0x403,0x300000,0xc00,0x9a58000,0x40000000,0,0x401400,0
.long 0xa,0,6,0x20,0x40000000,0,0,4
.long 0xa,0x20,6,0x30,0x40000000,0,0,4
.long 5,0x7602000,0x400,0x480400,0x403900,0x80,0,1
.long 0,0,0,0,0x40000000,0,0,0
.long 0,0,0,0,0x40000000,0,0,0
.long 1,0,0x1900,0x1266000,0x40000000,0,0x408600,0xa
.long 1,0x80000,0x1800,0x1a62000,0x40000000,0,0x409600,2
.long 1,0xc0000,0x1b00,0x1e6e000,0x40000000,0,0x409e00,2
.long 0xc60202,0x280000,0x1a00,0x3868000,0x40000000,0,0x40d600,1
.long 0x403,0x300000,0xd00,0x9a5e000,0x40000000,0,0x401500,0
.long 0xa,0,7,0x20,0x40000000,0,0,4
.long 0xa,0x20,7,0x30,0x40000000,0,0,4
.long 9,0,0,0,0x402800,0x20,0,0
.long 5,0x7602000,0xc200000,0x480500,0x403900,0x80,0,2
.long 0,0,0,0,0x40000000,0,0,0
.long 1,0,0x1a00,0x126a000,0x40000000,0,0x408600,0xa
.long 1,0x80000,0x1b00,0x1a6e000,0x40000000,0,0x409600,2
.long 1,0xc0000,0x1800,0x1e62000,0x40000000,0,0x409e00,2
.long 0xc50202,0x280000,0x1c00,0x3870000,0x40000000,0,0x40d700,1
.long 0x403,0x300000,0xe00,0x9a64000,0x40000000,0,0x401600,0
.long 0xa,1,6,0x20,0x40000000,0,0,4
.long 0xa,0x21,6,0x30,0x40000000,0,0,4
.long 5,0x7602000,0x600,0x480600,0x403900,0x80,0,1
.long 0,0,0,0,0x40000000,0,0,0
.long 0,0,0,0,0x40000000,0,0,0
.long 1,0,0x1b00,0x126e000,0x40000000,0,0x408600,0xa
.long 1,0x80000,0x1a00,0x1a6a000,0x40000000,0,0x409600,2
.long 1,0xc0000,0x1900,0x1e66000,0x40000000,0,0x409e00,2
.long 0xc40202,0x280000,0x1e00,0x3878000,0x40000000,0,0x40d700,1
.long 0x403,0x300000,0xf00,0x9a6a000,0x40000000,0,0x401700,0
.long 0xa,1,7,0x20,0x40000000,0,0,4
.long 0xa,0x21,7,0x30,0x40000000,0,0,4
.long 5,0x7602000,0x700,0x480700,0x403900,0x80,0,1
.long 0,0,0,0,0x40000000,0,0,0
.long 0,0,0,0,0x40000000,0,0,0
.long 1,0,0x1c00,0x1272000,0x40000000,0,0x408700,0xa
.long 1,0x80000,0x1d00,0x1a76000,0x40000000,0,0x409700,2
.long 1,0xc0000,0x1e00,0x1e7a000,0x40000000,0,0x409f00,2
.long 0xc30202,0x280000,0x1800,0x3a62000,0x40000000,0,0x40d600,2
.long 0x403,0x380000,0xc00,0x9ab8000,0x40000000,0,0x401400,0
.long 0xa,2,6,0x20,0x40000000,0,0,4
.long 0xa,0x22,6,0x30,0x40000000,0,0,4
.long 0xa,0x30,6,0x40,0x40000000,0,0,2
.long 0,0,0,0,0x40000000,0,0,0
.long 0,0,0,0,0x40000000,0,0,0
.long 1,0,0x1d00,0x1276000,0x40000000,0,0x408700,0xa
.long 1,0x80000,0x1c00,0x1a72000,0x40000000,0,0x409700,2
.long 1,0xc0000,0x1f00,0x1e7e000,0x40000000,0,0x409f00,2
.long 0xc20202,0x280000,0x1a00,0x3a6a000,0x40000000,0,0x40d600,2
.long 0x403,0x380000,0xd00,0x9abe000,0x40000000,0,0x401500,0
.long 0xa,2,7,0x20,0x40000000,0,0,4
.long 0xa,0x22,7,0x30,0x40000000,0,0,4
.long 0xa,0x30,7,0x40,0x40000000,0,0,2
.long 0,0,0,0,0x40000000,0,0,0
.long 0,0,0,0,0x40000000,0,0,0
.long 1,0,0x1e00,0x127a000,0x40000000,0,0x408700,0xa
.long 1,0x80000,0x1f00,0x1a7e000,0x40000000,0,0x409700,2
.long 1,0xc0000,0x1c00,0x1e72000,0x40000000,0,0x409f00,2
.long 0xc10202,0x280000,0x1c00,0x3a72000,0x40000000,0,0x40d700,2
.long 0x403,0x380000,0xe00,0x9ac4000,0x40000000,0,0x401600,0
.long 0xa,3,6,0x20,0x40000000,0,0,4
.long 0xa,0x23,6,0x30,0x40000000,0,0,4
.long 0xa,0x31,6,0x40,0x40000000,0,0,2
.long 0,0,0,0,0x40000000,0,0,0
.long 0,0,0,0,0x40000000,0,0,0
.long 1,0,0x1f00,0x127e000,0x40000000,0,0x408700,0xa
.long 1,0x80000,0x1e00,0x1a7a000,0x40000000,0,0x409700,2
.long 1,0xc0000,0x1d00,0x1e76000,0x40000000,0,0x409f00,2
.long 0xc00202,0x280000,0x1e00,0x3a7a000,0x40000000,0,0x40d700,2
.long 0x403,0x380000,0xf00,0x9aca000,0x40000000,0,0x401700,0
.long 0xa,3,7,0x20,0x40000000,0,0,4
.long 0xa,0x23,7,0x30,0x40000000,0,0,4
.long 0xa,0x31,7,0x40,0x40000000,0,0,2
.long 0,0,0,0,0x40000000,0,0,0
.long 0,0,0,0,0x40000000,0,0,0
.long 1,0x40000,0x1800,0x1460000,0x40000000,0,0x408e00,9
.long 0x8f0002,0x100000,0x1800,0x2060000,0x40000000,0,0x40a600,1
.long 0xcf0502,0,0x1800,0x5060000,0x40000000,0,0x408600,0
.long 0xcf0702,0x300000,0x1800,0x4060000,0x40000000,0,0x40e600,1
.long 0x402,0x200000,0x1800,0x7060000,0x40000000,0,0x40c600,0x20
.long 5,0x6202000,0x700,0x200700,0x403400,0x80,0,1
.long 7,0x7e02000,0x400,0x580400,0x407600,0x40,0,1
.long 0,0,0,0,0x40000000,0,0,0
.long 0,0,0,0,0x40000000,0,0,0
.long 0,0,0,0,0x40000000,0,0,0
.long 1,0x40000,0x1900,0x1464000,0x40000000,0,0x408e00,9
.long 0x8e0002,0x100000,0x1a00,0x2068000,0x40000000,0,0x40a600,1
.long 0xce0502,0,0x1a00,0x5068000,0x40000000,0,0x408600,0
.long 0xce0702,0x300000,0x1a00,0x4068000,0x40000000,0,0x40e600,1
.long 0x402,0x200000,0x1a00,0x7068000,0x40000000,0,0x40c600,0x20
.long 5,0x6202000,0x600,0x200600,0x403400,0x80,0,1
.long 9,0,0,0,0x402800,0x20,0,0
.long 7,0x7e02000,0xc200000,0x580500,0x407600,0x40,0,2
.long 0,0,0,0,0x40000000,0,0,0
.long 0,0,0,0,0x40000000,0,0,0
.long 1,0x40000,0x1a00,0x1468000,0x40000000,0,0x408e00,9
.long 0x8d0002,0x100000,0x1c00,0x2070000,0x40000000,0,0x40a700,1
.long 0xcd0502,0,0x1c00,0x5070000,0x40000000,0,0x408700,0
.long 0xcd0702,0x300000,0x1c00,0x4070000,0x40000000,0,0x40e700,1
.long 0x402,0x200000,0x1c00,0x7070000,0x40000000,0,0x40c700,0x20
.long 9,0,0,0,0x402800,0x20,0,0
.long 5,0x6202000,0xc200000,0x200500,0x403400,0x80,0,2
.long 7,0x7e02000,0x600,0x580600,0x407600,0x40,0,1
.long 0,0,0,0,0x40000000,0,0,0
.long 0,0,0,0,0x40000000,0,0,0
.long 1,0x40000,0x1b00,0x146c000,0x40000000,0,0x408e00,9
.long 0x8c0002,0x100000,0x1e00,0x2078000,0x40000000,0,0x40a700,1
.long 0xcc0502,0,0x1e00,0x5078000,0x40000000,0,0x408700,0
.long 0xcc0702,0x300000,0x1e00,0x4078000,0x40000000,0,0x40e700,1
.long 0x402,0x200000,0x1e00,0x7078000,0x40000000,0,0x40c700,0x20
.long 5,0x6202000,0x400,0x200400,0x403400,0x80,0,1
.long 7,0x7e02000,0x700,0x580700,0x407600,0x40,0,1
.long 0,0,0,0,0x40000000,0,0,0
.long 0,0,0,0,0x40000000,0,0,0
.long 0,0,0,0,0x40000000,0,0,0
.long 1,0x40000,0x1c00,0x1470000,0x40000000,0,0x408f00,9
.long 0x8b0002,0x100000,0x1800,0x2262000,0x40000000,0,0x40a600,2
.long 0xcb0502,0x80000,0x1800,0x5860000,0x40000000,0,0x409600,0
.long 0xcb0702,0x300000,0x1800,0x4262000,0x40000000,0,0x40e600,2
.long 0x402,0x280000,0x1800,0x7860000,0x40000000,0,0x40d600,0x20
.long 5,0x6602000,0x700,0x280700,0x403500,0x80,0,1
.long 7,0x7f02000,0x400,0x5c0400,0x407700,0x40,0,1
.long 0,0,0,0,0x40000000,0,0,0
.long 0,0,0,0,0x40000000,0,0,0
.long 0,0,0,0,0x40000000,0,0,0
.long 1,0x40000,0x1d00,0x1474000,0x40000000,0,0x408f00,9
.long 0x8a0002,0x100000,0x1a00,0x226a000,0x40000000,0,0x40a600,2
.long 0xca0502,0x80000,0x1a00,0x5868000,0x40000000,0,0x409600,0
.long 0xca0702,0x300000,0x1a00,0x426a000,0x40000000,0,0x40e600,2
.long 0x402,0x280000,0x1a00,0x7868000,0x40000000,0,0x40d600,0x20
.long 5,0x6602000,0x600,0x280600,0x403500,0x80,0,1
.long 9,0,0,0,0x402800,0x20,0,0
.long 7,0x7f02000,0xc200000,0x5c0500,0x407700,0x40,0,2
.long 0,0,0,0,0x40000000,0,0,0
.long 0,0,0,0,0x40000000,0,0,0
.long 1,0x40000,0x1e00,0x1478000,0x40000000,0,0x408f00,9
.long 0x890002,0x100000,0x1c00,0x2272000,0x40000000,0,0x40a700,2
.long 0xc90502,0x80000,0x1c00,0x5870000,0x40000000,0,0x409700,0
.long 0xc90702,0x300000,0x1c00,0x4272000,0x40000000,0,0x40e700,2
.long 0x402,0x280000,0x1c00,0x7870000,0x40000000,0,0x40d700,0x20
.long 9,0,0,0,0x402800,0x20,0,0
.long 5,0x6602000,0xc200000,0x280500,0x403500,0x80,0,2
.long 7,0x7f02000,0x600,0x5c0600,0x407700,0x40,0,1
.long 0,0,0,0,0x40000000,0,0,0
.long 0,0,0,0,0x40000000,0,0,0
.long 1,0x40000,0x1f00,0x147c000,0x40000000,0,0x408f00,9
.long 0x880002,0x100000,0x1e00,0x227a000,0x40000000,0,0x40a700,2
.long 0xc80502,0x80000,0x1e00,0x5878000,0x40000000,0,0x409700,0
.long 0xc80702,0x300000,0x1e00,0x427a000,0x40000000,0,0x40e700,2
.long 0x402,0x280000,0x1e00,0x7878000,0x40000000,0,0x40d700,0x20
.long 5,0x6602000,0x400,0x280400,0x403500,0x80,0,1
.long 7,0x7f02000,0x700,0x5c0700,0x407700,0x40,0,1
.long 0,0,0,0,0x40000000,0,0,0
.long 0,0,0,0,0x40000000,0,0,0
.long 0,0,0,0,0x40000000,0,0,0
.long 1,0x40000,0x1800,0x1662000,0x40000000,0,0x408e00,0xa
.long 0x870002,0x180000,0x1800,0x2860000,0x40000000,0,0x40b600,1
.long 0xc70502,0x100000,0x1800,0x6060000,0x40000000,0,0x40a600,0
.long 0xc70702,0x380000,0x1800,0x4860000,0x40000000,0,0x40f600,1
.long 0x402,0x300000,0x1800,0x8060000,0x40000000,0,0x40e600,0x20
.long 5,0x6a02000,0x700,0x300700,0x403600,0x80,0,1
.long 7,0x8302000,0x400,0x640400,0x407900,0x40,0,1
.long 0,0,0,0,0x40000000,0,0,0
.long 0,0,0,0,0x40000000,0,0,0
.long 0,0,0,0,0x40000000,0,0,0
.long 1,0x40000,0x1900,0x1666000,0x40000000,0,0x408e00,0xa
.long 0x860002,0x180000,0x1a00,0x2868000,0x40000000,0,0x40b600,1
.long 0xc60502,0x100000,0x1a00,0x6068000,0x40000000,0,0x40a600,0
.long 0xc60702,0x380000,0x1a00,0x4868000,0x40000000,0,0x40f600,1
.long 0x402,0x300000,0x1a00,0x8068000,0x40000000,0,0x40e600,0x20
.long 5,0x6a02000,0x600,0x300600,0x403600,0x80,0,1
.long 9,0,0,0,0x402800,0x20,0,0
.long 7,0x8302000,0xc200000,0x640500,0x407900,0x40,0,2
.long 0,0,0,0,0x40000000,0,0,0
.long 0,0,0,0,0x40000000,0,0,0
.long 1,0x40000,0x1a00,0x166a000,0x40000000,0,0x408e00,0xa
.long 0x850002,0x180000,0x1c00,0x2870000,0x40000000,0,0x40b700,1
.long 0xc50502,0x100000,0x1c00,0x6070000,0x40000000,0,0x40a700,0
.long 0xc50702,0x380000,0x1c00,0x4870000,0x40000000,0,0x40f700,1
.long 0x402,0x300000,0x1c00,0x8070000,0x40000000,0,0x40e700,0x20
.long 9,0,0,0,0x402800,0x20,0,0
.long 5,0x6a02000,0xc200000,0x300500,0x403600,0x80,0,2
.long 7,0x8302000,0x600,0x640600,0x407900,0x40,0,1
.long 0,0,0,0,0x40000000,0,0,0
.long 0,0,0,0,0x40000000,0,0,0
.long 1,0x40000,0x1b00,0x166e000,0x40000000,0,0x408e00,0xa
.long 0x840002,0x180000,0x1e00,0x2878000,0x40000000,0,0x40b700,1
.long 0xc40502,0x100000,0x1e00,0x6078000,0x40000000,0,0x40a700,0
.long 0xc40702,0x380000,0x1e00,0x4878000,0x40000000,0,0x40f700,1
.long 0x402,0x300000,0x1e00,0x8078000,0x40000000,0,0x40e700,0x20
.long 5,0x6a02000,0x400,0x300400,0x403600,0x80,0,1
.long 7,0x8302000,0x700,0x640700,0x407900,0x40,0,1
.long 0,0,0,0,0x40000000,0,0,0
.long 0,0,0,0,0x40000000,0,0,0
.long 0,0,0,0,0x40000000,0,0,0
.long 1,0x40000,0x1c00,0x1672000,0x40000000,0,0x408f00,0xa
.long 0x830002,0x180000,0x1800,0x2a62000,0x40000000,0,0x40b600,2
.long 0xc30502,0x180000,0x1800,0x6860000,0x40000000,0,0x40b600,0
.long 0xc30702,0x380000,0x1800,0x4a62000,0x40000000,0,0x40f600,2
.long 0x402,0x380000,0x1800,0x8860000,0x40000000,0,0x40f600,0x20
.long 5,0x6e02000,0x700,0x380700,0x403700,0x80,0,1
.long 7,0x8702000,0x400,0x6c0400,0x407b00,0x40,0,1
.long 0,0,0,0,0x40000000,0,0,0
.long 0,0,0,0,0x40000000,0,0,0
.long 0,0,0,0,0x40000000,0,0,0
.long 1,0x40000,0x1d00,0x1676000,0x40000000,0,0x408f00,0xa
.long 0x820002,0x180000,0x1a00,0x2a6a000,0x40000000,0,0x40b600,2
.long 0xc20502,0x180000,0x1a00,0x6868000,0x40000000,0,0x40b600,0
.long 0xc20702,0x380000,0x1a00,0x4a6a000,0x40000000,0,0x40f600,2
.long 0x402,0x380000,0x1a00,0x8868000,0x40000000,0,0x40f600,0x20
.long 5,0x6e02000,0x600,0x380600,0x403700,0x80,0,1
.long 9,0,0,0,0x402800,0x20,0,0
.long 7,0x8702000,0xc200000,0x6c0500,0x407b00,0x40,0,2
.long 0,0,0,0,0x40000000,0,0,0
.long 0,0,0,0,0x40000000,0,0,0
.long 1,0x40000,0x1e00,0x167a000,0x40000000,0,0x408f00,0xa
.long 0x810002,0x180000,0x1c00,0x2a72000,0x40000000,0,0x40b700,2
.long 0xc10502,0x180000,0x1c00,0x6870000,0x40000000,0,0x40b700,0
.long 0xc10702,0x380000,0x1c00,0x4a72000,0x40000000,0,0x40f700,2
.long 0x402,0x380000,0x1c00,0x8870000,0x40000000,0,0x40f700,0x20
.long 9,0,0,0,0x402800,0x20,0,0
.long 5,0x6e02000,0xc200000,0x380500,0x403700,0x80,0,2
.long 7,0x8702000,0x600,0x6c0600,0x407b00,0x40,0,1
.long 0,0,0,0,0x40000000,0,0,0
.long 0,0,0,0,0x40000000,0,0,0
.long 1,0x40000,0x1f00,0x167e000,0x40000000,0,0x408f00,0xa
.long 0x800002,0x180000,0x1e00,0x2a7a000,0x40000000,0,0x40b700,2
.long 0xc00502,0x180000,0x1e00,0x6878000,0x40000000,0,0x40b700,0
.long 0xc00702,0x380000,0x1e00,0x4a7a000,0x40000000,0,0x40f700,2
.long 0x402,0x380000,0x1e00,0x8878000,0x40000000,0,0x40f700,0x20
.long 5,0x6e02000,0x400,0x380400,0x403700,0x80,0,1
.long 7,0x8702000,0x700,0x6c0700,0x407b00,0x40,0,1
.long 0,0,0,0,0x40000000,0,0,0
.long 0,0,0,0,0x40000000,0,0,0
.long 0,0,0,0,0x40000000,0,0,0
L_codeend:
.section .rodata,"a"
.p2align 6
.amdhsa_kernel concat_heads__memory_aug_recurrent_mem_tr__linear_attn_block__prompt_kernel
  .amdhsa_next_free_vgpr 512
  .amdhsa_next_free_sgpr 102
  .amdhsa_accum_offset 256
  .amdhsa_group_segment_fixed_size 0
  .amdhsa_kernarg_size 104
  .amdhsa_user_sgpr_count 2
  .amdhsa_user_sgpr_kernarg_segment_ptr 1
  .amdhsa_system_sgpr_workgroup_id_x 1
  .amdhsa_float_denorm_mode_32 3
.end_amdhsa_kernel
```
